```python
import torch

def _softmax(x, axis=-1):
    return torch.softmax(x, dim=axis)
def _gelu(x):
    return torch.nn.functional.gelu(x, approximate="tanh")
def _silu(x):
    return torch.nn.functional.silu(x)
def _sigmoid(x):
    return torch.sigmoid(x)
def _layernorm(x, axis=-1, eps=1e-5):
    m = x.mean(dim=axis, keepdim=True)
    v = x.var(dim=axis, keepdim=True, unbiased=False)
    return (x - m) / torch.sqrt(v + eps)
def _scatter_add(tgt, idx, src, axis=0):
    return tgt.clone().index_add_(axis, idx, src)
def _segment_sum(src, seg, n):
    out = torch.zeros((n,) + src.shape[1:], dtype=src.dtype)
    return out.index_add_(0, seg, src)
def _pad(x, pw):
    flat = tuple(v for pair in reversed(pw) for v in pair)
    return torch.nn.functional.pad(x, flat)

kernel_name = 'gated_mix__mha_block__glu_gated_bilinear__prompt'

def setup_inputs():

    _w = (lambda a: (lambda t: t.to(torch.bfloat16) if t.is_floating_point() else t)(torch.as_tensor(a)))
    def _A_setup():
        B, S, D, H = 1, 2048, 512, 32
        return {
            "x": _w((lambda *s: torch.randn(*s, dtype=torch.bfloat16) * 0.05)(B, S, D)),
            "wqkv": _w((lambda *s: torch.randn(*s, dtype=torch.bfloat16) * 0.8)(D, 3 * D)),
            "wo": _w((lambda *s: torch.randn(*s, dtype=torch.bfloat16) * 0.05)(D, D)),
        }
    _A_in = _A_setup()

    def _B_setup():
        B, S, D, F = 1, 2048, 512, 1792
        return {
            "x": _w((lambda *s: torch.randn(*s, dtype=torch.bfloat16) * 0.05)(B, S, D)),
            "w_gate": _w((lambda *s: torch.randn(*s, dtype=torch.bfloat16) * 1.6)(D, F) * (D ** -0.5)),
            "w_up": _w((lambda *s: torch.randn(*s, dtype=torch.bfloat16) * 1.6)(D, F) * (D ** -0.5)),
            "w_down": _w((lambda *s: torch.randn(*s, dtype=torch.bfloat16) * 1.6)(F, D) * (F ** -0.5)),
        }
    _B_in = _B_setup()

    return {
        "A_x": _A_in["x"],
        "A_wqkv": _A_in["wqkv"],
        "A_wo": _A_in["wo"],
        "B_x": _B_in["x"],
        "B_w_gate": _B_in["w_gate"],
        "B_w_up": _B_in["w_up"],
        "B_w_down": _B_in["w_down"],
        "gate_w": _w((lambda *s: torch.randn(*s, dtype=torch.bfloat16) * 0.05)(512) * 16.0),
    }

def reference(A_x, A_wqkv, A_wo, B_x, B_w_gate, B_w_up, B_w_down, gate_w):
    def _A_ref(x, wqkv, wo):
        B, S, D = x.shape
        H = 32
        Dh = D // H
        qkv = (lambda x, *d: x.permute(*d))((x @ wqkv).reshape(B, S, 3, H, Dh), 2, 0, 3, 1, 4)
        q, k, v = qkv[0], qkv[1], qkv[2]
        scores = torch.einsum("bhqd,bhkd->bhqk", q, k) * (Dh ** -0.5)
        p = _softmax(scores, axis=-1)
        o = torch.einsum("bhqk,bhkd->bhqd", p, v)
        return (lambda x, *d: x.permute(*d))(o, 0, 2, 1, 3).reshape(B, S, D) @ wo

    def _B_ref(x, w_gate, w_up, w_down):
        g = torch.einsum("bsd,df->bsf", x, w_gate)
        u = torch.einsum("bsd,df->bsf", x, w_up)
        h = g * u
        return torch.einsum("bsf,fd->bsd", h, w_down)

    x = A_x
    g = _sigmoid((x * gate_w).sum(-1, keepdims=True))
    a = _A_ref(x, A_wqkv, A_wo)
    b = _B_ref(x, B_w_gate, B_w_up, B_w_down)
    return g * a + (1 - g) * b
```

```asm
; @launch kernel=mono_kernel grid=(256,1,1) block=(512,1,1) lds=163840
.amdgcn_target "amdgcn-amd-amdhsa--gfx950"
.text
.globl mono_kernel
.p2align 8
.type mono_kernel,@function
mono_kernel:
    s_cmp_ge_u32 s2, 256
    s_cbranch_scc1 K_END
    s_load_dwordx4 s[4:7], s[0:1], 0
    s_load_dwordx8 s[8:15], s[0:1], 32
    s_load_dwordx2 s[16:17], s[0:1], 80
    s_load_dwordx4 s[20:23], s[0:1], 64
    s_load_dwordx2 s[18:19], s[0:1], 16
    v_lshrrev_b32 v2, 6, v0
    v_and_b32 v1, 63, v0
    v_readfirstlane_b32 s44, v2
    s_mov_b32 s3, 131072
    s_and_b32 s50, s2, 7
    s_lshr_b32 s51, s2, 3
    s_and_b32 s45, s50, 1
    s_lshl_b32 s45, s45, 3
    s_and_b32 s52, s51, 7
    s_add_u32 s45, s45, s52
    s_lshr_b32 s46, s50, 1
    s_lshr_b32 s47, s51, 3
    s_mul_i32 s48, s46, 7
    s_lshl_b32 s52, s47, 1
    s_add_u32 s48, s48, s52
    s_mul_i32 s49, s46, 3
    s_add_u32 s52, s49, s47
    s_add_u32 s53, s52, 16
    s_add_u32 s54, s52, 4
    s_cmp_lt_u32 s52, 8
    s_cselect_b32 s53, s53, s54
    s_add_u32 s54, s49, 2
    s_add_u32 s72, s48, 1
    s_cmp_eq_u32 s47, 3
    s_cselect_b32 s53, s54, s53
    s_cselect_b32 s72, s48, s72
    s_cmp_ge_u32 s44, 4
    s_cbranch_scc1 K1_COMP
    v_lshrrev_b32 v14, 3, v1
    v_and_b32 v15, 7, v1
    v_lshrrev_b32 v16, 4, v1
    v_xor_b32 v16, v15, v16
    v_lshlrev_b32 v4, 10, v14
    v_lshl_add_u32 v4, v16, 4, v4
    v_add_u32 v5, 0x2000, v4
    v_xor_b32 v6, 64, v4
    v_add_u32 v6, 0x4000, v6
    v_add_u32 v7, 0x2000, v6
    s_lshl_b32 s55, s45, 17
    s_lshl_b32 s56, s44, 15
    s_add_u32 s55, s55, s56
    s_lshl_b32 s56, s44, 12
    s_lshl_b32 s61, s44, 11
    s_movk_i32 s57, 3584
    s_add_u32 s59, s49, 1
    s_cmp_eq_u32 s47, 3
    s_cselect_b32 s57, 3072, s57
    s_cselect_b32 s58, s49, s48
    s_cselect_b32 s59, s59, s48
    s_lshl_b32 s52, s44, 4
    s_mul_i32 s54, s52, s57
    s_lshl_b32 s58, s58, 7
    s_lshl_b32 s59, s59, 7
    s_add_u32 s58, s58, s54
    s_add_u32 s59, s59, s54
    s_lshl_b32 s60, s53, 7
    s_mul_i32 s54, s52, 3072
    s_add_u32 s60, s60, s54
    v_bfe_u32 v16, v1, 4, 1
    v_xor_b32 v15, v15, v16
    v_lshlrev_b32 v15, 4, v15
    v_xor_b32 v16, 64, v15
    v_mad_u32_u24 v8, v14, s57, v15
    v_add_u32 v17, 8, v14
    v_mad_u32_u24 v9, v17, s57, v16
    s_movk_i32 s54, 3072
    s_cmp_ge_u32 s53, 16
    s_cselect_b32 s63, 48, 0
    v_bfe_u32 v12, v1, 4, 1
    v_mul_u32_u24 v12, s63, v12
    v_xor_b32 v13, v12, v16
    v_xor_b32 v12, v12, v15
    v_mad_u32_u24 v10, v14, s54, v12
    v_mad_u32_u24 v11, v17, s54, v13
    s_lshl_b32 s57, s57, 6
    s_waitcnt lgkmcnt(0)
    s_mov_b32 s24, s4
    s_mov_b32 s25, s5
    s_mov_b32 s26, 0x200000
    s_mov_b32 s27, 0x00020000
    s_add_u32 m0, s56, 98304
    s_nop 0
    buffer_load_dwordx4 v4, s[24:27], s55 offen lds
    s_add_u32 m0, s56, 99328
    s_nop 0
    buffer_load_dwordx4 v5, s[24:27], s55 offen lds
    s_add_u32 m0, s56, 100352
    s_nop 0
    buffer_load_dwordx4 v6, s[24:27], s55 offen lds
    s_add_u32 m0, s56, 101376
    s_nop 0
    buffer_load_dwordx4 v7, s[24:27], s55 offen lds
    s_add_u32 s55, s55, 128
    s_mov_b32 s40, s6
    s_mov_b32 s41, s7
    s_mov_b32 s42, 0x180000
    s_mov_b32 s43, 0x00020000
    s_mov_b32 s32, s8
    s_mov_b32 s33, s9
    s_mov_b32 s34, 0x1c0000
    s_mov_b32 s35, 0x00020000
    s_mov_b32 s36, s10
    s_mov_b32 s37, s11
    s_mov_b32 s38, 0x1c0000
    s_mov_b32 s39, 0x00020000
    s_cmp_eq_u32 s47, 3
    s_cbranch_scc0 K1_LQ
    s_mov_b32 s32, s6
    s_mov_b32 s33, s7
    s_mov_b32 s34, 0x180000
    s_mov_b32 s35, 0x00020000
    s_mov_b32 s36, s6
    s_mov_b32 s37, s7
    s_mov_b32 s38, 0x180000
    s_mov_b32 s39, 0x00020000
K1_LQ:
    s_add_u32 m0, s61, 0
    s_nop 0
    buffer_load_dwordx4 v8, s[32:35], s58 offen lds
    s_add_u32 m0, s61, 1024
    s_nop 0
    buffer_load_dwordx4 v9, s[32:35], s58 offen lds
    s_add_u32 m0, s61, 8192
    s_nop 0
    buffer_load_dwordx4 v8, s[36:39], s59 offen lds
    s_add_u32 m0, s61, 9216
    s_nop 0
    buffer_load_dwordx4 v9, s[36:39], s59 offen lds
    s_add_u32 m0, s61, 65536
    s_nop 0
    buffer_load_dwordx4 v10, s[40:43], s60 offen lds
    s_add_u32 m0, s61, 66560
    s_nop 0
    buffer_load_dwordx4 v11, s[40:43], s60 offen lds
    s_add_u32 s58, s58, s57
    s_add_u32 s59, s59, s57
    s_add_u32 s60, s60, 196608
    s_add_u32 m0, s56, 114688
    s_nop 0
    buffer_load_dwordx4 v4, s[24:27], s55 offen lds
    s_add_u32 m0, s56, 115712
    s_nop 0
    buffer_load_dwordx4 v5, s[24:27], s55 offen lds
    s_add_u32 m0, s56, 116736
    s_nop 0
    buffer_load_dwordx4 v6, s[24:27], s55 offen lds
    s_add_u32 m0, s56, 117760
    s_nop 0
    buffer_load_dwordx4 v7, s[24:27], s55 offen lds
    s_add_u32 s55, s55, 128
    s_add_u32 m0, s61, 16384
    s_nop 0
    buffer_load_dwordx4 v8, s[32:35], s58 offen lds
    s_add_u32 m0, s61, 17408
    s_nop 0
    buffer_load_dwordx4 v9, s[32:35], s58 offen lds
    s_add_u32 m0, s61, 24576
    s_nop 0
    buffer_load_dwordx4 v8, s[36:39], s59 offen lds
    s_add_u32 m0, s61, 25600
    s_nop 0
    buffer_load_dwordx4 v9, s[36:39], s59 offen lds
    s_add_u32 m0, s61, 73728
    s_nop 0
    buffer_load_dwordx4 v10, s[40:43], s60 offen lds
    s_add_u32 m0, s61, 74752
    s_nop 0
    buffer_load_dwordx4 v11, s[40:43], s60 offen lds
    s_add_u32 s58, s58, s57
    s_add_u32 s59, s59, s57
    s_add_u32 s60, s60, 196608
    v_mov_b32 v43, 0
    s_or_b32 s54, s2, s44
    s_cmp_eq_u32 s54, 0
    s_cbranch_scc0 K1_NN
    s_mov_b32 s64, s22
    s_mov_b32 s65, s23
    s_mov_b32 s66, 0x100
    s_mov_b32 s67, 0x00020000
    s_memrealtime s[74:75]
    s_waitcnt lgkmcnt(0)
    s_or_b32 s74, s74, 1
    v_mov_b32 v42, s74
    s_mov_b64 exec, 1
    buffer_store_dword v42, v43, s[64:67], 0 offen sc1
    s_mov_b64 exec, -1
K1_NN:
    s_mov_b32 s28, s16
    s_mov_b32 s29, s17
    s_mov_b32 s30, 0x2000000
    s_mov_b32 s31, 0x00020000
    s_mov_b32 s64, s8
    s_mov_b32 s65, s9
    s_mov_b32 s66, 0x1c0000
    s_mov_b32 s67, 0x00020000
    s_mov_b32 s68, s10
    s_mov_b32 s69, s11
    s_mov_b32 s70, 0x1c0000
    s_mov_b32 s71, 0x00020000
    s_movk_i32 s54, 3584
    v_mad_u32_u24 v12, v14, s54, v15
    v_mad_u32_u24 v13, v17, s54, v16
    s_lshl_b32 s62, s72, 7
    s_mul_i32 s54, s52, 3584
    s_add_u32 s62, s62, s54
    v_and_b32 v20, 31, v1
    v_lshlrev_b32 v40, 2, v20
    v_lshlrev_b32 v20, 5, v20
    v_lshrrev_b32 v22, 5, v1
    v_lshl_add_u32 v21, v22, 10, v20
    v_lshl_add_u32 v40, v22, 12, v40
    v_add_u32 v41, 0x2000, v40
    v_lshlrev_b32 v22, 3, v22
    v_lshlrev_b32 v23, 4, v1
    s_lshl_b32 s73, s46, 2
    s_add_u32 s73, s73, s47
    s_lshl_b32 s73, s73, 3
    s_lshl_b32 s63, s45, 7
    s_add_u32 s73, s73, s63
    s_lshl_b32 s63, s44, 1
    s_add_u32 s73, s73, s63
    s_lshl_b32 s63, s73, 10
    s_lshl_b32 s73, s73, 3
    s_add_u32 s73, s73, 0x1100000
    s_lshl_b32 s52, s2, 2
    s_add_u32 s52, s52, s44
    s_and_b32 s54, s52, 7
    s_lshr_b32 s52, s52, 3
    s_cmp_ge_u32 s52, 112
    s_cbranch_scc1 K1_TO
    s_mov_b32 s98, 0
    s_mul_i32 s96, s54, 112
    s_add_u32 s96, s96, s52
    s_lshl_b32 s96, s96, 11
    s_add_u32 s96, s96, 0x800000
    s_mul_i32 s97, s52, 2341
    s_lshr_b32 s97, s97, 16
    s_lshl_b32 s97, s97, 2
    s_add_u32 s97, s97, s52
    s_branch K1_TE
K1_TO:
    s_mov_b32 s98, 1
    s_sub_u32 s52, s52, 112
    s_lshr_b32 s97, s52, 2
    s_mul_i32 s97, s97, 28
    s_add_u32 s97, s97, s52
    s_add_u32 s97, s97, 28
    s_lshl_b32 s52, s52, 1
    s_lshl_b32 s96, s54, 5
    s_add_u32 s96, s96, s52
    s_lshl_b32 s96, s96, 11
    s_add_u32 s96, s96, 0x1180000
K1_TE:
    s_lshl_b32 s95, s52, 14
    s_lshl_b32 s54, s54, 7
    s_add_u32 s95, s95, s54
    s_add_u32 s97, s97, s54
    s_lshl_b32 s97, s97, 2
    s_add_u32 s97, s97, 0x1118000
    s_waitcnt vmcnt(10)
    s_barrier
    s_add_u32 m0, s56, 131072
    s_nop 0
    buffer_load_dwordx4 v4, s[24:27], s55 offen lds
    s_add_u32 m0, s56, 132096
    s_nop 0
    buffer_load_dwordx4 v5, s[24:27], s55 offen lds
    s_add_u32 m0, s56, 133120
    s_nop 0
    buffer_load_dwordx4 v6, s[24:27], s55 offen lds
    s_add_u32 m0, s56, 134144
    s_nop 0
    buffer_load_dwordx4 v7, s[24:27], s55 offen lds
    s_add_u32 s55, s55, 128
    s_add_u32 m0, s61, 32768
    s_nop 0
    buffer_load_dwordx4 v8, s[32:35], s58 offen lds
    s_add_u32 m0, s61, 33792
    s_nop 0
    buffer_load_dwordx4 v9, s[32:35], s58 offen lds
    s_add_u32 m0, s61, 40960
    s_nop 0
    buffer_load_dwordx4 v8, s[36:39], s59 offen lds
    s_add_u32 m0, s61, 41984
    s_nop 0
    buffer_load_dwordx4 v9, s[36:39], s59 offen lds
    s_add_u32 m0, s61, 81920
    s_nop 0
    buffer_load_dwordx4 v10, s[40:43], s60 offen lds
    s_add_u32 m0, s61, 82944
    s_nop 0
    buffer_load_dwordx4 v11, s[40:43], s60 offen lds
    s_add_u32 s58, s58, s57
    s_add_u32 s59, s59, s57
    s_add_u32 s60, s60, 196608
    s_add_u32 m0, s56, 147456
    s_nop 0
    buffer_load_dwordx4 v4, s[24:27], s55 offen lds
    s_add_u32 m0, s56, 148480
    s_nop 0
    buffer_load_dwordx4 v5, s[24:27], s55 offen lds
    s_add_u32 m0, s56, 149504
    s_nop 0
    buffer_load_dwordx4 v6, s[24:27], s55 offen lds
    s_add_u32 m0, s56, 150528
    s_nop 0
    buffer_load_dwordx4 v7, s[24:27], s55 offen lds
    s_add_u32 s55, s55, 128
    s_add_u32 m0, s61, 49152
    s_nop 0
    buffer_load_dwordx4 v8, s[32:35], s58 offen lds
    s_add_u32 m0, s61, 50176
    s_nop 0
    buffer_load_dwordx4 v9, s[32:35], s58 offen lds
    s_add_u32 m0, s61, 57344
    s_nop 0
    buffer_load_dwordx4 v8, s[36:39], s59 offen lds
    s_add_u32 m0, s61, 58368
    s_nop 0
    buffer_load_dwordx4 v9, s[36:39], s59 offen lds
    s_add_u32 m0, s61, 90112
    s_nop 0
    buffer_load_dwordx4 v10, s[40:43], s60 offen lds
    s_add_u32 m0, s61, 91136
    s_nop 0
    buffer_load_dwordx4 v11, s[40:43], s60 offen lds
    s_add_u32 s58, s58, s57
    s_add_u32 s59, s59, s57
    s_add_u32 s60, s60, 196608
    s_waitcnt vmcnt(20)
    s_barrier
    s_add_u32 m0, s56, 98304
    s_nop 0
    buffer_load_dwordx4 v4, s[24:27], s55 offen lds
    s_add_u32 m0, s56, 99328
    s_nop 0
    buffer_load_dwordx4 v5, s[24:27], s55 offen lds
    s_add_u32 m0, s56, 100352
    s_nop 0
    buffer_load_dwordx4 v6, s[24:27], s55 offen lds
    s_add_u32 m0, s56, 101376
    s_nop 0
    buffer_load_dwordx4 v7, s[24:27], s55 offen lds
    s_add_u32 s55, s55, 128
    s_add_u32 m0, s61, 0
    s_nop 0
    buffer_load_dwordx4 v8, s[32:35], s58 offen lds
    s_add_u32 m0, s61, 1024
    s_nop 0
    buffer_load_dwordx4 v9, s[32:35], s58 offen lds
    s_add_u32 m0, s61, 8192
    s_nop 0
    buffer_load_dwordx4 v8, s[36:39], s59 offen lds
    s_add_u32 m0, s61, 9216
    s_nop 0
    buffer_load_dwordx4 v9, s[36:39], s59 offen lds
    s_add_u32 m0, s61, 65536
    s_nop 0
    buffer_load_dwordx4 v10, s[40:43], s60 offen lds
    s_add_u32 m0, s61, 66560
    s_nop 0
    buffer_load_dwordx4 v11, s[40:43], s60 offen lds
    s_add_u32 s58, s58, s57
    s_add_u32 s59, s59, s57
    s_add_u32 s60, s60, 196608
    s_waitcnt vmcnt(20)
    s_barrier
    s_add_u32 m0, s56, 114688
    s_nop 0
    buffer_load_dwordx4 v4, s[24:27], s55 offen lds
    s_add_u32 m0, s56, 115712
    s_nop 0
    buffer_load_dwordx4 v5, s[24:27], s55 offen lds
    s_add_u32 m0, s56, 116736
    s_nop 0
    buffer_load_dwordx4 v6, s[24:27], s55 offen lds
    s_add_u32 m0, s56, 117760
    s_nop 0
    buffer_load_dwordx4 v7, s[24:27], s55 offen lds
    s_add_u32 s55, s55, 128
    s_add_u32 m0, s61, 16384
    s_nop 0
    buffer_load_dwordx4 v8, s[32:35], s58 offen lds
    s_add_u32 m0, s61, 17408
    s_nop 0
    buffer_load_dwordx4 v9, s[32:35], s58 offen lds
    s_add_u32 m0, s61, 24576
    s_nop 0
    buffer_load_dwordx4 v8, s[36:39], s59 offen lds
    s_add_u32 m0, s61, 25600
    s_nop 0
    buffer_load_dwordx4 v9, s[36:39], s59 offen lds
    s_add_u32 m0, s61, 73728
    s_nop 0
    buffer_load_dwordx4 v10, s[40:43], s60 offen lds
    s_add_u32 m0, s61, 74752
    s_nop 0
    buffer_load_dwordx4 v11, s[40:43], s60 offen lds
    s_add_u32 s58, s58, s57
    s_add_u32 s59, s59, s57
    s_add_u32 s60, s60, 196608
    s_waitcnt vmcnt(20)
    s_barrier
    s_add_u32 m0, s56, 131072
    s_nop 0
    buffer_load_dwordx4 v4, s[24:27], s55 offen lds
    s_add_u32 m0, s56, 132096
    s_nop 0
    buffer_load_dwordx4 v5, s[24:27], s55 offen lds
    s_add_u32 m0, s56, 133120
    s_nop 0
    buffer_load_dwordx4 v6, s[24:27], s55 offen lds
    s_add_u32 m0, s56, 134144
    s_nop 0
    buffer_load_dwordx4 v7, s[24:27], s55 offen lds
    s_add_u32 s55, s55, 128
    s_add_u32 m0, s61, 32768
    s_nop 0
    buffer_load_dwordx4 v8, s[32:35], s58 offen lds
    s_add_u32 m0, s61, 33792
    s_nop 0
    buffer_load_dwordx4 v9, s[32:35], s58 offen lds
    s_add_u32 m0, s61, 40960
    s_nop 0
    buffer_load_dwordx4 v8, s[36:39], s59 offen lds
    s_add_u32 m0, s61, 41984
    s_nop 0
    buffer_load_dwordx4 v9, s[36:39], s59 offen lds
    s_add_u32 m0, s61, 81920
    s_nop 0
    buffer_load_dwordx4 v10, s[40:43], s60 offen lds
    s_add_u32 m0, s61, 82944
    s_nop 0
    buffer_load_dwordx4 v11, s[40:43], s60 offen lds
    s_add_u32 s58, s58, s57
    s_add_u32 s59, s59, s57
    s_add_u32 s60, s60, 196608
    s_waitcnt vmcnt(20)
    s_barrier
    s_add_u32 m0, s56, 147456
    s_nop 0
    buffer_load_dwordx4 v4, s[24:27], s55 offen lds
    s_add_u32 m0, s56, 148480
    s_nop 0
    buffer_load_dwordx4 v5, s[24:27], s55 offen lds
    s_add_u32 m0, s56, 149504
    s_nop 0
    buffer_load_dwordx4 v6, s[24:27], s55 offen lds
    s_add_u32 m0, s56, 150528
    s_nop 0
    buffer_load_dwordx4 v7, s[24:27], s55 offen lds
    s_sub_u32 s55, s55, 512
    s_add_u32 m0, s61, 49152
    s_nop 0
    buffer_load_dwordx4 v8, s[32:35], s58 offen lds
    s_add_u32 m0, s61, 50176
    s_nop 0
    buffer_load_dwordx4 v9, s[32:35], s58 offen lds
    s_add_u32 m0, s61, 57344
    s_nop 0
    buffer_load_dwordx4 v8, s[36:39], s59 offen lds
    s_add_u32 m0, s61, 58368
    s_nop 0
    buffer_load_dwordx4 v9, s[36:39], s59 offen lds
    s_add_u32 m0, s61, 90112
    s_nop 0
    buffer_load_dwordx4 v10, s[40:43], s60 offen lds
    s_add_u32 m0, s61, 91136
    s_nop 0
    buffer_load_dwordx4 v11, s[40:43], s60 offen lds
    s_mov_b32 s36, s22
    s_mov_b32 s37, s23
    s_mov_b32 s38, 0x100
    s_mov_b32 s39, 0x00020000
    s_mov_b32 s40, s12
    s_mov_b32 s41, s13
    s_mov_b32 s42, 0x1c0000
    s_mov_b32 s43, 0x00020000
    buffer_load_dword v42, v43, s[36:39], 0 offen sc1
    s_cmp_eq_u32 s98, 0
    s_cbranch_scc1 K1_T1
    s_mov_b32 s40, s18
    s_mov_b32 s41, s19
    s_mov_b32 s42, 0x80000
    s_mov_b32 s43, 0x00020000
    s_add_u32 s95, s95, 16384
    buffer_load_dword v168, v40, s[40:43], s95 offen offset:0
    buffer_load_dword v169, v40, s[40:43], s95 offen offset:1024
    buffer_load_dword v170, v40, s[40:43], s95 offen offset:2048
    buffer_load_dword v171, v40, s[40:43], s95 offen offset:3072
    buffer_load_dword v172, v41, s[40:43], s95 offen offset:0
    buffer_load_dword v173, v41, s[40:43], s95 offen offset:1024
    buffer_load_dword v174, v41, s[40:43], s95 offen offset:2048
    buffer_load_dword v175, v41, s[40:43], s95 offen offset:3072
    s_sub_u32 s95, s95, 16384
K1_T1:
    buffer_load_dword v160, v40, s[40:43], s95 offen offset:0
    buffer_load_dword v161, v40, s[40:43], s95 offen offset:1024
    buffer_load_dword v162, v40, s[40:43], s95 offen offset:2048
    buffer_load_dword v163, v40, s[40:43], s95 offen offset:3072
    buffer_load_dword v164, v41, s[40:43], s95 offen offset:0
    buffer_load_dword v165, v41, s[40:43], s95 offen offset:1024
    buffer_load_dword v166, v41, s[40:43], s95 offen offset:2048
    buffer_load_dword v167, v41, s[40:43], s95 offen offset:3072
    s_waitcnt vmcnt(29)
    s_barrier
    s_add_u32 s60, s62, 1605632
    s_add_u32 m0, s61, 0
    s_nop 0
    buffer_load_dwordx4 v12, s[64:67], s60 offen lds
    s_add_u32 m0, s61, 1024
    s_nop 0
    buffer_load_dwordx4 v13, s[64:67], s60 offen lds
    s_add_u32 m0, s61, 8192
    s_nop 0
    buffer_load_dwordx4 v12, s[68:71], s60 offen lds
    s_add_u32 m0, s61, 9216
    s_nop 0
    buffer_load_dwordx4 v13, s[68:71], s60 offen lds
    s_mov_b32 s32, s14
    s_mov_b32 s33, s15
    s_mov_b32 s34, 0x400
    s_mov_b32 s35, 0x00020000
    buffer_load_dwordx4 v[24:27], v21, s[24:27], s63 offen
    buffer_load_dwordx4 v[28:31], v21, s[24:27], s63 offen offset:16
    buffer_load_dwordx4 v[32:35], v20, s[32:35], 0 offen
    buffer_load_dwordx4 v[36:39], v20, s[32:35], 0 offen offset:16
    s_waitcnt vmcnt(27)
    s_barrier
    s_add_u32 s60, s62, 1376256
    s_add_u32 m0, s61, 16384
    s_nop 0
    buffer_load_dwordx4 v12, s[64:67], s60 offen lds
    s_add_u32 m0, s61, 17408
    s_nop 0
    buffer_load_dwordx4 v13, s[64:67], s60 offen lds
    s_add_u32 m0, s61, 24576
    s_nop 0
    buffer_load_dwordx4 v12, s[68:71], s60 offen lds
    s_add_u32 m0, s61, 25600
    s_nop 0
    buffer_load_dwordx4 v13, s[68:71], s60 offen lds
    s_add_u32 s60, s62, 688128
    s_add_u32 m0, s61, 65536
    s_nop 0
    buffer_load_dwordx4 v12, s[64:67], s60 offen lds
    s_add_u32 m0, s61, 66560
    s_nop 0
    buffer_load_dwordx4 v13, s[64:67], s60 offen lds
    s_add_u32 m0, s61, 73728
    s_nop 0
    buffer_load_dwordx4 v12, s[68:71], s60 offen lds
    s_add_u32 m0, s61, 74752
    s_nop 0
    buffer_load_dwordx4 v13, s[68:71], s60 offen lds
    s_lshl_b32 s48, s50, 1
    s_bfe_u32 s52, s51, 0x10001
    s_add_u32 s48, s48, s52
    s_mul_i32 s48, s48, 4352
    s_add_u32 s48, s48, 0x1140000
    s_lshr_b32 s72, s51, 2
    s_lshl_b32 s72, s72, 4
    s_add_u32 s72, s72, s48
    v_lshlrev_b32 v56, 2, v1
    v_and_b32 v57, 12, v56
    v_mov_b32 v3, 65280
    v_add_u32 v58, v56, v3
    s_waitcnt vmcnt(25)
    s_barrier
    s_add_u32 s60, s62, 1146880
    s_add_u32 m0, s61, 32768
    s_nop 0
    buffer_load_dwordx4 v12, s[64:67], s60 offen lds
    s_add_u32 m0, s61, 33792
    s_nop 0
    buffer_load_dwordx4 v13, s[64:67], s60 offen lds
    s_add_u32 m0, s61, 40960
    s_nop 0
    buffer_load_dwordx4 v12, s[68:71], s60 offen lds
    s_add_u32 m0, s61, 41984
    s_nop 0
    buffer_load_dwordx4 v13, s[68:71], s60 offen lds
    s_waitcnt vmcnt(16)
    s_barrier
    s_add_u32 s60, s62, 917504
    s_add_u32 m0, s61, 49152
    s_nop 0
    buffer_load_dwordx4 v12, s[64:67], s60 offen lds
    s_add_u32 m0, s61, 50176
    s_nop 0
    buffer_load_dwordx4 v13, s[64:67], s60 offen lds
    s_add_u32 m0, s61, 57344
    s_nop 0
    buffer_load_dwordx4 v12, s[68:71], s60 offen lds
    s_add_u32 m0, s61, 58368
    s_nop 0
    buffer_load_dwordx4 v13, s[68:71], s60 offen lds
    s_add_u32 m0, s56, 81920
    s_nop 0
    buffer_load_dwordx4 v4, s[24:27], s55 offen lds
    s_add_u32 m0, s56, 82944
    s_nop 0
    buffer_load_dwordx4 v5, s[24:27], s55 offen lds
    s_add_u32 m0, s56, 83968
    s_nop 0
    buffer_load_dwordx4 v6, s[24:27], s55 offen lds
    s_add_u32 m0, s56, 84992
    s_nop 0
    buffer_load_dwordx4 v7, s[24:27], s55 offen lds
    s_sub_u32 s55, s55, 128
NL_1:
    v_readfirstlane_b32 s94, v42
    s_cmp_lg_u32 s94, 0
    s_cbranch_scc1 ND_2
    s_sub_u32 s3, s3, 32
    s_cmp_lt_i32 s3, 0
    s_cbranch_scc1 ND_2
    s_sleep 4
    buffer_load_dword v42, v43, s[36:39], 0 offen sc1
    s_waitcnt vmcnt(0)
    s_branch NL_1
ND_2:
    s_waitcnt vmcnt(16)
    s_barrier
    s_add_u32 s60, s62, 458752
    s_add_u32 m0, s61, 0
    s_nop 0
    buffer_load_dwordx4 v12, s[64:67], s60 offen lds
    s_add_u32 m0, s61, 1024
    s_nop 0
    buffer_load_dwordx4 v13, s[64:67], s60 offen lds
    s_add_u32 m0, s61, 8192
    s_nop 0
    buffer_load_dwordx4 v12, s[68:71], s60 offen lds
    s_add_u32 m0, s61, 9216
    s_nop 0
    buffer_load_dwordx4 v13, s[68:71], s60 offen lds
    s_add_u32 m0, s56, 147456
    s_nop 0
    buffer_load_dwordx4 v4, s[24:27], s55 offen lds
    s_add_u32 m0, s56, 148480
    s_nop 0
    buffer_load_dwordx4 v5, s[24:27], s55 offen lds
    s_add_u32 m0, s56, 149504
    s_nop 0
    buffer_load_dwordx4 v6, s[24:27], s55 offen lds
    s_add_u32 m0, s56, 150528
    s_nop 0
    buffer_load_dwordx4 v7, s[24:27], s55 offen lds
    s_sub_u32 s55, s55, 128
    v_mov_b32 v192, 0
    v_dot2_f32_bf16 v192, v24, v32, v192
    v_dot2_f32_bf16 v192, v25, v33, v192
    v_dot2_f32_bf16 v192, v26, v34, v192
    v_dot2_f32_bf16 v192, v27, v35, v192
    v_dot2_f32_bf16 v192, v28, v36, v192
    v_dot2_f32_bf16 v192, v29, v37, v192
    v_dot2_f32_bf16 v192, v30, v38, v192
    v_dot2_f32_bf16 v192, v31, v39, v192
    s_nop 2
    v_add_f32_dpp v192, v192, v192 row_shr:1 row_mask:0xf bank_mask:0xf bound_ctrl:0
    s_nop 1
    v_add_f32_dpp v192, v192, v192 row_shr:2 row_mask:0xf bank_mask:0xf bound_ctrl:0
    s_nop 1
    v_add_f32_dpp v192, v192, v192 row_shr:4 row_mask:0xf bank_mask:0xf bound_ctrl:0
    s_nop 1
    v_add_f32_dpp v192, v192, v192 row_shr:8 row_mask:0xf bank_mask:0xf bound_ctrl:0
    s_nop 1
    v_add_f32_dpp v192, v192, v192 row_bcast:15 row_mask:0xa bank_mask:0xf
    v_cvt_pk_bf16_f32 v192, v192, v192
    v_and_b32 v192, 0xffff0000, v192
    v_mul_f32 v192, 0xbfb8aa3b, v192
    v_exp_f32 v192, v192
    s_nop 0
    v_add_f32 v192, 1.0, v192
    v_rcp_f32 v192, v192
    s_nop 0
    v_cvt_pk_bf16_f32 v192, v192, v192
    v_and_b32 v192, 0xffff0000, v192
    v_mov_b32 v193, s94
    v_mov_b32 v194, v22
    s_waitcnt vmcnt(16)
    s_barrier
    s_add_u32 s60, s62, 229376
    s_add_u32 m0, s61, 16384
    s_nop 0
    buffer_load_dwordx4 v12, s[64:67], s60 offen lds
    s_add_u32 m0, s61, 17408
    s_nop 0
    buffer_load_dwordx4 v13, s[64:67], s60 offen lds
    s_add_u32 m0, s61, 24576
    s_nop 0
    buffer_load_dwordx4 v12, s[68:71], s60 offen lds
    s_add_u32 m0, s61, 25600
    s_nop 0
    buffer_load_dwordx4 v13, s[68:71], s60 offen lds
    s_add_u32 m0, s56, 131072
    s_nop 0
    buffer_load_dwordx4 v4, s[24:27], s55 offen lds
    s_add_u32 m0, s56, 132096
    s_nop 0
    buffer_load_dwordx4 v5, s[24:27], s55 offen lds
    s_add_u32 m0, s56, 133120
    s_nop 0
    buffer_load_dwordx4 v6, s[24:27], s55 offen lds
    s_add_u32 m0, s56, 134144
    s_nop 0
    buffer_load_dwordx4 v7, s[24:27], s55 offen lds
    s_sub_u32 s55, s55, 128
    s_waitcnt vmcnt(20)
    s_barrier
    s_add_u32 s60, s62, 0
    s_add_u32 m0, s61, 32768
    s_nop 0
    buffer_load_dwordx4 v12, s[64:67], s60 offen lds
    s_add_u32 m0, s61, 33792
    s_nop 0
    buffer_load_dwordx4 v13, s[64:67], s60 offen lds
    s_add_u32 m0, s61, 40960
    s_nop 0
    buffer_load_dwordx4 v12, s[68:71], s60 offen lds
    s_add_u32 m0, s61, 41984
    s_nop 0
    buffer_load_dwordx4 v13, s[68:71], s60 offen lds
    s_add_u32 m0, s56, 114688
    s_nop 0
    buffer_load_dwordx4 v4, s[24:27], s55 offen lds
    s_add_u32 m0, s56, 115712
    s_nop 0
    buffer_load_dwordx4 v5, s[24:27], s55 offen lds
    s_add_u32 m0, s56, 116736
    s_nop 0
    buffer_load_dwordx4 v6, s[24:27], s55 offen lds
    s_add_u32 m0, s56, 117760
    s_nop 0
    buffer_load_dwordx4 v7, s[24:27], s55 offen lds
    s_waitcnt vmcnt(24)
    s_barrier
    v_mov_b32 v4, 1
    ds_write_b32 v58, v43
    s_waitcnt vmcnt(16)
    s_waitcnt lgkmcnt(0)
    s_barrier
    s_waitcnt vmcnt(0)
    s_mov_b64 exec, 1
    ds_add_u32 v3, v4 offset:56
    s_mov_b64 exec, -1
    s_lshl_b32 s45, s50, 2
    s_and_b32 s52, s51, 3
    s_add_u32 s45, s45, s52
    s_lshr_b32 s46, s51, 2
    s_and_b32 s47, s44, 3
    s_lshl_b32 s56, s47, 10
    s_lshl_b32 s52, s45, 16
    s_add_u32 s57, s52, 0x200000
    s_add_u32 s55, s52, s56
    s_add_u32 s55, s55, 0x200000
    v_lshlrev_b32 v2, 4, v1
    s_lshl_b32 s53, s46, 3
    s_lshl_b32 s54, s47, 1
    s_add_u32 s53, s53, s54
    s_lshl_b32 s49, s53, 10
    s_add_u32 s49, s49, s52
    v_add_u32 v6, s56, v2
    v_add_u32 v7, s56, v6
    v_add_u32 v6, 65536, v6
    s_lshl_b32 s58, s53, 15
    s_lshl_b32 s54, s45, 10
    s_add_u32 s58, s58, s54
    s_add_u32 s58, s58, 0x600000
    v_lshrrev_b32 v5, 5, v1
    v_and_b32 v22, 27, v1
    v_mov_b32 v23, 0x3f803f80
    v_cmp_eq_u32 vcc, 16, v22
    s_nop 1
    v_cndmask_b32 v23, 0, v23, vcc
    v_mov_b32 v128, v23
    v_mov_b32 v129, v23
    v_mov_b32 v130, v23
    v_mov_b32 v131, v23
    v_mov_b32 v132, v23
    v_mov_b32 v133, v23
    v_mov_b32 v134, v23
    v_mov_b32 v135, v23
    v_mov_b32 v136, v23
    v_mov_b32 v137, v23
    v_mov_b32 v138, v23
    v_mov_b32 v139, v23
    v_mov_b32 v140, v23
    v_mov_b32 v141, v23
    v_mov_b32 v142, v23
    v_mov_b32 v143, v23
    v_add_u32 v16, 0x10000, v2
    v_add_u32 v17, 0x20000, v2
    v_and_b32 v22, 15, v1
    v_lshlrev_b32 v22, 4, v22
    v_lshl_add_u32 v21, v5, 8, v22
    v_add_u32 v19, 0x10000, v21
    v_add_u32 v20, 0x20000, v21
    s_lshl_b32 s53, s56, 1
    s_add_u32 s53, s53, 49152
    s_cmp_eq_u32 s44, 0
    s_cbranch_scc1 L_POL
LW_3:
    ds_read_b32 v22, v3 offset:52
    s_waitcnt lgkmcnt(0)
    v_readfirstlane_b32 s70, v22
    s_cmp_ge_u32 s70, 1
    s_cbranch_scc1 LD_4
    s_sub_u32 s3, s3, 1
    s_cmp_lt_i32 s3, 0
    s_cbranch_scc1 LD_4
    s_sleep 1
    s_branch LW_3
LD_4:
    s_branch L_GO
L_POL:
    buffer_load_dword v60, v56, s[28:31], s48 offen offset:128 sc1
    buffer_load_dword v61, v57, s[28:31], s72 offen sc1
L_POLL:
    s_waitcnt vmcnt(0)
    v_cmp_eq_u32 vcc, s94, v60
    v_cmp_eq_u32 s[100:101], s94, v61
    s_and_b64 vcc, vcc, s[100:101]
    s_cmp_eq_u64 vcc, -1
    s_cbranch_scc1 L_G0
    s_sleep 12
    buffer_load_dword v60, v56, s[28:31], s48 offen offset:128 sc1
    buffer_load_dword v61, v57, s[28:31], s72 offen sc1
    s_sub_u32 s3, s3, 32
    s_cmp_lt_i32 s3, 0
    s_cbranch_scc1 L_G0
    s_branch L_POLL
L_G0:
    s_mov_b64 exec, 1
    ds_add_u32 v3, v4 offset:52
    s_mov_b64 exec, -1
L_GO:
    s_mov_b32 m0, s53
    s_nop 0
    buffer_load_dwordx4 v2, s[28:31], s49 offen sc1 lds
    buffer_load_dwordx4 v2, s[28:31], s49 offen offset:1024 sc1 lds
    s_add_u32 m0, s56, 98304
    s_add_u32 s52, s55, 0x0
    buffer_load_dwordx4 v2, s[28:31], s52 offen sc1 lds
    s_add_u32 m0, s56, 73728
    s_add_u32 s52, s55, 0x8000
    buffer_load_dwordx4 v2, s[28:31], s52 offen sc1 lds
    s_add_u32 m0, s56, 102400
    s_add_u32 s52, s55, 0x200000
    buffer_load_dwordx4 v2, s[28:31], s52 offen sc1 lds
    s_add_u32 m0, s56, 77824
    s_add_u32 s52, s55, 0x208000
    buffer_load_dwordx4 v2, s[28:31], s52 offen sc1 lds
    s_add_u32 m0, s56, 106496
    s_add_u32 s52, s55, 0x1000
    buffer_load_dwordx4 v2, s[28:31], s52 offen sc1 lds
    s_add_u32 m0, s56, 110592
    s_add_u32 s52, s55, 0x201000
    buffer_load_dwordx4 v2, s[28:31], s52 offen sc1 lds
    s_add_u32 m0, s56, 81920
    s_add_u32 s52, s55, 0x9000
    buffer_load_dwordx4 v2, s[28:31], s52 offen sc1 lds
    s_add_u32 m0, s56, 86016
    s_add_u32 s52, s55, 0x209000
    buffer_load_dwordx4 v2, s[28:31], s52 offen sc1 lds
    s_add_u32 m0, s56, 65536
    s_add_u32 s52, s55, 0x2000
    buffer_load_dwordx4 v2, s[28:31], s52 offen sc1 lds
    s_add_u32 m0, s56, 69632
    s_add_u32 s52, s55, 0x202000
    buffer_load_dwordx4 v2, s[28:31], s52 offen sc1 lds
    s_add_u32 m0, s56, 90112
    s_add_u32 s52, s55, 0xa000
    buffer_load_dwordx4 v2, s[28:31], s52 offen sc1 lds
    s_add_u32 m0, s56, 94208
    s_add_u32 s52, s55, 0x20a000
    buffer_load_dwordx4 v2, s[28:31], s52 offen sc1 lds
    s_mov_b32 s74, 0x05040100
    s_mov_b32 s75, 0x07060302
    s_cmp_eq_u32 s98, 0
    s_cbranch_scc1 K1_T2
    v_perm_b32 v184, v169, v168, s74
    v_perm_b32 v188, v169, v168, s75
    v_perm_b32 v185, v171, v170, s74
    v_perm_b32 v189, v171, v170, s75
    v_perm_b32 v186, v173, v172, s74
    v_perm_b32 v190, v173, v172, s75
    v_perm_b32 v187, v175, v174, s74
    v_perm_b32 v191, v175, v174, s75
    buffer_store_dwordx4 v[184:187], v2, s[28:31], s96 offen offset:2048 sc1
    buffer_store_dwordx4 v[188:191], v2, s[28:31], s96 offen offset:3072 sc1
K1_T2:
    v_perm_b32 v176, v161, v160, s74
    v_perm_b32 v180, v161, v160, s75
    v_perm_b32 v177, v163, v162, s74
    v_perm_b32 v181, v163, v162, s75
    v_perm_b32 v178, v165, v164, s74
    v_perm_b32 v182, v165, v164, s75
    v_perm_b32 v179, v167, v166, s74
    v_perm_b32 v183, v167, v166, s75
    buffer_store_dwordx4 v[176:179], v2, s[28:31], s96 offen offset:0 sc1
    buffer_store_dwordx4 v[180:183], v2, s[28:31], s96 offen offset:1024 sc1
    s_mov_b32 s74, 0x80000000
    s_mov_b32 s75, 0x80000000
    s_mov_b64 exec, s[74:75]
    buffer_store_dwordx2 v[192:193], v194, s[28:31], s73 offen sc1
    s_mov_b64 exec, -1
    s_mov_b32 s95, s97
    s_mov_b32 s74, 0
    s_mov_b32 s48, 0
    s_mul_i32 s59, s45, 229376
    s_mul_i32 s52, s47, 28672
    s_add_u32 s59, s59, s52
    s_add_u32 s59, s59, 0xa00000
    s_add_u32 s60, s59, 114688
    s_mul_i32 s61, s46, 229376
    s_lshl_b32 s52, s52, 1
    s_add_u32 s61, s61, s52
    s_add_u32 s61, s61, 0x800000
    s_lshl_b32 s62, s46, 16
    s_lshl_b32 s52, s47, 14
    s_add_u32 s62, s62, s52
    s_add_u32 s62, s62, 0x1180000
    s_lshl_b32 s65, s45, 16
    s_lshl_b32 s52, s47, 13
    s_add_u32 s63, s65, s52
    s_add_u32 s63, s63, 0x600000
    s_lshl_b32 s64, s45, 9
    s_add_u32 s64, s64, 0x1100000
    s_lshl_b32 s52, s46, 7
    s_add_u32 s65, s65, s52
    s_lshl_b32 s52, s47, 5
    s_add_u32 s65, s65, s52
    s_add_u32 s65, s65, 0
    s_lshl_b32 s52, s45, 7
    s_add_u32 s52, s52, 0x1114000
    s_lshl_b32 s53, s46, 9
    s_lshl_b32 s54, s47, 7
    s_add_u32 s53, s53, s54
    s_add_u32 s53, s53, 0x1117f80
    s_sub_u32 s53, s53, s52
    v_mul_lo_u32 v18, v5, s53
    v_lshl_add_u32 v18, v1, 2, v18
    v_add_u32 v18, s52, v18
    s_lshl_b32 s52, s47, 3
    s_lshr_b32 s75, 0x6131208, s52
    s_and_b32 s75, s75, 0xff
    s_lshl_b32 s75, s75, 13
    s_and_b32 s52, s47, 1
    s_lshl_b32 s52, s52, 12
    s_mov_b32 s72, 98304
    s_mov_b32 s73, 73728
    s_cmp_ge_u32 s47, 2
    s_cselect_b32 s72, 106496, s72
    s_cselect_b32 s73, 81920, s73
    s_add_u32 s72, s72, s52
    s_add_u32 s73, s73, s52
    s_waitcnt vmcnt(14)
    ds_read_b128 v[8:11], v7 offset:49152
    ds_read_b128 v[12:15], v7 offset:50176
    ds_read_b128 v[72:75], v6 offset:32768
    s_mov_b32 s96, 0x0000ffff
    s_mov_b32 s97, 0x0000ffff
    s_mov_b32 s70, 0x3eb8aa3b
    s_waitcnt lgkmcnt(2)
    v_lshlrev_b32 v24, 16, v8
    v_and_b32 v25, 0xffff0000, v8
    v_mul_f32 v24, s70, v24
    v_mul_f32 v25, s70, v25
    v_cvt_pk_bf16_f32 v8, v24, v25
    v_lshlrev_b32 v26, 16, v9
    v_and_b32 v27, 0xffff0000, v9
    v_mul_f32 v26, s70, v26
    v_mul_f32 v27, s70, v27
    v_cvt_pk_bf16_f32 v9, v26, v27
    v_lshlrev_b32 v28, 16, v10
    v_and_b32 v29, 0xffff0000, v10
    v_mul_f32 v28, s70, v28
    v_mul_f32 v29, s70, v29
    v_cvt_pk_bf16_f32 v10, v28, v29
    v_lshlrev_b32 v30, 16, v11
    v_and_b32 v31, 0xffff0000, v11
    v_mul_f32 v30, s70, v30
    v_mul_f32 v31, s70, v31
    v_cvt_pk_bf16_f32 v11, v30, v31
    s_waitcnt lgkmcnt(1)
    v_lshlrev_b32 v32, 16, v12
    v_and_b32 v33, 0xffff0000, v12
    v_mul_f32 v32, s70, v32
    v_mul_f32 v33, s70, v33
    v_cvt_pk_bf16_f32 v12, v32, v33
    v_lshlrev_b32 v34, 16, v13
    v_and_b32 v35, 0xffff0000, v13
    v_mul_f32 v34, s70, v34
    v_mul_f32 v35, s70, v35
    v_cvt_pk_bf16_f32 v13, v34, v35
    v_lshlrev_b32 v36, 16, v14
    v_and_b32 v37, 0xffff0000, v14
    v_mul_f32 v36, s70, v36
    v_mul_f32 v37, s70, v37
    v_cvt_pk_bf16_f32 v14, v36, v37
    v_lshlrev_b32 v38, 16, v15
    v_and_b32 v39, 0xffff0000, v15
    v_mul_f32 v38, s70, v38
    v_mul_f32 v39, s70, v39
    v_cvt_pk_bf16_f32 v15, v38, v39
    s_waitcnt lgkmcnt(0)
    v_mfma_f32_32x32x16_bf16 v[24:39], v[72:75], v[8:11], 0
    v_mfma_f32_32x32x16_bf16 v[40:55], v[72:75], v[12:15], 0
    s_waitcnt vmcnt(11)
    s_mov_b64 exec, 1
    ds_add_u32 v3, v4 offset:0
    s_mov_b64 exec, -1
    s_nop 6
    v_max3_f32 v22, v24, v25, v26
    v_max3_f32 v22, v22, v27, v28
    v_max3_f32 v22, v22, v29, v30
    v_max3_f32 v22, v22, v31, v32
    v_max3_f32 v22, v22, v33, v34
    v_max3_f32 v22, v22, v35, v36
    v_max3_f32 v22, v22, v37, v38
    v_max_f32 v22, v22, v39
    v_mov_b32 v6, v22
    s_nop 1
    v_permlane32_swap_b32 v22, v6
    v_max_f32 v22, v22, v6
    v_mul_f32 v24, -1.0, v22
    v_mul_f32 v25, -1.0, v22
    v_mul_f32 v26, -1.0, v22
    v_mul_f32 v27, -1.0, v22
    v_mul_f32 v28, -1.0, v22
    v_mul_f32 v29, -1.0, v22
    v_mul_f32 v30, -1.0, v22
    v_mul_f32 v31, -1.0, v22
    v_mul_f32 v32, -1.0, v22
    v_mul_f32 v33, -1.0, v22
    v_mul_f32 v34, -1.0, v22
    v_mul_f32 v35, -1.0, v22
    v_mul_f32 v36, -1.0, v22
    v_mul_f32 v37, -1.0, v22
    v_mul_f32 v38, -1.0, v22
    v_mul_f32 v39, -1.0, v22
    v_max3_f32 v23, v40, v41, v42
    v_max3_f32 v23, v23, v43, v44
    v_max3_f32 v23, v23, v45, v46
    v_max3_f32 v23, v23, v47, v48
    v_max3_f32 v23, v23, v49, v50
    v_max3_f32 v23, v23, v51, v52
    v_max3_f32 v23, v23, v53, v54
    v_max_f32 v23, v23, v55
    v_mov_b32 v6, v23
    s_nop 1
    v_permlane32_swap_b32 v23, v6
    v_max_f32 v23, v23, v6
    v_mul_f32 v40, -1.0, v23
    v_mul_f32 v41, -1.0, v23
    v_mul_f32 v42, -1.0, v23
    v_mul_f32 v43, -1.0, v23
    v_mul_f32 v44, -1.0, v23
    v_mul_f32 v45, -1.0, v23
    v_mul_f32 v46, -1.0, v23
    v_mul_f32 v47, -1.0, v23
    v_mul_f32 v48, -1.0, v23
    v_mul_f32 v49, -1.0, v23
    v_mul_f32 v50, -1.0, v23
    v_mul_f32 v51, -1.0, v23
    v_mul_f32 v52, -1.0, v23
    v_mul_f32 v53, -1.0, v23
    v_mul_f32 v54, -1.0, v23
    v_mul_f32 v55, -1.0, v23
LW_5:
    ds_read_b32 v22, v3 offset:0
    s_waitcnt lgkmcnt(0)
    v_readfirstlane_b32 s70, v22
    s_cmp_ge_u32 s70, 4
    s_cbranch_scc1 LD_6
    s_sub_u32 s3, s3, 1
    s_cmp_lt_i32 s3, 0
    s_cbranch_scc1 LD_6
    s_branch LW_5
LD_6:
    s_waitcnt vmcnt(3)
    s_mov_b64 exec, 1
    ds_add_u32 v3, v4 offset:0
    s_mov_b64 exec, -1
    ds_read_b128 v[120:123], v16 offset:32768
    s_mov_b64 exec, s[96:97]
    ds_read_b128 v[128:131], v19 offset:36864
    ds_read_b128 v[132:135], v19 offset:37376
    s_mov_b64 exec, -1
    s_setprio 0
    s_waitcnt lgkmcnt(2)
    v_mfma_f32_32x32x16_bf16 v[56:71], v[120:123], v[8:11], v[24:39]
    s_nop 7
    s_nop 3
    v_exp_f32 v56, v56
    v_exp_f32 v57, v57
    v_exp_f32 v58, v58
    v_exp_f32 v59, v59
    v_exp_f32 v60, v60
    v_mfma_f32_32x32x16_bf16 v[72:87], v[120:123], v[12:15], v[40:55]
    ds_read_b128 v[124:127], v16 offset:33792
    s_mov_b64 exec, s[96:97]
    ds_read_b128 v[136:139], v19 offset:37888
    ds_read_b128 v[140:143], v19 offset:38400
    s_mov_b64 exec, -1
    s_getreg_b32 s52, hwreg(HW_REG_IB_STS, 0, 4)
    s_add_u32 s52, s52, s74
    s_cmp_le_u32 s52, 1
    s_cbranch_scc0 HK_7_r
    s_waitcnt vmcnt(1)
    v_mov_b32 v6, s94
    s_mov_b64 exec, 1
    buffer_store_dword v6, off, s[28:31], s95 sc1
    s_mov_b64 exec, -1
    s_mov_b32 s74, 64
    s_nop 3
HK_7_r:
    v_exp_f32 v61, v61
    v_exp_f32 v62, v62
    v_exp_f32 v63, v63
    v_exp_f32 v64, v64
    v_cvt_pk_bf16_f32 v144, v56, v57
    v_cvt_pk_bf16_f32 v145, v58, v59
    v_cvt_pk_bf16_f32 v146, v60, v61
    v_cvt_pk_bf16_f32 v147, v62, v63
    v_exp_f32 v65, v65
    v_exp_f32 v66, v66
    v_exp_f32 v67, v67
    s_waitcnt lgkmcnt(3)
    v_mfma_f32_32x32x16_bf16 v[88:103], v[128:131], v[144:147], 0
    v_exp_f32 v68, v68
    v_exp_f32 v69, v69
    v_exp_f32 v70, v70
    v_exp_f32 v71, v71
    s_getreg_b32 s52, hwreg(HW_REG_IB_STS, 0, 4)
    s_add_u32 s52, s52, s74
    s_cmp_le_u32 s52, 1
    s_cbranch_scc0 HK_8_r
    s_waitcnt vmcnt(1)
    v_mov_b32 v6, s94
    s_mov_b64 exec, 1
    buffer_store_dword v6, off, s[28:31], s95 sc1
    s_mov_b64 exec, -1
    s_mov_b32 s74, 64
    s_nop 3
HK_8_r:
    v_cvt_pk_bf16_f32 v148, v64, v65
    v_cvt_pk_bf16_f32 v149, v66, v67
    v_cvt_pk_bf16_f32 v150, v68, v69
    v_cvt_pk_bf16_f32 v151, v70, v71
    v_exp_f32 v72, v72
    v_exp_f32 v73, v73
    v_mfma_f32_32x32x16_bf16 v[88:103], v[132:135], v[148:151], v[88:103]
    v_exp_f32 v74, v74
    v_exp_f32 v75, v75
    v_exp_f32 v76, v76
    s_waitcnt lgkmcnt(0)
    v_mfma_f32_32x32x16_bf16 v[56:71], v[124:127], v[8:11], v[24:39]
    s_getreg_b32 s52, hwreg(HW_REG_IB_STS, 0, 4)
    s_add_u32 s52, s52, s74
    s_cmp_le_u32 s52, 1
    s_cbranch_scc0 HK_9_r
    s_waitcnt vmcnt(1)
    v_mov_b32 v6, s94
    s_mov_b64 exec, 1
    buffer_store_dword v6, off, s[28:31], s95 sc1
    s_mov_b64 exec, -1
    s_mov_b32 s74, 64
    s_nop 3
HK_9_r:
    v_exp_f32 v77, v77
    v_exp_f32 v78, v78
    v_exp_f32 v79, v79
    v_exp_f32 v80, v80
    v_cvt_pk_bf16_f32 v152, v72, v73
    v_cvt_pk_bf16_f32 v153, v74, v75
    v_cvt_pk_bf16_f32 v154, v76, v77
    v_cvt_pk_bf16_f32 v155, v78, v79
    v_exp_f32 v81, v81
    v_exp_f32 v82, v82
    v_exp_f32 v83, v83
    v_mfma_f32_32x32x16_bf16 v[104:119], v[128:131], v[152:155], 0
    v_exp_f32 v84, v84
    v_exp_f32 v85, v85
    v_exp_f32 v86, v86
    v_exp_f32 v87, v87
    s_getreg_b32 s52, hwreg(HW_REG_IB_STS, 0, 4)
    s_add_u32 s52, s52, s74
    s_cmp_le_u32 s52, 1
    s_cbranch_scc0 HK_10_r
    s_waitcnt vmcnt(1)
    v_mov_b32 v6, s94
    s_mov_b64 exec, 1
    buffer_store_dword v6, off, s[28:31], s95 sc1
    s_mov_b64 exec, -1
    s_mov_b32 s74, 64
    s_nop 3
HK_10_r:
    v_cvt_pk_bf16_f32 v156, v80, v81
    v_cvt_pk_bf16_f32 v157, v82, v83
    v_cvt_pk_bf16_f32 v158, v84, v85
    v_cvt_pk_bf16_f32 v159, v86, v87
    v_exp_f32 v56, v56
    v_exp_f32 v57, v57
    v_mfma_f32_32x32x16_bf16 v[104:119], v[132:135], v[156:159], v[104:119]
    v_exp_f32 v58, v58
    v_exp_f32 v59, v59
    v_exp_f32 v60, v60
    v_mfma_f32_32x32x16_bf16 v[72:87], v[124:127], v[12:15], v[40:55]
    ds_read_b128 v[120:123], v16 offset:34816
    s_mov_b64 exec, s[96:97]
    ds_read_b128 v[128:131], v19 offset:38912
    ds_read_b128 v[132:135], v19 offset:39424
    s_mov_b64 exec, -1
    s_getreg_b32 s52, hwreg(HW_REG_IB_STS, 0, 4)
    s_add_u32 s52, s52, s74
    s_cmp_le_u32 s52, 1
    s_cbranch_scc0 HK_11_r
    s_waitcnt vmcnt(1)
    v_mov_b32 v6, s94
    s_mov_b64 exec, 1
    buffer_store_dword v6, off, s[28:31], s95 sc1
    s_mov_b64 exec, -1
    s_mov_b32 s74, 64
    s_nop 3
HK_11_r:
    ds_read_b32 v22, v3 offset:4
    v_exp_f32 v61, v61
    v_exp_f32 v62, v62
    v_exp_f32 v63, v63
    v_exp_f32 v64, v64
    v_cvt_pk_bf16_f32 v144, v56, v57
    v_cvt_pk_bf16_f32 v145, v58, v59
    v_cvt_pk_bf16_f32 v146, v60, v61
    v_cvt_pk_bf16_f32 v147, v62, v63
    v_exp_f32 v65, v65
    v_exp_f32 v66, v66
    v_exp_f32 v67, v67
    v_mfma_f32_32x32x16_bf16 v[88:103], v[136:139], v[144:147], v[88:103]
    v_exp_f32 v68, v68
    v_exp_f32 v69, v69
    v_exp_f32 v70, v70
    v_exp_f32 v71, v71
    s_getreg_b32 s52, hwreg(HW_REG_IB_STS, 0, 4)
    s_add_u32 s52, s52, s74
    s_cmp_le_u32 s52, 1
    s_cbranch_scc0 HK_12_r
    s_waitcnt vmcnt(1)
    v_mov_b32 v6, s94
    s_mov_b64 exec, 1
    buffer_store_dword v6, off, s[28:31], s95 sc1
    s_mov_b64 exec, -1
    s_mov_b32 s74, 64
    s_nop 3
HK_12_r:
    v_cvt_pk_bf16_f32 v148, v64, v65
    v_cvt_pk_bf16_f32 v149, v66, v67
    v_cvt_pk_bf16_f32 v150, v68, v69
    v_cvt_pk_bf16_f32 v151, v70, v71
    v_exp_f32 v72, v72
    v_exp_f32 v73, v73
    v_mfma_f32_32x32x16_bf16 v[88:103], v[140:143], v[148:151], v[88:103]
    v_exp_f32 v74, v74
    v_exp_f32 v75, v75
    v_exp_f32 v76, v76
    s_waitcnt lgkmcnt(0)
    v_mfma_f32_32x32x16_bf16 v[56:71], v[120:123], v[8:11], v[24:39]
    s_getreg_b32 s52, hwreg(HW_REG_IB_STS, 0, 4)
    s_add_u32 s52, s52, s74
    s_cmp_le_u32 s52, 1
    s_cbranch_scc0 HK_13_r
    s_waitcnt vmcnt(1)
    v_mov_b32 v6, s94
    s_mov_b64 exec, 1
    buffer_store_dword v6, off, s[28:31], s95 sc1
    s_mov_b64 exec, -1
    s_mov_b32 s74, 64
    s_nop 3
HK_13_r:
    v_readfirstlane_b32 s70, v22
    s_cmp_ge_u32 s70, 4
    s_cbranch_scc1 L_CD_K
LW_14:
    ds_read_b32 v22, v3 offset:4
    s_waitcnt lgkmcnt(0)
    v_readfirstlane_b32 s70, v22
    s_cmp_ge_u32 s70, 4
    s_cbranch_scc1 LD_15
    s_sub_u32 s3, s3, 1
    s_cmp_lt_i32 s3, 0
    s_cbranch_scc1 LD_15
    s_sleep 1
    s_branch LW_14
LD_15:
L_CD_K:
    s_add_u32 m0, s56, 147456
    s_add_u32 s52, s55, 0x3000
    buffer_load_dwordx4 v2, s[28:31], s52 offen sc1 lds
    s_add_u32 m0, s56, 151552
    s_add_u32 s52, s55, 0x203000
    buffer_load_dwordx4 v2, s[28:31], s52 offen sc1 lds
    v_exp_f32 v77, v77
    v_exp_f32 v78, v78
    v_exp_f32 v79, v79
    v_exp_f32 v80, v80
    v_cvt_pk_bf16_f32 v152, v72, v73
    v_cvt_pk_bf16_f32 v153, v74, v75
    v_cvt_pk_bf16_f32 v154, v76, v77
    v_cvt_pk_bf16_f32 v155, v78, v79
    v_exp_f32 v81, v81
    v_exp_f32 v82, v82
    v_exp_f32 v83, v83
    v_mfma_f32_32x32x16_bf16 v[104:119], v[136:139], v[152:155], v[104:119]
    v_exp_f32 v84, v84
    v_exp_f32 v85, v85
    v_exp_f32 v86, v86
    v_exp_f32 v87, v87
    s_getreg_b32 s52, hwreg(HW_REG_IB_STS, 0, 4)
    s_add_u32 s52, s52, s74
    s_cmp_le_u32 s52, 3
    s_cbranch_scc0 HK_16_r
    s_waitcnt vmcnt(3)
    v_mov_b32 v6, s94
    s_mov_b64 exec, 1
    buffer_store_dword v6, off, s[28:31], s95 sc1
    s_mov_b64 exec, -1
    s_mov_b32 s74, 64
    s_nop 3
HK_16_r:
    v_cvt_pk_bf16_f32 v156, v80, v81
    v_cvt_pk_bf16_f32 v157, v82, v83
    v_cvt_pk_bf16_f32 v158, v84, v85
    v_cvt_pk_bf16_f32 v159, v86, v87
    v_exp_f32 v56, v56
    v_exp_f32 v57, v57
    v_mfma_f32_32x32x16_bf16 v[104:119], v[140:143], v[156:159], v[104:119]
    v_exp_f32 v58, v58
    v_exp_f32 v59, v59
    v_exp_f32 v60, v60
    v_mfma_f32_32x32x16_bf16 v[72:87], v[120:123], v[12:15], v[40:55]
    ds_read_b128 v[124:127], v16 offset:35840
    s_mov_b64 exec, s[96:97]
    ds_read_b128 v[136:139], v19 offset:39936
    ds_read_b128 v[140:143], v19 offset:40448
    s_mov_b64 exec, -1
    s_getreg_b32 s52, hwreg(HW_REG_IB_STS, 0, 4)
    s_add_u32 s52, s52, s74
    s_cmp_le_u32 s52, 3
    s_cbranch_scc0 HK_17_r
    s_waitcnt vmcnt(3)
    v_mov_b32 v6, s94
    s_mov_b64 exec, 1
    buffer_store_dword v6, off, s[28:31], s95 sc1
    s_mov_b64 exec, -1
    s_mov_b32 s74, 64
    s_nop 3
HK_17_r:
    ds_read_b32 v22, v3 offset:0
    s_add_u32 m0, s56, 155648
    s_add_u32 s52, s55, 0x4000
    buffer_load_dwordx4 v2, s[28:31], s52 offen sc1 lds
    s_add_u32 m0, s56, 159744
    s_add_u32 s52, s55, 0x204000
    buffer_load_dwordx4 v2, s[28:31], s52 offen sc1 lds
    v_exp_f32 v61, v61
    v_exp_f32 v62, v62
    v_exp_f32 v63, v63
    v_exp_f32 v64, v64
    v_cvt_pk_bf16_f32 v144, v56, v57
    v_cvt_pk_bf16_f32 v145, v58, v59
    v_cvt_pk_bf16_f32 v146, v60, v61
    v_cvt_pk_bf16_f32 v147, v62, v63
    v_exp_f32 v65, v65
    v_exp_f32 v66, v66
    v_exp_f32 v67, v67
    v_mfma_f32_32x32x16_bf16 v[88:103], v[128:131], v[144:147], v[88:103]
    v_exp_f32 v68, v68
    v_exp_f32 v69, v69
    v_exp_f32 v70, v70
    v_exp_f32 v71, v71
    s_getreg_b32 s52, hwreg(HW_REG_IB_STS, 0, 4)
    s_add_u32 s52, s52, s74
    s_cmp_le_u32 s52, 5
    s_cbranch_scc0 HK_18_r
    s_waitcnt vmcnt(5)
    v_mov_b32 v6, s94
    s_mov_b64 exec, 1
    buffer_store_dword v6, off, s[28:31], s95 sc1
    s_mov_b64 exec, -1
    s_mov_b32 s74, 64
    s_nop 3
HK_18_r:
    v_cvt_pk_bf16_f32 v148, v64, v65
    v_cvt_pk_bf16_f32 v149, v66, v67
    v_cvt_pk_bf16_f32 v150, v68, v69
    v_cvt_pk_bf16_f32 v151, v70, v71
    v_exp_f32 v72, v72
    v_exp_f32 v73, v73
    v_mfma_f32_32x32x16_bf16 v[88:103], v[132:135], v[148:151], v[88:103]
    v_exp_f32 v74, v74
    v_exp_f32 v75, v75
    v_exp_f32 v76, v76
    s_waitcnt lgkmcnt(0)
    v_mfma_f32_32x32x16_bf16 v[56:71], v[124:127], v[8:11], v[24:39]
    s_cmp_eq_u32 s74, 0
    s_cbranch_scc0 HK_19_r
    s_waitcnt vmcnt(5)
    v_mov_b32 v6, s94
    s_mov_b64 exec, 1
    buffer_store_dword v6, off, s[28:31], s95 sc1
    s_mov_b64 exec, -1
    s_mov_b32 s74, 64
    s_nop 3
HK_19_r:
    v_readfirstlane_b32 s70, v22
    s_cmp_ge_u32 s70, 8
    s_cbranch_scc1 L_A8_K
LW_20:
    ds_read_b32 v22, v3 offset:0
    s_waitcnt lgkmcnt(0)
    v_readfirstlane_b32 s70, v22
    s_cmp_ge_u32 s70, 8
    s_cbranch_scc1 LD_21
    s_sub_u32 s3, s3, 1
    s_cmp_lt_i32 s3, 0
    s_cbranch_scc1 LD_21
    s_sleep 1
    s_branch LW_20
LD_21:
L_A8_K:
    s_add_u32 m0, s56, 131072
    s_add_u32 s52, s55, 0x5000
    buffer_load_dwordx4 v2, s[28:31], s52 offen sc1 lds
    s_add_u32 m0, s56, 135168
    s_add_u32 s52, s55, 0x205000
    buffer_load_dwordx4 v2, s[28:31], s52 offen sc1 lds
    v_exp_f32 v77, v77
    v_exp_f32 v78, v78
    v_exp_f32 v79, v79
    v_exp_f32 v80, v80
    v_cvt_pk_bf16_f32 v152, v72, v73
    v_cvt_pk_bf16_f32 v153, v74, v75
    v_cvt_pk_bf16_f32 v154, v76, v77
    v_cvt_pk_bf16_f32 v155, v78, v79
    v_exp_f32 v81, v81
    v_exp_f32 v82, v82
    v_exp_f32 v83, v83
    v_mfma_f32_32x32x16_bf16 v[104:119], v[128:131], v[152:155], v[104:119]
    v_exp_f32 v84, v84
    v_exp_f32 v85, v85
    v_exp_f32 v86, v86
    v_exp_f32 v87, v87
    v_cvt_pk_bf16_f32 v156, v80, v81
    v_cvt_pk_bf16_f32 v157, v82, v83
    v_cvt_pk_bf16_f32 v158, v84, v85
    v_cvt_pk_bf16_f32 v159, v86, v87
    v_exp_f32 v56, v56
    v_exp_f32 v57, v57
    v_mfma_f32_32x32x16_bf16 v[104:119], v[132:135], v[156:159], v[104:119]
    v_exp_f32 v58, v58
    v_exp_f32 v59, v59
    v_exp_f32 v60, v60
    v_mfma_f32_32x32x16_bf16 v[72:87], v[124:127], v[12:15], v[40:55]
    ds_read_b128 v[120:123], v16 offset:40960
    s_mov_b64 exec, s[96:97]
    ds_read_b128 v[128:131], v19 offset:45056
    ds_read_b128 v[132:135], v19 offset:45568
    s_mov_b64 exec, -1
    s_add_u32 m0, s56, 139264
    s_add_u32 s52, s55, 0x6000
    buffer_load_dwordx4 v2, s[28:31], s52 offen sc1 lds
    s_add_u32 m0, s56, 143360
    s_add_u32 s52, s55, 0x206000
    buffer_load_dwordx4 v2, s[28:31], s52 offen sc1 lds
    v_exp_f32 v61, v61
    v_exp_f32 v62, v62
    v_exp_f32 v63, v63
    v_exp_f32 v64, v64
    v_cvt_pk_bf16_f32 v144, v56, v57
    v_cvt_pk_bf16_f32 v145, v58, v59
    v_cvt_pk_bf16_f32 v146, v60, v61
    v_cvt_pk_bf16_f32 v147, v62, v63
    v_exp_f32 v65, v65
    v_exp_f32 v66, v66
    v_exp_f32 v67, v67
    v_mfma_f32_32x32x16_bf16 v[88:103], v[136:139], v[144:147], v[88:103]
    v_exp_f32 v68, v68
    v_exp_f32 v69, v69
    v_exp_f32 v70, v70
    v_exp_f32 v71, v71
    v_cvt_pk_bf16_f32 v148, v64, v65
    v_cvt_pk_bf16_f32 v149, v66, v67
    v_cvt_pk_bf16_f32 v150, v68, v69
    v_cvt_pk_bf16_f32 v151, v70, v71
    v_exp_f32 v72, v72
    v_exp_f32 v73, v73
    v_mfma_f32_32x32x16_bf16 v[88:103], v[140:143], v[148:151], v[88:103]
    v_exp_f32 v74, v74
    v_exp_f32 v75, v75
    v_exp_f32 v76, v76
    s_waitcnt lgkmcnt(0)
    v_mfma_f32_32x32x16_bf16 v[56:71], v[120:123], v[8:11], v[24:39]
    s_add_u32 m0, s56, 0
    s_add_u32 s52, s55, 0x7000
    buffer_load_dwordx4 v2, s[28:31], s52 offen sc1 lds
    s_add_u32 m0, s56, 4096
    s_add_u32 s52, s55, 0x207000
    buffer_load_dwordx4 v2, s[28:31], s52 offen sc1 lds
    v_exp_f32 v77, v77
    v_exp_f32 v78, v78
    v_exp_f32 v79, v79
    v_exp_f32 v80, v80
    v_cvt_pk_bf16_f32 v152, v72, v73
    v_cvt_pk_bf16_f32 v153, v74, v75
    v_cvt_pk_bf16_f32 v154, v76, v77
    v_cvt_pk_bf16_f32 v155, v78, v79
    v_exp_f32 v81, v81
    v_exp_f32 v82, v82
    v_exp_f32 v83, v83
    v_mfma_f32_32x32x16_bf16 v[104:119], v[136:139], v[152:155], v[104:119]
    v_exp_f32 v84, v84
    v_exp_f32 v85, v85
    v_exp_f32 v86, v86
    v_exp_f32 v87, v87
    v_cvt_pk_bf16_f32 v156, v80, v81
    v_cvt_pk_bf16_f32 v157, v82, v83
    v_cvt_pk_bf16_f32 v158, v84, v85
    v_cvt_pk_bf16_f32 v159, v86, v87
    v_exp_f32 v56, v56
    v_exp_f32 v57, v57
    v_mfma_f32_32x32x16_bf16 v[104:119], v[140:143], v[156:159], v[104:119]
    v_exp_f32 v58, v58
    v_exp_f32 v59, v59
    v_exp_f32 v60, v60
    v_mfma_f32_32x32x16_bf16 v[72:87], v[120:123], v[12:15], v[40:55]
    ds_read_b128 v[124:127], v16 offset:41984
    s_mov_b64 exec, s[96:97]
    ds_read_b128 v[136:139], v19 offset:46080
    ds_read_b128 v[140:143], v19 offset:46592
    s_mov_b64 exec, -1
    v_exp_f32 v61, v61
    v_exp_f32 v62, v62
    v_exp_f32 v63, v63
    v_exp_f32 v64, v64
    v_cvt_pk_bf16_f32 v144, v56, v57
    v_cvt_pk_bf16_f32 v145, v58, v59
    v_cvt_pk_bf16_f32 v146, v60, v61
    v_cvt_pk_bf16_f32 v147, v62, v63
    v_exp_f32 v65, v65
    v_exp_f32 v66, v66
    v_exp_f32 v67, v67
    v_mfma_f32_32x32x16_bf16 v[88:103], v[128:131], v[144:147], v[88:103]
    v_exp_f32 v68, v68
    v_exp_f32 v69, v69
    v_exp_f32 v70, v70
    v_exp_f32 v71, v71
    v_cvt_pk_bf16_f32 v148, v64, v65
    v_cvt_pk_bf16_f32 v149, v66, v67
    v_cvt_pk_bf16_f32 v150, v68, v69
    v_cvt_pk_bf16_f32 v151, v70, v71
    v_exp_f32 v72, v72
    v_exp_f32 v73, v73
    v_mfma_f32_32x32x16_bf16 v[88:103], v[132:135], v[148:151], v[88:103]
    v_exp_f32 v74, v74
    v_exp_f32 v75, v75
    v_exp_f32 v76, v76
    s_waitcnt lgkmcnt(0)
    v_mfma_f32_32x32x16_bf16 v[56:71], v[124:127], v[8:11], v[24:39]
    buffer_load_dword v0, v18, s[28:31], 0 offen sc1
    v_exp_f32 v77, v77
    v_exp_f32 v78, v78
    v_exp_f32 v79, v79
    v_exp_f32 v80, v80
    v_cvt_pk_bf16_f32 v152, v72, v73
    v_cvt_pk_bf16_f32 v153, v74, v75
    v_cvt_pk_bf16_f32 v154, v76, v77
    v_cvt_pk_bf16_f32 v155, v78, v79
    v_exp_f32 v81, v81
    v_exp_f32 v82, v82
    v_exp_f32 v83, v83
    v_mfma_f32_32x32x16_bf16 v[104:119], v[128:131], v[152:155], v[104:119]
    v_exp_f32 v84, v84
    v_exp_f32 v85, v85
    v_exp_f32 v86, v86
    v_exp_f32 v87, v87
    v_cvt_pk_bf16_f32 v156, v80, v81
    v_cvt_pk_bf16_f32 v157, v82, v83
    v_cvt_pk_bf16_f32 v158, v84, v85
    v_cvt_pk_bf16_f32 v159, v86, v87
    v_exp_f32 v56, v56
    v_exp_f32 v57, v57
    v_mfma_f32_32x32x16_bf16 v[104:119], v[132:135], v[156:159], v[104:119]
    v_exp_f32 v58, v58
    v_exp_f32 v59, v59
    v_exp_f32 v60, v60
    v_mfma_f32_32x32x16_bf16 v[72:87], v[124:127], v[12:15], v[40:55]
    ds_read_b128 v[120:123], v16 offset:43008
    s_mov_b64 exec, s[96:97]
    ds_read_b128 v[128:131], v19 offset:47104
    ds_read_b128 v[132:135], v19 offset:47616
    s_mov_b64 exec, -1
    v_exp_f32 v61, v61
    v_exp_f32 v62, v62
    v_exp_f32 v63, v63
    v_exp_f32 v64, v64
    v_cvt_pk_bf16_f32 v144, v56, v57
    v_cvt_pk_bf16_f32 v145, v58, v59
    v_cvt_pk_bf16_f32 v146, v60, v61
    v_cvt_pk_bf16_f32 v147, v62, v63
    v_exp_f32 v65, v65
    v_exp_f32 v66, v66
    v_exp_f32 v67, v67
    v_mfma_f32_32x32x16_bf16 v[88:103], v[136:139], v[144:147], v[88:103]
    v_exp_f32 v68, v68
    v_exp_f32 v69, v69
    v_exp_f32 v70, v70
    v_exp_f32 v71, v71
    v_cvt_pk_bf16_f32 v148, v64, v65
    v_cvt_pk_bf16_f32 v149, v66, v67
    v_cvt_pk_bf16_f32 v150, v68, v69
    v_cvt_pk_bf16_f32 v151, v70, v71
    v_exp_f32 v72, v72
    v_exp_f32 v73, v73
    v_mfma_f32_32x32x16_bf16 v[88:103], v[140:143], v[148:151], v[88:103]
    v_exp_f32 v74, v74
    v_exp_f32 v75, v75
    v_exp_f32 v76, v76
    s_waitcnt lgkmcnt(0)
    v_mfma_f32_32x32x16_bf16 v[56:71], v[120:123], v[8:11], v[24:39]
    v_exp_f32 v77, v77
    v_exp_f32 v78, v78
    v_exp_f32 v79, v79
    v_exp_f32 v80, v80
    v_cvt_pk_bf16_f32 v152, v72, v73
    v_cvt_pk_bf16_f32 v153, v74, v75
    v_cvt_pk_bf16_f32 v154, v76, v77
    v_cvt_pk_bf16_f32 v155, v78, v79
    v_exp_f32 v81, v81
    v_exp_f32 v82, v82
    v_exp_f32 v83, v83
    v_mfma_f32_32x32x16_bf16 v[104:119], v[136:139], v[152:155], v[104:119]
    v_exp_f32 v84, v84
    v_exp_f32 v85, v85
    v_exp_f32 v86, v86
    v_exp_f32 v87, v87
    v_cvt_pk_bf16_f32 v156, v80, v81
    v_cvt_pk_bf16_f32 v157, v82, v83
    v_cvt_pk_bf16_f32 v158, v84, v85
    v_cvt_pk_bf16_f32 v159, v86, v87
    v_exp_f32 v56, v56
    v_exp_f32 v57, v57
    v_mfma_f32_32x32x16_bf16 v[104:119], v[140:143], v[156:159], v[104:119]
    v_exp_f32 v58, v58
    v_exp_f32 v59, v59
    v_exp_f32 v60, v60
    v_mfma_f32_32x32x16_bf16 v[72:87], v[120:123], v[12:15], v[40:55]
    ds_read_b128 v[124:127], v16 offset:44032
    s_mov_b64 exec, s[96:97]
    ds_read_b128 v[136:139], v19 offset:48128
    ds_read_b128 v[140:143], v19 offset:48640
    s_mov_b64 exec, -1
    s_waitcnt vmcnt(0)
L_DW:
    v_cmp_eq_u32 vcc, s94, v0
    s_cmp_eq_u64 vcc, -1
    s_cbranch_scc1 L_DK
    s_sub_u32 s3, s3, 32
    s_cmp_lt_i32 s3, 0
    s_cbranch_scc1 L_DK
    s_sleep 10
    buffer_load_dword v0, v18, s[28:31], 0 offen sc1
    s_waitcnt vmcnt(0)
    s_branch L_DW
L_DK:
    v_add_u32 v18, s75, v2
    buffer_load_dwordx4 v[224:227], v2, s[28:31], s61 offen offset:0 sc1
    buffer_load_dwordx4 v[232:235], v2, s[28:31], s59 offen offset:0 sc1
    buffer_load_dwordx4 v[228:231], v2, s[28:31], s61 offen offset:1024 sc1
    buffer_load_dwordx4 v[236:239], v2, s[28:31], s60 offen offset:0 sc1
    v_exp_f32 v61, v61
    v_exp_f32 v62, v62
    v_exp_f32 v63, v63
    v_exp_f32 v64, v64
    v_cvt_pk_bf16_f32 v144, v56, v57
    v_cvt_pk_bf16_f32 v145, v58, v59
    v_cvt_pk_bf16_f32 v146, v60, v61
    v_cvt_pk_bf16_f32 v147, v62, v63
    v_exp_f32 v65, v65
    v_exp_f32 v66, v66
    v_exp_f32 v67, v67
    v_mfma_f32_32x32x16_bf16 v[88:103], v[128:131], v[144:147], v[88:103]
    v_exp_f32 v68, v68
    v_exp_f32 v69, v69
    v_exp_f32 v70, v70
    v_exp_f32 v71, v71
    v_cvt_pk_bf16_f32 v148, v64, v65
    v_cvt_pk_bf16_f32 v149, v66, v67
    v_cvt_pk_bf16_f32 v150, v68, v69
    v_cvt_pk_bf16_f32 v151, v70, v71
    v_exp_f32 v72, v72
    v_exp_f32 v73, v73
    v_mfma_f32_32x32x16_bf16 v[88:103], v[132:135], v[148:151], v[88:103]
    v_exp_f32 v74, v74
    v_exp_f32 v75, v75
    v_exp_f32 v76, v76
    s_waitcnt lgkmcnt(0)
    v_mfma_f32_32x32x16_bf16 v[56:71], v[124:127], v[8:11], v[24:39]
    buffer_load_dwordx4 v[240:243], v2, s[28:31], s61 offen offset:2048 sc1
    buffer_load_dwordx4 v[248:251], v2, s[28:31], s59 offen offset:1024 sc1
    buffer_load_dwordx4 v[244:247], v2, s[28:31], s61 offen offset:3072 sc1
    buffer_load_dwordx4 v[252:255], v2, s[28:31], s60 offen offset:1024 sc1
    s_add_u32 s61, s61, 4096
    v_exp_f32 v77, v77
    v_exp_f32 v78, v78
    v_exp_f32 v79, v79
    v_exp_f32 v80, v80
    v_cvt_pk_bf16_f32 v152, v72, v73
    v_cvt_pk_bf16_f32 v153, v74, v75
    v_cvt_pk_bf16_f32 v154, v76, v77
    v_cvt_pk_bf16_f32 v155, v78, v79
    v_exp_f32 v81, v81
    v_exp_f32 v82, v82
    v_exp_f32 v83, v83
    v_mfma_f32_32x32x16_bf16 v[104:119], v[128:131], v[152:155], v[104:119]
    v_exp_f32 v84, v84
    v_exp_f32 v85, v85
    v_exp_f32 v86, v86
    v_exp_f32 v87, v87
    v_cvt_pk_bf16_f32 v156, v80, v81
    v_cvt_pk_bf16_f32 v157, v82, v83
    v_cvt_pk_bf16_f32 v158, v84, v85
    v_cvt_pk_bf16_f32 v159, v86, v87
    v_exp_f32 v56, v56
    v_exp_f32 v57, v57
    v_mfma_f32_32x32x16_bf16 v[104:119], v[132:135], v[156:159], v[104:119]
    v_exp_f32 v58, v58
    v_exp_f32 v59, v59
    v_exp_f32 v60, v60
    v_mfma_f32_32x32x16_bf16 v[72:87], v[124:127], v[12:15], v[40:55]
    ds_read_b128 v[120:123], v16 offset:0
    s_mov_b64 exec, s[96:97]
    ds_read_b128 v[128:131], v19 offset:4096
    ds_read_b128 v[132:135], v19 offset:4608
    s_mov_b64 exec, -1
    v_exp_f32 v61, v61
    v_exp_f32 v62, v62
    v_exp_f32 v63, v63
    v_exp_f32 v64, v64
    v_cvt_pk_bf16_f32 v144, v56, v57
    v_cvt_pk_bf16_f32 v145, v58, v59
    v_cvt_pk_bf16_f32 v146, v60, v61
    v_cvt_pk_bf16_f32 v147, v62, v63
    v_exp_f32 v65, v65
    v_exp_f32 v66, v66
    v_exp_f32 v67, v67
    v_mfma_f32_32x32x16_bf16 v[88:103], v[136:139], v[144:147], v[88:103]
    v_exp_f32 v68, v68
    v_exp_f32 v69, v69
    v_exp_f32 v70, v70
    v_exp_f32 v71, v71
    v_cvt_pk_bf16_f32 v148, v64, v65
    v_cvt_pk_bf16_f32 v149, v66, v67
    v_cvt_pk_bf16_f32 v150, v68, v69
    v_cvt_pk_bf16_f32 v151, v70, v71
    v_exp_f32 v72, v72
    v_exp_f32 v73, v73
    v_mfma_f32_32x32x16_bf16 v[88:103], v[140:143], v[148:151], v[88:103]
    v_exp_f32 v74, v74
    v_exp_f32 v75, v75
    v_exp_f32 v76, v76
    s_waitcnt lgkmcnt(0)
    v_mfma_f32_32x32x16_bf16 v[56:71], v[120:123], v[8:11], v[24:39]
    v_exp_f32 v77, v77
    v_exp_f32 v78, v78
    v_exp_f32 v79, v79
    v_exp_f32 v80, v80
    s_waitcnt vmcnt(5)
    v_mfma_f32_32x32x16_bf16 v[160:175], v[224:227], v[232:235], 0
    v_cvt_pk_bf16_f32 v152, v72, v73
    v_cvt_pk_bf16_f32 v153, v74, v75
    v_cvt_pk_bf16_f32 v154, v76, v77
    v_cvt_pk_bf16_f32 v155, v78, v79
    v_exp_f32 v81, v81
    v_exp_f32 v82, v82
    v_exp_f32 v83, v83
    v_mfma_f32_32x32x16_bf16 v[104:119], v[136:139], v[152:155], v[104:119]
    v_exp_f32 v84, v84
    v_exp_f32 v85, v85
    v_exp_f32 v86, v86
    v_exp_f32 v87, v87
    v_mfma_f32_32x32x16_bf16 v[176:191], v[228:231], v[232:235], 0
    v_cvt_pk_bf16_f32 v156, v80, v81
    v_cvt_pk_bf16_f32 v157, v82, v83
    v_cvt_pk_bf16_f32 v158, v84, v85
    v_cvt_pk_bf16_f32 v159, v86, v87
    v_exp_f32 v56, v56
    v_exp_f32 v57, v57
    v_mfma_f32_32x32x16_bf16 v[104:119], v[140:143], v[156:159], v[104:119]
    v_exp_f32 v58, v58
    v_exp_f32 v59, v59
    v_exp_f32 v60, v60
    v_mfma_f32_32x32x16_bf16 v[72:87], v[120:123], v[12:15], v[40:55]
    ds_read_b128 v[124:127], v16 offset:1024
    s_mov_b64 exec, s[96:97]
    ds_read_b128 v[136:139], v19 offset:5120
    ds_read_b128 v[140:143], v19 offset:5632
    s_mov_b64 exec, -1
    v_exp_f32 v61, v61
    v_exp_f32 v62, v62
    v_exp_f32 v63, v63
    v_exp_f32 v64, v64
    s_waitcnt vmcnt(4)
    v_mfma_f32_32x32x16_bf16 v[192:207], v[224:227], v[236:239], 0
    v_cvt_pk_bf16_f32 v144, v56, v57
    v_cvt_pk_bf16_f32 v145, v58, v59
    v_cvt_pk_bf16_f32 v146, v60, v61
    v_cvt_pk_bf16_f32 v147, v62, v63
    v_exp_f32 v65, v65
    v_exp_f32 v66, v66
    v_exp_f32 v67, v67
    v_mfma_f32_32x32x16_bf16 v[88:103], v[128:131], v[144:147], v[88:103]
    v_exp_f32 v68, v68
    v_exp_f32 v69, v69
    v_exp_f32 v70, v70
    v_exp_f32 v71, v71
    v_mfma_f32_32x32x16_bf16 v[208:223], v[228:231], v[236:239], 0
    v_cvt_pk_bf16_f32 v148, v64, v65
    v_cvt_pk_bf16_f32 v149, v66, v67
    v_cvt_pk_bf16_f32 v150, v68, v69
    v_cvt_pk_bf16_f32 v151, v70, v71
    v_exp_f32 v72, v72
    v_exp_f32 v73, v73
    v_mfma_f32_32x32x16_bf16 v[88:103], v[132:135], v[148:151], v[88:103]
    v_exp_f32 v74, v74
    v_exp_f32 v75, v75
    v_exp_f32 v76, v76
    s_waitcnt lgkmcnt(0)
    v_mfma_f32_32x32x16_bf16 v[56:71], v[124:127], v[8:11], v[24:39]
    buffer_load_dwordx4 v[224:227], v2, s[28:31], s61 offen offset:0 sc1
    buffer_load_dwordx4 v[232:235], v2, s[28:31], s59 offen offset:2048 sc1
    buffer_load_dwordx4 v[228:231], v2, s[28:31], s61 offen offset:1024 sc1
    buffer_load_dwordx4 v[236:239], v2, s[28:31], s60 offen offset:2048 sc1
    v_exp_f32 v77, v77
    v_exp_f32 v78, v78
    v_exp_f32 v79, v79
    v_exp_f32 v80, v80
    s_waitcnt vmcnt(5)
    v_mfma_f32_32x32x16_bf16 v[160:175], v[240:243], v[248:251], v[160:175]
    v_cvt_pk_bf16_f32 v152, v72, v73
    v_cvt_pk_bf16_f32 v153, v74, v75
    v_cvt_pk_bf16_f32 v154, v76, v77
    v_cvt_pk_bf16_f32 v155, v78, v79
    v_exp_f32 v81, v81
    v_exp_f32 v82, v82
    v_exp_f32 v83, v83
    v_mfma_f32_32x32x16_bf16 v[104:119], v[128:131], v[152:155], v[104:119]
    v_exp_f32 v84, v84
    v_exp_f32 v85, v85
    v_exp_f32 v86, v86
    v_exp_f32 v87, v87
    v_mfma_f32_32x32x16_bf16 v[176:191], v[244:247], v[248:251], v[176:191]
    v_cvt_pk_bf16_f32 v156, v80, v81
    v_cvt_pk_bf16_f32 v157, v82, v83
    v_cvt_pk_bf16_f32 v158, v84, v85
    v_cvt_pk_bf16_f32 v159, v86, v87
    v_exp_f32 v56, v56
    v_exp_f32 v57, v57
    v_mfma_f32_32x32x16_bf16 v[104:119], v[132:135], v[156:159], v[104:119]
    v_exp_f32 v58, v58
    v_exp_f32 v59, v59
    v_exp_f32 v60, v60
    v_mfma_f32_32x32x16_bf16 v[72:87], v[124:127], v[12:15], v[40:55]
    ds_read_b128 v[120:123], v16 offset:2048
    s_mov_b64 exec, s[96:97]
    ds_read_b128 v[128:131], v19 offset:6144
    ds_read_b128 v[132:135], v19 offset:6656
    s_mov_b64 exec, -1
    s_mov_b64 exec, 1
    ds_add_u32 v3, v4 offset:8
    s_mov_b64 exec, -1
    v_exp_f32 v61, v61
    v_exp_f32 v62, v62
    v_exp_f32 v63, v63
    v_exp_f32 v64, v64
    s_waitcnt vmcnt(4)
    v_mfma_f32_32x32x16_bf16 v[192:207], v[240:243], v[252:255], v[192:207]
    v_cvt_pk_bf16_f32 v144, v56, v57
    v_cvt_pk_bf16_f32 v145, v58, v59
    v_cvt_pk_bf16_f32 v146, v60, v61
    v_cvt_pk_bf16_f32 v147, v62, v63
    v_exp_f32 v65, v65
    v_exp_f32 v66, v66
    v_exp_f32 v67, v67
    v_mfma_f32_32x32x16_bf16 v[88:103], v[136:139], v[144:147], v[88:103]
    v_exp_f32 v68, v68
    v_exp_f32 v69, v69
    v_exp_f32 v70, v70
    v_exp_f32 v71, v71
    v_mfma_f32_32x32x16_bf16 v[208:223], v[244:247], v[252:255], v[208:223]
    v_cvt_pk_bf16_f32 v148, v64, v65
    v_cvt_pk_bf16_f32 v149, v66, v67
    v_cvt_pk_bf16_f32 v150, v68, v69
    v_cvt_pk_bf16_f32 v151, v70, v71
    v_exp_f32 v72, v72
    v_exp_f32 v73, v73
    v_mfma_f32_32x32x16_bf16 v[88:103], v[140:143], v[148:151], v[88:103]
    v_exp_f32 v74, v74
    v_exp_f32 v75, v75
    v_exp_f32 v76, v76
    s_waitcnt lgkmcnt(0)
    v_mfma_f32_32x32x16_bf16 v[56:71], v[120:123], v[8:11], v[24:39]
    buffer_load_dwordx4 v[240:243], v2, s[28:31], s61 offen offset:2048 sc1
    buffer_load_dwordx4 v[248:251], v2, s[28:31], s59 offen offset:3072 sc1
    buffer_load_dwordx4 v[244:247], v2, s[28:31], s61 offen offset:3072 sc1
    buffer_load_dwordx4 v[252:255], v2, s[28:31], s60 offen offset:3072 sc1
    s_add_u32 s61, s61, 4096
    s_add_u32 s59, s59, 4096
    s_add_u32 s60, s60, 4096
    v_exp_f32 v77, v77
    v_exp_f32 v78, v78
    v_exp_f32 v79, v79
    v_exp_f32 v80, v80
    v_cvt_pk_bf16_f32 v152, v72, v73
    v_cvt_pk_bf16_f32 v153, v74, v75
    v_cvt_pk_bf16_f32 v154, v76, v77
    v_cvt_pk_bf16_f32 v155, v78, v79
    v_exp_f32 v81, v81
    v_exp_f32 v82, v82
    v_exp_f32 v83, v83
    v_mfma_f32_32x32x16_bf16 v[104:119], v[136:139], v[152:155], v[104:119]
    v_exp_f32 v84, v84
    v_exp_f32 v85, v85
    v_exp_f32 v86, v86
    v_exp_f32 v87, v87
    v_cvt_pk_bf16_f32 v156, v80, v81
    v_cvt_pk_bf16_f32 v157, v82, v83
    v_cvt_pk_bf16_f32 v158, v84, v85
    v_cvt_pk_bf16_f32 v159, v86, v87
    v_exp_f32 v56, v56
    v_exp_f32 v57, v57
    v_mfma_f32_32x32x16_bf16 v[104:119], v[140:143], v[156:159], v[104:119]
    v_exp_f32 v58, v58
    v_exp_f32 v59, v59
    v_exp_f32 v60, v60
    v_mfma_f32_32x32x16_bf16 v[72:87], v[120:123], v[12:15], v[40:55]
    ds_read_b128 v[124:127], v16 offset:3072
    s_mov_b64 exec, s[96:97]
    ds_read_b128 v[136:139], v19 offset:7168
    ds_read_b128 v[140:143], v19 offset:7680
    s_mov_b64 exec, -1
    ds_read_b32 v22, v3 offset:8
    v_exp_f32 v61, v61
    v_exp_f32 v62, v62
    v_exp_f32 v63, v63
    v_exp_f32 v64, v64
    s_waitcnt vmcnt(5)
    v_mfma_f32_32x32x16_bf16 v[160:175], v[224:227], v[232:235], v[160:175]
    v_cvt_pk_bf16_f32 v144, v56, v57
    v_cvt_pk_bf16_f32 v145, v58, v59
    v_cvt_pk_bf16_f32 v146, v60, v61
    v_cvt_pk_bf16_f32 v147, v62, v63
    v_exp_f32 v65, v65
    v_exp_f32 v66, v66
    v_exp_f32 v67, v67
    v_mfma_f32_32x32x16_bf16 v[88:103], v[128:131], v[144:147], v[88:103]
    v_exp_f32 v68, v68
    v_exp_f32 v69, v69
    v_exp_f32 v70, v70
    v_exp_f32 v71, v71
    v_mfma_f32_32x32x16_bf16 v[176:191], v[228:231], v[232:235], v[176:191]
    v_cvt_pk_bf16_f32 v148, v64, v65
    v_cvt_pk_bf16_f32 v149, v66, v67
    v_cvt_pk_bf16_f32 v150, v68, v69
    v_cvt_pk_bf16_f32 v151, v70, v71
    v_exp_f32 v72, v72
    v_exp_f32 v73, v73
    v_mfma_f32_32x32x16_bf16 v[88:103], v[132:135], v[148:151], v[88:103]
    v_exp_f32 v74, v74
    v_exp_f32 v75, v75
    v_exp_f32 v76, v76
    s_waitcnt lgkmcnt(0)
    v_mfma_f32_32x32x16_bf16 v[56:71], v[124:127], v[8:11], v[24:39]
    v_readfirstlane_b32 s70, v22
    s_cmp_ge_u32 s70, 4
    s_cbranch_scc1 L_AH_K
LW_22:
    ds_read_b32 v22, v3 offset:8
    s_waitcnt lgkmcnt(0)
    v_readfirstlane_b32 s70, v22
    s_cmp_ge_u32 s70, 4
    s_cbranch_scc1 LD_23
    s_sub_u32 s3, s3, 1
    s_cmp_lt_i32 s3, 0
    s_cbranch_scc1 LD_23
    s_sleep 1
    s_branch LW_22
LD_23:
L_AH_K:
    v_exp_f32 v77, v77
    v_exp_f32 v78, v78
    v_exp_f32 v79, v79
    v_exp_f32 v80, v80
    s_waitcnt vmcnt(4)
    v_mfma_f32_32x32x16_bf16 v[192:207], v[224:227], v[236:239], v[192:207]
    v_cvt_pk_bf16_f32 v152, v72, v73
    v_cvt_pk_bf16_f32 v153, v74, v75
    v_cvt_pk_bf16_f32 v154, v76, v77
    v_cvt_pk_bf16_f32 v155, v78, v79
    v_exp_f32 v81, v81
    v_exp_f32 v82, v82
    v_exp_f32 v83, v83
    v_mfma_f32_32x32x16_bf16 v[104:119], v[128:131], v[152:155], v[104:119]
    v_exp_f32 v84, v84
    v_exp_f32 v85, v85
    v_exp_f32 v86, v86
    v_exp_f32 v87, v87
    v_mfma_f32_32x32x16_bf16 v[208:223], v[228:231], v[236:239], v[208:223]
    v_cvt_pk_bf16_f32 v156, v80, v81
    v_cvt_pk_bf16_f32 v157, v82, v83
    v_cvt_pk_bf16_f32 v158, v84, v85
    v_cvt_pk_bf16_f32 v159, v86, v87
    v_exp_f32 v56, v56
    v_exp_f32 v57, v57
    v_mfma_f32_32x32x16_bf16 v[104:119], v[132:135], v[156:159], v[104:119]
    v_exp_f32 v58, v58
    v_exp_f32 v59, v59
    v_exp_f32 v60, v60
    v_mfma_f32_32x32x16_bf16 v[72:87], v[124:127], v[12:15], v[40:55]
    ds_read_b128 v[120:123], v17 offset:16384
    s_mov_b64 exec, s[96:97]
    ds_read_b128 v[128:131], v20 offset:20480
    ds_read_b128 v[132:135], v20 offset:20992
    s_mov_b64 exec, -1
    buffer_load_dwordx4 v[224:227], v2, s[28:31], s61 offen offset:0 sc1
    buffer_load_dwordx4 v[232:235], v2, s[28:31], s59 offen offset:0 sc1
    buffer_load_dwordx4 v[228:231], v2, s[28:31], s61 offen offset:1024 sc1
    buffer_load_dwordx4 v[236:239], v2, s[28:31], s60 offen offset:0 sc1
    v_exp_f32 v61, v61
    v_exp_f32 v62, v62
    v_exp_f32 v63, v63
    v_exp_f32 v64, v64
    s_waitcnt vmcnt(5)
    v_mfma_f32_32x32x16_bf16 v[160:175], v[240:243], v[248:251], v[160:175]
    v_cvt_pk_bf16_f32 v144, v56, v57
    v_cvt_pk_bf16_f32 v145, v58, v59
    v_cvt_pk_bf16_f32 v146, v60, v61
    v_cvt_pk_bf16_f32 v147, v62, v63
    v_exp_f32 v65, v65
    v_exp_f32 v66, v66
    v_exp_f32 v67, v67
    v_mfma_f32_32x32x16_bf16 v[88:103], v[136:139], v[144:147], v[88:103]
    v_exp_f32 v68, v68
    v_exp_f32 v69, v69
    v_exp_f32 v70, v70
    v_exp_f32 v71, v71
    v_mfma_f32_32x32x16_bf16 v[176:191], v[244:247], v[248:251], v[176:191]
    v_cvt_pk_bf16_f32 v148, v64, v65
    v_cvt_pk_bf16_f32 v149, v66, v67
    v_cvt_pk_bf16_f32 v150, v68, v69
    v_cvt_pk_bf16_f32 v151, v70, v71
    v_exp_f32 v72, v72
    v_exp_f32 v73, v73
    v_mfma_f32_32x32x16_bf16 v[88:103], v[140:143], v[148:151], v[88:103]
    v_exp_f32 v74, v74
    v_exp_f32 v75, v75
    v_exp_f32 v76, v76
    s_waitcnt lgkmcnt(0)
    v_mfma_f32_32x32x16_bf16 v[56:71], v[120:123], v[8:11], v[24:39]
    v_exp_f32 v77, v77
    v_exp_f32 v78, v78
    v_exp_f32 v79, v79
    v_exp_f32 v80, v80
    s_waitcnt vmcnt(4)
    v_mfma_f32_32x32x16_bf16 v[192:207], v[240:243], v[252:255], v[192:207]
    v_cvt_pk_bf16_f32 v152, v72, v73
    v_cvt_pk_bf16_f32 v153, v74, v75
    v_cvt_pk_bf16_f32 v154, v76, v77
    v_cvt_pk_bf16_f32 v155, v78, v79
    v_exp_f32 v81, v81
    v_exp_f32 v82, v82
    v_exp_f32 v83, v83
    v_mfma_f32_32x32x16_bf16 v[104:119], v[136:139], v[152:155], v[104:119]
    v_exp_f32 v84, v84
    v_exp_f32 v85, v85
    v_exp_f32 v86, v86
    v_exp_f32 v87, v87
    v_mfma_f32_32x32x16_bf16 v[208:223], v[244:247], v[252:255], v[208:223]
    v_cvt_pk_bf16_f32 v156, v80, v81
    v_cvt_pk_bf16_f32 v157, v82, v83
    v_cvt_pk_bf16_f32 v158, v84, v85
    v_cvt_pk_bf16_f32 v159, v86, v87
    v_exp_f32 v56, v56
    v_exp_f32 v57, v57
    v_mfma_f32_32x32x16_bf16 v[104:119], v[140:143], v[156:159], v[104:119]
    v_exp_f32 v58, v58
    v_exp_f32 v59, v59
    v_exp_f32 v60, v60
    v_mfma_f32_32x32x16_bf16 v[72:87], v[120:123], v[12:15], v[40:55]
    ds_read_b128 v[124:127], v17 offset:17408
    s_mov_b64 exec, s[96:97]
    ds_read_b128 v[136:139], v20 offset:21504
    ds_read_b128 v[140:143], v20 offset:22016
    s_mov_b64 exec, -1
    buffer_load_dwordx4 v[240:243], v2, s[28:31], s61 offen offset:2048 sc1
    buffer_load_dwordx4 v[248:251], v2, s[28:31], s59 offen offset:1024 sc1
    buffer_load_dwordx4 v[244:247], v2, s[28:31], s61 offen offset:3072 sc1
    buffer_load_dwordx4 v[252:255], v2, s[28:31], s60 offen offset:1024 sc1
    s_add_u32 s61, s61, 4096
    v_exp_f32 v61, v61
    v_exp_f32 v62, v62
    v_exp_f32 v63, v63
    v_exp_f32 v64, v64
    v_cvt_pk_bf16_f32 v144, v56, v57
    v_cvt_pk_bf16_f32 v145, v58, v59
    v_cvt_pk_bf16_f32 v146, v60, v61
    v_cvt_pk_bf16_f32 v147, v62, v63
    v_exp_f32 v65, v65
    v_exp_f32 v66, v66
    v_exp_f32 v67, v67
    v_mfma_f32_32x32x16_bf16 v[88:103], v[128:131], v[144:147], v[88:103]
    v_exp_f32 v68, v68
    v_exp_f32 v69, v69
    v_exp_f32 v70, v70
    v_exp_f32 v71, v71
    v_cvt_pk_bf16_f32 v148, v64, v65
    v_cvt_pk_bf16_f32 v149, v66, v67
    v_cvt_pk_bf16_f32 v150, v68, v69
    v_cvt_pk_bf16_f32 v151, v70, v71
    v_exp_f32 v72, v72
    v_exp_f32 v73, v73
    v_mfma_f32_32x32x16_bf16 v[88:103], v[132:135], v[148:151], v[88:103]
    v_exp_f32 v74, v74
    v_exp_f32 v75, v75
    v_exp_f32 v76, v76
    s_waitcnt lgkmcnt(0)
    v_mfma_f32_32x32x16_bf16 v[56:71], v[124:127], v[8:11], v[24:39]
    v_exp_f32 v77, v77
    v_exp_f32 v78, v78
    v_exp_f32 v79, v79
    v_exp_f32 v80, v80
    s_waitcnt vmcnt(5)
    v_mfma_f32_32x32x16_bf16 v[160:175], v[224:227], v[232:235], v[160:175]
    v_cvt_pk_bf16_f32 v152, v72, v73
    v_cvt_pk_bf16_f32 v153, v74, v75
    v_cvt_pk_bf16_f32 v154, v76, v77
    v_cvt_pk_bf16_f32 v155, v78, v79
    v_exp_f32 v81, v81
    v_exp_f32 v82, v82
    v_exp_f32 v83, v83
    v_mfma_f32_32x32x16_bf16 v[104:119], v[128:131], v[152:155], v[104:119]
    v_exp_f32 v84, v84
    v_exp_f32 v85, v85
    v_exp_f32 v86, v86
    v_exp_f32 v87, v87
    v_mfma_f32_32x32x16_bf16 v[176:191], v[228:231], v[232:235], v[176:191]
    v_cvt_pk_bf16_f32 v156, v80, v81
    v_cvt_pk_bf16_f32 v157, v82, v83
    v_cvt_pk_bf16_f32 v158, v84, v85
    v_cvt_pk_bf16_f32 v159, v86, v87
    v_exp_f32 v56, v56
    v_exp_f32 v57, v57
    v_mfma_f32_32x32x16_bf16 v[104:119], v[132:135], v[156:159], v[104:119]
    v_exp_f32 v58, v58
    v_exp_f32 v59, v59
    v_exp_f32 v60, v60
    v_mfma_f32_32x32x16_bf16 v[72:87], v[124:127], v[12:15], v[40:55]
    ds_read_b128 v[120:123], v17 offset:18432
    s_mov_b64 exec, s[96:97]
    ds_read_b128 v[128:131], v20 offset:22528
    ds_read_b128 v[132:135], v20 offset:23040
    s_mov_b64 exec, -1
    v_exp_f32 v61, v61
    v_exp_f32 v62, v62
    v_exp_f32 v63, v63
    v_exp_f32 v64, v64
    s_waitcnt vmcnt(4)
    v_mfma_f32_32x32x16_bf16 v[192:207], v[224:227], v[236:239], v[192:207]
    v_cvt_pk_bf16_f32 v144, v56, v57
    v_cvt_pk_bf16_f32 v145, v58, v59
    v_cvt_pk_bf16_f32 v146, v60, v61
    v_cvt_pk_bf16_f32 v147, v62, v63
    v_exp_f32 v65, v65
    v_exp_f32 v66, v66
    v_exp_f32 v67, v67
    v_mfma_f32_32x32x16_bf16 v[88:103], v[136:139], v[144:147], v[88:103]
    v_exp_f32 v68, v68
    v_exp_f32 v69, v69
    v_exp_f32 v70, v70
    v_exp_f32 v71, v71
    v_mfma_f32_32x32x16_bf16 v[208:223], v[228:231], v[236:239], v[208:223]
    v_cvt_pk_bf16_f32 v148, v64, v65
    v_cvt_pk_bf16_f32 v149, v66, v67
    v_cvt_pk_bf16_f32 v150, v68, v69
    v_cvt_pk_bf16_f32 v151, v70, v71
    v_exp_f32 v72, v72
    v_exp_f32 v73, v73
    v_mfma_f32_32x32x16_bf16 v[88:103], v[140:143], v[148:151], v[88:103]
    v_exp_f32 v74, v74
    v_exp_f32 v75, v75
    v_exp_f32 v76, v76
    s_waitcnt lgkmcnt(0)
    v_mfma_f32_32x32x16_bf16 v[56:71], v[120:123], v[8:11], v[24:39]
    buffer_load_dwordx4 v[224:227], v2, s[28:31], s61 offen offset:0 sc1
    buffer_load_dwordx4 v[232:235], v2, s[28:31], s59 offen offset:2048 sc1
    buffer_load_dwordx4 v[228:231], v2, s[28:31], s61 offen offset:1024 sc1
    buffer_load_dwordx4 v[236:239], v2, s[28:31], s60 offen offset:2048 sc1
    v_exp_f32 v77, v77
    v_exp_f32 v78, v78
    v_exp_f32 v79, v79
    v_exp_f32 v80, v80
    s_waitcnt vmcnt(5)
    v_mfma_f32_32x32x16_bf16 v[160:175], v[240:243], v[248:251], v[160:175]
    v_cvt_pk_bf16_f32 v152, v72, v73
    v_cvt_pk_bf16_f32 v153, v74, v75
    v_cvt_pk_bf16_f32 v154, v76, v77
    v_cvt_pk_bf16_f32 v155, v78, v79
    v_exp_f32 v81, v81
    v_exp_f32 v82, v82
    v_exp_f32 v83, v83
    v_mfma_f32_32x32x16_bf16 v[104:119], v[136:139], v[152:155], v[104:119]
    v_exp_f32 v84, v84
    v_exp_f32 v85, v85
    v_exp_f32 v86, v86
    v_exp_f32 v87, v87
    v_mfma_f32_32x32x16_bf16 v[176:191], v[244:247], v[248:251], v[176:191]
    v_cvt_pk_bf16_f32 v156, v80, v81
    v_cvt_pk_bf16_f32 v157, v82, v83
    v_cvt_pk_bf16_f32 v158, v84, v85
    v_cvt_pk_bf16_f32 v159, v86, v87
    v_exp_f32 v56, v56
    v_exp_f32 v57, v57
    v_mfma_f32_32x32x16_bf16 v[104:119], v[140:143], v[156:159], v[104:119]
    v_exp_f32 v58, v58
    v_exp_f32 v59, v59
    v_exp_f32 v60, v60
    v_mfma_f32_32x32x16_bf16 v[72:87], v[120:123], v[12:15], v[40:55]
    ds_read_b128 v[124:127], v17 offset:19456
    s_mov_b64 exec, s[96:97]
    ds_read_b128 v[136:139], v20 offset:23552
    ds_read_b128 v[140:143], v20 offset:24064
    s_mov_b64 exec, -1
    v_exp_f32 v61, v61
    v_exp_f32 v62, v62
    v_exp_f32 v63, v63
    v_exp_f32 v64, v64
    s_waitcnt vmcnt(4)
    v_mfma_f32_32x32x16_bf16 v[192:207], v[240:243], v[252:255], v[192:207]
    v_cvt_pk_bf16_f32 v144, v56, v57
    v_cvt_pk_bf16_f32 v145, v58, v59
    v_cvt_pk_bf16_f32 v146, v60, v61
    v_cvt_pk_bf16_f32 v147, v62, v63
    v_exp_f32 v65, v65
    v_exp_f32 v66, v66
    v_exp_f32 v67, v67
    v_mfma_f32_32x32x16_bf16 v[88:103], v[128:131], v[144:147], v[88:103]
    v_exp_f32 v68, v68
    v_exp_f32 v69, v69
    v_exp_f32 v70, v70
    v_exp_f32 v71, v71
    v_mfma_f32_32x32x16_bf16 v[208:223], v[244:247], v[252:255], v[208:223]
    v_cvt_pk_bf16_f32 v148, v64, v65
    v_cvt_pk_bf16_f32 v149, v66, v67
    v_cvt_pk_bf16_f32 v150, v68, v69
    v_cvt_pk_bf16_f32 v151, v70, v71
    v_exp_f32 v72, v72
    v_exp_f32 v73, v73
    v_mfma_f32_32x32x16_bf16 v[88:103], v[132:135], v[148:151], v[88:103]
    v_exp_f32 v74, v74
    v_exp_f32 v75, v75
    v_exp_f32 v76, v76
    s_waitcnt lgkmcnt(0)
    v_mfma_f32_32x32x16_bf16 v[56:71], v[124:127], v[8:11], v[24:39]
    buffer_load_dwordx4 v[240:243], v2, s[28:31], s61 offen offset:2048 sc1
    buffer_load_dwordx4 v[248:251], v2, s[28:31], s59 offen offset:3072 sc1
    buffer_load_dwordx4 v[244:247], v2, s[28:31], s61 offen offset:3072 sc1
    buffer_load_dwordx4 v[252:255], v2, s[28:31], s60 offen offset:3072 sc1
    s_add_u32 s61, s61, 4096
    s_add_u32 s59, s59, 4096
    s_add_u32 s60, s60, 4096
    v_exp_f32 v77, v77
    v_exp_f32 v78, v78
    v_exp_f32 v79, v79
    v_exp_f32 v80, v80
    v_cvt_pk_bf16_f32 v152, v72, v73
    v_cvt_pk_bf16_f32 v153, v74, v75
    v_cvt_pk_bf16_f32 v154, v76, v77
    v_cvt_pk_bf16_f32 v155, v78, v79
    v_exp_f32 v81, v81
    v_exp_f32 v82, v82
    v_exp_f32 v83, v83
    v_mfma_f32_32x32x16_bf16 v[104:119], v[128:131], v[152:155], v[104:119]
    v_exp_f32 v84, v84
    v_exp_f32 v85, v85
    v_exp_f32 v86, v86
    v_exp_f32 v87, v87
    v_cvt_pk_bf16_f32 v156, v80, v81
    v_cvt_pk_bf16_f32 v157, v82, v83
    v_cvt_pk_bf16_f32 v158, v84, v85
    v_cvt_pk_bf16_f32 v159, v86, v87
    v_exp_f32 v56, v56
    v_exp_f32 v57, v57
    v_mfma_f32_32x32x16_bf16 v[104:119], v[132:135], v[156:159], v[104:119]
    v_exp_f32 v58, v58
    v_exp_f32 v59, v59
    v_exp_f32 v60, v60
    v_mfma_f32_32x32x16_bf16 v[72:87], v[124:127], v[12:15], v[40:55]
    ds_read_b128 v[120:123], v17 offset:24576
    s_mov_b64 exec, s[96:97]
    ds_read_b128 v[128:131], v20 offset:28672
    ds_read_b128 v[132:135], v20 offset:29184
    s_mov_b64 exec, -1
    v_exp_f32 v61, v61
    v_exp_f32 v62, v62
    v_exp_f32 v63, v63
    v_exp_f32 v64, v64
    s_waitcnt vmcnt(5)
    v_mfma_f32_32x32x16_bf16 v[160:175], v[224:227], v[232:235], v[160:175]
    v_cvt_pk_bf16_f32 v144, v56, v57
    v_cvt_pk_bf16_f32 v145, v58, v59
    v_cvt_pk_bf16_f32 v146, v60, v61
    v_cvt_pk_bf16_f32 v147, v62, v63
    v_exp_f32 v65, v65
    v_exp_f32 v66, v66
    v_exp_f32 v67, v67
    v_mfma_f32_32x32x16_bf16 v[88:103], v[136:139], v[144:147], v[88:103]
    v_exp_f32 v68, v68
    v_exp_f32 v69, v69
    v_exp_f32 v70, v70
    v_exp_f32 v71, v71
    v_mfma_f32_32x32x16_bf16 v[176:191], v[228:231], v[232:235], v[176:191]
    v_cvt_pk_bf16_f32 v148, v64, v65
    v_cvt_pk_bf16_f32 v149, v66, v67
    v_cvt_pk_bf16_f32 v150, v68, v69
    v_cvt_pk_bf16_f32 v151, v70, v71
    v_exp_f32 v72, v72
    v_exp_f32 v73, v73
    v_mfma_f32_32x32x16_bf16 v[88:103], v[140:143], v[148:151], v[88:103]
    v_exp_f32 v74, v74
    v_exp_f32 v75, v75
    v_exp_f32 v76, v76
    s_waitcnt lgkmcnt(0)
    v_mfma_f32_32x32x16_bf16 v[56:71], v[120:123], v[8:11], v[24:39]
    v_exp_f32 v77, v77
    v_exp_f32 v78, v78
    v_exp_f32 v79, v79
    v_exp_f32 v80, v80
    s_waitcnt vmcnt(4)
    v_mfma_f32_32x32x16_bf16 v[192:207], v[224:227], v[236:239], v[192:207]
    v_cvt_pk_bf16_f32 v152, v72, v73
    v_cvt_pk_bf16_f32 v153, v74, v75
    v_cvt_pk_bf16_f32 v154, v76, v77
    v_cvt_pk_bf16_f32 v155, v78, v79
    v_exp_f32 v81, v81
    v_exp_f32 v82, v82
    v_exp_f32 v83, v83
    v_mfma_f32_32x32x16_bf16 v[104:119], v[136:139], v[152:155], v[104:119]
    v_exp_f32 v84, v84
    v_exp_f32 v85, v85
    v_exp_f32 v86, v86
    v_exp_f32 v87, v87
    v_mfma_f32_32x32x16_bf16 v[208:223], v[228:231], v[236:239], v[208:223]
    v_cvt_pk_bf16_f32 v156, v80, v81
    v_cvt_pk_bf16_f32 v157, v82, v83
    v_cvt_pk_bf16_f32 v158, v84, v85
    v_cvt_pk_bf16_f32 v159, v86, v87
    v_exp_f32 v56, v56
    v_exp_f32 v57, v57
    v_mfma_f32_32x32x16_bf16 v[104:119], v[140:143], v[156:159], v[104:119]
    v_exp_f32 v58, v58
    v_exp_f32 v59, v59
    v_exp_f32 v60, v60
    v_mfma_f32_32x32x16_bf16 v[72:87], v[120:123], v[12:15], v[40:55]
    ds_read_b128 v[124:127], v17 offset:25600
    s_mov_b64 exec, s[96:97]
    ds_read_b128 v[136:139], v20 offset:29696
    ds_read_b128 v[140:143], v20 offset:30208
    s_mov_b64 exec, -1
    buffer_load_dwordx4 v[224:227], v2, s[28:31], s61 offen offset:0 sc1
    buffer_load_dwordx4 v[232:235], v2, s[28:31], s59 offen offset:0 sc1
    buffer_load_dwordx4 v[228:231], v2, s[28:31], s61 offen offset:1024 sc1
    buffer_load_dwordx4 v[236:239], v2, s[28:31], s60 offen offset:0 sc1
    v_exp_f32 v61, v61
    v_exp_f32 v62, v62
    v_exp_f32 v63, v63
    v_exp_f32 v64, v64
    s_waitcnt vmcnt(5)
    v_mfma_f32_32x32x16_bf16 v[160:175], v[240:243], v[248:251], v[160:175]
    v_cvt_pk_bf16_f32 v144, v56, v57
    v_cvt_pk_bf16_f32 v145, v58, v59
    v_cvt_pk_bf16_f32 v146, v60, v61
    v_cvt_pk_bf16_f32 v147, v62, v63
    v_exp_f32 v65, v65
    v_exp_f32 v66, v66
    v_exp_f32 v67, v67
    v_mfma_f32_32x32x16_bf16 v[88:103], v[128:131], v[144:147], v[88:103]
    v_exp_f32 v68, v68
    v_exp_f32 v69, v69
    v_exp_f32 v70, v70
    v_exp_f32 v71, v71
    v_mfma_f32_32x32x16_bf16 v[176:191], v[244:247], v[248:251], v[176:191]
    v_cvt_pk_bf16_f32 v148, v64, v65
    v_cvt_pk_bf16_f32 v149, v66, v67
    v_cvt_pk_bf16_f32 v150, v68, v69
    v_cvt_pk_bf16_f32 v151, v70, v71
    v_exp_f32 v72, v72
    v_exp_f32 v73, v73
    v_mfma_f32_32x32x16_bf16 v[88:103], v[132:135], v[148:151], v[88:103]
    v_exp_f32 v74, v74
    v_exp_f32 v75, v75
    v_exp_f32 v76, v76
    s_waitcnt lgkmcnt(0)
    v_mfma_f32_32x32x16_bf16 v[56:71], v[124:127], v[8:11], v[24:39]
    v_exp_f32 v77, v77
    v_exp_f32 v78, v78
    v_exp_f32 v79, v79
    v_exp_f32 v80, v80
    s_waitcnt vmcnt(4)
    v_mfma_f32_32x32x16_bf16 v[192:207], v[240:243], v[252:255], v[192:207]
    v_cvt_pk_bf16_f32 v152, v72, v73
    v_cvt_pk_bf16_f32 v153, v74, v75
    v_cvt_pk_bf16_f32 v154, v76, v77
    v_cvt_pk_bf16_f32 v155, v78, v79
    v_exp_f32 v81, v81
    v_exp_f32 v82, v82
    v_exp_f32 v83, v83
    v_mfma_f32_32x32x16_bf16 v[104:119], v[128:131], v[152:155], v[104:119]
    v_exp_f32 v84, v84
    v_exp_f32 v85, v85
    v_exp_f32 v86, v86
    v_exp_f32 v87, v87
    v_mfma_f32_32x32x16_bf16 v[208:223], v[244:247], v[252:255], v[208:223]
    v_cvt_pk_bf16_f32 v156, v80, v81
    v_cvt_pk_bf16_f32 v157, v82, v83
    v_cvt_pk_bf16_f32 v158, v84, v85
    v_cvt_pk_bf16_f32 v159, v86, v87
    v_exp_f32 v56, v56
    v_exp_f32 v57, v57
    v_mfma_f32_32x32x16_bf16 v[104:119], v[132:135], v[156:159], v[104:119]
    v_exp_f32 v58, v58
    v_exp_f32 v59, v59
    v_exp_f32 v60, v60
    v_mfma_f32_32x32x16_bf16 v[72:87], v[124:127], v[12:15], v[40:55]
    ds_read_b128 v[120:123], v17 offset:26624
    s_mov_b64 exec, s[96:97]
    ds_read_b128 v[128:131], v20 offset:30720
    ds_read_b128 v[132:135], v20 offset:31232
    s_mov_b64 exec, -1
    buffer_load_dwordx4 v[240:243], v2, s[28:31], s61 offen offset:2048 sc1
    buffer_load_dwordx4 v[248:251], v2, s[28:31], s59 offen offset:1024 sc1
    buffer_load_dwordx4 v[244:247], v2, s[28:31], s61 offen offset:3072 sc1
    buffer_load_dwordx4 v[252:255], v2, s[28:31], s60 offen offset:1024 sc1
    s_add_u32 s61, s61, 4096
    v_exp_f32 v61, v61
    v_exp_f32 v62, v62
    v_exp_f32 v63, v63
    v_exp_f32 v64, v64
    v_cvt_pk_bf16_f32 v144, v56, v57
    v_cvt_pk_bf16_f32 v145, v58, v59
    v_cvt_pk_bf16_f32 v146, v60, v61
    v_cvt_pk_bf16_f32 v147, v62, v63
    v_exp_f32 v65, v65
    v_exp_f32 v66, v66
    v_exp_f32 v67, v67
    v_mfma_f32_32x32x16_bf16 v[88:103], v[136:139], v[144:147], v[88:103]
    v_exp_f32 v68, v68
    v_exp_f32 v69, v69
    v_exp_f32 v70, v70
    v_exp_f32 v71, v71
    v_cvt_pk_bf16_f32 v148, v64, v65
    v_cvt_pk_bf16_f32 v149, v66, v67
    v_cvt_pk_bf16_f32 v150, v68, v69
    v_cvt_pk_bf16_f32 v151, v70, v71
    v_exp_f32 v72, v72
    v_exp_f32 v73, v73
    v_mfma_f32_32x32x16_bf16 v[88:103], v[140:143], v[148:151], v[88:103]
    v_exp_f32 v74, v74
    v_exp_f32 v75, v75
    v_exp_f32 v76, v76
    s_waitcnt lgkmcnt(0)
    v_mfma_f32_32x32x16_bf16 v[56:71], v[120:123], v[8:11], v[24:39]
    v_exp_f32 v77, v77
    v_exp_f32 v78, v78
    v_exp_f32 v79, v79
    v_exp_f32 v80, v80
    s_waitcnt vmcnt(5)
    v_mfma_f32_32x32x16_bf16 v[160:175], v[224:227], v[232:235], v[160:175]
    v_cvt_pk_bf16_f32 v152, v72, v73
    v_cvt_pk_bf16_f32 v153, v74, v75
    v_cvt_pk_bf16_f32 v154, v76, v77
    v_cvt_pk_bf16_f32 v155, v78, v79
    v_exp_f32 v81, v81
    v_exp_f32 v82, v82
    v_exp_f32 v83, v83
    v_mfma_f32_32x32x16_bf16 v[104:119], v[136:139], v[152:155], v[104:119]
    v_exp_f32 v84, v84
    v_exp_f32 v85, v85
    v_exp_f32 v86, v86
    v_exp_f32 v87, v87
    v_mfma_f32_32x32x16_bf16 v[176:191], v[228:231], v[232:235], v[176:191]
    v_cvt_pk_bf16_f32 v156, v80, v81
    v_cvt_pk_bf16_f32 v157, v82, v83
    v_cvt_pk_bf16_f32 v158, v84, v85
    v_cvt_pk_bf16_f32 v159, v86, v87
    v_exp_f32 v56, v56
    v_exp_f32 v57, v57
    v_mfma_f32_32x32x16_bf16 v[104:119], v[140:143], v[156:159], v[104:119]
    v_exp_f32 v58, v58
    v_exp_f32 v59, v59
    v_exp_f32 v60, v60
    v_mfma_f32_32x32x16_bf16 v[72:87], v[120:123], v[12:15], v[40:55]
    ds_read_b128 v[124:127], v17 offset:27648
    s_mov_b64 exec, s[96:97]
    ds_read_b128 v[136:139], v20 offset:31744
    ds_read_b128 v[140:143], v20 offset:32256
    s_mov_b64 exec, -1
    v_exp_f32 v61, v61
    v_exp_f32 v62, v62
    v_exp_f32 v63, v63
    v_exp_f32 v64, v64
    s_waitcnt vmcnt(4)
    v_mfma_f32_32x32x16_bf16 v[192:207], v[224:227], v[236:239], v[192:207]
    v_cvt_pk_bf16_f32 v144, v56, v57
    v_cvt_pk_bf16_f32 v145, v58, v59
    v_cvt_pk_bf16_f32 v146, v60, v61
    v_cvt_pk_bf16_f32 v147, v62, v63
    v_exp_f32 v65, v65
    v_exp_f32 v66, v66
    v_exp_f32 v67, v67
    v_mfma_f32_32x32x16_bf16 v[88:103], v[128:131], v[144:147], v[88:103]
    v_exp_f32 v68, v68
    v_exp_f32 v69, v69
    v_exp_f32 v70, v70
    v_exp_f32 v71, v71
    v_mfma_f32_32x32x16_bf16 v[208:223], v[228:231], v[236:239], v[208:223]
    v_cvt_pk_bf16_f32 v148, v64, v65
    v_cvt_pk_bf16_f32 v149, v66, v67
    v_cvt_pk_bf16_f32 v150, v68, v69
    v_cvt_pk_bf16_f32 v151, v70, v71
    v_exp_f32 v72, v72
    v_exp_f32 v73, v73
    v_mfma_f32_32x32x16_bf16 v[88:103], v[132:135], v[148:151], v[88:103]
    v_exp_f32 v74, v74
    v_exp_f32 v75, v75
    v_exp_f32 v76, v76
    s_waitcnt lgkmcnt(0)
    v_mfma_f32_32x32x16_bf16 v[56:71], v[124:127], v[8:11], v[24:39]
    buffer_load_dwordx4 v[224:227], v2, s[28:31], s61 offen offset:0 sc1
    buffer_load_dwordx4 v[232:235], v2, s[28:31], s59 offen offset:2048 sc1
    buffer_load_dwordx4 v[228:231], v2, s[28:31], s61 offen offset:1024 sc1
    buffer_load_dwordx4 v[236:239], v2, s[28:31], s60 offen offset:2048 sc1
    v_exp_f32 v77, v77
    v_exp_f32 v78, v78
    v_exp_f32 v79, v79
    v_exp_f32 v80, v80
    s_waitcnt vmcnt(5)
    v_mfma_f32_32x32x16_bf16 v[160:175], v[240:243], v[248:251], v[160:175]
    v_cvt_pk_bf16_f32 v152, v72, v73
    v_cvt_pk_bf16_f32 v153, v74, v75
    v_cvt_pk_bf16_f32 v154, v76, v77
    v_cvt_pk_bf16_f32 v155, v78, v79
    v_exp_f32 v81, v81
    v_exp_f32 v82, v82
    v_exp_f32 v83, v83
    v_mfma_f32_32x32x16_bf16 v[104:119], v[128:131], v[152:155], v[104:119]
    v_exp_f32 v84, v84
    v_exp_f32 v85, v85
    v_exp_f32 v86, v86
    v_exp_f32 v87, v87
    v_mfma_f32_32x32x16_bf16 v[176:191], v[244:247], v[248:251], v[176:191]
    v_cvt_pk_bf16_f32 v156, v80, v81
    v_cvt_pk_bf16_f32 v157, v82, v83
    v_cvt_pk_bf16_f32 v158, v84, v85
    v_cvt_pk_bf16_f32 v159, v86, v87
    v_exp_f32 v56, v56
    v_exp_f32 v57, v57
    v_mfma_f32_32x32x16_bf16 v[104:119], v[132:135], v[156:159], v[104:119]
    v_exp_f32 v58, v58
    v_exp_f32 v59, v59
    v_exp_f32 v60, v60
    v_mfma_f32_32x32x16_bf16 v[72:87], v[124:127], v[12:15], v[40:55]
    ds_read_b128 v[120:123], v17 offset:0
    s_mov_b64 exec, s[96:97]
    ds_read_b128 v[128:131], v20 offset:4096
    ds_read_b128 v[132:135], v20 offset:4608
    s_mov_b64 exec, -1
    v_exp_f32 v61, v61
    v_exp_f32 v62, v62
    v_exp_f32 v63, v63
    v_exp_f32 v64, v64
    s_waitcnt vmcnt(4)
    v_mfma_f32_32x32x16_bf16 v[192:207], v[240:243], v[252:255], v[192:207]
    v_cvt_pk_bf16_f32 v144, v56, v57
    v_cvt_pk_bf16_f32 v145, v58, v59
    v_cvt_pk_bf16_f32 v146, v60, v61
    v_cvt_pk_bf16_f32 v147, v62, v63
    v_exp_f32 v65, v65
    v_exp_f32 v66, v66
    v_exp_f32 v67, v67
    v_mfma_f32_32x32x16_bf16 v[88:103], v[136:139], v[144:147], v[88:103]
    v_exp_f32 v68, v68
    v_exp_f32 v69, v69
    v_exp_f32 v70, v70
    v_exp_f32 v71, v71
    v_mfma_f32_32x32x16_bf16 v[208:223], v[244:247], v[252:255], v[208:223]
    v_cvt_pk_bf16_f32 v148, v64, v65
    v_cvt_pk_bf16_f32 v149, v66, v67
    v_cvt_pk_bf16_f32 v150, v68, v69
    v_cvt_pk_bf16_f32 v151, v70, v71
    v_exp_f32 v72, v72
    v_exp_f32 v73, v73
    v_mfma_f32_32x32x16_bf16 v[88:103], v[140:143], v[148:151], v[88:103]
    v_exp_f32 v74, v74
    v_exp_f32 v75, v75
    v_exp_f32 v76, v76
    s_waitcnt lgkmcnt(0)
    v_mfma_f32_32x32x16_bf16 v[56:71], v[120:123], v[8:11], v[24:39]
    buffer_load_dwordx4 v[240:243], v2, s[28:31], s61 offen offset:2048 sc1
    buffer_load_dwordx4 v[248:251], v2, s[28:31], s59 offen offset:3072 sc1
    buffer_load_dwordx4 v[244:247], v2, s[28:31], s61 offen offset:3072 sc1
    buffer_load_dwordx4 v[252:255], v2, s[28:31], s60 offen offset:3072 sc1
    s_add_u32 s61, s61, 4096
    s_add_u32 s59, s59, 4096
    s_add_u32 s60, s60, 4096
    v_exp_f32 v77, v77
    v_exp_f32 v78, v78
    v_exp_f32 v79, v79
    v_exp_f32 v80, v80
    v_cvt_pk_bf16_f32 v152, v72, v73
    v_cvt_pk_bf16_f32 v153, v74, v75
    v_cvt_pk_bf16_f32 v154, v76, v77
    v_cvt_pk_bf16_f32 v155, v78, v79
    v_exp_f32 v81, v81
    v_exp_f32 v82, v82
    v_exp_f32 v83, v83
    v_mfma_f32_32x32x16_bf16 v[104:119], v[136:139], v[152:155], v[104:119]
    v_exp_f32 v84, v84
    v_exp_f32 v85, v85
    v_exp_f32 v86, v86
    v_exp_f32 v87, v87
    v_cvt_pk_bf16_f32 v156, v80, v81
    v_cvt_pk_bf16_f32 v157, v82, v83
    v_cvt_pk_bf16_f32 v158, v84, v85
    v_cvt_pk_bf16_f32 v159, v86, v87
    v_exp_f32 v56, v56
    v_exp_f32 v57, v57
    v_mfma_f32_32x32x16_bf16 v[104:119], v[140:143], v[156:159], v[104:119]
    v_exp_f32 v58, v58
    v_exp_f32 v59, v59
    v_exp_f32 v60, v60
    v_mfma_f32_32x32x16_bf16 v[72:87], v[120:123], v[12:15], v[40:55]
    ds_read_b128 v[124:127], v17 offset:1024
    s_mov_b64 exec, s[96:97]
    ds_read_b128 v[136:139], v20 offset:5120
    ds_read_b128 v[140:143], v20 offset:5632
    s_mov_b64 exec, -1
    v_exp_f32 v61, v61
    v_exp_f32 v62, v62
    v_exp_f32 v63, v63
    v_exp_f32 v64, v64
    s_waitcnt vmcnt(5)
    v_mfma_f32_32x32x16_bf16 v[160:175], v[224:227], v[232:235], v[160:175]
    v_cvt_pk_bf16_f32 v144, v56, v57
    v_cvt_pk_bf16_f32 v145, v58, v59
    v_cvt_pk_bf16_f32 v146, v60, v61
    v_cvt_pk_bf16_f32 v147, v62, v63
    v_exp_f32 v65, v65
    v_exp_f32 v66, v66
    v_exp_f32 v67, v67
    v_mfma_f32_32x32x16_bf16 v[88:103], v[128:131], v[144:147], v[88:103]
    v_exp_f32 v68, v68
    v_exp_f32 v69, v69
    v_exp_f32 v70, v70
    v_exp_f32 v71, v71
    v_mfma_f32_32x32x16_bf16 v[176:191], v[228:231], v[232:235], v[176:191]
    v_cvt_pk_bf16_f32 v148, v64, v65
    v_cvt_pk_bf16_f32 v149, v66, v67
    v_cvt_pk_bf16_f32 v150, v68, v69
    v_cvt_pk_bf16_f32 v151, v70, v71
    v_exp_f32 v72, v72
    v_exp_f32 v73, v73
    v_mfma_f32_32x32x16_bf16 v[88:103], v[132:135], v[148:151], v[88:103]
    v_exp_f32 v74, v74
    v_exp_f32 v75, v75
    v_exp_f32 v76, v76
    s_waitcnt lgkmcnt(0)
    v_mfma_f32_32x32x16_bf16 v[56:71], v[124:127], v[8:11], v[24:39]
    v_exp_f32 v77, v77
    v_exp_f32 v78, v78
    v_exp_f32 v79, v79
    v_exp_f32 v80, v80
    s_waitcnt vmcnt(4)
    v_mfma_f32_32x32x16_bf16 v[192:207], v[224:227], v[236:239], v[192:207]
    v_cvt_pk_bf16_f32 v152, v72, v73
    v_cvt_pk_bf16_f32 v153, v74, v75
    v_cvt_pk_bf16_f32 v154, v76, v77
    v_cvt_pk_bf16_f32 v155, v78, v79
    v_exp_f32 v81, v81
    v_exp_f32 v82, v82
    v_exp_f32 v83, v83
    v_mfma_f32_32x32x16_bf16 v[104:119], v[128:131], v[152:155], v[104:119]
    v_exp_f32 v84, v84
    v_exp_f32 v85, v85
    v_exp_f32 v86, v86
    v_exp_f32 v87, v87
    v_mfma_f32_32x32x16_bf16 v[208:223], v[228:231], v[236:239], v[208:223]
    v_cvt_pk_bf16_f32 v156, v80, v81
    v_cvt_pk_bf16_f32 v157, v82, v83
    v_cvt_pk_bf16_f32 v158, v84, v85
    v_cvt_pk_bf16_f32 v159, v86, v87
    v_exp_f32 v56, v56
    v_exp_f32 v57, v57
    v_mfma_f32_32x32x16_bf16 v[104:119], v[132:135], v[156:159], v[104:119]
    v_exp_f32 v58, v58
    v_exp_f32 v59, v59
    v_exp_f32 v60, v60
    v_mfma_f32_32x32x16_bf16 v[72:87], v[124:127], v[12:15], v[40:55]
    ds_read_b128 v[120:123], v17 offset:2048
    s_mov_b64 exec, s[96:97]
    ds_read_b128 v[128:131], v20 offset:6144
    ds_read_b128 v[132:135], v20 offset:6656
    s_mov_b64 exec, -1
    buffer_load_dwordx4 v[224:227], v2, s[28:31], s61 offen offset:0 sc1
    buffer_load_dwordx4 v[232:235], v2, s[28:31], s59 offen offset:0 sc1
    buffer_load_dwordx4 v[228:231], v2, s[28:31], s61 offen offset:1024 sc1
    buffer_load_dwordx4 v[236:239], v2, s[28:31], s60 offen offset:0 sc1
    v_exp_f32 v61, v61
    v_exp_f32 v62, v62
    v_exp_f32 v63, v63
    v_exp_f32 v64, v64
    s_waitcnt vmcnt(5)
    v_mfma_f32_32x32x16_bf16 v[160:175], v[240:243], v[248:251], v[160:175]
    v_cvt_pk_bf16_f32 v144, v56, v57
    v_cvt_pk_bf16_f32 v145, v58, v59
    v_cvt_pk_bf16_f32 v146, v60, v61
    v_cvt_pk_bf16_f32 v147, v62, v63
    v_exp_f32 v65, v65
    v_exp_f32 v66, v66
    v_exp_f32 v67, v67
    v_mfma_f32_32x32x16_bf16 v[88:103], v[136:139], v[144:147], v[88:103]
    v_exp_f32 v68, v68
    v_exp_f32 v69, v69
    v_exp_f32 v70, v70
    v_exp_f32 v71, v71
    v_mfma_f32_32x32x16_bf16 v[176:191], v[244:247], v[248:251], v[176:191]
    v_cvt_pk_bf16_f32 v148, v64, v65
    v_cvt_pk_bf16_f32 v149, v66, v67
    v_cvt_pk_bf16_f32 v150, v68, v69
    v_cvt_pk_bf16_f32 v151, v70, v71
    v_exp_f32 v72, v72
    v_exp_f32 v73, v73
    v_mfma_f32_32x32x16_bf16 v[88:103], v[140:143], v[148:151], v[88:103]
    v_exp_f32 v74, v74
    v_exp_f32 v75, v75
    v_exp_f32 v76, v76
    s_waitcnt lgkmcnt(0)
    v_mfma_f32_32x32x16_bf16 v[56:71], v[120:123], v[8:11], v[24:39]
    v_exp_f32 v77, v77
    v_exp_f32 v78, v78
    v_exp_f32 v79, v79
    v_exp_f32 v80, v80
    s_waitcnt vmcnt(4)
    v_mfma_f32_32x32x16_bf16 v[192:207], v[240:243], v[252:255], v[192:207]
    v_cvt_pk_bf16_f32 v152, v72, v73
    v_cvt_pk_bf16_f32 v153, v74, v75
    v_cvt_pk_bf16_f32 v154, v76, v77
    v_cvt_pk_bf16_f32 v155, v78, v79
    v_exp_f32 v81, v81
    v_exp_f32 v82, v82
    v_exp_f32 v83, v83
    v_mfma_f32_32x32x16_bf16 v[104:119], v[136:139], v[152:155], v[104:119]
    v_exp_f32 v84, v84
    v_exp_f32 v85, v85
    v_exp_f32 v86, v86
    v_exp_f32 v87, v87
    v_mfma_f32_32x32x16_bf16 v[208:223], v[244:247], v[252:255], v[208:223]
    v_cvt_pk_bf16_f32 v156, v80, v81
    v_cvt_pk_bf16_f32 v157, v82, v83
    v_cvt_pk_bf16_f32 v158, v84, v85
    v_cvt_pk_bf16_f32 v159, v86, v87
    v_exp_f32 v56, v56
    v_exp_f32 v57, v57
    v_mfma_f32_32x32x16_bf16 v[104:119], v[140:143], v[156:159], v[104:119]
    v_exp_f32 v58, v58
    v_exp_f32 v59, v59
    v_exp_f32 v60, v60
    v_mfma_f32_32x32x16_bf16 v[72:87], v[120:123], v[12:15], v[40:55]
    ds_read_b128 v[124:127], v17 offset:3072
    s_mov_b64 exec, s[96:97]
    ds_read_b128 v[136:139], v20 offset:7168
    ds_read_b128 v[140:143], v20 offset:7680
    s_mov_b64 exec, -1
    buffer_load_dwordx4 v[240:243], v2, s[28:31], s61 offen offset:2048 sc1
    buffer_load_dwordx4 v[248:251], v2, s[28:31], s59 offen offset:1024 sc1
    buffer_load_dwordx4 v[244:247], v2, s[28:31], s61 offen offset:3072 sc1
    buffer_load_dwordx4 v[252:255], v2, s[28:31], s60 offen offset:1024 sc1
    s_add_u32 s61, s61, 4096
    v_exp_f32 v61, v61
    v_exp_f32 v62, v62
    v_exp_f32 v63, v63
    v_exp_f32 v64, v64
    v_cvt_pk_bf16_f32 v144, v56, v57
    v_cvt_pk_bf16_f32 v145, v58, v59
    v_cvt_pk_bf16_f32 v146, v60, v61
    v_cvt_pk_bf16_f32 v147, v62, v63
    v_exp_f32 v65, v65
    v_exp_f32 v66, v66
    v_exp_f32 v67, v67
    v_mfma_f32_32x32x16_bf16 v[88:103], v[128:131], v[144:147], v[88:103]
    v_exp_f32 v68, v68
    v_exp_f32 v69, v69
    v_exp_f32 v70, v70
    v_exp_f32 v71, v71
    v_cvt_pk_bf16_f32 v148, v64, v65
    v_cvt_pk_bf16_f32 v149, v66, v67
    v_cvt_pk_bf16_f32 v150, v68, v69
    v_cvt_pk_bf16_f32 v151, v70, v71
    v_exp_f32 v72, v72
    v_exp_f32 v73, v73
    v_mfma_f32_32x32x16_bf16 v[88:103], v[132:135], v[148:151], v[88:103]
    v_exp_f32 v74, v74
    v_exp_f32 v75, v75
    v_exp_f32 v76, v76
    s_waitcnt lgkmcnt(0)
    v_mfma_f32_32x32x16_bf16 v[56:71], v[124:127], v[8:11], v[24:39]
    v_exp_f32 v77, v77
    v_exp_f32 v78, v78
    v_exp_f32 v79, v79
    v_exp_f32 v80, v80
    s_waitcnt vmcnt(5)
    v_mfma_f32_32x32x16_bf16 v[160:175], v[224:227], v[232:235], v[160:175]
    v_cvt_pk_bf16_f32 v152, v72, v73
    v_cvt_pk_bf16_f32 v153, v74, v75
    v_cvt_pk_bf16_f32 v154, v76, v77
    v_cvt_pk_bf16_f32 v155, v78, v79
    v_exp_f32 v81, v81
    v_exp_f32 v82, v82
    v_exp_f32 v83, v83
    v_mfma_f32_32x32x16_bf16 v[104:119], v[128:131], v[152:155], v[104:119]
    v_exp_f32 v84, v84
    v_exp_f32 v85, v85
    v_exp_f32 v86, v86
    v_exp_f32 v87, v87
    v_mfma_f32_32x32x16_bf16 v[176:191], v[228:231], v[232:235], v[176:191]
    v_cvt_pk_bf16_f32 v156, v80, v81
    v_cvt_pk_bf16_f32 v157, v82, v83
    v_cvt_pk_bf16_f32 v158, v84, v85
    v_cvt_pk_bf16_f32 v159, v86, v87
    v_exp_f32 v56, v56
    v_exp_f32 v57, v57
    v_mfma_f32_32x32x16_bf16 v[104:119], v[132:135], v[156:159], v[104:119]
    v_exp_f32 v58, v58
    v_exp_f32 v59, v59
    v_exp_f32 v60, v60
    v_mfma_f32_32x32x16_bf16 v[72:87], v[124:127], v[12:15], v[40:55]
    ds_read_b128 v[120:123], v17 offset:8192
    s_mov_b64 exec, s[96:97]
    ds_read_b128 v[128:131], v20 offset:12288
    ds_read_b128 v[132:135], v20 offset:12800
    s_mov_b64 exec, -1
    v_exp_f32 v61, v61
    v_exp_f32 v62, v62
    v_exp_f32 v63, v63
    v_exp_f32 v64, v64
    s_waitcnt vmcnt(4)
    v_mfma_f32_32x32x16_bf16 v[192:207], v[224:227], v[236:239], v[192:207]
    v_cvt_pk_bf16_f32 v144, v56, v57
    v_cvt_pk_bf16_f32 v145, v58, v59
    v_cvt_pk_bf16_f32 v146, v60, v61
    v_cvt_pk_bf16_f32 v147, v62, v63
    v_exp_f32 v65, v65
    v_exp_f32 v66, v66
    v_exp_f32 v67, v67
    v_mfma_f32_32x32x16_bf16 v[88:103], v[136:139], v[144:147], v[88:103]
    v_exp_f32 v68, v68
    v_exp_f32 v69, v69
    v_exp_f32 v70, v70
    v_exp_f32 v71, v71
    v_mfma_f32_32x32x16_bf16 v[208:223], v[228:231], v[236:239], v[208:223]
    v_cvt_pk_bf16_f32 v148, v64, v65
    v_cvt_pk_bf16_f32 v149, v66, v67
    v_cvt_pk_bf16_f32 v150, v68, v69
    v_cvt_pk_bf16_f32 v151, v70, v71
    v_exp_f32 v72, v72
    v_exp_f32 v73, v73
    v_mfma_f32_32x32x16_bf16 v[88:103], v[140:143], v[148:151], v[88:103]
    v_exp_f32 v74, v74
    v_exp_f32 v75, v75
    v_exp_f32 v76, v76
    s_waitcnt lgkmcnt(0)
    v_mfma_f32_32x32x16_bf16 v[56:71], v[120:123], v[8:11], v[24:39]
    s_mov_b64 exec, 1
    ds_add_u32 v3, v4 offset:8
    s_mov_b64 exec, -1
    v_exp_f32 v77, v77
    v_exp_f32 v78, v78
    v_exp_f32 v79, v79
    v_exp_f32 v80, v80
    s_waitcnt vmcnt(1)
    v_mfma_f32_32x32x16_bf16 v[160:175], v[240:243], v[248:251], v[160:175]
    v_cvt_pk_bf16_f32 v152, v72, v73
    v_cvt_pk_bf16_f32 v153, v74, v75
    v_cvt_pk_bf16_f32 v154, v76, v77
    v_cvt_pk_bf16_f32 v155, v78, v79
    v_exp_f32 v81, v81
    v_exp_f32 v82, v82
    v_exp_f32 v83, v83
    v_mfma_f32_32x32x16_bf16 v[104:119], v[136:139], v[152:155], v[104:119]
    v_exp_f32 v84, v84
    v_exp_f32 v85, v85
    v_exp_f32 v86, v86
    v_exp_f32 v87, v87
    v_mfma_f32_32x32x16_bf16 v[176:191], v[244:247], v[248:251], v[176:191]
    v_cvt_pk_bf16_f32 v156, v80, v81
    v_cvt_pk_bf16_f32 v157, v82, v83
    v_cvt_pk_bf16_f32 v158, v84, v85
    v_cvt_pk_bf16_f32 v159, v86, v87
    v_exp_f32 v56, v56
    v_exp_f32 v57, v57
    v_mfma_f32_32x32x16_bf16 v[104:119], v[140:143], v[156:159], v[104:119]
    v_exp_f32 v58, v58
    v_exp_f32 v59, v59
    v_exp_f32 v60, v60
    v_mfma_f32_32x32x16_bf16 v[72:87], v[120:123], v[12:15], v[40:55]
    ds_read_b128 v[124:127], v17 offset:9216
    s_mov_b64 exec, s[96:97]
    ds_read_b128 v[136:139], v20 offset:13312
    ds_read_b128 v[140:143], v20 offset:13824
    s_mov_b64 exec, -1
    ds_read_b64 v[22:23], v3 offset:8
    v_exp_f32 v61, v61
    v_exp_f32 v62, v62
    v_exp_f32 v63, v63
    v_exp_f32 v64, v64
    s_waitcnt vmcnt(0)
    v_mfma_f32_32x32x16_bf16 v[192:207], v[240:243], v[252:255], v[192:207]
    v_cvt_pk_bf16_f32 v144, v56, v57
    v_cvt_pk_bf16_f32 v145, v58, v59
    v_cvt_pk_bf16_f32 v146, v60, v61
    v_cvt_pk_bf16_f32 v147, v62, v63
    v_exp_f32 v65, v65
    v_exp_f32 v66, v66
    v_exp_f32 v67, v67
    v_mfma_f32_32x32x16_bf16 v[88:103], v[128:131], v[144:147], v[88:103]
    v_exp_f32 v68, v68
    v_exp_f32 v69, v69
    v_exp_f32 v70, v70
    v_exp_f32 v71, v71
    v_mfma_f32_32x32x16_bf16 v[208:223], v[244:247], v[252:255], v[208:223]
    v_cvt_pk_bf16_f32 v148, v64, v65
    v_cvt_pk_bf16_f32 v149, v66, v67
    v_cvt_pk_bf16_f32 v150, v68, v69
    v_cvt_pk_bf16_f32 v151, v70, v71
    v_exp_f32 v72, v72
    v_exp_f32 v73, v73
    v_mfma_f32_32x32x16_bf16 v[88:103], v[132:135], v[148:151], v[88:103]
    v_exp_f32 v74, v74
    v_exp_f32 v75, v75
    v_exp_f32 v76, v76
    s_waitcnt lgkmcnt(0)
    v_mfma_f32_32x32x16_bf16 v[56:71], v[124:127], v[8:11], v[24:39]
    v_add_u32 v23, 4, v23
    v_min_u32 v22, v22, v23
    s_nop 0
    v_readfirstlane_b32 s70, v22
    s_cmp_ge_u32 s70, 8
    s_cbranch_scc1 L_A2_K
LW_24:
    ds_read_b32 v22, v3 offset:8
    s_waitcnt lgkmcnt(0)
    v_readfirstlane_b32 s70, v22
    s_cmp_ge_u32 s70, 8
    s_cbranch_scc1 LD_25
    s_sub_u32 s3, s3, 1
    s_cmp_lt_i32 s3, 0
    s_cbranch_scc1 LD_25
    s_sleep 1
    s_branch LW_24
LD_25:
LW_26:
    ds_read_b32 v22, v3 offset:12
    s_waitcnt lgkmcnt(0)
    v_readfirstlane_b32 s70, v22
    s_cmp_ge_u32 s70, 4
    s_cbranch_scc1 LD_27
    s_sub_u32 s3, s3, 1
    s_cmp_lt_i32 s3, 0
    s_cbranch_scc1 LD_27
    s_sleep 1
    s_branch LW_26
LD_27:
L_A2_K:
    v_exp_f32 v77, v77
    v_exp_f32 v78, v78
    v_exp_f32 v79, v79
    v_exp_f32 v80, v80
    v_cvt_pk_bf16_f32 v152, v72, v73
    v_cvt_pk_bf16_f32 v153, v74, v75
    v_cvt_pk_bf16_f32 v154, v76, v77
    v_cvt_pk_bf16_f32 v155, v78, v79
    v_exp_f32 v81, v81
    v_exp_f32 v82, v82
    v_exp_f32 v83, v83
    v_mfma_f32_32x32x16_bf16 v[104:119], v[128:131], v[152:155], v[104:119]
    v_exp_f32 v84, v84
    v_exp_f32 v85, v85
    v_exp_f32 v86, v86
    v_exp_f32 v87, v87
    v_cvt_pk_bf16_f32 v156, v80, v81
    v_cvt_pk_bf16_f32 v157, v82, v83
    v_cvt_pk_bf16_f32 v158, v84, v85
    v_cvt_pk_bf16_f32 v159, v86, v87
    v_exp_f32 v56, v56
    v_exp_f32 v57, v57
    v_mfma_f32_32x32x16_bf16 v[104:119], v[132:135], v[156:159], v[104:119]
    v_exp_f32 v58, v58
    v_exp_f32 v59, v59
    v_exp_f32 v60, v60
    v_mfma_f32_32x32x16_bf16 v[72:87], v[124:127], v[12:15], v[40:55]
    ds_read_b128 v[120:123], v17 offset:10240
    s_mov_b64 exec, s[96:97]
    ds_read_b128 v[128:131], v20 offset:14336
    ds_read_b128 v[132:135], v20 offset:14848
    s_mov_b64 exec, -1
    v_exp_f32 v61, v61
    v_cvt_pk_bf16_f32 v224, v160, v176
    v_exp_f32 v62, v62
    v_cvt_pk_bf16_f32 v225, v161, v177
    v_exp_f32 v63, v63
    v_cvt_pk_bf16_f32 v226, v162, v178
    v_exp_f32 v64, v64
    v_cvt_pk_bf16_f32 v227, v163, v179
    v_cvt_pk_bf16_f32 v144, v56, v57
    v_cvt_pk_bf16_f32 v145, v58, v59
    v_cvt_pk_bf16_f32 v146, v60, v61
    v_cvt_pk_bf16_f32 v147, v62, v63
    v_exp_f32 v65, v65
    ds_write_b128 v18, v[224:227] offset:0
    v_exp_f32 v66, v66
    v_cvt_pk_bf16_f32 v228, v164, v180
    v_exp_f32 v67, v67
    v_mfma_f32_32x32x16_bf16 v[88:103], v[136:139], v[144:147], v[88:103]
    v_exp_f32 v68, v68
    v_cvt_pk_bf16_f32 v229, v165, v181
    v_exp_f32 v69, v69
    v_cvt_pk_bf16_f32 v230, v166, v182
    v_exp_f32 v70, v70
    v_cvt_pk_bf16_f32 v231, v167, v183
    v_exp_f32 v71, v71
    ds_write_b128 v18, v[228:231] offset:1024
    v_cvt_pk_bf16_f32 v148, v64, v65
    v_cvt_pk_bf16_f32 v224, v168, v184
    v_cvt_pk_bf16_f32 v149, v66, v67
    v_cvt_pk_bf16_f32 v225, v169, v185
    v_cvt_pk_bf16_f32 v150, v68, v69
    v_cvt_pk_bf16_f32 v226, v170, v186
    v_cvt_pk_bf16_f32 v151, v70, v71
    v_cvt_pk_bf16_f32 v227, v171, v187
    v_exp_f32 v72, v72
    v_exp_f32 v73, v73
    v_mfma_f32_32x32x16_bf16 v[88:103], v[140:143], v[148:151], v[88:103]
    v_exp_f32 v74, v74
    v_exp_f32 v75, v75
    v_exp_f32 v76, v76
    s_waitcnt lgkmcnt(0)
    v_mfma_f32_32x32x16_bf16 v[56:71], v[120:123], v[8:11], v[24:39]
    v_exp_f32 v77, v77
    ds_write_b128 v18, v[224:227] offset:2048
    v_exp_f32 v78, v78
    v_cvt_pk_bf16_f32 v228, v172, v188
    v_exp_f32 v79, v79
    v_cvt_pk_bf16_f32 v229, v173, v189
    v_exp_f32 v80, v80
    v_cvt_pk_bf16_f32 v230, v174, v190
    v_cvt_pk_bf16_f32 v152, v72, v73
    v_cvt_pk_bf16_f32 v153, v74, v75
    v_cvt_pk_bf16_f32 v154, v76, v77
    v_cvt_pk_bf16_f32 v155, v78, v79
    v_exp_f32 v81, v81
    v_cvt_pk_bf16_f32 v231, v175, v191
    v_exp_f32 v82, v82
    ds_write_b128 v18, v[228:231] offset:3072
    v_exp_f32 v83, v83
    v_mfma_f32_32x32x16_bf16 v[104:119], v[136:139], v[152:155], v[104:119]
    v_exp_f32 v84, v84
    v_cvt_pk_bf16_f32 v224, v192, v208
    v_exp_f32 v85, v85
    v_cvt_pk_bf16_f32 v225, v193, v209
    v_exp_f32 v86, v86
    v_cvt_pk_bf16_f32 v226, v194, v210
    v_exp_f32 v87, v87
    v_cvt_pk_bf16_f32 v227, v195, v211
    v_cvt_pk_bf16_f32 v156, v80, v81
    ds_write_b128 v18, v[224:227] offset:4096
    v_cvt_pk_bf16_f32 v157, v82, v83
    v_cvt_pk_bf16_f32 v228, v196, v212
    v_cvt_pk_bf16_f32 v158, v84, v85
    v_cvt_pk_bf16_f32 v229, v197, v213
    v_cvt_pk_bf16_f32 v159, v86, v87
    v_cvt_pk_bf16_f32 v230, v198, v214
    v_exp_f32 v56, v56
    v_exp_f32 v57, v57
    v_mfma_f32_32x32x16_bf16 v[104:119], v[140:143], v[156:159], v[104:119]
    v_exp_f32 v58, v58
    v_exp_f32 v59, v59
    v_exp_f32 v60, v60
    v_mfma_f32_32x32x16_bf16 v[72:87], v[120:123], v[12:15], v[40:55]
    ds_read_b128 v[124:127], v17 offset:11264
    s_mov_b64 exec, s[96:97]
    ds_read_b128 v[136:139], v20 offset:15360
    ds_read_b128 v[140:143], v20 offset:15872
    s_mov_b64 exec, -1
    buffer_load_dwordx4 v[160:163], v2, s[28:31], s62 offen offset:0 sc1
    buffer_load_dwordx4 v[164:167], v2, s[28:31], s62 offen offset:1024 sc1
    v_exp_f32 v61, v61
    v_cvt_pk_bf16_f32 v231, v199, v215
    v_exp_f32 v62, v62
    ds_write_b128 v18, v[228:231] offset:5120
    v_exp_f32 v63, v63
    v_cvt_pk_bf16_f32 v224, v200, v216
    v_exp_f32 v64, v64
    v_cvt_pk_bf16_f32 v225, v201, v217
    v_cvt_pk_bf16_f32 v144, v56, v57
    v_cvt_pk_bf16_f32 v145, v58, v59
    v_cvt_pk_bf16_f32 v146, v60, v61
    v_cvt_pk_bf16_f32 v147, v62, v63
    v_exp_f32 v65, v65
    v_cvt_pk_bf16_f32 v226, v202, v218
    v_exp_f32 v66, v66
    v_cvt_pk_bf16_f32 v227, v203, v219
    v_exp_f32 v67, v67
    v_mfma_f32_32x32x16_bf16 v[88:103], v[128:131], v[144:147], v[88:103]
    v_exp_f32 v68, v68
    ds_write_b128 v18, v[224:227] offset:6144
    v_exp_f32 v69, v69
    v_cvt_pk_bf16_f32 v228, v204, v220
    v_exp_f32 v70, v70
    v_cvt_pk_bf16_f32 v229, v205, v221
    v_exp_f32 v71, v71
    v_cvt_pk_bf16_f32 v230, v206, v222
    v_cvt_pk_bf16_f32 v148, v64, v65
    v_cvt_pk_bf16_f32 v231, v207, v223
    v_cvt_pk_bf16_f32 v149, v66, v67
    ds_write_b128 v18, v[228:231] offset:7168
    v_cvt_pk_bf16_f32 v150, v68, v69
    v_cvt_pk_bf16_f32 v151, v70, v71
    v_exp_f32 v72, v72
    v_exp_f32 v73, v73
    v_mfma_f32_32x32x16_bf16 v[88:103], v[132:135], v[148:151], v[88:103]
    v_exp_f32 v74, v74
    v_exp_f32 v75, v75
    v_exp_f32 v76, v76
    s_waitcnt lgkmcnt(0)
    v_mfma_f32_32x32x16_bf16 v[56:71], v[124:127], v[8:11], v[24:39]
    buffer_load_dwordx4 v[168:171], v2, s[28:31], s62 offen offset:2048 sc1
    buffer_load_dwordx4 v[172:175], v2, s[28:31], s62 offen offset:3072 sc1
    v_exp_f32 v77, v77
    v_exp_f32 v78, v78
    v_exp_f32 v79, v79
    v_exp_f32 v80, v80
    v_cvt_pk_bf16_f32 v152, v72, v73
    v_cvt_pk_bf16_f32 v153, v74, v75
    v_cvt_pk_bf16_f32 v154, v76, v77
    v_cvt_pk_bf16_f32 v155, v78, v79
    v_exp_f32 v81, v81
    v_exp_f32 v82, v82
    v_exp_f32 v83, v83
    v_mfma_f32_32x32x16_bf16 v[104:119], v[128:131], v[152:155], v[104:119]
    v_exp_f32 v84, v84
    v_exp_f32 v85, v85
    v_exp_f32 v86, v86
    v_exp_f32 v87, v87
    v_cvt_pk_bf16_f32 v156, v80, v81
    v_cvt_pk_bf16_f32 v157, v82, v83
    v_cvt_pk_bf16_f32 v158, v84, v85
    v_cvt_pk_bf16_f32 v159, v86, v87
    v_exp_f32 v56, v56
    v_exp_f32 v57, v57
    v_mfma_f32_32x32x16_bf16 v[104:119], v[132:135], v[156:159], v[104:119]
    v_exp_f32 v58, v58
    v_exp_f32 v59, v59
    v_exp_f32 v60, v60
    v_mfma_f32_32x32x16_bf16 v[72:87], v[124:127], v[12:15], v[40:55]
    ds_read_b128 v[120:123], v2 offset:0
    s_mov_b64 exec, s[96:97]
    ds_read_b128 v[128:131], v21 offset:4096
    ds_read_b128 v[132:135], v21 offset:4608
    s_mov_b64 exec, -1
    s_add_u32 s62, s62, 4096
    buffer_load_dwordx4 v[176:179], v2, s[28:31], s62 offen offset:0 sc1
    buffer_load_dwordx4 v[180:183], v2, s[28:31], s62 offen offset:1024 sc1
    v_exp_f32 v61, v61
    v_exp_f32 v62, v62
    v_exp_f32 v63, v63
    v_exp_f32 v64, v64
    v_cvt_pk_bf16_f32 v144, v56, v57
    v_cvt_pk_bf16_f32 v145, v58, v59
    v_cvt_pk_bf16_f32 v146, v60, v61
    v_cvt_pk_bf16_f32 v147, v62, v63
    v_exp_f32 v65, v65
    v_exp_f32 v66, v66
    v_exp_f32 v67, v67
    v_mfma_f32_32x32x16_bf16 v[88:103], v[136:139], v[144:147], v[88:103]
    v_exp_f32 v68, v68
    v_exp_f32 v69, v69
    v_exp_f32 v70, v70
    v_exp_f32 v71, v71
    v_cvt_pk_bf16_f32 v148, v64, v65
    v_cvt_pk_bf16_f32 v149, v66, v67
    v_cvt_pk_bf16_f32 v150, v68, v69
    v_cvt_pk_bf16_f32 v151, v70, v71
    v_exp_f32 v72, v72
    v_exp_f32 v73, v73
    v_mfma_f32_32x32x16_bf16 v[88:103], v[140:143], v[148:151], v[88:103]
    v_exp_f32 v74, v74
    v_exp_f32 v75, v75
    v_exp_f32 v76, v76
    s_waitcnt lgkmcnt(0)
    v_mfma_f32_32x32x16_bf16 v[56:71], v[120:123], v[8:11], v[24:39]
    buffer_load_dwordx4 v[184:187], v2, s[28:31], s62 offen offset:2048 sc1
    buffer_load_dwordx4 v[188:191], v2, s[28:31], s62 offen offset:3072 sc1
    v_exp_f32 v77, v77
    v_exp_f32 v78, v78
    v_exp_f32 v79, v79
    v_exp_f32 v80, v80
    v_cvt_pk_bf16_f32 v152, v72, v73
    v_cvt_pk_bf16_f32 v153, v74, v75
    v_cvt_pk_bf16_f32 v154, v76, v77
    v_cvt_pk_bf16_f32 v155, v78, v79
    v_exp_f32 v81, v81
    v_exp_f32 v82, v82
    v_exp_f32 v83, v83
    v_mfma_f32_32x32x16_bf16 v[104:119], v[136:139], v[152:155], v[104:119]
    v_exp_f32 v84, v84
    v_exp_f32 v85, v85
    v_exp_f32 v86, v86
    v_exp_f32 v87, v87
    v_cvt_pk_bf16_f32 v156, v80, v81
    v_cvt_pk_bf16_f32 v157, v82, v83
    v_cvt_pk_bf16_f32 v158, v84, v85
    v_cvt_pk_bf16_f32 v159, v86, v87
    v_exp_f32 v56, v56
    v_exp_f32 v57, v57
    v_mfma_f32_32x32x16_bf16 v[104:119], v[140:143], v[156:159], v[104:119]
    v_exp_f32 v58, v58
    v_exp_f32 v59, v59
    v_exp_f32 v60, v60
    v_mfma_f32_32x32x16_bf16 v[72:87], v[120:123], v[12:15], v[40:55]
    ds_read_b128 v[124:127], v2 offset:1024
    s_mov_b64 exec, s[96:97]
    ds_read_b128 v[136:139], v21 offset:5120
    ds_read_b128 v[140:143], v21 offset:5632
    s_mov_b64 exec, -1
    s_add_u32 s62, s62, 4096
    buffer_load_dwordx4 v[192:195], v2, s[28:31], s62 offen offset:0 sc1
    buffer_load_dwordx4 v[196:199], v2, s[28:31], s62 offen offset:1024 sc1
    v_exp_f32 v61, v61
    v_exp_f32 v62, v62
    v_exp_f32 v63, v63
    v_exp_f32 v64, v64
    v_cvt_pk_bf16_f32 v144, v56, v57
    v_cvt_pk_bf16_f32 v145, v58, v59
    v_cvt_pk_bf16_f32 v146, v60, v61
    v_cvt_pk_bf16_f32 v147, v62, v63
    v_exp_f32 v65, v65
    v_exp_f32 v66, v66
    v_exp_f32 v67, v67
    v_mfma_f32_32x32x16_bf16 v[88:103], v[128:131], v[144:147], v[88:103]
    v_exp_f32 v68, v68
    v_exp_f32 v69, v69
    v_exp_f32 v70, v70
    v_exp_f32 v71, v71
    v_cvt_pk_bf16_f32 v148, v64, v65
    v_cvt_pk_bf16_f32 v149, v66, v67
    v_cvt_pk_bf16_f32 v150, v68, v69
    v_cvt_pk_bf16_f32 v151, v70, v71
    v_exp_f32 v72, v72
    v_exp_f32 v73, v73
    v_mfma_f32_32x32x16_bf16 v[88:103], v[132:135], v[148:151], v[88:103]
    v_exp_f32 v74, v74
    v_exp_f32 v75, v75
    v_exp_f32 v76, v76
    s_waitcnt lgkmcnt(0)
    v_mfma_f32_32x32x16_bf16 v[56:71], v[124:127], v[8:11], v[24:39]
    buffer_load_dwordx4 v[200:203], v2, s[28:31], s62 offen offset:2048 sc1
    buffer_load_dwordx4 v[204:207], v2, s[28:31], s62 offen offset:3072 sc1
    v_exp_f32 v77, v77
    v_exp_f32 v78, v78
    v_exp_f32 v79, v79
    v_exp_f32 v80, v80
    v_cvt_pk_bf16_f32 v152, v72, v73
    v_cvt_pk_bf16_f32 v153, v74, v75
    v_cvt_pk_bf16_f32 v154, v76, v77
    v_cvt_pk_bf16_f32 v155, v78, v79
    v_exp_f32 v81, v81
    v_exp_f32 v82, v82
    v_exp_f32 v83, v83
    v_mfma_f32_32x32x16_bf16 v[104:119], v[128:131], v[152:155], v[104:119]
    v_exp_f32 v84, v84
    v_exp_f32 v85, v85
    v_exp_f32 v86, v86
    v_exp_f32 v87, v87
    v_cvt_pk_bf16_f32 v156, v80, v81
    v_cvt_pk_bf16_f32 v157, v82, v83
    v_cvt_pk_bf16_f32 v158, v84, v85
    v_cvt_pk_bf16_f32 v159, v86, v87
    v_exp_f32 v56, v56
    v_exp_f32 v57, v57
    v_mfma_f32_32x32x16_bf16 v[104:119], v[132:135], v[156:159], v[104:119]
    v_exp_f32 v58, v58
    v_exp_f32 v59, v59
    v_exp_f32 v60, v60
    v_mfma_f32_32x32x16_bf16 v[72:87], v[124:127], v[12:15], v[40:55]
    ds_read_b128 v[120:123], v2 offset:2048
    s_mov_b64 exec, s[96:97]
    ds_read_b128 v[128:131], v21 offset:6144
    ds_read_b128 v[132:135], v21 offset:6656
    s_mov_b64 exec, -1
    s_add_u32 s62, s62, 4096
    buffer_load_dwordx4 v[208:211], v2, s[28:31], s62 offen offset:0 sc1
    buffer_load_dwordx4 v[212:215], v2, s[28:31], s62 offen offset:1024 sc1
    v_exp_f32 v61, v61
    v_exp_f32 v62, v62
    v_exp_f32 v63, v63
    v_exp_f32 v64, v64
    v_cvt_pk_bf16_f32 v144, v56, v57
    v_cvt_pk_bf16_f32 v145, v58, v59
    v_cvt_pk_bf16_f32 v146, v60, v61
    v_cvt_pk_bf16_f32 v147, v62, v63
    v_exp_f32 v65, v65
    v_exp_f32 v66, v66
    v_exp_f32 v67, v67
    v_mfma_f32_32x32x16_bf16 v[88:103], v[136:139], v[144:147], v[88:103]
    v_exp_f32 v68, v68
    v_exp_f32 v69, v69
    v_exp_f32 v70, v70
    v_exp_f32 v71, v71
    v_cvt_pk_bf16_f32 v148, v64, v65
    v_cvt_pk_bf16_f32 v149, v66, v67
    v_cvt_pk_bf16_f32 v150, v68, v69
    v_cvt_pk_bf16_f32 v151, v70, v71
    v_exp_f32 v72, v72
    v_exp_f32 v73, v73
    v_mfma_f32_32x32x16_bf16 v[88:103], v[140:143], v[148:151], v[88:103]
    v_exp_f32 v74, v74
    v_exp_f32 v75, v75
    v_exp_f32 v76, v76
    s_waitcnt lgkmcnt(0)
    v_mfma_f32_32x32x16_bf16 v[56:71], v[120:123], v[8:11], v[24:39]
    buffer_load_dwordx4 v[216:219], v2, s[28:31], s62 offen offset:2048 sc1
    buffer_load_dwordx4 v[220:223], v2, s[28:31], s62 offen offset:3072 sc1
    s_mov_b64 exec, 1
    ds_add_u32 v3, v4 offset:48
    s_mov_b64 exec, -1
    v_and_b32 v6, 31, v1
    v_lshlrev_b32 v6, 3, v6
    buffer_load_dwordx2 v[22:23], v6, s[28:31], s64 offen sc1
    v_exp_f32 v77, v77
    v_exp_f32 v78, v78
    v_exp_f32 v79, v79
    v_exp_f32 v80, v80
    v_cvt_pk_bf16_f32 v152, v72, v73
    v_cvt_pk_bf16_f32 v153, v74, v75
    v_cvt_pk_bf16_f32 v154, v76, v77
    v_cvt_pk_bf16_f32 v155, v78, v79
    v_exp_f32 v81, v81
    v_exp_f32 v82, v82
    v_exp_f32 v83, v83
    v_mfma_f32_32x32x16_bf16 v[104:119], v[136:139], v[152:155], v[104:119]
    v_exp_f32 v84, v84
    v_exp_f32 v85, v85
    v_exp_f32 v86, v86
    v_exp_f32 v87, v87
    v_cvt_pk_bf16_f32 v156, v80, v81
    v_cvt_pk_bf16_f32 v157, v82, v83
    v_cvt_pk_bf16_f32 v158, v84, v85
    v_cvt_pk_bf16_f32 v159, v86, v87
    v_exp_f32 v56, v56
    v_exp_f32 v57, v57
    v_mfma_f32_32x32x16_bf16 v[104:119], v[140:143], v[156:159], v[104:119]
    v_exp_f32 v58, v58
    v_exp_f32 v59, v59
    v_exp_f32 v60, v60
    v_mfma_f32_32x32x16_bf16 v[72:87], v[120:123], v[12:15], v[40:55]
    ds_read_b128 v[124:127], v2 offset:3072
    s_mov_b64 exec, s[96:97]
    ds_read_b128 v[136:139], v21 offset:7168
    ds_read_b128 v[140:143], v21 offset:7680
    s_mov_b64 exec, -1
    s_add_u32 s74, s63, 4096
    buffer_load_dwordx4 v[224:227], v2, s[28:31], s63 offen offset:0 sc1
    buffer_load_dwordx4 v[228:231], v2, s[28:31], s63 offen offset:1024 sc1
    v_exp_f32 v61, v61
    v_exp_f32 v62, v62
    v_exp_f32 v63, v63
    v_exp_f32 v64, v64
    v_cvt_pk_bf16_f32 v144, v56, v57
    v_cvt_pk_bf16_f32 v145, v58, v59
    v_cvt_pk_bf16_f32 v146, v60, v61
    v_cvt_pk_bf16_f32 v147, v62, v63
    v_exp_f32 v65, v65
    v_exp_f32 v66, v66
    v_exp_f32 v67, v67
    v_mfma_f32_32x32x16_bf16 v[88:103], v[128:131], v[144:147], v[88:103]
    v_exp_f32 v68, v68
    v_exp_f32 v69, v69
    v_exp_f32 v70, v70
    v_exp_f32 v71, v71
    v_cvt_pk_bf16_f32 v148, v64, v65
    v_cvt_pk_bf16_f32 v149, v66, v67
    v_cvt_pk_bf16_f32 v150, v68, v69
    v_cvt_pk_bf16_f32 v151, v70, v71
    v_exp_f32 v72, v72
    v_exp_f32 v73, v73
    v_mfma_f32_32x32x16_bf16 v[88:103], v[132:135], v[148:151], v[88:103]
    v_exp_f32 v74, v74
    v_exp_f32 v75, v75
    v_exp_f32 v76, v76
    s_waitcnt lgkmcnt(0)
    v_mfma_f32_32x32x16_bf16 v[56:71], v[124:127], v[8:11], v[24:39]
    buffer_load_dwordx4 v[232:235], v2, s[28:31], s63 offen offset:2048 sc1
    buffer_load_dwordx4 v[236:239], v2, s[28:31], s63 offen offset:3072 sc1
    v_exp_f32 v77, v77
    v_exp_f32 v78, v78
    v_exp_f32 v79, v79
    v_exp_f32 v80, v80
    v_cvt_pk_bf16_f32 v152, v72, v73
    v_cvt_pk_bf16_f32 v153, v74, v75
    v_cvt_pk_bf16_f32 v154, v76, v77
    v_cvt_pk_bf16_f32 v155, v78, v79
    v_exp_f32 v81, v81
    v_exp_f32 v82, v82
    v_exp_f32 v83, v83
    v_mfma_f32_32x32x16_bf16 v[104:119], v[128:131], v[152:155], v[104:119]
    v_exp_f32 v84, v84
    v_exp_f32 v85, v85
    v_exp_f32 v86, v86
    v_exp_f32 v87, v87
    v_cvt_pk_bf16_f32 v156, v80, v81
    v_cvt_pk_bf16_f32 v157, v82, v83
    v_cvt_pk_bf16_f32 v158, v84, v85
    v_cvt_pk_bf16_f32 v159, v86, v87
    v_exp_f32 v56, v56
    v_exp_f32 v57, v57
    v_mfma_f32_32x32x16_bf16 v[104:119], v[132:135], v[156:159], v[104:119]
    v_exp_f32 v58, v58
    v_exp_f32 v59, v59
    v_exp_f32 v60, v60
    v_mfma_f32_32x32x16_bf16 v[72:87], v[124:127], v[12:15], v[40:55]
    buffer_load_dwordx4 v[240:243], v2, s[28:31], s74 offen offset:0 sc1
    buffer_load_dwordx4 v[244:247], v2, s[28:31], s74 offen offset:1024 sc1
    v_exp_f32 v61, v61
    v_exp_f32 v62, v62
    v_exp_f32 v63, v63
    v_exp_f32 v64, v64
    v_cvt_pk_bf16_f32 v144, v56, v57
    v_cvt_pk_bf16_f32 v145, v58, v59
    v_cvt_pk_bf16_f32 v146, v60, v61
    v_cvt_pk_bf16_f32 v147, v62, v63
    v_exp_f32 v65, v65
    v_exp_f32 v66, v66
    v_exp_f32 v67, v67
    v_mfma_f32_32x32x16_bf16 v[88:103], v[136:139], v[144:147], v[88:103]
    v_exp_f32 v68, v68
    v_exp_f32 v69, v69
    v_exp_f32 v70, v70
    v_exp_f32 v71, v71
    v_cvt_pk_bf16_f32 v148, v64, v65
    v_cvt_pk_bf16_f32 v149, v66, v67
    v_cvt_pk_bf16_f32 v150, v68, v69
    v_cvt_pk_bf16_f32 v151, v70, v71
    v_exp_f32 v72, v72
    v_exp_f32 v73, v73
    v_mfma_f32_32x32x16_bf16 v[88:103], v[140:143], v[148:151], v[88:103]
    v_exp_f32 v74, v74
    v_exp_f32 v75, v75
    v_exp_f32 v76, v76
    s_waitcnt lgkmcnt(0)
    buffer_load_dwordx4 v[248:251], v2, s[28:31], s74 offen offset:2048 sc1
    buffer_load_dwordx4 v[252:255], v2, s[28:31], s74 offen offset:3072 sc1
    v_exp_f32 v77, v77
    v_exp_f32 v78, v78
    v_exp_f32 v79, v79
    v_exp_f32 v80, v80
    v_cvt_pk_bf16_f32 v152, v72, v73
    v_cvt_pk_bf16_f32 v153, v74, v75
    v_cvt_pk_bf16_f32 v154, v76, v77
    v_cvt_pk_bf16_f32 v155, v78, v79
    v_exp_f32 v81, v81
    v_exp_f32 v82, v82
    v_exp_f32 v83, v83
    v_mfma_f32_32x32x16_bf16 v[104:119], v[136:139], v[152:155], v[104:119]
    v_exp_f32 v84, v84
    v_exp_f32 v85, v85
    v_exp_f32 v86, v86
    v_exp_f32 v87, v87
    v_cvt_pk_bf16_f32 v156, v80, v81
    v_cvt_pk_bf16_f32 v157, v82, v83
    v_cvt_pk_bf16_f32 v158, v84, v85
    v_cvt_pk_bf16_f32 v159, v86, v87
    s_nop 1
    v_mfma_f32_32x32x16_bf16 v[104:119], v[140:143], v[156:159], v[104:119]
    s_branch TAIL
K1_COMP:
    s_setprio 1
    s_cmp_eq_u32 s44, 7
    s_cbranch_scc1 K1_TX
    s_cmp_eq_u32 s44, 6
    s_cbranch_scc1 K1_TQ
    v_bfe_u32 v12, v1, 2, 2
    v_and_b32 v14, 3, v1
    v_mul_u32_u24 v12, 114688, v12
    v_min_u32 v15, 2, v14
    v_lshl_add_u32 v12, v15, 8, v12
    v_lshrrev_b32 v13, 2, v1
    v_mul_u32_u24 v13, 114688, v13
    v_lshlrev_b32 v14, 8, v14
    v_add_u32 v14, 128, v14
    v_min_u32 v14, 768, v14
    v_add_u32 v13, v13, v14
    s_mul_i32 s62, s51, 3584
    s_mul_i32 s54, s46, 896
    s_add_u32 s62, s62, s54
    s_mov_b32 s63, 458752
    s_waitcnt lgkmcnt(0)
    s_mov_b32 s32, s8
    s_mov_b32 s33, s9
    s_mov_b32 s34, 0x1c0000
    s_mov_b32 s35, 0x00020000
    s_cmp_eq_u32 s44, 4
    s_cbranch_scc1 K1_TG
    s_mov_b32 s32, s10
    s_mov_b32 s33, s11
    s_branch K1_TG
K1_TQ:
    v_bfe_u32 v12, v1, 3, 2
    v_and_b32 v13, 7, v1
    v_min_u32 v13, 5, v13
    v_add_u32 v13, s49, v13
    v_add_u32 v14, 13, v13
    v_add_u32 v15, 1, v13
    v_cmp_gt_u32 vcc, 11, v13
    s_nop 1
    v_cndmask_b32 v14, v15, v14, vcc
    s_add_u32 s52, s49, 3
    v_cmp_gt_u32 vcc, s52, v13
    s_nop 1
    v_cndmask_b32 v13, v14, v13, vcc
    v_mul_u32_u24 v12, 98304, v12
    v_lshl_add_u32 v12, v13, 7, v12
    v_mov_b32 v13, 0
    s_mul_i32 s62, s51, 3072
    s_mov_b32 s63, 393216
    s_waitcnt lgkmcnt(0)
    s_mov_b32 s32, s6
    s_mov_b32 s33, s7
    s_mov_b32 s34, 0x180000
    s_mov_b32 s35, 0x00020000
    s_branch K1_TG
K1_TX:
    v_and_b32 v12, 31, v1
    v_lshlrev_b32 v12, 10, v12
    v_lshrrev_b32 v13, 5, v1
    v_lshl_add_u32 v12, v13, 7, v12
    v_mov_b32 v13, 0
    s_and_b32 s62, s50, 1
    s_lshl_b32 s62, s62, 20
    s_lshl_b32 s54, s51, 15
    s_add_u32 s62, s62, s54
    s_movk_i32 s63, 256
    s_waitcnt lgkmcnt(0)
    s_mov_b32 s32, s4
    s_mov_b32 s33, s5
    s_mov_b32 s34, 0x200000
    s_mov_b32 s35, 0x00020000
K1_TG:
    s_mov_b32 s64, s62
    buffer_load_dword v14, v12, s[32:35], s62 offen
    s_add_u32 s62, s62, s63
    buffer_load_dword v14, v12, s[32:35], s62 offen
    s_add_u32 s62, s62, s63
    s_getpc_b64 s[40:41]
K1_PC:
    s_sub_u32 s40, s40, K1_PC-mono_kernel
    s_subb_u32 s41, s41, 0
    s_mov_b32 s42, K_END-mono_kernel
    s_mov_b32 s43, 0x00020000
    s_lshl_b32 s52, s51, 2
    s_add_u32 s52, s52, s44
    s_sub_u32 s52, s52, 4
    s_lshl_b32 s52, s52, 10
    s_mov_b32 s75, s52
    s_mov_b32 s24, s16
    s_mov_b32 s25, s17
    s_mov_b32 s26, 0x2000000
    s_mov_b32 s27, 0x00020000
    s_mov_b32 s52, 0x14000
    s_cmp_eq_u32 s44, 5
    s_cselect_b32 s24, s20, s24
    s_cselect_b32 s25, s21, s25
    s_cselect_b32 s26, 0x200000, s26
    s_cselect_b32 s52, 0x2000, s52
    s_cmp_eq_u32 s44, 6
    s_cselect_b32 s24, s12, s24
    s_cselect_b32 s25, s13, s25
    s_cselect_b32 s26, 0x1c0000, s26
    s_cselect_b32 s52, 0x1c00, s52
    s_cmp_eq_u32 s44, 7
    s_cselect_b32 s24, s18, s24
    s_cselect_b32 s25, s19, s25
    s_cselect_b32 s26, 0x80000, s26
    s_cselect_b32 s52, 0x800, s52
    v_lshl_add_u32 v255, v1, 2, s47
    v_mul_lo_u32 v255, v255, s52
    s_and_b32 s55, s44, 1
    s_bfe_u32 s56, s44, 0x10001
    v_and_b32 v19, 15, v1
    v_lshrrev_b32 v20, 4, v1
    v_and_b32 v16, 8, v1
    v_add_u32 v16, v16, v19
    v_lshrrev_b32 v17, 1, v19
    v_xor_b32 v17, v17, v20
    v_lshlrev_b32 v17, 4, v17
    v_lshl_add_u32 v17, v16, 7, v17
    s_lshl_b32 s52, s55, 13
    s_add_u32 s52, s52, 98304
    v_add_u32 v5, s52, v17
    v_xor_b32 v6, 64, v5
    v_lshlrev_b32 v16, 4, v16
    v_lshl_add_u32 v3, v20, 9, v16
    v_lshrrev_b32 v17, 5, v1
    v_mul_u32_u24 v17, 896, v17
    v_sub_u32 v3, v3, v17
    v_add_u32 v2, 0x10000, v3
    v_lshlrev_b32 v4, 4, v1
    v_bfe_u32 v18, v1, 3, 1
    v_lshrrev_b32 v16, 2, v19
    v_lshl_add_u32 v16, v20, 3, v16
    v_lshlrev_b32 v16, 7, v16
    v_and_b32 v17, 2, v1
    v_or_b32 v17, v17, v18
    v_bfe_u32 v18, v1, 4, 1
    v_xor_b32 v18, s56, v18
    v_lshl_or_b32 v17, v18, 2, v17
    v_lshl_add_u32 v16, v17, 4, v16
    v_and_b32 v17, 1, v1
    v_lshl_add_u32 v7, v17, 3, v16
    v_xor_b32 v8, 16, v7
    v_add_u32 v9, 0x10000, v7
    v_add_u32 v10, 0x10000, v8
    v_min_u32 v16, 2, v1
    v_sub_u32 v16, s53, v16
    v_and_b32 v17, 7, v16
    v_lshrrev_b32 v16, 3, v16
    v_lshlrev_b32 v16, 7, v16
    v_mul_u32_u24 v17, 8704, v17
    v_add_u32 v11, v17, v16
    v_mov_b32 v0, 0
    s_lshl_b32 s57, s45, 1
    s_add_u32 s57, s57, s55
    s_lshl_b32 s70, s57, 2
    s_mul_i32 s52, s56, 4352
    s_add_u32 s70, s70, s52
    s_add_u32 s70, s70, 0x1140000
    s_lshl_b32 s71, s46, 2
    s_add_u32 s71, s71, s47
    s_lshl_b32 s71, s71, 1
    s_add_u32 s71, s71, s56
    s_lshl_b32 s52, s57, 5
    s_add_u32 s71, s71, s52
    s_lshl_b32 s71, s71, 2
    s_add_u32 s95, s71, 0x1114000
    s_lshl_b32 s57, s57, 1
    s_lshl_b32 s73, s57, 15
    s_mul_i32 s58, s57, 114688
    s_lshl_b32 s52, s56, 11
    s_add_u32 s73, s73, s52
    s_add_u32 s58, s58, s52
    s_add_u32 s58, s58, 0xa00000
    s_lshl_b32 s52, s72, 12
    s_add_u32 s60, s58, s52
    s_add_u32 s61, s60, 114688
    s_lshl_b32 s52, s48, 12
    s_add_u32 s58, s58, s52
    s_add_u32 s59, s58, 114688
    s_lshl_b32 s57, s57, 10
    s_lshl_b32 s52, s56, 17
    s_add_u32 s57, s57, s52
    s_lshl_b32 s52, s53, 18
    s_add_u32 s68, s57, s52
    s_sub_u32 s67, s68, 0x40000
    s_sub_u32 s66, s68, 0x80000
    s_mov_b32 s28, s16
    s_mov_b32 s29, s17
    s_mov_b32 s30, 0x2000000
    s_mov_b32 s31, 0x00020000
    s_mov_b32 s36, s22
    s_mov_b32 s37, s23
    s_mov_b32 s38, 0x100
    s_mov_b32 s39, 0x00020000
    s_cmp_ge_u32 s53, 16
    s_cbranch_scc1 K1_CV
    s_barrier
    ds_read_b128 v[16:19], v5 offset:0
    ds_read_b64_tr_b16 v[32:33], v7 offset:0
    ds_read_b64_tr_b16 v[34:35], v7 offset:512
    ds_read_b128 v[20:23], v5 offset:1024
    ds_read_b128 v[24:27], v5 offset:4096
    ds_read_b128 v[28:31], v5 offset:5120
    ds_read_b64_tr_b16 v[36:37], v8 offset:0
    ds_read_b64_tr_b16 v[38:39], v8 offset:512
    ds_read_b64_tr_b16 v[40:41], v7 offset:8192
    ds_read_b64_tr_b16 v[42:43], v7 offset:8704
    ds_read_b64_tr_b16 v[44:45], v8 offset:8192
    ds_read_b64_tr_b16 v[46:47], v8 offset:8704
    ds_read_b64_tr_b16 v[48:49], v9 offset:0
    ds_read_b64_tr_b16 v[50:51], v9 offset:512
    ds_read_b64_tr_b16 v[52:53], v10 offset:0
    ds_read_b64_tr_b16 v[54:55], v10 offset:512
    s_waitcnt lgkmcnt(13)
    v_mfma_f32_16x16x32_bf16 v[96:99], v[32:35], v[16:19], 0
    ds_read_b128 v[56:59], v6 offset:0
    s_waitcnt lgkmcnt(13)
    v_mfma_f32_16x16x32_bf16 v[104:107], v[32:35], v[20:23], 0
    ds_read_b64_tr_b16 v[72:73], v7 offset:4096
    s_waitcnt lgkmcnt(13)
    v_mfma_f32_16x16x32_bf16 v[112:115], v[32:35], v[24:27], 0
    ds_read_b64_tr_b16 v[74:75], v7 offset:4608
    s_waitcnt lgkmcnt(13)
    v_mfma_f32_16x16x32_bf16 v[120:123], v[32:35], v[28:31], 0
    ds_read_b128 v[60:63], v6 offset:1024
    s_waitcnt lgkmcnt(12)
    v_mfma_f32_16x16x32_bf16 v[100:103], v[36:39], v[16:19], 0
    ds_read_b128 v[64:67], v6 offset:4096
    v_mfma_f32_16x16x32_bf16 v[108:111], v[36:39], v[20:23], 0
    ds_read_b128 v[68:71], v6 offset:5120
    v_mfma_f32_16x16x32_bf16 v[116:119], v[36:39], v[24:27], 0
    ds_read_b64_tr_b16 v[76:77], v8 offset:4096
    v_mfma_f32_16x16x32_bf16 v[124:127], v[36:39], v[28:31], 0
    ds_read_b64_tr_b16 v[78:79], v8 offset:4608
    s_waitcnt lgkmcnt(14)
    v_mfma_f32_16x16x32_bf16 v[128:131], v[40:43], v[16:19], 0
    ds_read_b64_tr_b16 v[80:81], v7 offset:12288
    v_mfma_f32_16x16x32_bf16 v[136:139], v[40:43], v[20:23], 0
    ds_read_b64_tr_b16 v[82:83], v7 offset:12800
    v_mfma_f32_16x16x32_bf16 v[144:147], v[40:43], v[24:27], 0
    ds_read_b64_tr_b16 v[84:85], v8 offset:12288
    v_mfma_f32_16x16x32_bf16 v[152:155], v[40:43], v[28:31], 0
    ds_read_b64_tr_b16 v[86:87], v8 offset:12800
    s_waitcnt lgkmcnt(15)
    v_mfma_f32_16x16x32_bf16 v[132:135], v[44:47], v[16:19], 0
    ds_read_b64_tr_b16 v[88:89], v9 offset:4096
    v_mfma_f32_16x16x32_bf16 v[140:143], v[44:47], v[20:23], 0
    ds_read_b64_tr_b16 v[90:91], v9 offset:4608
    v_mfma_f32_16x16x32_bf16 v[148:151], v[44:47], v[24:27], 0
    ds_read_b64_tr_b16 v[92:93], v10 offset:4096
    v_mfma_f32_16x16x32_bf16 v[156:159], v[44:47], v[28:31], 0
    ds_read_b64_tr_b16 v[94:95], v10 offset:4608
    s_waitcnt lgkmcnt(15)
    v_mfma_f32_16x16x32_bf16 v[160:163], v[48:51], v[16:19], 0
    v_mfma_f32_16x16x32_bf16 v[168:171], v[48:51], v[20:23], 0
    v_mfma_f32_16x16x32_bf16 v[176:179], v[48:51], v[24:27], 0
    v_mfma_f32_16x16x32_bf16 v[184:187], v[48:51], v[28:31], 0
    v_mfma_f32_16x16x32_bf16 v[164:167], v[52:55], v[16:19], 0
    v_mfma_f32_16x16x32_bf16 v[172:175], v[52:55], v[20:23], 0
    v_mfma_f32_16x16x32_bf16 v[180:183], v[52:55], v[24:27], 0
    v_mfma_f32_16x16x32_bf16 v[188:191], v[52:55], v[28:31], 0
    s_waitcnt lgkmcnt(13)
    v_mfma_f32_16x16x32_bf16 v[96:99], v[72:75], v[56:59], v[96:99]
    s_waitcnt lgkmcnt(12)
    v_mfma_f32_16x16x32_bf16 v[104:107], v[72:75], v[60:63], v[104:107]
    s_waitcnt lgkmcnt(0)
    s_barrier
    s_and_b32 s52, s51, 7
    s_cbranch_scc1 TT_28
    buffer_load_dword v14, v255, s[24:27], 0 offen sc1
TT_28:
    buffer_load_dword v14, v12, s[32:35], s62 offen
    s_add_u32 s62, s62, s63
    ds_read_b128 v[16:19], v5 offset:16384
    v_mfma_f32_16x16x32_bf16 v[112:115], v[72:75], v[64:67], v[112:115]
    ds_read_b64_tr_b16 v[32:33], v7 offset:16384
    v_mfma_f32_16x16x32_bf16 v[120:123], v[72:75], v[68:71], v[120:123]
    ds_read_b64_tr_b16 v[34:35], v7 offset:16896
    v_mfma_f32_16x16x32_bf16 v[100:103], v[76:79], v[56:59], v[100:103]
    ds_read_b128 v[20:23], v5 offset:17408
    v_mfma_f32_16x16x32_bf16 v[108:111], v[76:79], v[60:63], v[108:111]
    ds_read_b128 v[24:27], v5 offset:20480
    v_mfma_f32_16x16x32_bf16 v[116:119], v[76:79], v[64:67], v[116:119]
    ds_read_b128 v[28:31], v5 offset:21504
    v_mfma_f32_16x16x32_bf16 v[124:127], v[76:79], v[68:71], v[124:127]
    ds_read_b64_tr_b16 v[36:37], v8 offset:16384
    v_mfma_f32_16x16x32_bf16 v[128:131], v[80:83], v[56:59], v[128:131]
    ds_read_b64_tr_b16 v[38:39], v8 offset:16896
    v_mfma_f32_16x16x32_bf16 v[136:139], v[80:83], v[60:63], v[136:139]
    ds_read_b64_tr_b16 v[40:41], v7 offset:24576
    v_mfma_f32_16x16x32_bf16 v[144:147], v[80:83], v[64:67], v[144:147]
    ds_read_b64_tr_b16 v[42:43], v7 offset:25088
    v_mfma_f32_16x16x32_bf16 v[152:155], v[80:83], v[68:71], v[152:155]
    ds_read_b64_tr_b16 v[44:45], v8 offset:24576
    v_mfma_f32_16x16x32_bf16 v[132:135], v[84:87], v[56:59], v[132:135]
    ds_read_b64_tr_b16 v[46:47], v8 offset:25088
    v_mfma_f32_16x16x32_bf16 v[140:143], v[84:87], v[60:63], v[140:143]
    ds_read_b64_tr_b16 v[48:49], v9 offset:8192
    v_mfma_f32_16x16x32_bf16 v[148:151], v[84:87], v[64:67], v[148:151]
    ds_read_b64_tr_b16 v[50:51], v9 offset:8704
    v_mfma_f32_16x16x32_bf16 v[156:159], v[84:87], v[68:71], v[156:159]
    ds_read_b64_tr_b16 v[52:53], v10 offset:8192
    v_mfma_f32_16x16x32_bf16 v[160:163], v[88:91], v[56:59], v[160:163]
    ds_read_b64_tr_b16 v[54:55], v10 offset:8704
    v_mfma_f32_16x16x32_bf16 v[168:171], v[88:91], v[60:63], v[168:171]
    v_mfma_f32_16x16x32_bf16 v[176:179], v[88:91], v[64:67], v[176:179]
    v_mfma_f32_16x16x32_bf16 v[184:187], v[88:91], v[68:71], v[184:187]
    v_mfma_f32_16x16x32_bf16 v[164:167], v[92:95], v[56:59], v[164:167]
    v_mfma_f32_16x16x32_bf16 v[172:175], v[92:95], v[60:63], v[172:175]
    v_mfma_f32_16x16x32_bf16 v[180:183], v[92:95], v[64:67], v[180:183]
    v_mfma_f32_16x16x32_bf16 v[188:191], v[92:95], v[68:71], v[188:191]
    s_waitcnt lgkmcnt(13)
    v_mfma_f32_16x16x32_bf16 v[96:99], v[32:35], v[16:19], v[96:99]
    ds_read_b128 v[56:59], v6 offset:16384
    s_waitcnt lgkmcnt(13)
    v_mfma_f32_16x16x32_bf16 v[104:107], v[32:35], v[20:23], v[104:107]
    ds_read_b64_tr_b16 v[72:73], v7 offset:20480
    s_waitcnt lgkmcnt(13)
    v_mfma_f32_16x16x32_bf16 v[112:115], v[32:35], v[24:27], v[112:115]
    ds_read_b64_tr_b16 v[74:75], v7 offset:20992
    s_waitcnt lgkmcnt(13)
    v_mfma_f32_16x16x32_bf16 v[120:123], v[32:35], v[28:31], v[120:123]
    ds_read_b128 v[60:63], v6 offset:17408
    s_waitcnt lgkmcnt(12)
    v_mfma_f32_16x16x32_bf16 v[100:103], v[36:39], v[16:19], v[100:103]
    ds_read_b128 v[64:67], v6 offset:20480
    v_mfma_f32_16x16x32_bf16 v[108:111], v[36:39], v[20:23], v[108:111]
    ds_read_b128 v[68:71], v6 offset:21504
    v_mfma_f32_16x16x32_bf16 v[116:119], v[36:39], v[24:27], v[116:119]
    ds_read_b64_tr_b16 v[76:77], v8 offset:20480
    v_mfma_f32_16x16x32_bf16 v[124:127], v[36:39], v[28:31], v[124:127]
    ds_read_b64_tr_b16 v[78:79], v8 offset:20992
    s_waitcnt lgkmcnt(14)
    v_mfma_f32_16x16x32_bf16 v[128:131], v[40:43], v[16:19], v[128:131]
    ds_read_b64_tr_b16 v[80:81], v7 offset:28672
    v_mfma_f32_16x16x32_bf16 v[136:139], v[40:43], v[20:23], v[136:139]
    ds_read_b64_tr_b16 v[82:83], v7 offset:29184
    v_mfma_f32_16x16x32_bf16 v[144:147], v[40:43], v[24:27], v[144:147]
    ds_read_b64_tr_b16 v[84:85], v8 offset:28672
    v_mfma_f32_16x16x32_bf16 v[152:155], v[40:43], v[28:31], v[152:155]
    ds_read_b64_tr_b16 v[86:87], v8 offset:29184
    s_waitcnt lgkmcnt(15)
    v_mfma_f32_16x16x32_bf16 v[132:135], v[44:47], v[16:19], v[132:135]
    ds_read_b64_tr_b16 v[88:89], v9 offset:12288
    v_mfma_f32_16x16x32_bf16 v[140:143], v[44:47], v[20:23], v[140:143]
    ds_read_b64_tr_b16 v[90:91], v9 offset:12800
    v_mfma_f32_16x16x32_bf16 v[148:151], v[44:47], v[24:27], v[148:151]
    ds_read_b64_tr_b16 v[92:93], v10 offset:12288
    v_mfma_f32_16x16x32_bf16 v[156:159], v[44:47], v[28:31], v[156:159]
    ds_read_b64_tr_b16 v[94:95], v10 offset:12800
    s_waitcnt lgkmcnt(15)
    v_mfma_f32_16x16x32_bf16 v[160:163], v[48:51], v[16:19], v[160:163]
    v_mfma_f32_16x16x32_bf16 v[168:171], v[48:51], v[20:23], v[168:171]
    v_mfma_f32_16x16x32_bf16 v[176:179], v[48:51], v[24:27], v[176:179]
    v_mfma_f32_16x16x32_bf16 v[184:187], v[48:51], v[28:31], v[184:187]
    v_mfma_f32_16x16x32_bf16 v[164:167], v[52:55], v[16:19], v[164:167]
    v_mfma_f32_16x16x32_bf16 v[172:175], v[52:55], v[20:23], v[172:175]
    v_mfma_f32_16x16x32_bf16 v[180:183], v[52:55], v[24:27], v[180:183]
    v_mfma_f32_16x16x32_bf16 v[188:191], v[52:55], v[28:31], v[188:191]
    s_waitcnt lgkmcnt(13)
    v_mfma_f32_16x16x32_bf16 v[96:99], v[72:75], v[56:59], v[96:99]
    s_waitcnt lgkmcnt(12)
    v_mfma_f32_16x16x32_bf16 v[104:107], v[72:75], v[60:63], v[104:107]
    s_waitcnt lgkmcnt(0)
    s_barrier
    v_and_b32 v15, 7, v1
    v_lshlrev_b32 v15, 7, v15
    buffer_load_dword v14, v15, s[40:43], s75 offen
    ds_read_b128 v[16:19], v5 offset:32768
    v_mfma_f32_16x16x32_bf16 v[112:115], v[72:75], v[64:67], v[112:115]
    ds_read_b64_tr_b16 v[32:33], v7 offset:32768
    v_mfma_f32_16x16x32_bf16 v[120:123], v[72:75], v[68:71], v[120:123]
    ds_read_b64_tr_b16 v[34:35], v7 offset:33280
    v_mfma_f32_16x16x32_bf16 v[100:103], v[76:79], v[56:59], v[100:103]
    ds_read_b128 v[20:23], v5 offset:33792
    v_mfma_f32_16x16x32_bf16 v[108:111], v[76:79], v[60:63], v[108:111]
    ds_read_b128 v[24:27], v5 offset:36864
    v_mfma_f32_16x16x32_bf16 v[116:119], v[76:79], v[64:67], v[116:119]
    ds_read_b128 v[28:31], v5 offset:37888
    v_mfma_f32_16x16x32_bf16 v[124:127], v[76:79], v[68:71], v[124:127]
    ds_read_b64_tr_b16 v[36:37], v8 offset:32768
    v_mfma_f32_16x16x32_bf16 v[128:131], v[80:83], v[56:59], v[128:131]
    ds_read_b64_tr_b16 v[38:39], v8 offset:33280
    v_mfma_f32_16x16x32_bf16 v[136:139], v[80:83], v[60:63], v[136:139]
    ds_read_b64_tr_b16 v[40:41], v7 offset:40960
    v_mfma_f32_16x16x32_bf16 v[144:147], v[80:83], v[64:67], v[144:147]
    ds_read_b64_tr_b16 v[42:43], v7 offset:41472
    v_mfma_f32_16x16x32_bf16 v[152:155], v[80:83], v[68:71], v[152:155]
    ds_read_b64_tr_b16 v[44:45], v8 offset:40960
    v_mfma_f32_16x16x32_bf16 v[132:135], v[84:87], v[56:59], v[132:135]
    ds_read_b64_tr_b16 v[46:47], v8 offset:41472
    v_mfma_f32_16x16x32_bf16 v[140:143], v[84:87], v[60:63], v[140:143]
    ds_read_b64_tr_b16 v[48:49], v9 offset:16384
    v_mfma_f32_16x16x32_bf16 v[148:151], v[84:87], v[64:67], v[148:151]
    ds_read_b64_tr_b16 v[50:51], v9 offset:16896
    v_mfma_f32_16x16x32_bf16 v[156:159], v[84:87], v[68:71], v[156:159]
    ds_read_b64_tr_b16 v[52:53], v10 offset:16384
    v_mfma_f32_16x16x32_bf16 v[160:163], v[88:91], v[56:59], v[160:163]
    ds_read_b64_tr_b16 v[54:55], v10 offset:16896
    v_mfma_f32_16x16x32_bf16 v[168:171], v[88:91], v[60:63], v[168:171]
    v_mfma_f32_16x16x32_bf16 v[176:179], v[88:91], v[64:67], v[176:179]
    v_mfma_f32_16x16x32_bf16 v[184:187], v[88:91], v[68:71], v[184:187]
    v_mfma_f32_16x16x32_bf16 v[164:167], v[92:95], v[56:59], v[164:167]
    v_mfma_f32_16x16x32_bf16 v[172:175], v[92:95], v[60:63], v[172:175]
    v_mfma_f32_16x16x32_bf16 v[180:183], v[92:95], v[64:67], v[180:183]
    v_mfma_f32_16x16x32_bf16 v[188:191], v[92:95], v[68:71], v[188:191]
    s_waitcnt lgkmcnt(13)
    v_mfma_f32_16x16x32_bf16 v[96:99], v[32:35], v[16:19], v[96:99]
    ds_read_b128 v[56:59], v6 offset:32768
    s_waitcnt lgkmcnt(13)
    v_mfma_f32_16x16x32_bf16 v[104:107], v[32:35], v[20:23], v[104:107]
    ds_read_b64_tr_b16 v[72:73], v7 offset:36864
    s_waitcnt lgkmcnt(13)
    v_mfma_f32_16x16x32_bf16 v[112:115], v[32:35], v[24:27], v[112:115]
    ds_read_b64_tr_b16 v[74:75], v7 offset:37376
    s_waitcnt lgkmcnt(13)
    v_mfma_f32_16x16x32_bf16 v[120:123], v[32:35], v[28:31], v[120:123]
    ds_read_b128 v[60:63], v6 offset:33792
    s_waitcnt lgkmcnt(12)
    v_mfma_f32_16x16x32_bf16 v[100:103], v[36:39], v[16:19], v[100:103]
    ds_read_b128 v[64:67], v6 offset:36864
    v_mfma_f32_16x16x32_bf16 v[108:111], v[36:39], v[20:23], v[108:111]
    ds_read_b128 v[68:71], v6 offset:37888
    v_mfma_f32_16x16x32_bf16 v[116:119], v[36:39], v[24:27], v[116:119]
    ds_read_b64_tr_b16 v[76:77], v8 offset:36864
    v_mfma_f32_16x16x32_bf16 v[124:127], v[36:39], v[28:31], v[124:127]
    ds_read_b64_tr_b16 v[78:79], v8 offset:37376
    s_waitcnt lgkmcnt(14)
    v_mfma_f32_16x16x32_bf16 v[128:131], v[40:43], v[16:19], v[128:131]
    ds_read_b64_tr_b16 v[80:81], v7 offset:45056
    v_mfma_f32_16x16x32_bf16 v[136:139], v[40:43], v[20:23], v[136:139]
    ds_read_b64_tr_b16 v[82:83], v7 offset:45568
    v_mfma_f32_16x16x32_bf16 v[144:147], v[40:43], v[24:27], v[144:147]
    ds_read_b64_tr_b16 v[84:85], v8 offset:45056
    v_mfma_f32_16x16x32_bf16 v[152:155], v[40:43], v[28:31], v[152:155]
    ds_read_b64_tr_b16 v[86:87], v8 offset:45568
    s_waitcnt lgkmcnt(15)
    v_mfma_f32_16x16x32_bf16 v[132:135], v[44:47], v[16:19], v[132:135]
    ds_read_b64_tr_b16 v[88:89], v9 offset:20480
    v_mfma_f32_16x16x32_bf16 v[140:143], v[44:47], v[20:23], v[140:143]
    ds_read_b64_tr_b16 v[90:91], v9 offset:20992
    v_mfma_f32_16x16x32_bf16 v[148:151], v[44:47], v[24:27], v[148:151]
    ds_read_b64_tr_b16 v[92:93], v10 offset:20480
    v_mfma_f32_16x16x32_bf16 v[156:159], v[44:47], v[28:31], v[156:159]
    ds_read_b64_tr_b16 v[94:95], v10 offset:20992
    s_waitcnt lgkmcnt(15)
    v_mfma_f32_16x16x32_bf16 v[160:163], v[48:51], v[16:19], v[160:163]
    v_mfma_f32_16x16x32_bf16 v[168:171], v[48:51], v[20:23], v[168:171]
    v_mfma_f32_16x16x32_bf16 v[176:179], v[48:51], v[24:27], v[176:179]
    v_mfma_f32_16x16x32_bf16 v[184:187], v[48:51], v[28:31], v[184:187]
    v_mfma_f32_16x16x32_bf16 v[164:167], v[52:55], v[16:19], v[164:167]
    v_mfma_f32_16x16x32_bf16 v[172:175], v[52:55], v[20:23], v[172:175]
    v_mfma_f32_16x16x32_bf16 v[180:183], v[52:55], v[24:27], v[180:183]
    v_mfma_f32_16x16x32_bf16 v[188:191], v[52:55], v[28:31], v[188:191]
    s_waitcnt lgkmcnt(13)
    v_mfma_f32_16x16x32_bf16 v[96:99], v[72:75], v[56:59], v[96:99]
    s_waitcnt lgkmcnt(12)
    v_mfma_f32_16x16x32_bf16 v[104:107], v[72:75], v[60:63], v[104:107]
    s_waitcnt lgkmcnt(0)
    s_barrier
    buffer_load_dword v14, v12, s[32:35], s62 offen
    s_add_u32 s62, s62, s63
    ds_read_b128 v[16:19], v5 offset:49152
    v_mfma_f32_16x16x32_bf16 v[112:115], v[72:75], v[64:67], v[112:115]
    ds_read_b64_tr_b16 v[32:33], v7 offset:49152
    v_mfma_f32_16x16x32_bf16 v[120:123], v[72:75], v[68:71], v[120:123]
    ds_read_b64_tr_b16 v[34:35], v7 offset:49664
    v_mfma_f32_16x16x32_bf16 v[100:103], v[76:79], v[56:59], v[100:103]
    ds_read_b128 v[20:23], v5 offset:50176
    v_mfma_f32_16x16x32_bf16 v[108:111], v[76:79], v[60:63], v[108:111]
    ds_read_b128 v[24:27], v5 offset:53248
    v_mfma_f32_16x16x32_bf16 v[116:119], v[76:79], v[64:67], v[116:119]
    ds_read_b128 v[28:31], v5 offset:54272
    v_mfma_f32_16x16x32_bf16 v[124:127], v[76:79], v[68:71], v[124:127]
    ds_read_b64_tr_b16 v[36:37], v8 offset:49152
    v_mfma_f32_16x16x32_bf16 v[128:131], v[80:83], v[56:59], v[128:131]
    ds_read_b64_tr_b16 v[38:39], v8 offset:49664
    v_mfma_f32_16x16x32_bf16 v[136:139], v[80:83], v[60:63], v[136:139]
    ds_read_b64_tr_b16 v[40:41], v7 offset:57344
    v_mfma_f32_16x16x32_bf16 v[144:147], v[80:83], v[64:67], v[144:147]
    ds_read_b64_tr_b16 v[42:43], v7 offset:57856
    v_mfma_f32_16x16x32_bf16 v[152:155], v[80:83], v[68:71], v[152:155]
    ds_read_b64_tr_b16 v[44:45], v8 offset:57344
    v_mfma_f32_16x16x32_bf16 v[132:135], v[84:87], v[56:59], v[132:135]
    ds_read_b64_tr_b16 v[46:47], v8 offset:57856
    v_mfma_f32_16x16x32_bf16 v[140:143], v[84:87], v[60:63], v[140:143]
    ds_read_b64_tr_b16 v[48:49], v9 offset:24576
    v_mfma_f32_16x16x32_bf16 v[148:151], v[84:87], v[64:67], v[148:151]
    ds_read_b64_tr_b16 v[50:51], v9 offset:25088
    v_mfma_f32_16x16x32_bf16 v[156:159], v[84:87], v[68:71], v[156:159]
    ds_read_b64_tr_b16 v[52:53], v10 offset:24576
    v_mfma_f32_16x16x32_bf16 v[160:163], v[88:91], v[56:59], v[160:163]
    ds_read_b64_tr_b16 v[54:55], v10 offset:25088
    v_mfma_f32_16x16x32_bf16 v[168:171], v[88:91], v[60:63], v[168:171]
    v_mfma_f32_16x16x32_bf16 v[176:179], v[88:91], v[64:67], v[176:179]
    v_mfma_f32_16x16x32_bf16 v[184:187], v[88:91], v[68:71], v[184:187]
    v_mfma_f32_16x16x32_bf16 v[164:167], v[92:95], v[56:59], v[164:167]
    v_mfma_f32_16x16x32_bf16 v[172:175], v[92:95], v[60:63], v[172:175]
    v_mfma_f32_16x16x32_bf16 v[180:183], v[92:95], v[64:67], v[180:183]
    v_mfma_f32_16x16x32_bf16 v[188:191], v[92:95], v[68:71], v[188:191]
    s_waitcnt lgkmcnt(13)
    v_mfma_f32_16x16x32_bf16 v[96:99], v[32:35], v[16:19], v[96:99]
    ds_read_b128 v[56:59], v6 offset:49152
    s_waitcnt lgkmcnt(13)
    v_mfma_f32_16x16x32_bf16 v[104:107], v[32:35], v[20:23], v[104:107]
    ds_read_b64_tr_b16 v[72:73], v7 offset:53248
    s_waitcnt lgkmcnt(13)
    v_mfma_f32_16x16x32_bf16 v[112:115], v[32:35], v[24:27], v[112:115]
    ds_read_b64_tr_b16 v[74:75], v7 offset:53760
    s_waitcnt lgkmcnt(13)
    v_mfma_f32_16x16x32_bf16 v[120:123], v[32:35], v[28:31], v[120:123]
    ds_read_b128 v[60:63], v6 offset:50176
    s_waitcnt lgkmcnt(12)
    v_mfma_f32_16x16x32_bf16 v[100:103], v[36:39], v[16:19], v[100:103]
    ds_read_b128 v[64:67], v6 offset:53248
    v_mfma_f32_16x16x32_bf16 v[108:111], v[36:39], v[20:23], v[108:111]
    ds_read_b128 v[68:71], v6 offset:54272
    v_mfma_f32_16x16x32_bf16 v[116:119], v[36:39], v[24:27], v[116:119]
    ds_read_b64_tr_b16 v[76:77], v8 offset:53248
    v_mfma_f32_16x16x32_bf16 v[124:127], v[36:39], v[28:31], v[124:127]
    ds_read_b64_tr_b16 v[78:79], v8 offset:53760
    s_waitcnt lgkmcnt(14)
    v_mfma_f32_16x16x32_bf16 v[128:131], v[40:43], v[16:19], v[128:131]
    ds_read_b64_tr_b16 v[80:81], v7 offset:61440
    v_mfma_f32_16x16x32_bf16 v[136:139], v[40:43], v[20:23], v[136:139]
    ds_read_b64_tr_b16 v[82:83], v7 offset:61952
    v_mfma_f32_16x16x32_bf16 v[144:147], v[40:43], v[24:27], v[144:147]
    ds_read_b64_tr_b16 v[84:85], v8 offset:61440
    v_mfma_f32_16x16x32_bf16 v[152:155], v[40:43], v[28:31], v[152:155]
    ds_read_b64_tr_b16 v[86:87], v8 offset:61952
    s_waitcnt lgkmcnt(15)
    v_mfma_f32_16x16x32_bf16 v[132:135], v[44:47], v[16:19], v[132:135]
    ds_read_b64_tr_b16 v[88:89], v9 offset:28672
    v_mfma_f32_16x16x32_bf16 v[140:143], v[44:47], v[20:23], v[140:143]
    ds_read_b64_tr_b16 v[90:91], v9 offset:29184
    v_mfma_f32_16x16x32_bf16 v[148:151], v[44:47], v[24:27], v[148:151]
    ds_read_b64_tr_b16 v[92:93], v10 offset:28672
    v_mfma_f32_16x16x32_bf16 v[156:159], v[44:47], v[28:31], v[156:159]
    ds_read_b64_tr_b16 v[94:95], v10 offset:29184
    s_waitcnt lgkmcnt(15)
    v_mfma_f32_16x16x32_bf16 v[160:163], v[48:51], v[16:19], v[160:163]
    v_mfma_f32_16x16x32_bf16 v[168:171], v[48:51], v[20:23], v[168:171]
    v_mfma_f32_16x16x32_bf16 v[176:179], v[48:51], v[24:27], v[176:179]
    v_mfma_f32_16x16x32_bf16 v[184:187], v[48:51], v[28:31], v[184:187]
    v_mfma_f32_16x16x32_bf16 v[164:167], v[52:55], v[16:19], v[164:167]
    v_mfma_f32_16x16x32_bf16 v[172:175], v[52:55], v[20:23], v[172:175]
    v_mfma_f32_16x16x32_bf16 v[180:183], v[52:55], v[24:27], v[180:183]
    v_mfma_f32_16x16x32_bf16 v[188:191], v[52:55], v[28:31], v[188:191]
    s_waitcnt lgkmcnt(13)
    v_mfma_f32_16x16x32_bf16 v[96:99], v[72:75], v[56:59], v[96:99]
    s_waitcnt lgkmcnt(12)
    v_mfma_f32_16x16x32_bf16 v[104:107], v[72:75], v[60:63], v[104:107]
    s_waitcnt lgkmcnt(0)
    s_barrier
    buffer_load_dword v14, v13, s[32:35], s64 offen
    ds_read_b128 v[16:19], v5 offset:0
    v_mfma_f32_16x16x32_bf16 v[112:115], v[72:75], v[64:67], v[112:115]
    ds_read_b64_tr_b16 v[32:33], v7 offset:0
    v_mfma_f32_16x16x32_bf16 v[120:123], v[72:75], v[68:71], v[120:123]
    ds_read_b64_tr_b16 v[34:35], v7 offset:512
    v_mfma_f32_16x16x32_bf16 v[100:103], v[76:79], v[56:59], v[100:103]
    ds_read_b128 v[20:23], v5 offset:1024
    v_mfma_f32_16x16x32_bf16 v[108:111], v[76:79], v[60:63], v[108:111]
    ds_read_b128 v[24:27], v5 offset:4096
    v_mfma_f32_16x16x32_bf16 v[116:119], v[76:79], v[64:67], v[116:119]
    ds_read_b128 v[28:31], v5 offset:5120
    v_mfma_f32_16x16x32_bf16 v[124:127], v[76:79], v[68:71], v[124:127]
    ds_read_b64_tr_b16 v[36:37], v8 offset:0
    v_mfma_f32_16x16x32_bf16 v[128:131], v[80:83], v[56:59], v[128:131]
    ds_read_b64_tr_b16 v[38:39], v8 offset:512
    v_mfma_f32_16x16x32_bf16 v[136:139], v[80:83], v[60:63], v[136:139]
    ds_read_b64_tr_b16 v[40:41], v7 offset:8192
    v_mfma_f32_16x16x32_bf16 v[144:147], v[80:83], v[64:67], v[144:147]
    ds_read_b64_tr_b16 v[42:43], v7 offset:8704
    v_mfma_f32_16x16x32_bf16 v[152:155], v[80:83], v[68:71], v[152:155]
    ds_read_b64_tr_b16 v[44:45], v8 offset:8192
    v_mfma_f32_16x16x32_bf16 v[132:135], v[84:87], v[56:59], v[132:135]
    ds_read_b64_tr_b16 v[46:47], v8 offset:8704
    v_mfma_f32_16x16x32_bf16 v[140:143], v[84:87], v[60:63], v[140:143]
    ds_read_b64_tr_b16 v[48:49], v9 offset:0
    v_mfma_f32_16x16x32_bf16 v[148:151], v[84:87], v[64:67], v[148:151]
    ds_read_b64_tr_b16 v[50:51], v9 offset:512
    v_mfma_f32_16x16x32_bf16 v[156:159], v[84:87], v[68:71], v[156:159]
    ds_read_b64_tr_b16 v[52:53], v10 offset:0
    v_mfma_f32_16x16x32_bf16 v[160:163], v[88:91], v[56:59], v[160:163]
    ds_read_b64_tr_b16 v[54:55], v10 offset:512
    v_mfma_f32_16x16x32_bf16 v[168:171], v[88:91], v[60:63], v[168:171]
    v_mfma_f32_16x16x32_bf16 v[176:179], v[88:91], v[64:67], v[176:179]
    v_mfma_f32_16x16x32_bf16 v[184:187], v[88:91], v[68:71], v[184:187]
    v_mfma_f32_16x16x32_bf16 v[164:167], v[92:95], v[56:59], v[164:167]
    v_mfma_f32_16x16x32_bf16 v[172:175], v[92:95], v[60:63], v[172:175]
    v_mfma_f32_16x16x32_bf16 v[180:183], v[92:95], v[64:67], v[180:183]
    v_mfma_f32_16x16x32_bf16 v[188:191], v[92:95], v[68:71], v[188:191]
    s_waitcnt lgkmcnt(13)
    v_mfma_f32_16x16x32_bf16 v[96:99], v[32:35], v[16:19], v[96:99]
    ds_read_b128 v[56:59], v6 offset:0
    s_waitcnt lgkmcnt(13)
    v_mfma_f32_16x16x32_bf16 v[104:107], v[32:35], v[20:23], v[104:107]
    ds_read_b64_tr_b16 v[72:73], v7 offset:4096
    s_waitcnt lgkmcnt(13)
    v_mfma_f32_16x16x32_bf16 v[112:115], v[32:35], v[24:27], v[112:115]
    ds_read_b64_tr_b16 v[74:75], v7 offset:4608
    s_waitcnt lgkmcnt(13)
    v_mfma_f32_16x16x32_bf16 v[120:123], v[32:35], v[28:31], v[120:123]
    ds_read_b128 v[60:63], v6 offset:1024
    s_waitcnt lgkmcnt(12)
    v_mfma_f32_16x16x32_bf16 v[100:103], v[36:39], v[16:19], v[100:103]
    ds_read_b128 v[64:67], v6 offset:4096
    v_mfma_f32_16x16x32_bf16 v[108:111], v[36:39], v[20:23], v[108:111]
    ds_read_b128 v[68:71], v6 offset:5120
    v_mfma_f32_16x16x32_bf16 v[116:119], v[36:39], v[24:27], v[116:119]
    ds_read_b64_tr_b16 v[76:77], v8 offset:4096
    v_mfma_f32_16x16x32_bf16 v[124:127], v[36:39], v[28:31], v[124:127]
    ds_read_b64_tr_b16 v[78:79], v8 offset:4608
    s_waitcnt lgkmcnt(14)
    v_mfma_f32_16x16x32_bf16 v[128:131], v[40:43], v[16:19], v[128:131]
    ds_read_b64_tr_b16 v[80:81], v7 offset:12288
    v_mfma_f32_16x16x32_bf16 v[136:139], v[40:43], v[20:23], v[136:139]
    ds_read_b64_tr_b16 v[82:83], v7 offset:12800
    v_mfma_f32_16x16x32_bf16 v[144:147], v[40:43], v[24:27], v[144:147]
    ds_read_b64_tr_b16 v[84:85], v8 offset:12288
    v_mfma_f32_16x16x32_bf16 v[152:155], v[40:43], v[28:31], v[152:155]
    ds_read_b64_tr_b16 v[86:87], v8 offset:12800
    s_waitcnt lgkmcnt(15)
    v_mfma_f32_16x16x32_bf16 v[132:135], v[44:47], v[16:19], v[132:135]
    ds_read_b64_tr_b16 v[88:89], v9 offset:4096
    v_mfma_f32_16x16x32_bf16 v[140:143], v[44:47], v[20:23], v[140:143]
    ds_read_b64_tr_b16 v[90:91], v9 offset:4608
    v_mfma_f32_16x16x32_bf16 v[148:151], v[44:47], v[24:27], v[148:151]
    ds_read_b64_tr_b16 v[92:93], v10 offset:4096
    v_mfma_f32_16x16x32_bf16 v[156:159], v[44:47], v[28:31], v[156:159]
    ds_read_b64_tr_b16 v[94:95], v10 offset:4608
    s_waitcnt lgkmcnt(15)
    v_mfma_f32_16x16x32_bf16 v[160:163], v[48:51], v[16:19], v[160:163]
    v_mfma_f32_16x16x32_bf16 v[168:171], v[48:51], v[20:23], v[168:171]
    v_mfma_f32_16x16x32_bf16 v[176:179], v[48:51], v[24:27], v[176:179]
    v_mfma_f32_16x16x32_bf16 v[184:187], v[48:51], v[28:31], v[184:187]
    v_mfma_f32_16x16x32_bf16 v[164:167], v[52:55], v[16:19], v[164:167]
    v_mfma_f32_16x16x32_bf16 v[172:175], v[52:55], v[20:23], v[172:175]
    v_mfma_f32_16x16x32_bf16 v[180:183], v[52:55], v[24:27], v[180:183]
    v_mfma_f32_16x16x32_bf16 v[188:191], v[52:55], v[28:31], v[188:191]
    s_waitcnt lgkmcnt(13)
    v_mfma_f32_16x16x32_bf16 v[96:99], v[72:75], v[56:59], v[96:99]
    s_waitcnt lgkmcnt(12)
    v_mfma_f32_16x16x32_bf16 v[104:107], v[72:75], v[60:63], v[104:107]
    s_waitcnt lgkmcnt(0)
    s_barrier
    buffer_load_dword v15, v0, s[36:39], 0 offen sc1
    ds_read_b128 v[16:19], v5 offset:16384
    v_mfma_f32_16x16x32_bf16 v[112:115], v[72:75], v[64:67], v[112:115]
    ds_read_b64_tr_b16 v[32:33], v7 offset:16384
    v_mfma_f32_16x16x32_bf16 v[120:123], v[72:75], v[68:71], v[120:123]
    ds_read_b64_tr_b16 v[34:35], v7 offset:16896
    v_mfma_f32_16x16x32_bf16 v[100:103], v[76:79], v[56:59], v[100:103]
    ds_read_b128 v[20:23], v5 offset:17408
    v_mfma_f32_16x16x32_bf16 v[108:111], v[76:79], v[60:63], v[108:111]
    ds_read_b128 v[24:27], v5 offset:20480
    v_mfma_f32_16x16x32_bf16 v[116:119], v[76:79], v[64:67], v[116:119]
    ds_read_b128 v[28:31], v5 offset:21504
    v_mfma_f32_16x16x32_bf16 v[124:127], v[76:79], v[68:71], v[124:127]
    ds_read_b64_tr_b16 v[36:37], v8 offset:16384
    v_mfma_f32_16x16x32_bf16 v[128:131], v[80:83], v[56:59], v[128:131]
    ds_read_b64_tr_b16 v[38:39], v8 offset:16896
    v_mfma_f32_16x16x32_bf16 v[136:139], v[80:83], v[60:63], v[136:139]
    ds_read_b64_tr_b16 v[40:41], v7 offset:24576
    v_mfma_f32_16x16x32_bf16 v[144:147], v[80:83], v[64:67], v[144:147]
    ds_read_b64_tr_b16 v[42:43], v7 offset:25088
    v_mfma_f32_16x16x32_bf16 v[152:155], v[80:83], v[68:71], v[152:155]
    ds_read_b64_tr_b16 v[44:45], v8 offset:24576
    v_mfma_f32_16x16x32_bf16 v[132:135], v[84:87], v[56:59], v[132:135]
    ds_read_b64_tr_b16 v[46:47], v8 offset:25088
    v_mfma_f32_16x16x32_bf16 v[140:143], v[84:87], v[60:63], v[140:143]
    ds_read_b64_tr_b16 v[48:49], v9 offset:8192
    v_mfma_f32_16x16x32_bf16 v[148:151], v[84:87], v[64:67], v[148:151]
    ds_read_b64_tr_b16 v[50:51], v9 offset:8704
    v_mfma_f32_16x16x32_bf16 v[156:159], v[84:87], v[68:71], v[156:159]
    ds_read_b64_tr_b16 v[52:53], v10 offset:8192
    v_mfma_f32_16x16x32_bf16 v[160:163], v[88:91], v[56:59], v[160:163]
    ds_read_b64_tr_b16 v[54:55], v10 offset:8704
    v_mfma_f32_16x16x32_bf16 v[168:171], v[88:91], v[60:63], v[168:171]
    v_mfma_f32_16x16x32_bf16 v[176:179], v[88:91], v[64:67], v[176:179]
    v_mfma_f32_16x16x32_bf16 v[184:187], v[88:91], v[68:71], v[184:187]
    v_mfma_f32_16x16x32_bf16 v[164:167], v[92:95], v[56:59], v[164:167]
    v_mfma_f32_16x16x32_bf16 v[172:175], v[92:95], v[60:63], v[172:175]
    v_mfma_f32_16x16x32_bf16 v[180:183], v[92:95], v[64:67], v[180:183]
    v_mfma_f32_16x16x32_bf16 v[188:191], v[92:95], v[68:71], v[188:191]
    s_waitcnt lgkmcnt(13)
    v_mfma_f32_16x16x32_bf16 v[96:99], v[32:35], v[16:19], v[96:99]
    ds_read_b128 v[56:59], v6 offset:16384
    s_waitcnt lgkmcnt(13)
    v_mfma_f32_16x16x32_bf16 v[104:107], v[32:35], v[20:23], v[104:107]
    ds_read_b64_tr_b16 v[72:73], v7 offset:20480
    s_waitcnt lgkmcnt(13)
    v_mfma_f32_16x16x32_bf16 v[112:115], v[32:35], v[24:27], v[112:115]
    ds_read_b64_tr_b16 v[74:75], v7 offset:20992
    s_waitcnt lgkmcnt(13)
    v_mfma_f32_16x16x32_bf16 v[120:123], v[32:35], v[28:31], v[120:123]
    ds_read_b128 v[60:63], v6 offset:17408
    s_waitcnt lgkmcnt(12)
    v_mfma_f32_16x16x32_bf16 v[100:103], v[36:39], v[16:19], v[100:103]
    ds_read_b128 v[64:67], v6 offset:20480
    v_mfma_f32_16x16x32_bf16 v[108:111], v[36:39], v[20:23], v[108:111]
    ds_read_b128 v[68:71], v6 offset:21504
    v_mfma_f32_16x16x32_bf16 v[116:119], v[36:39], v[24:27], v[116:119]
    ds_read_b64_tr_b16 v[76:77], v8 offset:20480
    v_mfma_f32_16x16x32_bf16 v[124:127], v[36:39], v[28:31], v[124:127]
    ds_read_b64_tr_b16 v[78:79], v8 offset:20992
    s_waitcnt lgkmcnt(14)
    v_mfma_f32_16x16x32_bf16 v[128:131], v[40:43], v[16:19], v[128:131]
    ds_read_b64_tr_b16 v[80:81], v7 offset:28672
    v_mfma_f32_16x16x32_bf16 v[136:139], v[40:43], v[20:23], v[136:139]
    ds_read_b64_tr_b16 v[82:83], v7 offset:29184
    v_mfma_f32_16x16x32_bf16 v[144:147], v[40:43], v[24:27], v[144:147]
    ds_read_b64_tr_b16 v[84:85], v8 offset:28672
    v_mfma_f32_16x16x32_bf16 v[152:155], v[40:43], v[28:31], v[152:155]
    ds_read_b64_tr_b16 v[86:87], v8 offset:29184
    s_waitcnt lgkmcnt(15)
    v_mfma_f32_16x16x32_bf16 v[132:135], v[44:47], v[16:19], v[132:135]
    ds_read_b64_tr_b16 v[88:89], v9 offset:12288
    v_mfma_f32_16x16x32_bf16 v[140:143], v[44:47], v[20:23], v[140:143]
    ds_read_b64_tr_b16 v[90:91], v9 offset:12800
    v_mfma_f32_16x16x32_bf16 v[148:151], v[44:47], v[24:27], v[148:151]
    ds_read_b64_tr_b16 v[92:93], v10 offset:12288
    v_mfma_f32_16x16x32_bf16 v[156:159], v[44:47], v[28:31], v[156:159]
    ds_read_b64_tr_b16 v[94:95], v10 offset:12800
    s_waitcnt lgkmcnt(15)
    v_mfma_f32_16x16x32_bf16 v[160:163], v[48:51], v[16:19], v[160:163]
    v_mfma_f32_16x16x32_bf16 v[168:171], v[48:51], v[20:23], v[168:171]
    v_mfma_f32_16x16x32_bf16 v[176:179], v[48:51], v[24:27], v[176:179]
    v_mfma_f32_16x16x32_bf16 v[184:187], v[48:51], v[28:31], v[184:187]
    v_mfma_f32_16x16x32_bf16 v[164:167], v[52:55], v[16:19], v[164:167]
    v_mfma_f32_16x16x32_bf16 v[172:175], v[52:55], v[20:23], v[172:175]
    v_mfma_f32_16x16x32_bf16 v[180:183], v[52:55], v[24:27], v[180:183]
    v_mfma_f32_16x16x32_bf16 v[188:191], v[52:55], v[28:31], v[188:191]
    s_waitcnt lgkmcnt(13)
    v_mfma_f32_16x16x32_bf16 v[96:99], v[72:75], v[56:59], v[96:99]
    s_waitcnt lgkmcnt(12)
    v_mfma_f32_16x16x32_bf16 v[104:107], v[72:75], v[60:63], v[104:107]
    s_waitcnt lgkmcnt(0)
    s_barrier
    ds_read_b128 v[16:19], v5 offset:32768
    v_mfma_f32_16x16x32_bf16 v[112:115], v[72:75], v[64:67], v[112:115]
    ds_read_b64_tr_b16 v[32:33], v7 offset:32768
    v_mfma_f32_16x16x32_bf16 v[120:123], v[72:75], v[68:71], v[120:123]
    ds_read_b64_tr_b16 v[34:35], v7 offset:33280
    v_mfma_f32_16x16x32_bf16 v[100:103], v[76:79], v[56:59], v[100:103]
    ds_read_b128 v[20:23], v5 offset:33792
    v_mfma_f32_16x16x32_bf16 v[108:111], v[76:79], v[60:63], v[108:111]
    ds_read_b128 v[24:27], v5 offset:36864
    v_mfma_f32_16x16x32_bf16 v[116:119], v[76:79], v[64:67], v[116:119]
    ds_read_b128 v[28:31], v5 offset:37888
    v_mfma_f32_16x16x32_bf16 v[124:127], v[76:79], v[68:71], v[124:127]
    ds_read_b64_tr_b16 v[36:37], v8 offset:32768
    v_mfma_f32_16x16x32_bf16 v[128:131], v[80:83], v[56:59], v[128:131]
    ds_read_b64_tr_b16 v[38:39], v8 offset:33280
    v_mfma_f32_16x16x32_bf16 v[136:139], v[80:83], v[60:63], v[136:139]
    ds_read_b64_tr_b16 v[40:41], v7 offset:40960
    v_mfma_f32_16x16x32_bf16 v[144:147], v[80:83], v[64:67], v[144:147]
    ds_read_b64_tr_b16 v[42:43], v7 offset:41472
    v_mfma_f32_16x16x32_bf16 v[152:155], v[80:83], v[68:71], v[152:155]
    ds_read_b64_tr_b16 v[44:45], v8 offset:40960
    v_mfma_f32_16x16x32_bf16 v[132:135], v[84:87], v[56:59], v[132:135]
    ds_read_b64_tr_b16 v[46:47], v8 offset:41472
    v_mfma_f32_16x16x32_bf16 v[140:143], v[84:87], v[60:63], v[140:143]
    ds_read_b64_tr_b16 v[48:49], v9 offset:16384
    v_mfma_f32_16x16x32_bf16 v[148:151], v[84:87], v[64:67], v[148:151]
    ds_read_b64_tr_b16 v[50:51], v9 offset:16896
    v_mfma_f32_16x16x32_bf16 v[156:159], v[84:87], v[68:71], v[156:159]
    ds_read_b64_tr_b16 v[52:53], v10 offset:16384
    v_mfma_f32_16x16x32_bf16 v[160:163], v[88:91], v[56:59], v[160:163]
    ds_read_b64_tr_b16 v[54:55], v10 offset:16896
    v_mfma_f32_16x16x32_bf16 v[168:171], v[88:91], v[60:63], v[168:171]
    v_mfma_f32_16x16x32_bf16 v[176:179], v[88:91], v[64:67], v[176:179]
    v_mfma_f32_16x16x32_bf16 v[184:187], v[88:91], v[68:71], v[184:187]
    v_mfma_f32_16x16x32_bf16 v[164:167], v[92:95], v[56:59], v[164:167]
    v_mfma_f32_16x16x32_bf16 v[172:175], v[92:95], v[60:63], v[172:175]
    v_mfma_f32_16x16x32_bf16 v[180:183], v[92:95], v[64:67], v[180:183]
    v_mfma_f32_16x16x32_bf16 v[188:191], v[92:95], v[68:71], v[188:191]
    s_waitcnt lgkmcnt(13)
    v_mfma_f32_16x16x32_bf16 v[96:99], v[32:35], v[16:19], v[96:99]
    ds_read_b128 v[56:59], v6 offset:32768
    s_waitcnt lgkmcnt(13)
    v_mfma_f32_16x16x32_bf16 v[104:107], v[32:35], v[20:23], v[104:107]
    ds_read_b64_tr_b16 v[72:73], v7 offset:36864
    s_waitcnt lgkmcnt(13)
    v_mfma_f32_16x16x32_bf16 v[112:115], v[32:35], v[24:27], v[112:115]
    ds_read_b64_tr_b16 v[74:75], v7 offset:37376
    s_waitcnt lgkmcnt(13)
    v_mfma_f32_16x16x32_bf16 v[120:123], v[32:35], v[28:31], v[120:123]
    ds_read_b128 v[60:63], v6 offset:33792
    s_waitcnt lgkmcnt(12)
    v_mfma_f32_16x16x32_bf16 v[100:103], v[36:39], v[16:19], v[100:103]
    ds_read_b128 v[64:67], v6 offset:36864
    v_mfma_f32_16x16x32_bf16 v[108:111], v[36:39], v[20:23], v[108:111]
    ds_read_b128 v[68:71], v6 offset:37888
    v_mfma_f32_16x16x32_bf16 v[116:119], v[36:39], v[24:27], v[116:119]
    ds_read_b64_tr_b16 v[76:77], v8 offset:36864
    v_mfma_f32_16x16x32_bf16 v[124:127], v[36:39], v[28:31], v[124:127]
    ds_read_b64_tr_b16 v[78:79], v8 offset:37376
    s_waitcnt lgkmcnt(14)
    v_mfma_f32_16x16x32_bf16 v[128:131], v[40:43], v[16:19], v[128:131]
    ds_read_b64_tr_b16 v[80:81], v7 offset:45056
    v_mfma_f32_16x16x32_bf16 v[136:139], v[40:43], v[20:23], v[136:139]
    ds_read_b64_tr_b16 v[82:83], v7 offset:45568
    v_mfma_f32_16x16x32_bf16 v[144:147], v[40:43], v[24:27], v[144:147]
    ds_read_b64_tr_b16 v[84:85], v8 offset:45056
    v_mfma_f32_16x16x32_bf16 v[152:155], v[40:43], v[28:31], v[152:155]
    ds_read_b64_tr_b16 v[86:87], v8 offset:45568
    s_waitcnt lgkmcnt(15)
    v_mfma_f32_16x16x32_bf16 v[132:135], v[44:47], v[16:19], v[132:135]
    ds_read_b64_tr_b16 v[88:89], v9 offset:20480
    v_mfma_f32_16x16x32_bf16 v[140:143], v[44:47], v[20:23], v[140:143]
    ds_read_b64_tr_b16 v[90:91], v9 offset:20992
    v_mfma_f32_16x16x32_bf16 v[148:151], v[44:47], v[24:27], v[148:151]
    ds_read_b64_tr_b16 v[92:93], v10 offset:20480
    v_mfma_f32_16x16x32_bf16 v[156:159], v[44:47], v[28:31], v[156:159]
    ds_read_b64_tr_b16 v[94:95], v10 offset:20992
    s_waitcnt lgkmcnt(15)
    v_mfma_f32_16x16x32_bf16 v[160:163], v[48:51], v[16:19], v[160:163]
    v_mfma_f32_16x16x32_bf16 v[168:171], v[48:51], v[20:23], v[168:171]
    v_mfma_f32_16x16x32_bf16 v[176:179], v[48:51], v[24:27], v[176:179]
    v_mfma_f32_16x16x32_bf16 v[184:187], v[48:51], v[28:31], v[184:187]
    v_mfma_f32_16x16x32_bf16 v[164:167], v[52:55], v[16:19], v[164:167]
    v_mfma_f32_16x16x32_bf16 v[172:175], v[52:55], v[20:23], v[172:175]
    v_mfma_f32_16x16x32_bf16 v[180:183], v[52:55], v[24:27], v[180:183]
    v_mfma_f32_16x16x32_bf16 v[188:191], v[52:55], v[28:31], v[188:191]
    s_waitcnt lgkmcnt(13)
    v_mfma_f32_16x16x32_bf16 v[96:99], v[72:75], v[56:59], v[96:99]
    s_waitcnt lgkmcnt(12)
    v_mfma_f32_16x16x32_bf16 v[104:107], v[72:75], v[60:63], v[104:107]
    s_waitcnt lgkmcnt(0)
    s_barrier
    ds_read_b128 v[16:19], v5 offset:49152
    v_mfma_f32_16x16x32_bf16 v[112:115], v[72:75], v[64:67], v[112:115]
    ds_read_b64_tr_b16 v[32:33], v7 offset:49152
    v_mfma_f32_16x16x32_bf16 v[120:123], v[72:75], v[68:71], v[120:123]
    ds_read_b64_tr_b16 v[34:35], v7 offset:49664
    v_mfma_f32_16x16x32_bf16 v[100:103], v[76:79], v[56:59], v[100:103]
    ds_read_b128 v[20:23], v5 offset:50176
    v_mfma_f32_16x16x32_bf16 v[108:111], v[76:79], v[60:63], v[108:111]
    ds_read_b128 v[24:27], v5 offset:53248
    v_mfma_f32_16x16x32_bf16 v[116:119], v[76:79], v[64:67], v[116:119]
    ds_read_b128 v[28:31], v5 offset:54272
    v_mfma_f32_16x16x32_bf16 v[124:127], v[76:79], v[68:71], v[124:127]
    ds_read_b64_tr_b16 v[36:37], v8 offset:49152
    v_mfma_f32_16x16x32_bf16 v[128:131], v[80:83], v[56:59], v[128:131]
    ds_read_b64_tr_b16 v[38:39], v8 offset:49664
    v_mfma_f32_16x16x32_bf16 v[136:139], v[80:83], v[60:63], v[136:139]
    ds_read_b64_tr_b16 v[40:41], v7 offset:57344
    v_mfma_f32_16x16x32_bf16 v[144:147], v[80:83], v[64:67], v[144:147]
    ds_read_b64_tr_b16 v[42:43], v7 offset:57856
    v_mfma_f32_16x16x32_bf16 v[152:155], v[80:83], v[68:71], v[152:155]
    ds_read_b64_tr_b16 v[44:45], v8 offset:57344
    v_mfma_f32_16x16x32_bf16 v[132:135], v[84:87], v[56:59], v[132:135]
    ds_read_b64_tr_b16 v[46:47], v8 offset:57856
    v_mfma_f32_16x16x32_bf16 v[140:143], v[84:87], v[60:63], v[140:143]
    ds_read_b64_tr_b16 v[48:49], v9 offset:24576
    v_mfma_f32_16x16x32_bf16 v[148:151], v[84:87], v[64:67], v[148:151]
    ds_read_b64_tr_b16 v[50:51], v9 offset:25088
    v_mfma_f32_16x16x32_bf16 v[156:159], v[84:87], v[68:71], v[156:159]
    ds_read_b64_tr_b16 v[52:53], v10 offset:24576
    v_mfma_f32_16x16x32_bf16 v[160:163], v[88:91], v[56:59], v[160:163]
    ds_read_b64_tr_b16 v[54:55], v10 offset:25088
    v_mfma_f32_16x16x32_bf16 v[168:171], v[88:91], v[60:63], v[168:171]
    v_mfma_f32_16x16x32_bf16 v[176:179], v[88:91], v[64:67], v[176:179]
    v_mfma_f32_16x16x32_bf16 v[184:187], v[88:91], v[68:71], v[184:187]
    v_mfma_f32_16x16x32_bf16 v[164:167], v[92:95], v[56:59], v[164:167]
    v_mfma_f32_16x16x32_bf16 v[172:175], v[92:95], v[60:63], v[172:175]
    v_mfma_f32_16x16x32_bf16 v[180:183], v[92:95], v[64:67], v[180:183]
    v_mfma_f32_16x16x32_bf16 v[188:191], v[92:95], v[68:71], v[188:191]
    s_waitcnt lgkmcnt(13)
    v_mfma_f32_16x16x32_bf16 v[96:99], v[32:35], v[16:19], v[96:99]
    ds_read_b128 v[56:59], v6 offset:49152
    s_waitcnt lgkmcnt(13)
    v_mfma_f32_16x16x32_bf16 v[104:107], v[32:35], v[20:23], v[104:107]
    ds_read_b64_tr_b16 v[72:73], v7 offset:53248
    s_waitcnt lgkmcnt(13)
    v_mfma_f32_16x16x32_bf16 v[112:115], v[32:35], v[24:27], v[112:115]
    ds_read_b64_tr_b16 v[74:75], v7 offset:53760
    s_waitcnt lgkmcnt(13)
    v_mfma_f32_16x16x32_bf16 v[120:123], v[32:35], v[28:31], v[120:123]
    ds_read_b128 v[60:63], v6 offset:50176
    s_waitcnt lgkmcnt(12)
    v_mfma_f32_16x16x32_bf16 v[100:103], v[36:39], v[16:19], v[100:103]
    ds_read_b128 v[64:67], v6 offset:53248
    v_mfma_f32_16x16x32_bf16 v[108:111], v[36:39], v[20:23], v[108:111]
    ds_read_b128 v[68:71], v6 offset:54272
    v_mfma_f32_16x16x32_bf16 v[116:119], v[36:39], v[24:27], v[116:119]
    ds_read_b64_tr_b16 v[76:77], v8 offset:53248
    v_mfma_f32_16x16x32_bf16 v[124:127], v[36:39], v[28:31], v[124:127]
    ds_read_b64_tr_b16 v[78:79], v8 offset:53760
    s_waitcnt lgkmcnt(14)
    v_mfma_f32_16x16x32_bf16 v[128:131], v[40:43], v[16:19], v[128:131]
    ds_read_b64_tr_b16 v[80:81], v7 offset:61440
    v_mfma_f32_16x16x32_bf16 v[136:139], v[40:43], v[20:23], v[136:139]
    ds_read_b64_tr_b16 v[82:83], v7 offset:61952
    v_mfma_f32_16x16x32_bf16 v[144:147], v[40:43], v[24:27], v[144:147]
    ds_read_b64_tr_b16 v[84:85], v8 offset:61440
    v_mfma_f32_16x16x32_bf16 v[152:155], v[40:43], v[28:31], v[152:155]
    ds_read_b64_tr_b16 v[86:87], v8 offset:61952
    s_waitcnt lgkmcnt(15)
    v_mfma_f32_16x16x32_bf16 v[132:135], v[44:47], v[16:19], v[132:135]
    ds_read_b64_tr_b16 v[88:89], v9 offset:28672
    v_mfma_f32_16x16x32_bf16 v[140:143], v[44:47], v[20:23], v[140:143]
    ds_read_b64_tr_b16 v[90:91], v9 offset:29184
    v_mfma_f32_16x16x32_bf16 v[148:151], v[44:47], v[24:27], v[148:151]
    ds_read_b64_tr_b16 v[92:93], v10 offset:28672
    v_mfma_f32_16x16x32_bf16 v[156:159], v[44:47], v[28:31], v[156:159]
    ds_read_b64_tr_b16 v[94:95], v10 offset:29184
    s_waitcnt lgkmcnt(15)
    v_mfma_f32_16x16x32_bf16 v[160:163], v[48:51], v[16:19], v[160:163]
    v_mfma_f32_16x16x32_bf16 v[168:171], v[48:51], v[20:23], v[168:171]
    v_mfma_f32_16x16x32_bf16 v[176:179], v[48:51], v[24:27], v[176:179]
    v_mfma_f32_16x16x32_bf16 v[184:187], v[48:51], v[28:31], v[184:187]
    v_mfma_f32_16x16x32_bf16 v[164:167], v[52:55], v[16:19], v[164:167]
    v_mfma_f32_16x16x32_bf16 v[172:175], v[52:55], v[20:23], v[172:175]
    v_mfma_f32_16x16x32_bf16 v[180:183], v[52:55], v[24:27], v[180:183]
    v_mfma_f32_16x16x32_bf16 v[188:191], v[52:55], v[28:31], v[188:191]
    s_waitcnt lgkmcnt(13)
    v_mfma_f32_16x16x32_bf16 v[96:99], v[72:75], v[56:59], v[96:99]
    s_waitcnt lgkmcnt(12)
    v_mfma_f32_16x16x32_bf16 v[104:107], v[72:75], v[60:63], v[104:107]
    s_waitcnt lgkmcnt(0)
    s_barrier
    ds_read_b128 v[16:19], v5 offset:49152
    v_mfma_f32_16x16x32_bf16 v[112:115], v[72:75], v[64:67], v[112:115]
    ds_read_b64_tr_b16 v[32:33], v7 offset:0
    v_mfma_f32_16x16x32_bf16 v[120:123], v[72:75], v[68:71], v[120:123]
    ds_read_b64_tr_b16 v[34:35], v7 offset:512
    v_mfma_f32_16x16x32_bf16 v[100:103], v[76:79], v[56:59], v[100:103]
    ds_read_b128 v[20:23], v5 offset:50176
    v_mfma_f32_16x16x32_bf16 v[108:111], v[76:79], v[60:63], v[108:111]
    ds_read_b128 v[24:27], v5 offset:53248
    v_mfma_f32_16x16x32_bf16 v[116:119], v[76:79], v[64:67], v[116:119]
    ds_read_b128 v[28:31], v5 offset:54272
    v_mfma_f32_16x16x32_bf16 v[124:127], v[76:79], v[68:71], v[124:127]
    ds_read_b64_tr_b16 v[36:37], v8 offset:0
    v_mfma_f32_16x16x32_bf16 v[128:131], v[80:83], v[56:59], v[128:131]
    ds_read_b64_tr_b16 v[38:39], v8 offset:512
    v_mfma_f32_16x16x32_bf16 v[136:139], v[80:83], v[60:63], v[136:139]
    ds_read_b64_tr_b16 v[40:41], v7 offset:8192
    v_mfma_f32_16x16x32_bf16 v[144:147], v[80:83], v[64:67], v[144:147]
    ds_read_b64_tr_b16 v[42:43], v7 offset:8704
    v_mfma_f32_16x16x32_bf16 v[152:155], v[80:83], v[68:71], v[152:155]
    ds_read_b64_tr_b16 v[44:45], v8 offset:8192
    v_mfma_f32_16x16x32_bf16 v[132:135], v[84:87], v[56:59], v[132:135]
    ds_read_b64_tr_b16 v[46:47], v8 offset:8704
    v_mfma_f32_16x16x32_bf16 v[140:143], v[84:87], v[60:63], v[140:143]
    v_mfma_f32_16x16x32_bf16 v[148:151], v[84:87], v[64:67], v[148:151]
    v_mfma_f32_16x16x32_bf16 v[156:159], v[84:87], v[68:71], v[156:159]
    v_mfma_f32_16x16x32_bf16 v[160:163], v[88:91], v[56:59], v[160:163]
    v_mfma_f32_16x16x32_bf16 v[168:171], v[88:91], v[60:63], v[168:171]
    v_mfma_f32_16x16x32_bf16 v[176:179], v[88:91], v[64:67], v[176:179]
    v_mfma_f32_16x16x32_bf16 v[184:187], v[88:91], v[68:71], v[184:187]
    v_mfma_f32_16x16x32_bf16 v[164:167], v[92:95], v[56:59], v[164:167]
    v_mfma_f32_16x16x32_bf16 v[172:175], v[92:95], v[60:63], v[172:175]
    v_mfma_f32_16x16x32_bf16 v[180:183], v[92:95], v[64:67], v[180:183]
    v_mfma_f32_16x16x32_bf16 v[188:191], v[92:95], v[68:71], v[188:191]
    s_cmp_eq_u32 s47, 3
    s_cbranch_scc1 K1_FQ
    s_waitcnt vmcnt(0)
NL_29:
    v_readfirstlane_b32 s94, v15
    s_cmp_lg_u32 s94, 0
    s_cbranch_scc1 ND_30
    s_sub_u32 s3, s3, 32
    s_cmp_lt_i32 s3, 0
    s_cbranch_scc1 ND_30
    s_sleep 4
    buffer_load_dword v15, v0, s[36:39], 0 offen sc1
    s_waitcnt vmcnt(0)
    s_branch NL_29
ND_30:
    s_mov_b32 s74, 0
    s_waitcnt lgkmcnt(9)
    v_mfma_f32_16x16x32_bf16 v[192:195], v[32:35], v[16:19], 0
    ds_read_b128 v[56:59], v6 offset:49152
    s_waitcnt lgkmcnt(9)
    v_mfma_f32_16x16x32_bf16 v[200:203], v[32:35], v[20:23], 0
    ds_read_b64_tr_b16 v[72:73], v7 offset:4096
    s_waitcnt lgkmcnt(9)
    v_mfma_f32_16x16x32_bf16 v[208:211], v[32:35], v[24:27], 0
    ds_read_b64_tr_b16 v[74:75], v7 offset:4608
    v_cvt_pk_bf16_f32 v160, v160, v161
    v_cvt_pk_bf16_f32 v161, v162, v163
    v_cvt_pk_bf16_f32 v162, v164, v165
    v_cvt_pk_bf16_f32 v163, v166, v167
    v_cvt_pk_bf16_f32 v168, v168, v169
    s_waitcnt lgkmcnt(9)
    v_mfma_f32_16x16x32_bf16 v[216:219], v[32:35], v[28:31], 0
    ds_read_b128 v[60:63], v6 offset:50176
    v_cvt_pk_bf16_f32 v169, v170, v171
    v_cvt_pk_bf16_f32 v170, v172, v173
    v_cvt_pk_bf16_f32 v171, v174, v175
    v_permlane32_swap_b32 v160, v168
    v_permlane32_swap_b32 v161, v169
    s_waitcnt lgkmcnt(8)
    v_mfma_f32_16x16x32_bf16 v[196:199], v[36:39], v[16:19], 0
    ds_read_b128 v[64:67], v6 offset:53248
    v_permlane32_swap_b32 v162, v170
    v_permlane32_swap_b32 v163, v171
    buffer_store_dwordx4 v[160:163], v3, s[28:31], s68 offen offset:0 sc1
    buffer_store_dwordx4 v[168:171], v2, s[28:31], s68 offen offset:0 sc1
    v_cvt_pk_bf16_f32 v176, v176, v177
    v_mfma_f32_16x16x32_bf16 v[204:207], v[36:39], v[20:23], 0
    ds_read_b128 v[68:71], v6 offset:54272
    v_cvt_pk_bf16_f32 v177, v178, v179
    v_cvt_pk_bf16_f32 v178, v180, v181
    v_cvt_pk_bf16_f32 v179, v182, v183
    v_cvt_pk_bf16_f32 v184, v184, v185
    v_cvt_pk_bf16_f32 v185, v186, v187
    v_mfma_f32_16x16x32_bf16 v[212:215], v[36:39], v[24:27], 0
    ds_read_b64_tr_b16 v[76:77], v8 offset:4096
    v_cvt_pk_bf16_f32 v186, v188, v189
    v_cvt_pk_bf16_f32 v187, v190, v191
    v_permlane32_swap_b32 v176, v184
    v_permlane32_swap_b32 v177, v185
    v_permlane32_swap_b32 v178, v186
    v_mfma_f32_16x16x32_bf16 v[220:223], v[36:39], v[28:31], 0
    ds_read_b64_tr_b16 v[78:79], v8 offset:4608
    v_permlane32_swap_b32 v179, v187
    buffer_store_dwordx4 v[176:179], v3, s[28:31], s68 offen offset:1024 sc1
    buffer_store_dwordx4 v[184:187], v2, s[28:31], s68 offen offset:1024 sc1
    v_mul_f32 v96, v96, v128
    v_mul_f32 v97, v97, v129
    s_waitcnt lgkmcnt(10)
    v_mfma_f32_16x16x32_bf16 v[224:227], v[40:43], v[16:19], 0
    ds_read_b64_tr_b16 v[80:81], v7 offset:12288
    v_mfma_f32_16x16x32_bf16 v[232:235], v[40:43], v[20:23], 0
    ds_read_b64_tr_b16 v[82:83], v7 offset:12800
    v_mfma_f32_16x16x32_bf16 v[240:243], v[40:43], v[24:27], 0
    ds_read_b64_tr_b16 v[84:85], v8 offset:12288
    v_mfma_f32_16x16x32_bf16 v[248:251], v[40:43], v[28:31], 0
    ds_read_b64_tr_b16 v[86:87], v8 offset:12800
    s_getreg_b32 s52, hwreg(HW_REG_IB_STS, 0, 4)
    s_add_u32 s52, s52, s74
    s_cmp_le_u32 s52, 0
    s_cbranch_scc0 FK_31_r
    s_waitcnt vmcnt(0)
    s_mov_b64 exec, 1
    buffer_store_dword v15, v11, s[28:31], s70 offen sc1
    s_mov_b64 exec, -1
    s_mov_b32 s74, 64
FK_31_r:
    s_waitcnt lgkmcnt(12)
    v_mfma_f32_16x16x32_bf16 v[228:231], v[44:47], v[16:19], 0
    v_mfma_f32_16x16x32_bf16 v[236:239], v[44:47], v[20:23], 0
    v_mfma_f32_16x16x32_bf16 v[244:247], v[44:47], v[24:27], 0
    v_mfma_f32_16x16x32_bf16 v[252:255], v[44:47], v[28:31], 0
    s_waitcnt lgkmcnt(9)
    v_mfma_f32_16x16x32_bf16 v[192:195], v[72:75], v[56:59], v[192:195]
    s_waitcnt lgkmcnt(8)
    v_mfma_f32_16x16x32_bf16 v[200:203], v[72:75], v[60:63], v[200:203]
    s_waitcnt lgkmcnt(0)
    s_barrier
    ds_read_b128 v[16:19], v5 offset:32768
    v_mfma_f32_16x16x32_bf16 v[208:211], v[72:75], v[64:67], v[208:211]
    ds_read_b64_tr_b16 v[32:33], v7 offset:16384
    v_mul_f32 v98, v98, v130
    v_mfma_f32_16x16x32_bf16 v[216:219], v[72:75], v[68:71], v[216:219]
    ds_read_b64_tr_b16 v[34:35], v7 offset:16896
    v_mul_f32 v99, v99, v131
    s_getreg_b32 s52, hwreg(HW_REG_IB_STS, 0, 4)
    s_add_u32 s52, s52, s74
    s_cmp_le_u32 s52, 0
    s_cbranch_scc0 FK_32_r
    s_waitcnt vmcnt(0)
    s_mov_b64 exec, 1
    buffer_store_dword v15, v11, s[28:31], s70 offen sc1
    s_mov_b64 exec, -1
    s_mov_b32 s74, 64
FK_32_r:
    v_mfma_f32_16x16x32_bf16 v[196:199], v[76:79], v[56:59], v[196:199]
    ds_read_b128 v[20:23], v5 offset:33792
    v_mul_f32 v100, v100, v132
    v_mfma_f32_16x16x32_bf16 v[204:207], v[76:79], v[60:63], v[204:207]
    ds_read_b128 v[24:27], v5 offset:36864
    v_mul_f32 v101, v101, v133
    v_mfma_f32_16x16x32_bf16 v[212:215], v[76:79], v[64:67], v[212:215]
    ds_read_b128 v[28:31], v5 offset:37888
    v_mul_f32 v102, v102, v134
    v_mfma_f32_16x16x32_bf16 v[220:223], v[76:79], v[68:71], v[220:223]
    ds_read_b64_tr_b16 v[36:37], v8 offset:16384
    v_mul_f32 v103, v103, v135
    v_mfma_f32_16x16x32_bf16 v[224:227], v[80:83], v[56:59], v[224:227]
    ds_read_b64_tr_b16 v[38:39], v8 offset:16896
    v_cvt_pk_bf16_f32 v96, v96, v97
    v_mfma_f32_16x16x32_bf16 v[232:235], v[80:83], v[60:63], v[232:235]
    ds_read_b64_tr_b16 v[40:41], v7 offset:24576
    v_cvt_pk_bf16_f32 v97, v98, v99
    v_mfma_f32_16x16x32_bf16 v[240:243], v[80:83], v[64:67], v[240:243]
    ds_read_b64_tr_b16 v[42:43], v7 offset:25088
    v_cvt_pk_bf16_f32 v98, v100, v101
    v_mfma_f32_16x16x32_bf16 v[248:251], v[80:83], v[68:71], v[248:251]
    ds_read_b64_tr_b16 v[44:45], v8 offset:24576
    v_cvt_pk_bf16_f32 v99, v102, v103
    s_getreg_b32 s52, hwreg(HW_REG_IB_STS, 0, 4)
    s_add_u32 s52, s52, s74
    s_cmp_le_u32 s52, 0
    s_cbranch_scc0 FK_33_r
    s_waitcnt vmcnt(0)
    s_mov_b64 exec, 1
    buffer_store_dword v15, v11, s[28:31], s70 offen sc1
    s_mov_b64 exec, -1
    s_mov_b32 s74, 64
FK_33_r:
    v_mfma_f32_16x16x32_bf16 v[228:231], v[84:87], v[56:59], v[228:231]
    ds_read_b64_tr_b16 v[46:47], v8 offset:25088
    v_mul_f32 v104, v104, v136
    v_mfma_f32_16x16x32_bf16 v[236:239], v[84:87], v[60:63], v[236:239]
    v_mul_f32 v105, v105, v137
    v_mul_f32 v106, v106, v138
    v_mfma_f32_16x16x32_bf16 v[244:247], v[84:87], v[64:67], v[244:247]
    v_mul_f32 v107, v107, v139
    v_mul_f32 v108, v108, v140
    v_mfma_f32_16x16x32_bf16 v[252:255], v[84:87], v[68:71], v[252:255]
    v_mul_f32 v109, v109, v141
    v_mul_f32 v110, v110, v142
    s_waitcnt lgkmcnt(9)
    v_mfma_f32_16x16x32_bf16 v[192:195], v[32:35], v[16:19], v[192:195]
    ds_read_b128 v[56:59], v6 offset:32768
    s_waitcnt lgkmcnt(9)
    v_mfma_f32_16x16x32_bf16 v[200:203], v[32:35], v[20:23], v[200:203]
    ds_read_b64_tr_b16 v[72:73], v7 offset:20480
    s_waitcnt lgkmcnt(9)
    v_mfma_f32_16x16x32_bf16 v[208:211], v[32:35], v[24:27], v[208:211]
    ds_read_b64_tr_b16 v[74:75], v7 offset:20992
    v_mul_f32 v111, v111, v143
    s_waitcnt lgkmcnt(9)
    v_mfma_f32_16x16x32_bf16 v[216:219], v[32:35], v[28:31], v[216:219]
    ds_read_b128 v[60:63], v6 offset:33792
    v_cvt_pk_bf16_f32 v104, v104, v105
    s_getreg_b32 s52, hwreg(HW_REG_IB_STS, 0, 4)
    s_add_u32 s52, s52, s74
    s_cmp_le_u32 s52, 0
    s_cbranch_scc0 FK_34_r
    s_waitcnt vmcnt(0)
    s_mov_b64 exec, 1
    buffer_store_dword v15, v11, s[28:31], s70 offen sc1
    s_mov_b64 exec, -1
    s_mov_b32 s74, 64
FK_34_r:
    s_waitcnt lgkmcnt(8)
    v_mfma_f32_16x16x32_bf16 v[196:199], v[36:39], v[16:19], v[196:199]
    ds_read_b128 v[64:67], v6 offset:36864
    v_cvt_pk_bf16_f32 v105, v106, v107
    v_mfma_f32_16x16x32_bf16 v[204:207], v[36:39], v[20:23], v[204:207]
    ds_read_b128 v[68:71], v6 offset:37888
    v_cvt_pk_bf16_f32 v106, v108, v109
    v_mfma_f32_16x16x32_bf16 v[212:215], v[36:39], v[24:27], v[212:215]
    ds_read_b64_tr_b16 v[76:77], v8 offset:20480
    v_cvt_pk_bf16_f32 v107, v110, v111
    v_mfma_f32_16x16x32_bf16 v[220:223], v[36:39], v[28:31], v[220:223]
    ds_read_b64_tr_b16 v[78:79], v8 offset:20992
    v_permlane32_swap_b32 v96, v104
    s_waitcnt lgkmcnt(10)
    v_mfma_f32_16x16x32_bf16 v[224:227], v[40:43], v[16:19], v[224:227]
    ds_read_b64_tr_b16 v[80:81], v7 offset:28672
    v_permlane32_swap_b32 v97, v105
    v_mfma_f32_16x16x32_bf16 v[232:235], v[40:43], v[20:23], v[232:235]
    ds_read_b64_tr_b16 v[82:83], v7 offset:29184
    v_permlane32_swap_b32 v98, v106
    v_mfma_f32_16x16x32_bf16 v[240:243], v[40:43], v[24:27], v[240:243]
    ds_read_b64_tr_b16 v[84:85], v8 offset:28672
    v_permlane32_swap_b32 v99, v107
    v_mfma_f32_16x16x32_bf16 v[248:251], v[40:43], v[28:31], v[248:251]
    ds_read_b64_tr_b16 v[86:87], v8 offset:29184
    s_getreg_b32 s52, hwreg(HW_REG_IB_STS, 0, 4)
    s_add_u32 s52, s52, s74
    s_cmp_le_u32 s52, 0
    s_cbranch_scc0 FK_35_r
    s_waitcnt vmcnt(0)
    s_mov_b64 exec, 1
    buffer_store_dword v15, v11, s[28:31], s70 offen sc1
    s_mov_b64 exec, -1
    s_mov_b32 s74, 64
FK_35_r:
    s_waitcnt lgkmcnt(12)
    v_mfma_f32_16x16x32_bf16 v[228:231], v[44:47], v[16:19], v[228:231]
    v_mfma_f32_16x16x32_bf16 v[236:239], v[44:47], v[20:23], v[236:239]
    v_mfma_f32_16x16x32_bf16 v[244:247], v[44:47], v[24:27], v[244:247]
    v_mfma_f32_16x16x32_bf16 v[252:255], v[44:47], v[28:31], v[252:255]
    s_waitcnt lgkmcnt(9)
    v_mfma_f32_16x16x32_bf16 v[192:195], v[72:75], v[56:59], v[192:195]
    s_waitcnt lgkmcnt(8)
    v_mfma_f32_16x16x32_bf16 v[200:203], v[72:75], v[60:63], v[200:203]
    s_waitcnt lgkmcnt(0)
    s_barrier
    ds_read_b128 v[16:19], v5 offset:16384
    v_mfma_f32_16x16x32_bf16 v[208:211], v[72:75], v[64:67], v[208:211]
    ds_read_b64_tr_b16 v[32:33], v7 offset:32768
    v_mfma_f32_16x16x32_bf16 v[216:219], v[72:75], v[68:71], v[216:219]
    ds_read_b64_tr_b16 v[34:35], v7 offset:33280
    s_getreg_b32 s52, hwreg(HW_REG_IB_STS, 0, 4)
    s_add_u32 s52, s52, s74
    s_cmp_le_u32 s52, 0
    s_cbranch_scc0 FK_36_r
    s_waitcnt vmcnt(0)
    s_mov_b64 exec, 1
    buffer_store_dword v15, v11, s[28:31], s70 offen sc1
    s_mov_b64 exec, -1
    s_mov_b32 s74, 64
FK_36_r:
    v_mfma_f32_16x16x32_bf16 v[196:199], v[76:79], v[56:59], v[196:199]
    ds_read_b128 v[20:23], v5 offset:17408
    v_mfma_f32_16x16x32_bf16 v[204:207], v[76:79], v[60:63], v[204:207]
    ds_read_b128 v[24:27], v5 offset:20480
    v_mfma_f32_16x16x32_bf16 v[212:215], v[76:79], v[64:67], v[212:215]
    ds_read_b128 v[28:31], v5 offset:21504
    v_mfma_f32_16x16x32_bf16 v[220:223], v[76:79], v[68:71], v[220:223]
    ds_read_b64_tr_b16 v[36:37], v8 offset:32768
    v_mfma_f32_16x16x32_bf16 v[224:227], v[80:83], v[56:59], v[224:227]
    ds_read_b64_tr_b16 v[38:39], v8 offset:33280
    v_mfma_f32_16x16x32_bf16 v[232:235], v[80:83], v[60:63], v[232:235]
    ds_read_b64_tr_b16 v[40:41], v7 offset:40960
    v_mfma_f32_16x16x32_bf16 v[240:243], v[80:83], v[64:67], v[240:243]
    ds_read_b64_tr_b16 v[42:43], v7 offset:41472
    v_mfma_f32_16x16x32_bf16 v[248:251], v[80:83], v[68:71], v[248:251]
    ds_read_b64_tr_b16 v[44:45], v8 offset:40960
    s_getreg_b32 s52, hwreg(HW_REG_IB_STS, 0, 4)
    s_add_u32 s52, s52, s74
    s_cmp_le_u32 s52, 0
    s_cbranch_scc0 FK_37_r
    s_waitcnt vmcnt(0)
    s_mov_b64 exec, 1
    buffer_store_dword v15, v11, s[28:31], s70 offen sc1
    s_mov_b64 exec, -1
    s_mov_b32 s74, 64
FK_37_r:
    v_mfma_f32_16x16x32_bf16 v[228:231], v[84:87], v[56:59], v[228:231]
    ds_read_b64_tr_b16 v[46:47], v8 offset:41472
    v_mfma_f32_16x16x32_bf16 v[236:239], v[84:87], v[60:63], v[236:239]
    v_mfma_f32_16x16x32_bf16 v[244:247], v[84:87], v[64:67], v[244:247]
    v_mfma_f32_16x16x32_bf16 v[252:255], v[84:87], v[68:71], v[252:255]
    s_waitcnt lgkmcnt(9)
    v_mfma_f32_16x16x32_bf16 v[192:195], v[32:35], v[16:19], v[192:195]
    ds_read_b128 v[56:59], v6 offset:16384
    s_waitcnt lgkmcnt(9)
    v_mfma_f32_16x16x32_bf16 v[200:203], v[32:35], v[20:23], v[200:203]
    ds_read_b64_tr_b16 v[72:73], v7 offset:36864
    s_waitcnt lgkmcnt(9)
    v_mfma_f32_16x16x32_bf16 v[208:211], v[32:35], v[24:27], v[208:211]
    ds_read_b64_tr_b16 v[74:75], v7 offset:37376
    s_waitcnt lgkmcnt(9)
    v_mfma_f32_16x16x32_bf16 v[216:219], v[32:35], v[28:31], v[216:219]
    ds_read_b128 v[60:63], v6 offset:17408
    s_getreg_b32 s52, hwreg(HW_REG_IB_STS, 0, 4)
    s_add_u32 s52, s52, s74
    s_cmp_le_u32 s52, 0
    s_cbranch_scc0 FK_38_r
    s_waitcnt vmcnt(0)
    s_mov_b64 exec, 1
    buffer_store_dword v15, v11, s[28:31], s70 offen sc1
    s_mov_b64 exec, -1
    s_mov_b32 s74, 64
FK_38_r:
    s_waitcnt lgkmcnt(8)
    v_mfma_f32_16x16x32_bf16 v[196:199], v[36:39], v[16:19], v[196:199]
    ds_read_b128 v[64:67], v6 offset:20480
    v_mfma_f32_16x16x32_bf16 v[204:207], v[36:39], v[20:23], v[204:207]
    ds_read_b128 v[68:71], v6 offset:21504
    v_mfma_f32_16x16x32_bf16 v[212:215], v[36:39], v[24:27], v[212:215]
    ds_read_b64_tr_b16 v[76:77], v8 offset:36864
    v_mfma_f32_16x16x32_bf16 v[220:223], v[36:39], v[28:31], v[220:223]
    ds_read_b64_tr_b16 v[78:79], v8 offset:37376
    s_waitcnt lgkmcnt(10)
    v_mfma_f32_16x16x32_bf16 v[224:227], v[40:43], v[16:19], v[224:227]
    ds_read_b64_tr_b16 v[80:81], v7 offset:45056
    v_mfma_f32_16x16x32_bf16 v[232:235], v[40:43], v[20:23], v[232:235]
    ds_read_b64_tr_b16 v[82:83], v7 offset:45568
    v_mfma_f32_16x16x32_bf16 v[240:243], v[40:43], v[24:27], v[240:243]
    ds_read_b64_tr_b16 v[84:85], v8 offset:45056
    v_mfma_f32_16x16x32_bf16 v[248:251], v[40:43], v[28:31], v[248:251]
    ds_read_b64_tr_b16 v[86:87], v8 offset:45568
    s_getreg_b32 s52, hwreg(HW_REG_IB_STS, 0, 4)
    s_add_u32 s52, s52, s74
    s_cmp_le_u32 s52, 0
    s_cbranch_scc0 FK_39_r
    s_waitcnt vmcnt(0)
    s_mov_b64 exec, 1
    buffer_store_dword v15, v11, s[28:31], s70 offen sc1
    s_mov_b64 exec, -1
    s_mov_b32 s74, 64
FK_39_r:
    s_waitcnt lgkmcnt(12)
    v_mfma_f32_16x16x32_bf16 v[228:231], v[44:47], v[16:19], v[228:231]
    v_mfma_f32_16x16x32_bf16 v[236:239], v[44:47], v[20:23], v[236:239]
    v_mfma_f32_16x16x32_bf16 v[244:247], v[44:47], v[24:27], v[244:247]
    v_mfma_f32_16x16x32_bf16 v[252:255], v[44:47], v[28:31], v[252:255]
    s_waitcnt lgkmcnt(9)
    v_mfma_f32_16x16x32_bf16 v[192:195], v[72:75], v[56:59], v[192:195]
    s_waitcnt lgkmcnt(8)
    v_mfma_f32_16x16x32_bf16 v[200:203], v[72:75], v[60:63], v[200:203]
    s_waitcnt lgkmcnt(0)
    s_barrier
    ds_read_b128 v[16:19], v5 offset:0
    v_mfma_f32_16x16x32_bf16 v[208:211], v[72:75], v[64:67], v[208:211]
    ds_read_b64_tr_b16 v[32:33], v7 offset:49152
    v_mfma_f32_16x16x32_bf16 v[216:219], v[72:75], v[68:71], v[216:219]
    ds_read_b64_tr_b16 v[34:35], v7 offset:49664
    s_getreg_b32 s52, hwreg(HW_REG_IB_STS, 0, 4)
    s_add_u32 s52, s52, s74
    s_cmp_le_u32 s52, 0
    s_cbranch_scc0 FK_40_r
    s_waitcnt vmcnt(0)
    s_mov_b64 exec, 1
    buffer_store_dword v15, v11, s[28:31], s70 offen sc1
    s_mov_b64 exec, -1
    s_mov_b32 s74, 64
FK_40_r:
    v_mfma_f32_16x16x32_bf16 v[196:199], v[76:79], v[56:59], v[196:199]
    ds_read_b128 v[20:23], v5 offset:1024
    v_mfma_f32_16x16x32_bf16 v[204:207], v[76:79], v[60:63], v[204:207]
    ds_read_b128 v[24:27], v5 offset:4096
    v_mfma_f32_16x16x32_bf16 v[212:215], v[76:79], v[64:67], v[212:215]
    ds_read_b128 v[28:31], v5 offset:5120
    v_mfma_f32_16x16x32_bf16 v[220:223], v[76:79], v[68:71], v[220:223]
    ds_read_b64_tr_b16 v[36:37], v8 offset:49152
    v_mfma_f32_16x16x32_bf16 v[224:227], v[80:83], v[56:59], v[224:227]
    ds_read_b64_tr_b16 v[38:39], v8 offset:49664
    v_mfma_f32_16x16x32_bf16 v[232:235], v[80:83], v[60:63], v[232:235]
    ds_read_b64_tr_b16 v[40:41], v7 offset:57344
    v_mfma_f32_16x16x32_bf16 v[240:243], v[80:83], v[64:67], v[240:243]
    ds_read_b64_tr_b16 v[42:43], v7 offset:57856
    v_mfma_f32_16x16x32_bf16 v[248:251], v[80:83], v[68:71], v[248:251]
    ds_read_b64_tr_b16 v[44:45], v8 offset:57344
    s_getreg_b32 s52, hwreg(HW_REG_IB_STS, 0, 4)
    s_add_u32 s52, s52, s74
    s_cmp_le_u32 s52, 0
    s_cbranch_scc0 FK_41_r
    s_waitcnt vmcnt(0)
    s_mov_b64 exec, 1
    buffer_store_dword v15, v11, s[28:31], s70 offen sc1
    s_mov_b64 exec, -1
    s_mov_b32 s74, 64
FK_41_r:
    v_mfma_f32_16x16x32_bf16 v[228:231], v[84:87], v[56:59], v[228:231]
    ds_read_b64_tr_b16 v[46:47], v8 offset:57856
    v_mfma_f32_16x16x32_bf16 v[236:239], v[84:87], v[60:63], v[236:239]
    v_mfma_f32_16x16x32_bf16 v[244:247], v[84:87], v[64:67], v[244:247]
    v_mfma_f32_16x16x32_bf16 v[252:255], v[84:87], v[68:71], v[252:255]
    s_waitcnt lgkmcnt(9)
    v_mfma_f32_16x16x32_bf16 v[192:195], v[32:35], v[16:19], v[192:195]
    ds_read_b128 v[56:59], v6 offset:0
    s_waitcnt lgkmcnt(9)
    v_mfma_f32_16x16x32_bf16 v[200:203], v[32:35], v[20:23], v[200:203]
    ds_read_b64_tr_b16 v[72:73], v7 offset:53248
    s_waitcnt lgkmcnt(9)
    v_mfma_f32_16x16x32_bf16 v[208:211], v[32:35], v[24:27], v[208:211]
    ds_read_b64_tr_b16 v[74:75], v7 offset:53760
    buffer_store_dwordx4 v[96:99], v3, s[28:31], s58 offen sc1
    s_waitcnt lgkmcnt(9)
    v_mfma_f32_16x16x32_bf16 v[216:219], v[32:35], v[28:31], v[216:219]
    ds_read_b128 v[60:63], v6 offset:1024
    buffer_store_dwordx4 v[104:107], v3, s[28:31], s58 offen offset:1024 sc1
    s_getreg_b32 s52, hwreg(HW_REG_IB_STS, 0, 4)
    s_add_u32 s52, s52, s74
    s_cmp_le_u32 s52, 2
    s_cbranch_scc0 FK_42_r
    s_waitcnt vmcnt(2)
    s_mov_b64 exec, 1
    buffer_store_dword v15, v11, s[28:31], s70 offen sc1
    s_mov_b64 exec, -1
    s_mov_b32 s74, 64
FK_42_r:
    s_waitcnt lgkmcnt(8)
    v_mfma_f32_16x16x32_bf16 v[196:199], v[36:39], v[16:19], v[196:199]
    ds_read_b128 v[64:67], v6 offset:4096
    v_mul_f32 v112, v112, v144
    v_mfma_f32_16x16x32_bf16 v[204:207], v[36:39], v[20:23], v[204:207]
    ds_read_b128 v[68:71], v6 offset:5120
    v_mul_f32 v113, v113, v145
    v_mfma_f32_16x16x32_bf16 v[212:215], v[36:39], v[24:27], v[212:215]
    ds_read_b64_tr_b16 v[76:77], v8 offset:53248
    v_mul_f32 v114, v114, v146
    v_mfma_f32_16x16x32_bf16 v[220:223], v[36:39], v[28:31], v[220:223]
    ds_read_b64_tr_b16 v[78:79], v8 offset:53760
    v_mul_f32 v115, v115, v147
    s_waitcnt lgkmcnt(10)
    v_mfma_f32_16x16x32_bf16 v[224:227], v[40:43], v[16:19], v[224:227]
    ds_read_b64_tr_b16 v[80:81], v7 offset:61440
    v_mul_f32 v116, v116, v148
    v_mfma_f32_16x16x32_bf16 v[232:235], v[40:43], v[20:23], v[232:235]
    ds_read_b64_tr_b16 v[82:83], v7 offset:61952
    v_mul_f32 v117, v117, v149
    v_mfma_f32_16x16x32_bf16 v[240:243], v[40:43], v[24:27], v[240:243]
    ds_read_b64_tr_b16 v[84:85], v8 offset:61440
    v_mul_f32 v118, v118, v150
    v_mfma_f32_16x16x32_bf16 v[248:251], v[40:43], v[28:31], v[248:251]
    ds_read_b64_tr_b16 v[86:87], v8 offset:61952
    v_mul_f32 v119, v119, v151
    s_getreg_b32 s52, hwreg(HW_REG_IB_STS, 0, 4)
    s_add_u32 s52, s52, s74
    s_cmp_le_u32 s52, 2
    s_cbranch_scc0 FK_43_r
    s_waitcnt vmcnt(2)
    s_mov_b64 exec, 1
    buffer_store_dword v15, v11, s[28:31], s70 offen sc1
    s_mov_b64 exec, -1
    s_mov_b32 s74, 64
FK_43_r:
    s_waitcnt lgkmcnt(12)
    v_mfma_f32_16x16x32_bf16 v[228:231], v[44:47], v[16:19], v[228:231]
    v_cvt_pk_bf16_f32 v112, v112, v113
    v_cvt_pk_bf16_f32 v113, v114, v115
    v_mfma_f32_16x16x32_bf16 v[236:239], v[44:47], v[20:23], v[236:239]
    v_cvt_pk_bf16_f32 v114, v116, v117
    v_cvt_pk_bf16_f32 v115, v118, v119
    v_mfma_f32_16x16x32_bf16 v[244:247], v[44:47], v[24:27], v[244:247]
    v_mul_f32 v120, v120, v152
    v_mul_f32 v121, v121, v153
    v_mfma_f32_16x16x32_bf16 v[252:255], v[44:47], v[28:31], v[252:255]
    v_mul_f32 v122, v122, v154
    v_mul_f32 v123, v123, v155
    v_subrev_u32 v5, 0x10000, v5
    s_waitcnt lgkmcnt(9)
    v_mfma_f32_16x16x32_bf16 v[192:195], v[72:75], v[56:59], v[192:195]
    s_waitcnt lgkmcnt(8)
    v_mfma_f32_16x16x32_bf16 v[200:203], v[72:75], v[60:63], v[200:203]
    s_waitcnt lgkmcnt(0)
    s_barrier
    ds_read_b128 v[16:19], v5 offset:49152
    v_mfma_f32_16x16x32_bf16 v[208:211], v[72:75], v[64:67], v[208:211]
    ds_read_b64_tr_b16 v[32:33], v9 offset:0
    v_mul_f32 v124, v124, v156
    v_mfma_f32_16x16x32_bf16 v[216:219], v[72:75], v[68:71], v[216:219]
    ds_read_b64_tr_b16 v[34:35], v9 offset:512
    v_mul_f32 v125, v125, v157
    s_getreg_b32 s52, hwreg(HW_REG_IB_STS, 0, 4)
    s_add_u32 s52, s52, s74
    s_cmp_le_u32 s52, 2
    s_cbranch_scc0 FK_44_r
    s_waitcnt vmcnt(2)
    s_mov_b64 exec, 1
    buffer_store_dword v15, v11, s[28:31], s70 offen sc1
    s_mov_b64 exec, -1
    s_mov_b32 s74, 64
FK_44_r:
    v_mfma_f32_16x16x32_bf16 v[196:199], v[76:79], v[56:59], v[196:199]
    ds_read_b128 v[20:23], v5 offset:50176
    v_mul_f32 v126, v126, v158
    v_mfma_f32_16x16x32_bf16 v[204:207], v[76:79], v[60:63], v[204:207]
    ds_read_b128 v[24:27], v5 offset:53248
    v_mul_f32 v127, v127, v159
    v_mfma_f32_16x16x32_bf16 v[212:215], v[76:79], v[64:67], v[212:215]
    ds_read_b128 v[28:31], v5 offset:54272
    v_cvt_pk_bf16_f32 v120, v120, v121
    v_mfma_f32_16x16x32_bf16 v[220:223], v[76:79], v[68:71], v[220:223]
    ds_read_b64_tr_b16 v[36:37], v10 offset:0
    v_cvt_pk_bf16_f32 v121, v122, v123
    v_mfma_f32_16x16x32_bf16 v[224:227], v[80:83], v[56:59], v[224:227]
    ds_read_b64_tr_b16 v[38:39], v10 offset:512
    v_cvt_pk_bf16_f32 v122, v124, v125
    v_mfma_f32_16x16x32_bf16 v[232:235], v[80:83], v[60:63], v[232:235]
    ds_read_b64_tr_b16 v[40:41], v9 offset:8192
    v_cvt_pk_bf16_f32 v123, v126, v127
    v_mfma_f32_16x16x32_bf16 v[240:243], v[80:83], v[64:67], v[240:243]
    ds_read_b64_tr_b16 v[42:43], v9 offset:8704
    v_permlane32_swap_b32 v112, v120
    v_mfma_f32_16x16x32_bf16 v[248:251], v[80:83], v[68:71], v[248:251]
    ds_read_b64_tr_b16 v[44:45], v10 offset:8192
    v_permlane32_swap_b32 v113, v121
    s_getreg_b32 s52, hwreg(HW_REG_IB_STS, 0, 4)
    s_add_u32 s52, s52, s74
    s_cmp_le_u32 s52, 2
    s_cbranch_scc0 FK_45_r
    s_waitcnt vmcnt(2)
    s_mov_b64 exec, 1
    buffer_store_dword v15, v11, s[28:31], s70 offen sc1
    s_mov_b64 exec, -1
    s_mov_b32 s74, 64
FK_45_r:
    v_mfma_f32_16x16x32_bf16 v[228:231], v[84:87], v[56:59], v[228:231]
    ds_read_b64_tr_b16 v[46:47], v10 offset:8704
    v_permlane32_swap_b32 v114, v122
    v_mfma_f32_16x16x32_bf16 v[236:239], v[84:87], v[60:63], v[236:239]
    v_permlane32_swap_b32 v115, v123
    buffer_store_dwordx4 v[112:115], v3, s[28:31], s59 offen sc1
    v_mfma_f32_16x16x32_bf16 v[244:247], v[84:87], v[64:67], v[244:247]
    buffer_store_dwordx4 v[120:123], v3, s[28:31], s59 offen offset:1024 sc1
    v_mfma_f32_16x16x32_bf16 v[252:255], v[84:87], v[68:71], v[252:255]
    v_subrev_u32 v6, 0x10000, v6
    s_waitcnt lgkmcnt(9)
    v_mfma_f32_16x16x32_bf16 v[192:195], v[32:35], v[16:19], v[192:195]
    ds_read_b128 v[56:59], v6 offset:49152
    s_waitcnt lgkmcnt(9)
    v_mfma_f32_16x16x32_bf16 v[200:203], v[32:35], v[20:23], v[200:203]
    ds_read_b64_tr_b16 v[72:73], v9 offset:4096
    s_waitcnt lgkmcnt(9)
    v_mfma_f32_16x16x32_bf16 v[208:211], v[32:35], v[24:27], v[208:211]
    ds_read_b64_tr_b16 v[74:75], v9 offset:4608
    s_waitcnt lgkmcnt(9)
    v_mfma_f32_16x16x32_bf16 v[216:219], v[32:35], v[28:31], v[216:219]
    ds_read_b128 v[60:63], v6 offset:50176
    s_getreg_b32 s52, hwreg(HW_REG_IB_STS, 0, 4)
    s_add_u32 s52, s52, s74
    s_cmp_le_u32 s52, 4
    s_cbranch_scc0 FK_46_r
    s_waitcnt vmcnt(4)
    s_mov_b64 exec, 1
    buffer_store_dword v15, v11, s[28:31], s70 offen sc1
    s_mov_b64 exec, -1
    s_mov_b32 s74, 64
FK_46_r:
    s_waitcnt lgkmcnt(8)
    v_mfma_f32_16x16x32_bf16 v[196:199], v[36:39], v[16:19], v[196:199]
    ds_read_b128 v[64:67], v6 offset:53248
    v_mfma_f32_16x16x32_bf16 v[204:207], v[36:39], v[20:23], v[204:207]
    ds_read_b128 v[68:71], v6 offset:54272
    v_mfma_f32_16x16x32_bf16 v[212:215], v[36:39], v[24:27], v[212:215]
    ds_read_b64_tr_b16 v[76:77], v10 offset:4096
    v_mfma_f32_16x16x32_bf16 v[220:223], v[36:39], v[28:31], v[220:223]
    ds_read_b64_tr_b16 v[78:79], v10 offset:4608
    s_waitcnt lgkmcnt(10)
    v_mfma_f32_16x16x32_bf16 v[224:227], v[40:43], v[16:19], v[224:227]
    ds_read_b64_tr_b16 v[80:81], v9 offset:12288
    v_mfma_f32_16x16x32_bf16 v[232:235], v[40:43], v[20:23], v[232:235]
    ds_read_b64_tr_b16 v[82:83], v9 offset:12800
    v_mfma_f32_16x16x32_bf16 v[240:243], v[40:43], v[24:27], v[240:243]
    ds_read_b64_tr_b16 v[84:85], v10 offset:12288
    v_mfma_f32_16x16x32_bf16 v[248:251], v[40:43], v[28:31], v[248:251]
    ds_read_b64_tr_b16 v[86:87], v10 offset:12800
    s_getreg_b32 s52, hwreg(HW_REG_IB_STS, 0, 4)
    s_add_u32 s52, s52, s74
    s_cmp_le_u32 s52, 4
    s_cbranch_scc0 FK_47_r
    s_waitcnt vmcnt(4)
    s_mov_b64 exec, 1
    buffer_store_dword v15, v11, s[28:31], s70 offen sc1
    s_mov_b64 exec, -1
    s_mov_b32 s74, 64
FK_47_r:
    s_waitcnt lgkmcnt(12)
    v_mfma_f32_16x16x32_bf16 v[228:231], v[44:47], v[16:19], v[228:231]
    v_mfma_f32_16x16x32_bf16 v[236:239], v[44:47], v[20:23], v[236:239]
    v_mfma_f32_16x16x32_bf16 v[244:247], v[44:47], v[24:27], v[244:247]
    v_mfma_f32_16x16x32_bf16 v[252:255], v[44:47], v[28:31], v[252:255]
    v_add_u32 v5, 0x10000, v5
    s_waitcnt lgkmcnt(9)
    v_mfma_f32_16x16x32_bf16 v[192:195], v[72:75], v[56:59], v[192:195]
    s_waitcnt lgkmcnt(8)
    v_mfma_f32_16x16x32_bf16 v[200:203], v[72:75], v[60:63], v[200:203]
    s_waitcnt lgkmcnt(0)
    s_barrier
    ds_read_b128 v[16:19], v5 offset:49152
    v_mfma_f32_16x16x32_bf16 v[208:211], v[72:75], v[64:67], v[208:211]
    ds_read_b64_tr_b16 v[32:33], v7 offset:0
    v_mfma_f32_16x16x32_bf16 v[216:219], v[72:75], v[68:71], v[216:219]
    ds_read_b64_tr_b16 v[34:35], v7 offset:512
    s_getreg_b32 s52, hwreg(HW_REG_IB_STS, 0, 4)
    s_add_u32 s52, s52, s74
    s_cmp_le_u32 s52, 4
    s_cbranch_scc0 FK_48_r
    s_waitcnt vmcnt(4)
    s_mov_b64 exec, 1
    buffer_store_dword v15, v11, s[28:31], s70 offen sc1
    s_mov_b64 exec, -1
    s_mov_b32 s74, 64
FK_48_r:
    v_mfma_f32_16x16x32_bf16 v[196:199], v[76:79], v[56:59], v[196:199]
    ds_read_b128 v[20:23], v5 offset:50176
    v_mfma_f32_16x16x32_bf16 v[204:207], v[76:79], v[60:63], v[204:207]
    ds_read_b128 v[24:27], v5 offset:53248
    v_mfma_f32_16x16x32_bf16 v[212:215], v[76:79], v[64:67], v[212:215]
    ds_read_b128 v[28:31], v5 offset:54272
    v_mfma_f32_16x16x32_bf16 v[220:223], v[76:79], v[68:71], v[220:223]
    ds_read_b64_tr_b16 v[36:37], v8 offset:0
    v_mfma_f32_16x16x32_bf16 v[224:227], v[80:83], v[56:59], v[224:227]
    ds_read_b64_tr_b16 v[38:39], v8 offset:512
    v_mfma_f32_16x16x32_bf16 v[232:235], v[80:83], v[60:63], v[232:235]
    ds_read_b64_tr_b16 v[40:41], v7 offset:8192
    v_mfma_f32_16x16x32_bf16 v[240:243], v[80:83], v[64:67], v[240:243]
    ds_read_b64_tr_b16 v[42:43], v7 offset:8704
    v_mfma_f32_16x16x32_bf16 v[248:251], v[80:83], v[68:71], v[248:251]
    ds_read_b64_tr_b16 v[44:45], v8 offset:8192
    s_getreg_b32 s52, hwreg(HW_REG_IB_STS, 0, 4)
    s_add_u32 s52, s52, s74
    s_cmp_le_u32 s52, 4
    s_cbranch_scc0 FK_49_r
    s_waitcnt vmcnt(4)
    s_mov_b64 exec, 1
    buffer_store_dword v15, v11, s[28:31], s70 offen sc1
    s_mov_b64 exec, -1
    s_mov_b32 s74, 64
FK_49_r:
    v_mfma_f32_16x16x32_bf16 v[228:231], v[84:87], v[56:59], v[228:231]
    ds_read_b64_tr_b16 v[46:47], v8 offset:8704
    v_mfma_f32_16x16x32_bf16 v[236:239], v[84:87], v[60:63], v[236:239]
    v_mfma_f32_16x16x32_bf16 v[244:247], v[84:87], v[64:67], v[244:247]
    v_mfma_f32_16x16x32_bf16 v[252:255], v[84:87], v[68:71], v[252:255]
    v_add_u32 v6, 0x10000, v6
    s_waitcnt lgkmcnt(9)
    v_mfma_f32_16x16x32_bf16 v[192:195], v[32:35], v[16:19], v[192:195]
    ds_read_b128 v[56:59], v6 offset:49152
    s_waitcnt lgkmcnt(9)
    v_mfma_f32_16x16x32_bf16 v[200:203], v[32:35], v[20:23], v[200:203]
    ds_read_b64_tr_b16 v[72:73], v7 offset:4096
    s_waitcnt lgkmcnt(9)
    v_mfma_f32_16x16x32_bf16 v[208:211], v[32:35], v[24:27], v[208:211]
    ds_read_b64_tr_b16 v[74:75], v7 offset:4608
    s_waitcnt lgkmcnt(9)
    v_mfma_f32_16x16x32_bf16 v[216:219], v[32:35], v[28:31], v[216:219]
    ds_read_b128 v[60:63], v6 offset:50176
    s_getreg_b32 s52, hwreg(HW_REG_IB_STS, 0, 4)
    s_add_u32 s52, s52, s74
    s_cmp_le_u32 s52, 4
    s_cbranch_scc0 FK_50_r
    s_waitcnt vmcnt(4)
    s_mov_b64 exec, 1
    buffer_store_dword v15, v11, s[28:31], s70 offen sc1
    s_mov_b64 exec, -1
    s_mov_b32 s74, 64
FK_50_r:
    s_waitcnt lgkmcnt(8)
    v_mfma_f32_16x16x32_bf16 v[196:199], v[36:39], v[16:19], v[196:199]
    ds_read_b128 v[64:67], v6 offset:53248
    v_mfma_f32_16x16x32_bf16 v[204:207], v[36:39], v[20:23], v[204:207]
    ds_read_b128 v[68:71], v6 offset:54272
    v_mfma_f32_16x16x32_bf16 v[212:215], v[36:39], v[24:27], v[212:215]
    ds_read_b64_tr_b16 v[76:77], v8 offset:4096
    v_mfma_f32_16x16x32_bf16 v[220:223], v[36:39], v[28:31], v[220:223]
    ds_read_b64_tr_b16 v[78:79], v8 offset:4608
    s_waitcnt lgkmcnt(10)
    v_mfma_f32_16x16x32_bf16 v[224:227], v[40:43], v[16:19], v[224:227]
    ds_read_b64_tr_b16 v[80:81], v7 offset:12288
    v_mfma_f32_16x16x32_bf16 v[232:235], v[40:43], v[20:23], v[232:235]
    ds_read_b64_tr_b16 v[82:83], v7 offset:12800
    v_mfma_f32_16x16x32_bf16 v[240:243], v[40:43], v[24:27], v[240:243]
    ds_read_b64_tr_b16 v[84:85], v8 offset:12288
    v_mfma_f32_16x16x32_bf16 v[248:251], v[40:43], v[28:31], v[248:251]
    ds_read_b64_tr_b16 v[86:87], v8 offset:12800
    s_getreg_b32 s52, hwreg(HW_REG_IB_STS, 0, 4)
    s_add_u32 s52, s52, s74
    s_cmp_le_u32 s52, 4
    s_cbranch_scc0 FK_51_r
    s_waitcnt vmcnt(4)
    s_mov_b64 exec, 1
    buffer_store_dword v15, v11, s[28:31], s70 offen sc1
    s_mov_b64 exec, -1
    s_mov_b32 s74, 64
FK_51_r:
    s_waitcnt lgkmcnt(12)
    v_mfma_f32_16x16x32_bf16 v[228:231], v[44:47], v[16:19], v[228:231]
    ds_read_b32 v13, v0 offset:65336
    v_mfma_f32_16x16x32_bf16 v[236:239], v[44:47], v[20:23], v[236:239]
    v_mfma_f32_16x16x32_bf16 v[244:247], v[44:47], v[24:27], v[244:247]
    v_mfma_f32_16x16x32_bf16 v[252:255], v[44:47], v[28:31], v[252:255]
    s_waitcnt lgkmcnt(0)
    v_readfirstlane_b32 s52, v13
    s_cmp_ge_u32 s52, 4
    s_cbranch_scc1 CF_52
LW_53:
    ds_read_b32 v13, v0 offset:65336
    s_waitcnt lgkmcnt(0)
    v_readfirstlane_b32 s52, v13
    s_cmp_ge_u32 s52, 4
    s_cbranch_scc1 LD_54
    s_sub_u32 s3, s3, 1
    s_cmp_lt_i32 s3, 0
    s_cbranch_scc1 LD_54
    s_branch LW_53
LD_54:
CF_52:
    v_mfma_f32_16x16x32_bf16 v[192:195], v[72:75], v[56:59], v[192:195]
    ds_read_b128 v[16:19], v5 offset:32768
    v_mfma_f32_16x16x32_bf16 v[200:203], v[72:75], v[60:63], v[200:203]
    ds_read_b64_tr_b16 v[32:33], v7 offset:16384
    v_mfma_f32_16x16x32_bf16 v[208:211], v[72:75], v[64:67], v[208:211]
    ds_read_b64_tr_b16 v[34:35], v7 offset:16896
    v_mfma_f32_16x16x32_bf16 v[216:219], v[72:75], v[68:71], v[216:219]
    ds_read_b128 v[20:23], v5 offset:33792
    s_getreg_b32 s52, hwreg(HW_REG_IB_STS, 0, 4)
    s_add_u32 s52, s52, s74
    s_cmp_le_u32 s52, 4
    s_cbranch_scc0 FK_55_r
    s_waitcnt vmcnt(4)
    s_mov_b64 exec, 1
    buffer_store_dword v15, v11, s[28:31], s70 offen sc1
    s_mov_b64 exec, -1
    s_mov_b32 s74, 64
FK_55_r:
    v_mfma_f32_16x16x32_bf16 v[196:199], v[76:79], v[56:59], v[196:199]
    ds_read_b128 v[24:27], v5 offset:36864
    v_mfma_f32_16x16x32_bf16 v[204:207], v[76:79], v[60:63], v[204:207]
    ds_read_b128 v[28:31], v5 offset:37888
    v_mfma_f32_16x16x32_bf16 v[212:215], v[76:79], v[64:67], v[212:215]
    ds_read_b64_tr_b16 v[36:37], v8 offset:16384
    v_mfma_f32_16x16x32_bf16 v[220:223], v[76:79], v[68:71], v[220:223]
    ds_read_b64_tr_b16 v[38:39], v8 offset:16896
    v_mfma_f32_16x16x32_bf16 v[224:227], v[80:83], v[56:59], v[224:227]
    ds_read_b64_tr_b16 v[40:41], v7 offset:24576
    v_mfma_f32_16x16x32_bf16 v[232:235], v[80:83], v[60:63], v[232:235]
    ds_read_b64_tr_b16 v[42:43], v7 offset:25088
    v_mfma_f32_16x16x32_bf16 v[240:243], v[80:83], v[64:67], v[240:243]
    ds_read_b64_tr_b16 v[44:45], v8 offset:24576
    v_mfma_f32_16x16x32_bf16 v[248:251], v[80:83], v[68:71], v[248:251]
    ds_read_b64_tr_b16 v[46:47], v8 offset:25088
    s_getreg_b32 s52, hwreg(HW_REG_IB_STS, 0, 4)
    s_add_u32 s52, s52, s74
    s_cmp_le_u32 s52, 4
    s_cbranch_scc0 FK_56_r
    s_waitcnt vmcnt(4)
    s_mov_b64 exec, 1
    buffer_store_dword v15, v11, s[28:31], s70 offen sc1
    s_mov_b64 exec, -1
    s_mov_b32 s74, 64
FK_56_r:
    v_mfma_f32_16x16x32_bf16 v[228:231], v[84:87], v[56:59], v[228:231]
    v_mfma_f32_16x16x32_bf16 v[236:239], v[84:87], v[60:63], v[236:239]
    v_mfma_f32_16x16x32_bf16 v[244:247], v[84:87], v[64:67], v[244:247]
    v_mfma_f32_16x16x32_bf16 v[252:255], v[84:87], v[68:71], v[252:255]
    s_waitcnt lgkmcnt(9)
    v_mfma_f32_16x16x32_bf16 v[192:195], v[32:35], v[16:19], v[192:195]
    ds_read_b128 v[56:59], v6 offset:32768
    s_waitcnt lgkmcnt(9)
    v_mfma_f32_16x16x32_bf16 v[200:203], v[32:35], v[20:23], v[200:203]
    ds_read_b64_tr_b16 v[72:73], v7 offset:20480
    s_waitcnt lgkmcnt(9)
    v_mfma_f32_16x16x32_bf16 v[208:211], v[32:35], v[24:27], v[208:211]
    ds_read_b64_tr_b16 v[74:75], v7 offset:20992
    s_waitcnt lgkmcnt(9)
    v_mfma_f32_16x16x32_bf16 v[216:219], v[32:35], v[28:31], v[216:219]
    ds_read_b128 v[60:63], v6 offset:33792
    s_getreg_b32 s52, hwreg(HW_REG_IB_STS, 0, 4)
    s_add_u32 s52, s52, s74
    s_cmp_le_u32 s52, 4
    s_cbranch_scc0 FK_57_r
    s_waitcnt vmcnt(4)
    s_mov_b64 exec, 1
    buffer_store_dword v15, v11, s[28:31], s70 offen sc1
    s_mov_b64 exec, -1
    s_mov_b32 s74, 64
FK_57_r:
    s_waitcnt lgkmcnt(8)
    v_mfma_f32_16x16x32_bf16 v[196:199], v[36:39], v[16:19], v[196:199]
    ds_read_b128 v[64:67], v6 offset:36864
    v_mfma_f32_16x16x32_bf16 v[204:207], v[36:39], v[20:23], v[204:207]
    ds_read_b128 v[68:71], v6 offset:37888
    v_mfma_f32_16x16x32_bf16 v[212:215], v[36:39], v[24:27], v[212:215]
    ds_read_b64_tr_b16 v[76:77], v8 offset:20480
    v_mfma_f32_16x16x32_bf16 v[220:223], v[36:39], v[28:31], v[220:223]
    ds_read_b64_tr_b16 v[78:79], v8 offset:20992
    s_waitcnt lgkmcnt(10)
    v_mfma_f32_16x16x32_bf16 v[224:227], v[40:43], v[16:19], v[224:227]
    ds_read_b64_tr_b16 v[80:81], v7 offset:28672
    v_mfma_f32_16x16x32_bf16 v[232:235], v[40:43], v[20:23], v[232:235]
    ds_read_b64_tr_b16 v[82:83], v7 offset:29184
    v_mfma_f32_16x16x32_bf16 v[240:243], v[40:43], v[24:27], v[240:243]
    ds_read_b64_tr_b16 v[84:85], v8 offset:28672
    v_mfma_f32_16x16x32_bf16 v[248:251], v[40:43], v[28:31], v[248:251]
    ds_read_b64_tr_b16 v[86:87], v8 offset:29184
    s_getreg_b32 s52, hwreg(HW_REG_IB_STS, 0, 4)
    s_add_u32 s52, s52, s74
    s_cmp_le_u32 s52, 4
    s_cbranch_scc0 FK_58_r
    s_waitcnt vmcnt(4)
    s_mov_b64 exec, 1
    buffer_store_dword v15, v11, s[28:31], s70 offen sc1
    s_mov_b64 exec, -1
    s_mov_b32 s74, 64
FK_58_r:
    s_waitcnt lgkmcnt(12)
    v_mfma_f32_16x16x32_bf16 v[228:231], v[44:47], v[16:19], v[228:231]
    v_mfma_f32_16x16x32_bf16 v[236:239], v[44:47], v[20:23], v[236:239]
    v_mfma_f32_16x16x32_bf16 v[244:247], v[44:47], v[24:27], v[244:247]
    v_mfma_f32_16x16x32_bf16 v[252:255], v[44:47], v[28:31], v[252:255]
    s_waitcnt lgkmcnt(9)
    v_mfma_f32_16x16x32_bf16 v[192:195], v[72:75], v[56:59], v[192:195]
    ds_read_b128 v[16:19], v5 offset:16384
    s_waitcnt lgkmcnt(9)
    v_mfma_f32_16x16x32_bf16 v[200:203], v[72:75], v[60:63], v[200:203]
    ds_read_b64_tr_b16 v[32:33], v7 offset:32768
    s_waitcnt lgkmcnt(9)
    v_mfma_f32_16x16x32_bf16 v[208:211], v[72:75], v[64:67], v[208:211]
    ds_read_b64_tr_b16 v[34:35], v7 offset:33280
    s_waitcnt lgkmcnt(9)
    v_mfma_f32_16x16x32_bf16 v[216:219], v[72:75], v[68:71], v[216:219]
    ds_read_b128 v[20:23], v5 offset:17408
    s_getreg_b32 s52, hwreg(HW_REG_IB_STS, 0, 4)
    s_add_u32 s52, s52, s74
    s_cmp_le_u32 s52, 4
    s_cbranch_scc0 FK_59_r
    s_waitcnt vmcnt(4)
    s_mov_b64 exec, 1
    buffer_store_dword v15, v11, s[28:31], s70 offen sc1
    s_mov_b64 exec, -1
    s_mov_b32 s74, 64
FK_59_r:
    s_waitcnt lgkmcnt(8)
    v_mfma_f32_16x16x32_bf16 v[196:199], v[76:79], v[56:59], v[196:199]
    ds_read_b128 v[24:27], v5 offset:20480
    v_mfma_f32_16x16x32_bf16 v[204:207], v[76:79], v[60:63], v[204:207]
    ds_read_b128 v[28:31], v5 offset:21504
    v_mfma_f32_16x16x32_bf16 v[212:215], v[76:79], v[64:67], v[212:215]
    ds_read_b64_tr_b16 v[36:37], v8 offset:32768
    v_mfma_f32_16x16x32_bf16 v[220:223], v[76:79], v[68:71], v[220:223]
    ds_read_b64_tr_b16 v[38:39], v8 offset:33280
    s_waitcnt lgkmcnt(10)
    v_mfma_f32_16x16x32_bf16 v[224:227], v[80:83], v[56:59], v[224:227]
    ds_read_b64_tr_b16 v[40:41], v7 offset:40960
    v_mfma_f32_16x16x32_bf16 v[232:235], v[80:83], v[60:63], v[232:235]
    ds_read_b64_tr_b16 v[42:43], v7 offset:41472
    v_mfma_f32_16x16x32_bf16 v[240:243], v[80:83], v[64:67], v[240:243]
    ds_read_b64_tr_b16 v[44:45], v8 offset:40960
    v_mfma_f32_16x16x32_bf16 v[248:251], v[80:83], v[68:71], v[248:251]
    ds_read_b64_tr_b16 v[46:47], v8 offset:41472
    s_getreg_b32 s52, hwreg(HW_REG_IB_STS, 0, 4)
    s_add_u32 s52, s52, s74
    s_cmp_le_u32 s52, 4
    s_cbranch_scc0 FK_60_r
    s_waitcnt vmcnt(4)
    s_mov_b64 exec, 1
    buffer_store_dword v15, v11, s[28:31], s70 offen sc1
    s_mov_b64 exec, -1
    s_mov_b32 s74, 64
FK_60_r:
    s_waitcnt lgkmcnt(12)
    v_mfma_f32_16x16x32_bf16 v[228:231], v[84:87], v[56:59], v[228:231]
    v_mfma_f32_16x16x32_bf16 v[236:239], v[84:87], v[60:63], v[236:239]
    v_mfma_f32_16x16x32_bf16 v[244:247], v[84:87], v[64:67], v[244:247]
    v_mfma_f32_16x16x32_bf16 v[252:255], v[84:87], v[68:71], v[252:255]
    s_waitcnt lgkmcnt(9)
    v_mfma_f32_16x16x32_bf16 v[192:195], v[32:35], v[16:19], v[192:195]
    ds_read_b128 v[56:59], v6 offset:16384
    s_waitcnt lgkmcnt(9)
    v_mfma_f32_16x16x32_bf16 v[200:203], v[32:35], v[20:23], v[200:203]
    ds_read_b64_tr_b16 v[72:73], v7 offset:36864
    s_waitcnt lgkmcnt(9)
    v_mfma_f32_16x16x32_bf16 v[208:211], v[32:35], v[24:27], v[208:211]
    ds_read_b64_tr_b16 v[74:75], v7 offset:37376
    s_waitcnt lgkmcnt(9)
    v_mfma_f32_16x16x32_bf16 v[216:219], v[32:35], v[28:31], v[216:219]
    ds_read_b128 v[60:63], v6 offset:17408
    s_getreg_b32 s52, hwreg(HW_REG_IB_STS, 0, 4)
    s_add_u32 s52, s52, s74
    s_cmp_le_u32 s52, 4
    s_cbranch_scc0 FK_61_r
    s_waitcnt vmcnt(4)
    s_mov_b64 exec, 1
    buffer_store_dword v15, v11, s[28:31], s70 offen sc1
    s_mov_b64 exec, -1
    s_mov_b32 s74, 64
FK_61_r:
    s_waitcnt lgkmcnt(8)
    v_mfma_f32_16x16x32_bf16 v[196:199], v[36:39], v[16:19], v[196:199]
    ds_read_b128 v[64:67], v6 offset:20480
    v_mfma_f32_16x16x32_bf16 v[204:207], v[36:39], v[20:23], v[204:207]
    ds_read_b128 v[68:71], v6 offset:21504
    v_mfma_f32_16x16x32_bf16 v[212:215], v[36:39], v[24:27], v[212:215]
    ds_read_b64_tr_b16 v[76:77], v8 offset:36864
    v_mfma_f32_16x16x32_bf16 v[220:223], v[36:39], v[28:31], v[220:223]
    ds_read_b64_tr_b16 v[78:79], v8 offset:37376
    s_waitcnt lgkmcnt(10)
    v_mfma_f32_16x16x32_bf16 v[224:227], v[40:43], v[16:19], v[224:227]
    ds_read_b64_tr_b16 v[80:81], v7 offset:45056
    v_mfma_f32_16x16x32_bf16 v[232:235], v[40:43], v[20:23], v[232:235]
    ds_read_b64_tr_b16 v[82:83], v7 offset:45568
    v_mfma_f32_16x16x32_bf16 v[240:243], v[40:43], v[24:27], v[240:243]
    ds_read_b64_tr_b16 v[84:85], v8 offset:45056
    v_mfma_f32_16x16x32_bf16 v[248:251], v[40:43], v[28:31], v[248:251]
    ds_read_b64_tr_b16 v[86:87], v8 offset:45568
    s_getreg_b32 s52, hwreg(HW_REG_IB_STS, 0, 4)
    s_add_u32 s52, s52, s74
    s_cmp_le_u32 s52, 4
    s_cbranch_scc0 FK_62_r
    s_waitcnt vmcnt(4)
    s_mov_b64 exec, 1
    buffer_store_dword v15, v11, s[28:31], s70 offen sc1
    s_mov_b64 exec, -1
    s_mov_b32 s74, 64
FK_62_r:
    s_waitcnt lgkmcnt(12)
    v_mfma_f32_16x16x32_bf16 v[228:231], v[44:47], v[16:19], v[228:231]
    v_mfma_f32_16x16x32_bf16 v[236:239], v[44:47], v[20:23], v[236:239]
    v_mfma_f32_16x16x32_bf16 v[244:247], v[44:47], v[24:27], v[244:247]
    v_mfma_f32_16x16x32_bf16 v[252:255], v[44:47], v[28:31], v[252:255]
    s_cmp_eq_u32 s74, 0
    s_cbranch_scc0 FK_63_r
    s_waitcnt vmcnt(4)
    s_mov_b64 exec, 1
    buffer_store_dword v15, v11, s[28:31], s70 offen sc1
    s_mov_b64 exec, -1
    s_mov_b32 s74, 64
FK_63_r:
    s_waitcnt lgkmcnt(9)
    v_mfma_f32_16x16x32_bf16 v[192:195], v[72:75], v[56:59], v[192:195]
    s_waitcnt lgkmcnt(2)
    v_mfma_f32_16x16x32_bf16 v[224:227], v[80:83], v[56:59], v[224:227]
    v_mfma_f32_16x16x32_bf16 v[196:199], v[76:79], v[56:59], v[196:199]
    s_waitcnt lgkmcnt(0)
    v_mfma_f32_16x16x32_bf16 v[228:231], v[84:87], v[56:59], v[228:231]
    v_mfma_f32_16x16x32_bf16 v[200:203], v[72:75], v[60:63], v[200:203]
    v_mfma_f32_16x16x32_bf16 v[232:235], v[80:83], v[60:63], v[232:235]
    s_nop 2
    v_mul_f32 v192, v192, v224
    v_mul_f32 v193, v193, v225
    v_mul_f32 v194, v194, v226
    v_mfma_f32_16x16x32_bf16 v[204:207], v[76:79], v[60:63], v[204:207]
    v_mul_f32 v195, v195, v227
    v_mul_f32 v196, v196, v228
    v_mul_f32 v197, v197, v229
    v_mfma_f32_16x16x32_bf16 v[236:239], v[84:87], v[60:63], v[236:239]
    v_mul_f32 v198, v198, v230
    v_mul_f32 v199, v199, v231
    v_cvt_pk_bf16_f32 v192, v192, v193
    v_mfma_f32_16x16x32_bf16 v[208:211], v[72:75], v[64:67], v[208:211]
    v_cvt_pk_bf16_f32 v193, v194, v195
    v_cvt_pk_bf16_f32 v194, v196, v197
    v_cvt_pk_bf16_f32 v195, v198, v199
    v_mfma_f32_16x16x32_bf16 v[240:243], v[80:83], v[64:67], v[240:243]
    v_mul_f32 v200, v200, v232
    v_mul_f32 v201, v201, v233
    v_mul_f32 v202, v202, v234
    v_mfma_f32_16x16x32_bf16 v[212:215], v[76:79], v[64:67], v[212:215]
    v_mul_f32 v203, v203, v235
    v_mul_f32 v204, v204, v236
    v_mul_f32 v205, v205, v237
    v_mfma_f32_16x16x32_bf16 v[244:247], v[84:87], v[64:67], v[244:247]
    v_mul_f32 v206, v206, v238
    v_mul_f32 v207, v207, v239
    v_cvt_pk_bf16_f32 v200, v200, v201
    v_mfma_f32_16x16x32_bf16 v[216:219], v[72:75], v[68:71], v[216:219]
    v_cvt_pk_bf16_f32 v201, v202, v203
    v_cvt_pk_bf16_f32 v202, v204, v205
    v_cvt_pk_bf16_f32 v203, v206, v207
    v_mfma_f32_16x16x32_bf16 v[248:251], v[80:83], v[68:71], v[248:251]
    v_permlane32_swap_b32 v192, v200
    v_permlane32_swap_b32 v193, v201
    v_permlane32_swap_b32 v194, v202
    v_mfma_f32_16x16x32_bf16 v[220:223], v[76:79], v[68:71], v[220:223]
    v_permlane32_swap_b32 v195, v203
    buffer_store_dwordx4 v[192:195], v3, s[28:31], s60 offen sc1
    buffer_store_dwordx4 v[200:203], v3, s[28:31], s60 offen offset:1024 sc1
    v_mfma_f32_16x16x32_bf16 v[252:255], v[84:87], v[68:71], v[252:255]
    v_mul_f32 v208, v208, v240
    v_mul_f32 v209, v209, v241
    v_mul_f32 v210, v210, v242
    v_mul_f32 v211, v211, v243
    v_mul_f32 v212, v212, v244
    v_mul_f32 v213, v213, v245
    v_mul_f32 v214, v214, v246
    v_mul_f32 v215, v215, v247
    v_cvt_pk_bf16_f32 v208, v208, v209
    v_cvt_pk_bf16_f32 v209, v210, v211
    v_cvt_pk_bf16_f32 v210, v212, v213
    v_cvt_pk_bf16_f32 v211, v214, v215
    v_mul_f32 v216, v216, v248
    v_mul_f32 v217, v217, v249
    v_mul_f32 v218, v218, v250
    v_mul_f32 v219, v219, v251
    v_mul_f32 v220, v220, v252
    v_mul_f32 v221, v221, v253
    v_mul_f32 v222, v222, v254
    v_mul_f32 v223, v223, v255
    v_cvt_pk_bf16_f32 v216, v216, v217
    v_cvt_pk_bf16_f32 v217, v218, v219
    v_cvt_pk_bf16_f32 v218, v220, v221
    v_cvt_pk_bf16_f32 v219, v222, v223
    v_permlane32_swap_b32 v208, v216
    v_permlane32_swap_b32 v209, v217
    v_permlane32_swap_b32 v210, v218
    v_permlane32_swap_b32 v211, v219
    buffer_store_dwordx4 v[208:211], v3, s[28:31], s61 offen sc1
    buffer_store_dwordx4 v[216:219], v3, s[28:31], s61 offen offset:1024 sc1
    s_branch C_ATT
K1_FQ:
    s_waitcnt vmcnt(0)
NL_64:
    v_readfirstlane_b32 s94, v15
    s_cmp_lg_u32 s94, 0
    s_cbranch_scc1 ND_65
    s_sub_u32 s3, s3, 32
    s_cmp_lt_i32 s3, 0
    s_cbranch_scc1 ND_65
    s_sleep 4
    buffer_load_dword v15, v0, s[36:39], 0 offen sc1
    s_waitcnt vmcnt(0)
    s_branch NL_64
ND_65:
    s_mov_b32 s74, 0
    s_waitcnt lgkmcnt(9)
    v_mfma_f32_16x16x32_bf16 v[192:195], v[32:35], v[16:19], 0
    ds_read_b128 v[56:59], v6 offset:49152
    s_waitcnt lgkmcnt(9)
    v_mfma_f32_16x16x32_bf16 v[200:203], v[32:35], v[20:23], 0
    ds_read_b64_tr_b16 v[72:73], v7 offset:4096
    s_waitcnt lgkmcnt(9)
    v_mfma_f32_16x16x32_bf16 v[208:211], v[32:35], v[24:27], 0
    ds_read_b64_tr_b16 v[74:75], v7 offset:4608
    v_cvt_pk_bf16_f32 v96, v96, v97
    v_cvt_pk_bf16_f32 v97, v98, v99
    v_cvt_pk_bf16_f32 v98, v100, v101
    v_cvt_pk_bf16_f32 v99, v102, v103
    v_cvt_pk_bf16_f32 v104, v104, v105
    v_cvt_pk_bf16_f32 v105, v106, v107
    v_cvt_pk_bf16_f32 v106, v108, v109
    s_waitcnt lgkmcnt(9)
    v_mfma_f32_16x16x32_bf16 v[216:219], v[32:35], v[28:31], 0
    ds_read_b128 v[60:63], v6 offset:50176
    v_cvt_pk_bf16_f32 v107, v110, v111
    v_permlane32_swap_b32 v96, v104
    v_permlane32_swap_b32 v97, v105
    v_permlane32_swap_b32 v98, v106
    v_permlane32_swap_b32 v99, v107
    buffer_store_dwordx4 v[96:99], v3, s[28:31], s66 offen offset:0 sc1
    buffer_store_dwordx4 v[104:107], v2, s[28:31], s66 offen offset:0 sc1
    s_waitcnt lgkmcnt(8)
    v_mfma_f32_16x16x32_bf16 v[196:199], v[36:39], v[16:19], 0
    ds_read_b128 v[64:67], v6 offset:53248
    v_cvt_pk_bf16_f32 v112, v112, v113
    v_cvt_pk_bf16_f32 v113, v114, v115
    v_cvt_pk_bf16_f32 v114, v116, v117
    v_cvt_pk_bf16_f32 v115, v118, v119
    v_cvt_pk_bf16_f32 v120, v120, v121
    v_cvt_pk_bf16_f32 v121, v122, v123
    v_cvt_pk_bf16_f32 v122, v124, v125
    v_mfma_f32_16x16x32_bf16 v[204:207], v[36:39], v[20:23], 0
    ds_read_b128 v[68:71], v6 offset:54272
    v_cvt_pk_bf16_f32 v123, v126, v127
    v_permlane32_swap_b32 v112, v120
    v_permlane32_swap_b32 v113, v121
    v_permlane32_swap_b32 v114, v122
    v_permlane32_swap_b32 v115, v123
    buffer_store_dwordx4 v[112:115], v3, s[28:31], s66 offen offset:1024 sc1
    buffer_store_dwordx4 v[120:123], v2, s[28:31], s66 offen offset:1024 sc1
    v_mfma_f32_16x16x32_bf16 v[212:215], v[36:39], v[24:27], 0
    ds_read_b64_tr_b16 v[76:77], v8 offset:4096
    v_cvt_pk_bf16_f32 v128, v128, v129
    v_cvt_pk_bf16_f32 v129, v130, v131
    v_cvt_pk_bf16_f32 v130, v132, v133
    v_cvt_pk_bf16_f32 v131, v134, v135
    v_cvt_pk_bf16_f32 v136, v136, v137
    v_cvt_pk_bf16_f32 v137, v138, v139
    v_cvt_pk_bf16_f32 v138, v140, v141
    v_mfma_f32_16x16x32_bf16 v[220:223], v[36:39], v[28:31], 0
    ds_read_b64_tr_b16 v[78:79], v8 offset:4608
    v_cvt_pk_bf16_f32 v139, v142, v143
    v_permlane32_swap_b32 v128, v136
    v_permlane32_swap_b32 v129, v137
    v_permlane32_swap_b32 v130, v138
    v_permlane32_swap_b32 v131, v139
    buffer_store_dwordx4 v[128:131], v3, s[28:31], s67 offen offset:0 sc1
    buffer_store_dwordx4 v[136:139], v2, s[28:31], s67 offen offset:0 sc1
    s_waitcnt lgkmcnt(10)
    v_mfma_f32_16x16x32_bf16 v[224:227], v[40:43], v[16:19], 0
    ds_read_b64_tr_b16 v[80:81], v7 offset:12288
    v_cvt_pk_bf16_f32 v144, v144, v145
    v_cvt_pk_bf16_f32 v145, v146, v147
    v_cvt_pk_bf16_f32 v146, v148, v149
    v_cvt_pk_bf16_f32 v147, v150, v151
    v_cvt_pk_bf16_f32 v152, v152, v153
    v_cvt_pk_bf16_f32 v153, v154, v155
    v_cvt_pk_bf16_f32 v154, v156, v157
    v_mfma_f32_16x16x32_bf16 v[232:235], v[40:43], v[20:23], 0
    ds_read_b64_tr_b16 v[82:83], v7 offset:12800
    v_cvt_pk_bf16_f32 v155, v158, v159
    v_permlane32_swap_b32 v144, v152
    v_permlane32_swap_b32 v145, v153
    v_permlane32_swap_b32 v146, v154
    v_permlane32_swap_b32 v147, v155
    buffer_store_dwordx4 v[144:147], v3, s[28:31], s67 offen offset:1024 sc1
    buffer_store_dwordx4 v[152:155], v2, s[28:31], s67 offen offset:1024 sc1
    v_mfma_f32_16x16x32_bf16 v[240:243], v[40:43], v[24:27], 0
    ds_read_b64_tr_b16 v[84:85], v8 offset:12288
    v_cvt_pk_bf16_f32 v160, v160, v161
    v_cvt_pk_bf16_f32 v161, v162, v163
    v_cvt_pk_bf16_f32 v162, v164, v165
    v_cvt_pk_bf16_f32 v163, v166, v167
    v_cvt_pk_bf16_f32 v168, v168, v169
    v_cvt_pk_bf16_f32 v169, v170, v171
    v_cvt_pk_bf16_f32 v170, v172, v173
    v_mfma_f32_16x16x32_bf16 v[248:251], v[40:43], v[28:31], 0
    ds_read_b64_tr_b16 v[86:87], v8 offset:12800
    v_cvt_pk_bf16_f32 v171, v174, v175
    v_permlane32_swap_b32 v160, v168
    v_permlane32_swap_b32 v161, v169
    v_permlane32_swap_b32 v162, v170
    v_permlane32_swap_b32 v163, v171
    buffer_store_dwordx4 v[160:163], v3, s[28:31], s68 offen offset:0 sc1
    buffer_store_dwordx4 v[168:171], v2, s[28:31], s68 offen offset:0 sc1
    s_waitcnt lgkmcnt(12)
    v_mfma_f32_16x16x32_bf16 v[228:231], v[44:47], v[16:19], 0
    v_cvt_pk_bf16_f32 v176, v176, v177
    v_cvt_pk_bf16_f32 v177, v178, v179
    v_cvt_pk_bf16_f32 v178, v180, v181
    v_cvt_pk_bf16_f32 v179, v182, v183
    v_cvt_pk_bf16_f32 v184, v184, v185
    v_cvt_pk_bf16_f32 v185, v186, v187
    v_cvt_pk_bf16_f32 v186, v188, v189
    v_cvt_pk_bf16_f32 v187, v190, v191
    v_mfma_f32_16x16x32_bf16 v[236:239], v[44:47], v[20:23], 0
    v_permlane32_swap_b32 v176, v184
    v_permlane32_swap_b32 v177, v185
    v_permlane32_swap_b32 v178, v186
    v_permlane32_swap_b32 v179, v187
    buffer_store_dwordx4 v[176:179], v3, s[28:31], s68 offen offset:1024 sc1
    buffer_store_dwordx4 v[184:187], v2, s[28:31], s68 offen offset:1024 sc1
    v_mfma_f32_16x16x32_bf16 v[244:247], v[44:47], v[24:27], 0
    v_mfma_f32_16x16x32_bf16 v[252:255], v[44:47], v[28:31], 0
    s_waitcnt lgkmcnt(9)
    v_mfma_f32_16x16x32_bf16 v[192:195], v[72:75], v[56:59], v[192:195]
    s_waitcnt lgkmcnt(8)
    v_mfma_f32_16x16x32_bf16 v[200:203], v[72:75], v[60:63], v[200:203]
    s_waitcnt lgkmcnt(0)
    s_barrier
    ds_read_b128 v[16:19], v5 offset:32768
    v_mfma_f32_16x16x32_bf16 v[208:211], v[72:75], v[64:67], v[208:211]
    ds_read_b64_tr_b16 v[32:33], v7 offset:16384
    v_mfma_f32_16x16x32_bf16 v[216:219], v[72:75], v[68:71], v[216:219]
    ds_read_b64_tr_b16 v[34:35], v7 offset:16896
    s_getreg_b32 s52, hwreg(HW_REG_IB_STS, 0, 4)
    s_add_u32 s52, s52, s74
    s_cmp_le_u32 s52, 0
    s_cbranch_scc0 FK_66_r
    s_waitcnt vmcnt(0)
    s_mov_b64 exec, 7
    buffer_store_dword v15, v11, s[28:31], s70 offen sc1
    s_mov_b64 exec, -1
    s_mov_b32 s74, 64
FK_66_r:
    v_mfma_f32_16x16x32_bf16 v[196:199], v[76:79], v[56:59], v[196:199]
    ds_read_b128 v[20:23], v5 offset:33792
    v_mfma_f32_16x16x32_bf16 v[204:207], v[76:79], v[60:63], v[204:207]
    ds_read_b128 v[24:27], v5 offset:36864
    v_mfma_f32_16x16x32_bf16 v[212:215], v[76:79], v[64:67], v[212:215]
    ds_read_b128 v[28:31], v5 offset:37888
    v_mfma_f32_16x16x32_bf16 v[220:223], v[76:79], v[68:71], v[220:223]
    ds_read_b64_tr_b16 v[36:37], v8 offset:16384
    v_mfma_f32_16x16x32_bf16 v[224:227], v[80:83], v[56:59], v[224:227]
    ds_read_b64_tr_b16 v[38:39], v8 offset:16896
    v_mfma_f32_16x16x32_bf16 v[232:235], v[80:83], v[60:63], v[232:235]
    ds_read_b64_tr_b16 v[40:41], v7 offset:24576
    v_mfma_f32_16x16x32_bf16 v[240:243], v[80:83], v[64:67], v[240:243]
    ds_read_b64_tr_b16 v[42:43], v7 offset:25088
    v_mfma_f32_16x16x32_bf16 v[248:251], v[80:83], v[68:71], v[248:251]
    ds_read_b64_tr_b16 v[44:45], v8 offset:24576
    s_getreg_b32 s52, hwreg(HW_REG_IB_STS, 0, 4)
    s_add_u32 s52, s52, s74
    s_cmp_le_u32 s52, 0
    s_cbranch_scc0 FK_67_r
    s_waitcnt vmcnt(0)
    s_mov_b64 exec, 7
    buffer_store_dword v15, v11, s[28:31], s70 offen sc1
    s_mov_b64 exec, -1
    s_mov_b32 s74, 64
FK_67_r:
    v_mfma_f32_16x16x32_bf16 v[228:231], v[84:87], v[56:59], v[228:231]
    ds_read_b64_tr_b16 v[46:47], v8 offset:25088
    v_mfma_f32_16x16x32_bf16 v[236:239], v[84:87], v[60:63], v[236:239]
    v_mfma_f32_16x16x32_bf16 v[244:247], v[84:87], v[64:67], v[244:247]
    v_mfma_f32_16x16x32_bf16 v[252:255], v[84:87], v[68:71], v[252:255]
    s_waitcnt lgkmcnt(9)
    v_mfma_f32_16x16x32_bf16 v[192:195], v[32:35], v[16:19], v[192:195]
    ds_read_b128 v[56:59], v6 offset:32768
    s_waitcnt lgkmcnt(9)
    v_mfma_f32_16x16x32_bf16 v[200:203], v[32:35], v[20:23], v[200:203]
    ds_read_b64_tr_b16 v[72:73], v7 offset:20480
    s_waitcnt lgkmcnt(9)
    v_mfma_f32_16x16x32_bf16 v[208:211], v[32:35], v[24:27], v[208:211]
    ds_read_b64_tr_b16 v[74:75], v7 offset:20992
    s_waitcnt lgkmcnt(9)
    v_mfma_f32_16x16x32_bf16 v[216:219], v[32:35], v[28:31], v[216:219]
    ds_read_b128 v[60:63], v6 offset:33792
    s_getreg_b32 s52, hwreg(HW_REG_IB_STS, 0, 4)
    s_add_u32 s52, s52, s74
    s_cmp_le_u32 s52, 0
    s_cbranch_scc0 FK_68_r
    s_waitcnt vmcnt(0)
    s_mov_b64 exec, 7
    buffer_store_dword v15, v11, s[28:31], s70 offen sc1
    s_mov_b64 exec, -1
    s_mov_b32 s74, 64
FK_68_r:
    s_waitcnt lgkmcnt(8)
    v_mfma_f32_16x16x32_bf16 v[196:199], v[36:39], v[16:19], v[196:199]
    ds_read_b128 v[64:67], v6 offset:36864
    v_mfma_f32_16x16x32_bf16 v[204:207], v[36:39], v[20:23], v[204:207]
    ds_read_b128 v[68:71], v6 offset:37888
    v_mfma_f32_16x16x32_bf16 v[212:215], v[36:39], v[24:27], v[212:215]
    ds_read_b64_tr_b16 v[76:77], v8 offset:20480
    v_mfma_f32_16x16x32_bf16 v[220:223], v[36:39], v[28:31], v[220:223]
    ds_read_b64_tr_b16 v[78:79], v8 offset:20992
    s_waitcnt lgkmcnt(10)
    v_mfma_f32_16x16x32_bf16 v[224:227], v[40:43], v[16:19], v[224:227]
    ds_read_b64_tr_b16 v[80:81], v7 offset:28672
    v_mfma_f32_16x16x32_bf16 v[232:235], v[40:43], v[20:23], v[232:235]
    ds_read_b64_tr_b16 v[82:83], v7 offset:29184
    v_mfma_f32_16x16x32_bf16 v[240:243], v[40:43], v[24:27], v[240:243]
    ds_read_b64_tr_b16 v[84:85], v8 offset:28672
    v_mfma_f32_16x16x32_bf16 v[248:251], v[40:43], v[28:31], v[248:251]
    ds_read_b64_tr_b16 v[86:87], v8 offset:29184
    s_getreg_b32 s52, hwreg(HW_REG_IB_STS, 0, 4)
    s_add_u32 s52, s52, s74
    s_cmp_le_u32 s52, 0
    s_cbranch_scc0 FK_69_r
    s_waitcnt vmcnt(0)
    s_mov_b64 exec, 7
    buffer_store_dword v15, v11, s[28:31], s70 offen sc1
    s_mov_b64 exec, -1
    s_mov_b32 s74, 64
FK_69_r:
    s_waitcnt lgkmcnt(12)
    v_mfma_f32_16x16x32_bf16 v[228:231], v[44:47], v[16:19], v[228:231]
    v_mfma_f32_16x16x32_bf16 v[236:239], v[44:47], v[20:23], v[236:239]
    v_mfma_f32_16x16x32_bf16 v[244:247], v[44:47], v[24:27], v[244:247]
    v_mfma_f32_16x16x32_bf16 v[252:255], v[44:47], v[28:31], v[252:255]
    s_waitcnt lgkmcnt(9)
    v_mfma_f32_16x16x32_bf16 v[192:195], v[72:75], v[56:59], v[192:195]
    s_waitcnt lgkmcnt(8)
    v_mfma_f32_16x16x32_bf16 v[200:203], v[72:75], v[60:63], v[200:203]
    s_waitcnt lgkmcnt(0)
    s_barrier
    ds_read_b128 v[16:19], v5 offset:16384
    v_mfma_f32_16x16x32_bf16 v[208:211], v[72:75], v[64:67], v[208:211]
    ds_read_b64_tr_b16 v[32:33], v7 offset:32768
    v_mfma_f32_16x16x32_bf16 v[216:219], v[72:75], v[68:71], v[216:219]
    ds_read_b64_tr_b16 v[34:35], v7 offset:33280
    s_getreg_b32 s52, hwreg(HW_REG_IB_STS, 0, 4)
    s_add_u32 s52, s52, s74
    s_cmp_le_u32 s52, 0
    s_cbranch_scc0 FK_70_r
    s_waitcnt vmcnt(0)
    s_mov_b64 exec, 7
    buffer_store_dword v15, v11, s[28:31], s70 offen sc1
    s_mov_b64 exec, -1
    s_mov_b32 s74, 64
FK_70_r:
    v_mfma_f32_16x16x32_bf16 v[196:199], v[76:79], v[56:59], v[196:199]
    ds_read_b128 v[20:23], v5 offset:17408
    v_mfma_f32_16x16x32_bf16 v[204:207], v[76:79], v[60:63], v[204:207]
    ds_read_b128 v[24:27], v5 offset:20480
    v_mfma_f32_16x16x32_bf16 v[212:215], v[76:79], v[64:67], v[212:215]
    ds_read_b128 v[28:31], v5 offset:21504
    v_mfma_f32_16x16x32_bf16 v[220:223], v[76:79], v[68:71], v[220:223]
    ds_read_b64_tr_b16 v[36:37], v8 offset:32768
    v_mfma_f32_16x16x32_bf16 v[224:227], v[80:83], v[56:59], v[224:227]
    ds_read_b64_tr_b16 v[38:39], v8 offset:33280
    v_mfma_f32_16x16x32_bf16 v[232:235], v[80:83], v[60:63], v[232:235]
    ds_read_b64_tr_b16 v[40:41], v7 offset:40960
    v_mfma_f32_16x16x32_bf16 v[240:243], v[80:83], v[64:67], v[240:243]
    ds_read_b64_tr_b16 v[42:43], v7 offset:41472
    v_mfma_f32_16x16x32_bf16 v[248:251], v[80:83], v[68:71], v[248:251]
    ds_read_b64_tr_b16 v[44:45], v8 offset:40960
    s_getreg_b32 s52, hwreg(HW_REG_IB_STS, 0, 4)
    s_add_u32 s52, s52, s74
    s_cmp_le_u32 s52, 0
    s_cbranch_scc0 FK_71_r
    s_waitcnt vmcnt(0)
    s_mov_b64 exec, 7
    buffer_store_dword v15, v11, s[28:31], s70 offen sc1
    s_mov_b64 exec, -1
    s_mov_b32 s74, 64
FK_71_r:
    v_mfma_f32_16x16x32_bf16 v[228:231], v[84:87], v[56:59], v[228:231]
    ds_read_b64_tr_b16 v[46:47], v8 offset:41472
    v_mfma_f32_16x16x32_bf16 v[236:239], v[84:87], v[60:63], v[236:239]
    v_mfma_f32_16x16x32_bf16 v[244:247], v[84:87], v[64:67], v[244:247]
    v_mfma_f32_16x16x32_bf16 v[252:255], v[84:87], v[68:71], v[252:255]
    s_waitcnt lgkmcnt(9)
    v_mfma_f32_16x16x32_bf16 v[192:195], v[32:35], v[16:19], v[192:195]
    ds_read_b128 v[56:59], v6 offset:16384
    s_waitcnt lgkmcnt(9)
    v_mfma_f32_16x16x32_bf16 v[200:203], v[32:35], v[20:23], v[200:203]
    ds_read_b64_tr_b16 v[72:73], v7 offset:36864
    s_waitcnt lgkmcnt(9)
    v_mfma_f32_16x16x32_bf16 v[208:211], v[32:35], v[24:27], v[208:211]
    ds_read_b64_tr_b16 v[74:75], v7 offset:37376
    s_waitcnt lgkmcnt(9)
    v_mfma_f32_16x16x32_bf16 v[216:219], v[32:35], v[28:31], v[216:219]
    ds_read_b128 v[60:63], v6 offset:17408
    s_getreg_b32 s52, hwreg(HW_REG_IB_STS, 0, 4)
    s_add_u32 s52, s52, s74
    s_cmp_le_u32 s52, 0
    s_cbranch_scc0 FK_72_r
    s_waitcnt vmcnt(0)
    s_mov_b64 exec, 7
    buffer_store_dword v15, v11, s[28:31], s70 offen sc1
    s_mov_b64 exec, -1
    s_mov_b32 s74, 64
FK_72_r:
    s_waitcnt lgkmcnt(8)
    v_mfma_f32_16x16x32_bf16 v[196:199], v[36:39], v[16:19], v[196:199]
    ds_read_b128 v[64:67], v6 offset:20480
    v_mfma_f32_16x16x32_bf16 v[204:207], v[36:39], v[20:23], v[204:207]
    ds_read_b128 v[68:71], v6 offset:21504
    v_mfma_f32_16x16x32_bf16 v[212:215], v[36:39], v[24:27], v[212:215]
    ds_read_b64_tr_b16 v[76:77], v8 offset:36864
    v_mfma_f32_16x16x32_bf16 v[220:223], v[36:39], v[28:31], v[220:223]
    ds_read_b64_tr_b16 v[78:79], v8 offset:37376
    s_waitcnt lgkmcnt(10)
    v_mfma_f32_16x16x32_bf16 v[224:227], v[40:43], v[16:19], v[224:227]
    ds_read_b64_tr_b16 v[80:81], v7 offset:45056
    v_mfma_f32_16x16x32_bf16 v[232:235], v[40:43], v[20:23], v[232:235]
    ds_read_b64_tr_b16 v[82:83], v7 offset:45568
    v_mfma_f32_16x16x32_bf16 v[240:243], v[40:43], v[24:27], v[240:243]
    ds_read_b64_tr_b16 v[84:85], v8 offset:45056
    v_mfma_f32_16x16x32_bf16 v[248:251], v[40:43], v[28:31], v[248:251]
    ds_read_b64_tr_b16 v[86:87], v8 offset:45568
    s_getreg_b32 s52, hwreg(HW_REG_IB_STS, 0, 4)
    s_add_u32 s52, s52, s74
    s_cmp_le_u32 s52, 0
    s_cbranch_scc0 FK_73_r
    s_waitcnt vmcnt(0)
    s_mov_b64 exec, 7
    buffer_store_dword v15, v11, s[28:31], s70 offen sc1
    s_mov_b64 exec, -1
    s_mov_b32 s74, 64
FK_73_r:
    s_waitcnt lgkmcnt(12)
    v_mfma_f32_16x16x32_bf16 v[228:231], v[44:47], v[16:19], v[228:231]
    v_mfma_f32_16x16x32_bf16 v[236:239], v[44:47], v[20:23], v[236:239]
    v_mfma_f32_16x16x32_bf16 v[244:247], v[44:47], v[24:27], v[244:247]
    v_mfma_f32_16x16x32_bf16 v[252:255], v[44:47], v[28:31], v[252:255]
    s_waitcnt lgkmcnt(9)
    v_mfma_f32_16x16x32_bf16 v[192:195], v[72:75], v[56:59], v[192:195]
    s_waitcnt lgkmcnt(8)
    v_mfma_f32_16x16x32_bf16 v[200:203], v[72:75], v[60:63], v[200:203]
    s_waitcnt lgkmcnt(0)
    s_barrier
    ds_read_b128 v[16:19], v5 offset:0
    v_mfma_f32_16x16x32_bf16 v[208:211], v[72:75], v[64:67], v[208:211]
    ds_read_b64_tr_b16 v[32:33], v7 offset:49152
    v_mfma_f32_16x16x32_bf16 v[216:219], v[72:75], v[68:71], v[216:219]
    ds_read_b64_tr_b16 v[34:35], v7 offset:49664
    s_getreg_b32 s52, hwreg(HW_REG_IB_STS, 0, 4)
    s_add_u32 s52, s52, s74
    s_cmp_le_u32 s52, 0
    s_cbranch_scc0 FK_74_r
    s_waitcnt vmcnt(0)
    s_mov_b64 exec, 7
    buffer_store_dword v15, v11, s[28:31], s70 offen sc1
    s_mov_b64 exec, -1
    s_mov_b32 s74, 64
FK_74_r:
    v_mfma_f32_16x16x32_bf16 v[196:199], v[76:79], v[56:59], v[196:199]
    ds_read_b128 v[20:23], v5 offset:1024
    v_mfma_f32_16x16x32_bf16 v[204:207], v[76:79], v[60:63], v[204:207]
    ds_read_b128 v[24:27], v5 offset:4096
    v_mfma_f32_16x16x32_bf16 v[212:215], v[76:79], v[64:67], v[212:215]
    ds_read_b128 v[28:31], v5 offset:5120
    v_mfma_f32_16x16x32_bf16 v[220:223], v[76:79], v[68:71], v[220:223]
    ds_read_b64_tr_b16 v[36:37], v8 offset:49152
    v_mfma_f32_16x16x32_bf16 v[224:227], v[80:83], v[56:59], v[224:227]
    ds_read_b64_tr_b16 v[38:39], v8 offset:49664
    v_mfma_f32_16x16x32_bf16 v[232:235], v[80:83], v[60:63], v[232:235]
    ds_read_b64_tr_b16 v[40:41], v7 offset:57344
    v_mfma_f32_16x16x32_bf16 v[240:243], v[80:83], v[64:67], v[240:243]
    ds_read_b64_tr_b16 v[42:43], v7 offset:57856
    v_mfma_f32_16x16x32_bf16 v[248:251], v[80:83], v[68:71], v[248:251]
    ds_read_b64_tr_b16 v[44:45], v8 offset:57344
    s_getreg_b32 s52, hwreg(HW_REG_IB_STS, 0, 4)
    s_add_u32 s52, s52, s74
    s_cmp_le_u32 s52, 0
    s_cbranch_scc0 FK_75_r
    s_waitcnt vmcnt(0)
    s_mov_b64 exec, 7
    buffer_store_dword v15, v11, s[28:31], s70 offen sc1
    s_mov_b64 exec, -1
    s_mov_b32 s74, 64
FK_75_r:
    v_mfma_f32_16x16x32_bf16 v[228:231], v[84:87], v[56:59], v[228:231]
    ds_read_b64_tr_b16 v[46:47], v8 offset:57856
    v_mfma_f32_16x16x32_bf16 v[236:239], v[84:87], v[60:63], v[236:239]
    v_mfma_f32_16x16x32_bf16 v[244:247], v[84:87], v[64:67], v[244:247]
    v_mfma_f32_16x16x32_bf16 v[252:255], v[84:87], v[68:71], v[252:255]
    s_waitcnt lgkmcnt(9)
    v_mfma_f32_16x16x32_bf16 v[192:195], v[32:35], v[16:19], v[192:195]
    ds_read_b128 v[56:59], v6 offset:0
    s_waitcnt lgkmcnt(9)
    v_mfma_f32_16x16x32_bf16 v[200:203], v[32:35], v[20:23], v[200:203]
    ds_read_b64_tr_b16 v[72:73], v7 offset:53248
    s_waitcnt lgkmcnt(9)
    v_mfma_f32_16x16x32_bf16 v[208:211], v[32:35], v[24:27], v[208:211]
    ds_read_b64_tr_b16 v[74:75], v7 offset:53760
    s_waitcnt lgkmcnt(9)
    v_mfma_f32_16x16x32_bf16 v[216:219], v[32:35], v[28:31], v[216:219]
    ds_read_b128 v[60:63], v6 offset:1024
    s_getreg_b32 s52, hwreg(HW_REG_IB_STS, 0, 4)
    s_add_u32 s52, s52, s74
    s_cmp_le_u32 s52, 0
    s_cbranch_scc0 FK_76_r
    s_waitcnt vmcnt(0)
    s_mov_b64 exec, 7
    buffer_store_dword v15, v11, s[28:31], s70 offen sc1
    s_mov_b64 exec, -1
    s_mov_b32 s74, 64
FK_76_r:
    s_waitcnt lgkmcnt(8)
    v_mfma_f32_16x16x32_bf16 v[196:199], v[36:39], v[16:19], v[196:199]
    ds_read_b128 v[64:67], v6 offset:4096
    v_mfma_f32_16x16x32_bf16 v[204:207], v[36:39], v[20:23], v[204:207]
    ds_read_b128 v[68:71], v6 offset:5120
    v_mfma_f32_16x16x32_bf16 v[212:215], v[36:39], v[24:27], v[212:215]
    ds_read_b64_tr_b16 v[76:77], v8 offset:53248
    v_mfma_f32_16x16x32_bf16 v[220:223], v[36:39], v[28:31], v[220:223]
    ds_read_b64_tr_b16 v[78:79], v8 offset:53760
    s_waitcnt lgkmcnt(10)
    v_mfma_f32_16x16x32_bf16 v[224:227], v[40:43], v[16:19], v[224:227]
    ds_read_b64_tr_b16 v[80:81], v7 offset:61440
    v_mfma_f32_16x16x32_bf16 v[232:235], v[40:43], v[20:23], v[232:235]
    ds_read_b64_tr_b16 v[82:83], v7 offset:61952
    v_mfma_f32_16x16x32_bf16 v[240:243], v[40:43], v[24:27], v[240:243]
    ds_read_b64_tr_b16 v[84:85], v8 offset:61440
    v_mfma_f32_16x16x32_bf16 v[248:251], v[40:43], v[28:31], v[248:251]
    ds_read_b64_tr_b16 v[86:87], v8 offset:61952
    s_getreg_b32 s52, hwreg(HW_REG_IB_STS, 0, 4)
    s_add_u32 s52, s52, s74
    s_cmp_le_u32 s52, 0
    s_cbranch_scc0 FK_77_r
    s_waitcnt vmcnt(0)
    s_mov_b64 exec, 7
    buffer_store_dword v15, v11, s[28:31], s70 offen sc1
    s_mov_b64 exec, -1
    s_mov_b32 s74, 64
FK_77_r:
    s_waitcnt lgkmcnt(12)
    v_mfma_f32_16x16x32_bf16 v[228:231], v[44:47], v[16:19], v[228:231]
    v_mfma_f32_16x16x32_bf16 v[236:239], v[44:47], v[20:23], v[236:239]
    v_mfma_f32_16x16x32_bf16 v[244:247], v[44:47], v[24:27], v[244:247]
    v_mfma_f32_16x16x32_bf16 v[252:255], v[44:47], v[28:31], v[252:255]
    v_subrev_u32 v5, 0x10000, v5
    s_waitcnt lgkmcnt(9)
    v_mfma_f32_16x16x32_bf16 v[192:195], v[72:75], v[56:59], v[192:195]
    s_waitcnt lgkmcnt(8)
    v_mfma_f32_16x16x32_bf16 v[200:203], v[72:75], v[60:63], v[200:203]
    s_waitcnt lgkmcnt(0)
    s_barrier
    ds_read_b128 v[16:19], v5 offset:49152
    v_mfma_f32_16x16x32_bf16 v[208:211], v[72:75], v[64:67], v[208:211]
    ds_read_b64_tr_b16 v[32:33], v9 offset:0
    v_mfma_f32_16x16x32_bf16 v[216:219], v[72:75], v[68:71], v[216:219]
    ds_read_b64_tr_b16 v[34:35], v9 offset:512
    s_getreg_b32 s52, hwreg(HW_REG_IB_STS, 0, 4)
    s_add_u32 s52, s52, s74
    s_cmp_le_u32 s52, 0
    s_cbranch_scc0 FK_78_r
    s_waitcnt vmcnt(0)
    s_mov_b64 exec, 7
    buffer_store_dword v15, v11, s[28:31], s70 offen sc1
    s_mov_b64 exec, -1
    s_mov_b32 s74, 64
FK_78_r:
    v_mfma_f32_16x16x32_bf16 v[196:199], v[76:79], v[56:59], v[196:199]
    ds_read_b128 v[20:23], v5 offset:50176
    v_mfma_f32_16x16x32_bf16 v[204:207], v[76:79], v[60:63], v[204:207]
    ds_read_b128 v[24:27], v5 offset:53248
    v_mfma_f32_16x16x32_bf16 v[212:215], v[76:79], v[64:67], v[212:215]
    ds_read_b128 v[28:31], v5 offset:54272
    v_mfma_f32_16x16x32_bf16 v[220:223], v[76:79], v[68:71], v[220:223]
    ds_read_b64_tr_b16 v[36:37], v10 offset:0
    v_mfma_f32_16x16x32_bf16 v[224:227], v[80:83], v[56:59], v[224:227]
    ds_read_b64_tr_b16 v[38:39], v10 offset:512
    v_mfma_f32_16x16x32_bf16 v[232:235], v[80:83], v[60:63], v[232:235]
    ds_read_b64_tr_b16 v[40:41], v9 offset:8192
    v_mfma_f32_16x16x32_bf16 v[240:243], v[80:83], v[64:67], v[240:243]
    ds_read_b64_tr_b16 v[42:43], v9 offset:8704
    v_mfma_f32_16x16x32_bf16 v[248:251], v[80:83], v[68:71], v[248:251]
    ds_read_b64_tr_b16 v[44:45], v10 offset:8192
    s_getreg_b32 s52, hwreg(HW_REG_IB_STS, 0, 4)
    s_add_u32 s52, s52, s74
    s_cmp_le_u32 s52, 0
    s_cbranch_scc0 FK_79_r
    s_waitcnt vmcnt(0)
    s_mov_b64 exec, 7
    buffer_store_dword v15, v11, s[28:31], s70 offen sc1
    s_mov_b64 exec, -1
    s_mov_b32 s74, 64
FK_79_r:
    v_mfma_f32_16x16x32_bf16 v[228:231], v[84:87], v[56:59], v[228:231]
    ds_read_b64_tr_b16 v[46:47], v10 offset:8704
    v_mfma_f32_16x16x32_bf16 v[236:239], v[84:87], v[60:63], v[236:239]
    v_mfma_f32_16x16x32_bf16 v[244:247], v[84:87], v[64:67], v[244:247]
    v_mfma_f32_16x16x32_bf16 v[252:255], v[84:87], v[68:71], v[252:255]
    v_subrev_u32 v6, 0x10000, v6
    s_waitcnt lgkmcnt(9)
    v_mfma_f32_16x16x32_bf16 v[192:195], v[32:35], v[16:19], v[192:195]
    ds_read_b128 v[56:59], v6 offset:49152
    s_waitcnt lgkmcnt(9)
    v_mfma_f32_16x16x32_bf16 v[200:203], v[32:35], v[20:23], v[200:203]
    ds_read_b64_tr_b16 v[72:73], v9 offset:4096
    s_waitcnt lgkmcnt(9)
    v_mfma_f32_16x16x32_bf16 v[208:211], v[32:35], v[24:27], v[208:211]
    ds_read_b64_tr_b16 v[74:75], v9 offset:4608
    s_waitcnt lgkmcnt(9)
    v_mfma_f32_16x16x32_bf16 v[216:219], v[32:35], v[28:31], v[216:219]
    ds_read_b128 v[60:63], v6 offset:50176
    s_getreg_b32 s52, hwreg(HW_REG_IB_STS, 0, 4)
    s_add_u32 s52, s52, s74
    s_cmp_le_u32 s52, 0
    s_cbranch_scc0 FK_80_r
    s_waitcnt vmcnt(0)
    s_mov_b64 exec, 7
    buffer_store_dword v15, v11, s[28:31], s70 offen sc1
    s_mov_b64 exec, -1
    s_mov_b32 s74, 64
FK_80_r:
    s_waitcnt lgkmcnt(8)
    v_mfma_f32_16x16x32_bf16 v[196:199], v[36:39], v[16:19], v[196:199]
    ds_read_b128 v[64:67], v6 offset:53248
    v_mfma_f32_16x16x32_bf16 v[204:207], v[36:39], v[20:23], v[204:207]
    ds_read_b128 v[68:71], v6 offset:54272
    v_mfma_f32_16x16x32_bf16 v[212:215], v[36:39], v[24:27], v[212:215]
    ds_read_b64_tr_b16 v[76:77], v10 offset:4096
    v_mfma_f32_16x16x32_bf16 v[220:223], v[36:39], v[28:31], v[220:223]
    ds_read_b64_tr_b16 v[78:79], v10 offset:4608
    s_waitcnt lgkmcnt(10)
    v_mfma_f32_16x16x32_bf16 v[224:227], v[40:43], v[16:19], v[224:227]
    ds_read_b64_tr_b16 v[80:81], v9 offset:12288
    v_mfma_f32_16x16x32_bf16 v[232:235], v[40:43], v[20:23], v[232:235]
    ds_read_b64_tr_b16 v[82:83], v9 offset:12800
    v_mfma_f32_16x16x32_bf16 v[240:243], v[40:43], v[24:27], v[240:243]
    ds_read_b64_tr_b16 v[84:85], v10 offset:12288
    v_mfma_f32_16x16x32_bf16 v[248:251], v[40:43], v[28:31], v[248:251]
    ds_read_b64_tr_b16 v[86:87], v10 offset:12800
    s_getreg_b32 s52, hwreg(HW_REG_IB_STS, 0, 4)
    s_add_u32 s52, s52, s74
    s_cmp_le_u32 s52, 0
    s_cbranch_scc0 FK_81_r
    s_waitcnt vmcnt(0)
    s_mov_b64 exec, 7
    buffer_store_dword v15, v11, s[28:31], s70 offen sc1
    s_mov_b64 exec, -1
    s_mov_b32 s74, 64
FK_81_r:
    s_waitcnt lgkmcnt(12)
    v_mfma_f32_16x16x32_bf16 v[228:231], v[44:47], v[16:19], v[228:231]
    v_mfma_f32_16x16x32_bf16 v[236:239], v[44:47], v[20:23], v[236:239]
    v_mfma_f32_16x16x32_bf16 v[244:247], v[44:47], v[24:27], v[244:247]
    v_mfma_f32_16x16x32_bf16 v[252:255], v[44:47], v[28:31], v[252:255]
    v_add_u32 v5, 0x10000, v5
    s_waitcnt lgkmcnt(9)
    v_mfma_f32_16x16x32_bf16 v[192:195], v[72:75], v[56:59], v[192:195]
    s_waitcnt lgkmcnt(8)
    v_mfma_f32_16x16x32_bf16 v[200:203], v[72:75], v[60:63], v[200:203]
    s_waitcnt lgkmcnt(0)
    s_barrier
    ds_read_b128 v[16:19], v5 offset:49152
    v_mfma_f32_16x16x32_bf16 v[208:211], v[72:75], v[64:67], v[208:211]
    ds_read_b64_tr_b16 v[32:33], v7 offset:0
    v_mfma_f32_16x16x32_bf16 v[216:219], v[72:75], v[68:71], v[216:219]
    ds_read_b64_tr_b16 v[34:35], v7 offset:512
    s_getreg_b32 s52, hwreg(HW_REG_IB_STS, 0, 4)
    s_add_u32 s52, s52, s74
    s_cmp_le_u32 s52, 0
    s_cbranch_scc0 FK_82_r
    s_waitcnt vmcnt(0)
    s_mov_b64 exec, 7
    buffer_store_dword v15, v11, s[28:31], s70 offen sc1
    s_mov_b64 exec, -1
    s_mov_b32 s74, 64
FK_82_r:
    v_mfma_f32_16x16x32_bf16 v[196:199], v[76:79], v[56:59], v[196:199]
    ds_read_b128 v[20:23], v5 offset:50176
    v_mfma_f32_16x16x32_bf16 v[204:207], v[76:79], v[60:63], v[204:207]
    ds_read_b128 v[24:27], v5 offset:53248
    v_mfma_f32_16x16x32_bf16 v[212:215], v[76:79], v[64:67], v[212:215]
    ds_read_b128 v[28:31], v5 offset:54272
    v_mfma_f32_16x16x32_bf16 v[220:223], v[76:79], v[68:71], v[220:223]
    ds_read_b64_tr_b16 v[36:37], v8 offset:0
    v_mfma_f32_16x16x32_bf16 v[224:227], v[80:83], v[56:59], v[224:227]
    ds_read_b64_tr_b16 v[38:39], v8 offset:512
    v_mfma_f32_16x16x32_bf16 v[232:235], v[80:83], v[60:63], v[232:235]
    ds_read_b64_tr_b16 v[40:41], v7 offset:8192
    v_mfma_f32_16x16x32_bf16 v[240:243], v[80:83], v[64:67], v[240:243]
    ds_read_b64_tr_b16 v[42:43], v7 offset:8704
    v_mfma_f32_16x16x32_bf16 v[248:251], v[80:83], v[68:71], v[248:251]
    ds_read_b64_tr_b16 v[44:45], v8 offset:8192
    s_getreg_b32 s52, hwreg(HW_REG_IB_STS, 0, 4)
    s_add_u32 s52, s52, s74
    s_cmp_le_u32 s52, 0
    s_cbranch_scc0 FK_83_r
    s_waitcnt vmcnt(0)
    s_mov_b64 exec, 7
    buffer_store_dword v15, v11, s[28:31], s70 offen sc1
    s_mov_b64 exec, -1
    s_mov_b32 s74, 64
FK_83_r:
    v_mfma_f32_16x16x32_bf16 v[228:231], v[84:87], v[56:59], v[228:231]
    ds_read_b64_tr_b16 v[46:47], v8 offset:8704
    v_mfma_f32_16x16x32_bf16 v[236:239], v[84:87], v[60:63], v[236:239]
    v_mfma_f32_16x16x32_bf16 v[244:247], v[84:87], v[64:67], v[244:247]
    v_mfma_f32_16x16x32_bf16 v[252:255], v[84:87], v[68:71], v[252:255]
    v_add_u32 v6, 0x10000, v6
    s_waitcnt lgkmcnt(9)
    v_mfma_f32_16x16x32_bf16 v[192:195], v[32:35], v[16:19], v[192:195]
    ds_read_b128 v[56:59], v6 offset:49152
    s_waitcnt lgkmcnt(9)
    v_mfma_f32_16x16x32_bf16 v[200:203], v[32:35], v[20:23], v[200:203]
    ds_read_b64_tr_b16 v[72:73], v7 offset:4096
    s_waitcnt lgkmcnt(9)
    v_mfma_f32_16x16x32_bf16 v[208:211], v[32:35], v[24:27], v[208:211]
    ds_read_b64_tr_b16 v[74:75], v7 offset:4608
    s_waitcnt lgkmcnt(9)
    v_mfma_f32_16x16x32_bf16 v[216:219], v[32:35], v[28:31], v[216:219]
    ds_read_b128 v[60:63], v6 offset:50176
    s_getreg_b32 s52, hwreg(HW_REG_IB_STS, 0, 4)
    s_add_u32 s52, s52, s74
    s_cmp_le_u32 s52, 0
    s_cbranch_scc0 FK_84_r
    s_waitcnt vmcnt(0)
    s_mov_b64 exec, 7
    buffer_store_dword v15, v11, s[28:31], s70 offen sc1
    s_mov_b64 exec, -1
    s_mov_b32 s74, 64
FK_84_r:
    s_waitcnt lgkmcnt(8)
    v_mfma_f32_16x16x32_bf16 v[196:199], v[36:39], v[16:19], v[196:199]
    ds_read_b128 v[64:67], v6 offset:53248
    v_mfma_f32_16x16x32_bf16 v[204:207], v[36:39], v[20:23], v[204:207]
    ds_read_b128 v[68:71], v6 offset:54272
    v_mfma_f32_16x16x32_bf16 v[212:215], v[36:39], v[24:27], v[212:215]
    ds_read_b64_tr_b16 v[76:77], v8 offset:4096
    v_mfma_f32_16x16x32_bf16 v[220:223], v[36:39], v[28:31], v[220:223]
    ds_read_b64_tr_b16 v[78:79], v8 offset:4608
    s_waitcnt lgkmcnt(10)
    v_mfma_f32_16x16x32_bf16 v[224:227], v[40:43], v[16:19], v[224:227]
    ds_read_b64_tr_b16 v[80:81], v7 offset:12288
    v_mfma_f32_16x16x32_bf16 v[232:235], v[40:43], v[20:23], v[232:235]
    ds_read_b64_tr_b16 v[82:83], v7 offset:12800
    v_mfma_f32_16x16x32_bf16 v[240:243], v[40:43], v[24:27], v[240:243]
    ds_read_b64_tr_b16 v[84:85], v8 offset:12288
    v_mfma_f32_16x16x32_bf16 v[248:251], v[40:43], v[28:31], v[248:251]
    ds_read_b64_tr_b16 v[86:87], v8 offset:12800
    s_getreg_b32 s52, hwreg(HW_REG_IB_STS, 0, 4)
    s_add_u32 s52, s52, s74
    s_cmp_le_u32 s52, 0
    s_cbranch_scc0 FK_85_r
    s_waitcnt vmcnt(0)
    s_mov_b64 exec, 7
    buffer_store_dword v15, v11, s[28:31], s70 offen sc1
    s_mov_b64 exec, -1
    s_mov_b32 s74, 64
FK_85_r:
    s_waitcnt lgkmcnt(12)
    v_mfma_f32_16x16x32_bf16 v[228:231], v[44:47], v[16:19], v[228:231]
    ds_read_b32 v13, v0 offset:65336
    v_mfma_f32_16x16x32_bf16 v[236:239], v[44:47], v[20:23], v[236:239]
    v_mfma_f32_16x16x32_bf16 v[244:247], v[44:47], v[24:27], v[244:247]
    v_mfma_f32_16x16x32_bf16 v[252:255], v[44:47], v[28:31], v[252:255]
    s_waitcnt lgkmcnt(0)
    v_readfirstlane_b32 s52, v13
    s_cmp_ge_u32 s52, 4
    s_cbranch_scc1 CF_86
LW_87:
    ds_read_b32 v13, v0 offset:65336
    s_waitcnt lgkmcnt(0)
    v_readfirstlane_b32 s52, v13
    s_cmp_ge_u32 s52, 4
    s_cbranch_scc1 LD_88
    s_sub_u32 s3, s3, 1
    s_cmp_lt_i32 s3, 0
    s_cbranch_scc1 LD_88
    s_branch LW_87
LD_88:
CF_86:
    v_mfma_f32_16x16x32_bf16 v[192:195], v[72:75], v[56:59], v[192:195]
    ds_read_b128 v[16:19], v5 offset:32768
    v_mfma_f32_16x16x32_bf16 v[200:203], v[72:75], v[60:63], v[200:203]
    ds_read_b64_tr_b16 v[32:33], v7 offset:16384
    v_mfma_f32_16x16x32_bf16 v[208:211], v[72:75], v[64:67], v[208:211]
    ds_read_b64_tr_b16 v[34:35], v7 offset:16896
    v_mfma_f32_16x16x32_bf16 v[216:219], v[72:75], v[68:71], v[216:219]
    ds_read_b128 v[20:23], v5 offset:33792
    s_getreg_b32 s52, hwreg(HW_REG_IB_STS, 0, 4)
    s_add_u32 s52, s52, s74
    s_cmp_le_u32 s52, 0
    s_cbranch_scc0 FK_89_r
    s_waitcnt vmcnt(0)
    s_mov_b64 exec, 7
    buffer_store_dword v15, v11, s[28:31], s70 offen sc1
    s_mov_b64 exec, -1
    s_mov_b32 s74, 64
FK_89_r:
    v_mfma_f32_16x16x32_bf16 v[196:199], v[76:79], v[56:59], v[196:199]
    ds_read_b128 v[24:27], v5 offset:36864
    v_mfma_f32_16x16x32_bf16 v[204:207], v[76:79], v[60:63], v[204:207]
    ds_read_b128 v[28:31], v5 offset:37888
    v_mfma_f32_16x16x32_bf16 v[212:215], v[76:79], v[64:67], v[212:215]
    ds_read_b64_tr_b16 v[36:37], v8 offset:16384
    v_mfma_f32_16x16x32_bf16 v[220:223], v[76:79], v[68:71], v[220:223]
    ds_read_b64_tr_b16 v[38:39], v8 offset:16896
    v_mfma_f32_16x16x32_bf16 v[224:227], v[80:83], v[56:59], v[224:227]
    ds_read_b64_tr_b16 v[40:41], v7 offset:24576
    v_mfma_f32_16x16x32_bf16 v[232:235], v[80:83], v[60:63], v[232:235]
    ds_read_b64_tr_b16 v[42:43], v7 offset:25088
    v_mfma_f32_16x16x32_bf16 v[240:243], v[80:83], v[64:67], v[240:243]
    ds_read_b64_tr_b16 v[44:45], v8 offset:24576
    v_mfma_f32_16x16x32_bf16 v[248:251], v[80:83], v[68:71], v[248:251]
    ds_read_b64_tr_b16 v[46:47], v8 offset:25088
    s_getreg_b32 s52, hwreg(HW_REG_IB_STS, 0, 4)
    s_add_u32 s52, s52, s74
    s_cmp_le_u32 s52, 0
    s_cbranch_scc0 FK_90_r
    s_waitcnt vmcnt(0)
    s_mov_b64 exec, 7
    buffer_store_dword v15, v11, s[28:31], s70 offen sc1
    s_mov_b64 exec, -1
    s_mov_b32 s74, 64
FK_90_r:
    v_mfma_f32_16x16x32_bf16 v[228:231], v[84:87], v[56:59], v[228:231]
    v_mfma_f32_16x16x32_bf16 v[236:239], v[84:87], v[60:63], v[236:239]
    v_mfma_f32_16x16x32_bf16 v[244:247], v[84:87], v[64:67], v[244:247]
    v_mfma_f32_16x16x32_bf16 v[252:255], v[84:87], v[68:71], v[252:255]
    s_waitcnt lgkmcnt(9)
    v_mfma_f32_16x16x32_bf16 v[192:195], v[32:35], v[16:19], v[192:195]
    ds_read_b128 v[56:59], v6 offset:32768
    s_waitcnt lgkmcnt(9)
    v_mfma_f32_16x16x32_bf16 v[200:203], v[32:35], v[20:23], v[200:203]
    ds_read_b64_tr_b16 v[72:73], v7 offset:20480
    s_waitcnt lgkmcnt(9)
    v_mfma_f32_16x16x32_bf16 v[208:211], v[32:35], v[24:27], v[208:211]
    ds_read_b64_tr_b16 v[74:75], v7 offset:20992
    s_waitcnt lgkmcnt(9)
    v_mfma_f32_16x16x32_bf16 v[216:219], v[32:35], v[28:31], v[216:219]
    ds_read_b128 v[60:63], v6 offset:33792
    s_getreg_b32 s52, hwreg(HW_REG_IB_STS, 0, 4)
    s_add_u32 s52, s52, s74
    s_cmp_le_u32 s52, 0
    s_cbranch_scc0 FK_91_r
    s_waitcnt vmcnt(0)
    s_mov_b64 exec, 7
    buffer_store_dword v15, v11, s[28:31], s70 offen sc1
    s_mov_b64 exec, -1
    s_mov_b32 s74, 64
FK_91_r:
    s_waitcnt lgkmcnt(8)
    v_mfma_f32_16x16x32_bf16 v[196:199], v[36:39], v[16:19], v[196:199]
    ds_read_b128 v[64:67], v6 offset:36864
    v_mfma_f32_16x16x32_bf16 v[204:207], v[36:39], v[20:23], v[204:207]
    ds_read_b128 v[68:71], v6 offset:37888
    v_mfma_f32_16x16x32_bf16 v[212:215], v[36:39], v[24:27], v[212:215]
    ds_read_b64_tr_b16 v[76:77], v8 offset:20480
    v_mfma_f32_16x16x32_bf16 v[220:223], v[36:39], v[28:31], v[220:223]
    ds_read_b64_tr_b16 v[78:79], v8 offset:20992
    s_waitcnt lgkmcnt(10)
    v_mfma_f32_16x16x32_bf16 v[224:227], v[40:43], v[16:19], v[224:227]
    ds_read_b64_tr_b16 v[80:81], v7 offset:28672
    v_mfma_f32_16x16x32_bf16 v[232:235], v[40:43], v[20:23], v[232:235]
    ds_read_b64_tr_b16 v[82:83], v7 offset:29184
    v_mfma_f32_16x16x32_bf16 v[240:243], v[40:43], v[24:27], v[240:243]
    ds_read_b64_tr_b16 v[84:85], v8 offset:28672
    v_mfma_f32_16x16x32_bf16 v[248:251], v[40:43], v[28:31], v[248:251]
    ds_read_b64_tr_b16 v[86:87], v8 offset:29184
    s_getreg_b32 s52, hwreg(HW_REG_IB_STS, 0, 4)
    s_add_u32 s52, s52, s74
    s_cmp_le_u32 s52, 0
    s_cbranch_scc0 FK_92_r
    s_waitcnt vmcnt(0)
    s_mov_b64 exec, 7
    buffer_store_dword v15, v11, s[28:31], s70 offen sc1
    s_mov_b64 exec, -1
    s_mov_b32 s74, 64
FK_92_r:
    s_waitcnt lgkmcnt(12)
    v_mfma_f32_16x16x32_bf16 v[228:231], v[44:47], v[16:19], v[228:231]
    v_mfma_f32_16x16x32_bf16 v[236:239], v[44:47], v[20:23], v[236:239]
    v_mfma_f32_16x16x32_bf16 v[244:247], v[44:47], v[24:27], v[244:247]
    v_mfma_f32_16x16x32_bf16 v[252:255], v[44:47], v[28:31], v[252:255]
    s_waitcnt lgkmcnt(9)
    v_mfma_f32_16x16x32_bf16 v[192:195], v[72:75], v[56:59], v[192:195]
    ds_read_b128 v[16:19], v5 offset:16384
    s_waitcnt lgkmcnt(9)
    v_mfma_f32_16x16x32_bf16 v[200:203], v[72:75], v[60:63], v[200:203]
    ds_read_b64_tr_b16 v[32:33], v7 offset:32768
    s_waitcnt lgkmcnt(9)
    v_mfma_f32_16x16x32_bf16 v[208:211], v[72:75], v[64:67], v[208:211]
    ds_read_b64_tr_b16 v[34:35], v7 offset:33280
    s_waitcnt lgkmcnt(9)
    v_mfma_f32_16x16x32_bf16 v[216:219], v[72:75], v[68:71], v[216:219]
    ds_read_b128 v[20:23], v5 offset:17408
    s_getreg_b32 s52, hwreg(HW_REG_IB_STS, 0, 4)
    s_add_u32 s52, s52, s74
    s_cmp_le_u32 s52, 0
    s_cbranch_scc0 FK_93_r
    s_waitcnt vmcnt(0)
    s_mov_b64 exec, 7
    buffer_store_dword v15, v11, s[28:31], s70 offen sc1
    s_mov_b64 exec, -1
    s_mov_b32 s74, 64
FK_93_r:
    s_waitcnt lgkmcnt(8)
    v_mfma_f32_16x16x32_bf16 v[196:199], v[76:79], v[56:59], v[196:199]
    ds_read_b128 v[24:27], v5 offset:20480
    v_mfma_f32_16x16x32_bf16 v[204:207], v[76:79], v[60:63], v[204:207]
    ds_read_b128 v[28:31], v5 offset:21504
    v_mfma_f32_16x16x32_bf16 v[212:215], v[76:79], v[64:67], v[212:215]
    ds_read_b64_tr_b16 v[36:37], v8 offset:32768
    v_mfma_f32_16x16x32_bf16 v[220:223], v[76:79], v[68:71], v[220:223]
    ds_read_b64_tr_b16 v[38:39], v8 offset:33280
    s_waitcnt lgkmcnt(10)
    v_mfma_f32_16x16x32_bf16 v[224:227], v[80:83], v[56:59], v[224:227]
    ds_read_b64_tr_b16 v[40:41], v7 offset:40960
    v_mfma_f32_16x16x32_bf16 v[232:235], v[80:83], v[60:63], v[232:235]
    ds_read_b64_tr_b16 v[42:43], v7 offset:41472
    v_mfma_f32_16x16x32_bf16 v[240:243], v[80:83], v[64:67], v[240:243]
    ds_read_b64_tr_b16 v[44:45], v8 offset:40960
    v_mfma_f32_16x16x32_bf16 v[248:251], v[80:83], v[68:71], v[248:251]
    ds_read_b64_tr_b16 v[46:47], v8 offset:41472
    s_getreg_b32 s52, hwreg(HW_REG_IB_STS, 0, 4)
    s_add_u32 s52, s52, s74
    s_cmp_le_u32 s52, 0
    s_cbranch_scc0 FK_94_r
    s_waitcnt vmcnt(0)
    s_mov_b64 exec, 7
    buffer_store_dword v15, v11, s[28:31], s70 offen sc1
    s_mov_b64 exec, -1
    s_mov_b32 s74, 64
FK_94_r:
    s_waitcnt lgkmcnt(12)
    v_mfma_f32_16x16x32_bf16 v[228:231], v[84:87], v[56:59], v[228:231]
    v_mfma_f32_16x16x32_bf16 v[236:239], v[84:87], v[60:63], v[236:239]
    v_mfma_f32_16x16x32_bf16 v[244:247], v[84:87], v[64:67], v[244:247]
    v_mfma_f32_16x16x32_bf16 v[252:255], v[84:87], v[68:71], v[252:255]
    s_waitcnt lgkmcnt(9)
    v_mfma_f32_16x16x32_bf16 v[192:195], v[32:35], v[16:19], v[192:195]
    ds_read_b128 v[56:59], v6 offset:16384
    s_waitcnt lgkmcnt(9)
    v_mfma_f32_16x16x32_bf16 v[200:203], v[32:35], v[20:23], v[200:203]
    ds_read_b64_tr_b16 v[72:73], v7 offset:36864
    s_waitcnt lgkmcnt(9)
    v_mfma_f32_16x16x32_bf16 v[208:211], v[32:35], v[24:27], v[208:211]
    ds_read_b64_tr_b16 v[74:75], v7 offset:37376
    s_waitcnt lgkmcnt(9)
    v_mfma_f32_16x16x32_bf16 v[216:219], v[32:35], v[28:31], v[216:219]
    ds_read_b128 v[60:63], v6 offset:17408
    s_getreg_b32 s52, hwreg(HW_REG_IB_STS, 0, 4)
    s_add_u32 s52, s52, s74
    s_cmp_le_u32 s52, 0
    s_cbranch_scc0 FK_95_r
    s_waitcnt vmcnt(0)
    s_mov_b64 exec, 7
    buffer_store_dword v15, v11, s[28:31], s70 offen sc1
    s_mov_b64 exec, -1
    s_mov_b32 s74, 64
FK_95_r:
    s_waitcnt lgkmcnt(8)
    v_mfma_f32_16x16x32_bf16 v[196:199], v[36:39], v[16:19], v[196:199]
    ds_read_b128 v[64:67], v6 offset:20480
    v_mfma_f32_16x16x32_bf16 v[204:207], v[36:39], v[20:23], v[204:207]
    ds_read_b128 v[68:71], v6 offset:21504
    v_mfma_f32_16x16x32_bf16 v[212:215], v[36:39], v[24:27], v[212:215]
    ds_read_b64_tr_b16 v[76:77], v8 offset:36864
    v_mfma_f32_16x16x32_bf16 v[220:223], v[36:39], v[28:31], v[220:223]
    ds_read_b64_tr_b16 v[78:79], v8 offset:37376
    s_waitcnt lgkmcnt(10)
    v_mfma_f32_16x16x32_bf16 v[224:227], v[40:43], v[16:19], v[224:227]
    ds_read_b64_tr_b16 v[80:81], v7 offset:45056
    v_mfma_f32_16x16x32_bf16 v[232:235], v[40:43], v[20:23], v[232:235]
    ds_read_b64_tr_b16 v[82:83], v7 offset:45568
    v_mfma_f32_16x16x32_bf16 v[240:243], v[40:43], v[24:27], v[240:243]
    ds_read_b64_tr_b16 v[84:85], v8 offset:45056
    v_mfma_f32_16x16x32_bf16 v[248:251], v[40:43], v[28:31], v[248:251]
    ds_read_b64_tr_b16 v[86:87], v8 offset:45568
    s_getreg_b32 s52, hwreg(HW_REG_IB_STS, 0, 4)
    s_add_u32 s52, s52, s74
    s_cmp_le_u32 s52, 0
    s_cbranch_scc0 FK_96_r
    s_waitcnt vmcnt(0)
    s_mov_b64 exec, 7
    buffer_store_dword v15, v11, s[28:31], s70 offen sc1
    s_mov_b64 exec, -1
    s_mov_b32 s74, 64
FK_96_r:
    s_waitcnt lgkmcnt(12)
    v_mfma_f32_16x16x32_bf16 v[228:231], v[44:47], v[16:19], v[228:231]
    v_mfma_f32_16x16x32_bf16 v[236:239], v[44:47], v[20:23], v[236:239]
    v_mfma_f32_16x16x32_bf16 v[244:247], v[44:47], v[24:27], v[244:247]
    v_mfma_f32_16x16x32_bf16 v[252:255], v[44:47], v[28:31], v[252:255]
    s_cmp_eq_u32 s74, 0
    s_cbranch_scc0 FK_97_r
    s_waitcnt vmcnt(0)
    s_mov_b64 exec, 7
    buffer_store_dword v15, v11, s[28:31], s70 offen sc1
    s_mov_b64 exec, -1
    s_mov_b32 s74, 64
FK_97_r:
    s_waitcnt lgkmcnt(9)
    v_mfma_f32_16x16x32_bf16 v[192:195], v[72:75], v[56:59], v[192:195]
    s_waitcnt lgkmcnt(2)
    v_mfma_f32_16x16x32_bf16 v[224:227], v[80:83], v[56:59], v[224:227]
    v_mfma_f32_16x16x32_bf16 v[196:199], v[76:79], v[56:59], v[196:199]
    s_waitcnt lgkmcnt(0)
    v_mfma_f32_16x16x32_bf16 v[228:231], v[84:87], v[56:59], v[228:231]
    v_mfma_f32_16x16x32_bf16 v[200:203], v[72:75], v[60:63], v[200:203]
    v_mfma_f32_16x16x32_bf16 v[232:235], v[80:83], v[60:63], v[232:235]
    s_nop 2
    v_mul_f32 v192, v192, v224
    v_mul_f32 v193, v193, v225
    v_mul_f32 v194, v194, v226
    v_mfma_f32_16x16x32_bf16 v[204:207], v[76:79], v[60:63], v[204:207]
    v_mul_f32 v195, v195, v227
    v_mul_f32 v196, v196, v228
    v_mul_f32 v197, v197, v229
    v_mfma_f32_16x16x32_bf16 v[236:239], v[84:87], v[60:63], v[236:239]
    v_mul_f32 v198, v198, v230
    v_mul_f32 v199, v199, v231
    v_cvt_pk_bf16_f32 v192, v192, v193
    v_mfma_f32_16x16x32_bf16 v[208:211], v[72:75], v[64:67], v[208:211]
    v_cvt_pk_bf16_f32 v193, v194, v195
    v_cvt_pk_bf16_f32 v194, v196, v197
    v_cvt_pk_bf16_f32 v195, v198, v199
    v_mfma_f32_16x16x32_bf16 v[240:243], v[80:83], v[64:67], v[240:243]
    v_mul_f32 v200, v200, v232
    v_mul_f32 v201, v201, v233
    v_mul_f32 v202, v202, v234
    v_mfma_f32_16x16x32_bf16 v[212:215], v[76:79], v[64:67], v[212:215]
    v_mul_f32 v203, v203, v235
    v_mul_f32 v204, v204, v236
    v_mul_f32 v205, v205, v237
    v_mfma_f32_16x16x32_bf16 v[244:247], v[84:87], v[64:67], v[244:247]
    v_mul_f32 v206, v206, v238
    v_mul_f32 v207, v207, v239
    v_cvt_pk_bf16_f32 v200, v200, v201
    v_mfma_f32_16x16x32_bf16 v[216:219], v[72:75], v[68:71], v[216:219]
    v_cvt_pk_bf16_f32 v201, v202, v203
    v_cvt_pk_bf16_f32 v202, v204, v205
    v_cvt_pk_bf16_f32 v203, v206, v207
    v_mfma_f32_16x16x32_bf16 v[248:251], v[80:83], v[68:71], v[248:251]
    v_permlane32_swap_b32 v192, v200
    v_permlane32_swap_b32 v193, v201
    v_permlane32_swap_b32 v194, v202
    v_mfma_f32_16x16x32_bf16 v[220:223], v[76:79], v[68:71], v[220:223]
    v_permlane32_swap_b32 v195, v203
    buffer_store_dwordx4 v[192:195], v3, s[28:31], s60 offen sc1
    buffer_store_dwordx4 v[200:203], v3, s[28:31], s60 offen offset:1024 sc1
    v_mfma_f32_16x16x32_bf16 v[252:255], v[84:87], v[68:71], v[252:255]
    v_mul_f32 v208, v208, v240
    v_mul_f32 v209, v209, v241
    v_mul_f32 v210, v210, v242
    v_mul_f32 v211, v211, v243
    v_mul_f32 v212, v212, v244
    v_mul_f32 v213, v213, v245
    v_mul_f32 v214, v214, v246
    v_mul_f32 v215, v215, v247
    v_cvt_pk_bf16_f32 v208, v208, v209
    v_cvt_pk_bf16_f32 v209, v210, v211
    v_cvt_pk_bf16_f32 v210, v212, v213
    v_cvt_pk_bf16_f32 v211, v214, v215
    v_mul_f32 v216, v216, v248
    v_mul_f32 v217, v217, v249
    v_mul_f32 v218, v218, v250
    v_mul_f32 v219, v219, v251
    v_mul_f32 v220, v220, v252
    v_mul_f32 v221, v221, v253
    v_mul_f32 v222, v222, v254
    v_mul_f32 v223, v223, v255
    v_cvt_pk_bf16_f32 v216, v216, v217
    v_cvt_pk_bf16_f32 v217, v218, v219
    v_cvt_pk_bf16_f32 v218, v220, v221
    v_cvt_pk_bf16_f32 v219, v222, v223
    v_permlane32_swap_b32 v208, v216
    v_permlane32_swap_b32 v209, v217
    v_permlane32_swap_b32 v210, v218
    v_permlane32_swap_b32 v211, v219
    buffer_store_dwordx4 v[208:211], v3, s[28:31], s61 offen sc1
    buffer_store_dwordx4 v[216:219], v3, s[28:31], s61 offen offset:1024 sc1
    s_branch C_ATT
K1_CV:
    v_lshrrev_b32 v16, 1, v7
    v_xor_b32 v16, v16, v7
    v_and_b32 v16, 16, v16
    v_mul_u32_u24 v16, 3, v16
    v_xor_b32 v9, v16, v9
    v_xor_b32 v10, 32, v9
    s_add_u32 s69, s68, 0x10000
    v_mov_b32 v192, -1
    v_mov_b32 v193, -1
    v_mov_b32 v194, -1
    v_mov_b32 v195, -1
    s_lshl_b32 s52, s53, 12
    s_add_u32 s73, s73, s52
    s_add_u32 s73, s73, 0x5f0000
    s_add_u32 s74, s73, 0x8000
    buffer_store_dwordx4 v[192:195], v4, s[28:31], s73 offen offset:0 sc1
    buffer_store_dwordx4 v[192:195], v4, s[28:31], s73 offen offset:1024 sc1
    buffer_store_dwordx4 v[192:195], v4, s[28:31], s74 offen offset:0 sc1
    buffer_store_dwordx4 v[192:195], v4, s[28:31], s74 offen offset:1024 sc1
    s_barrier
    ds_read_b128 v[16:19], v5 offset:0
    ds_read_b64_tr_b16 v[32:33], v7 offset:0
    ds_read_b64_tr_b16 v[34:35], v7 offset:512
    ds_read_b128 v[20:23], v5 offset:1024
    ds_read_b128 v[24:27], v5 offset:4096
    ds_read_b128 v[28:31], v5 offset:5120
    ds_read_b64_tr_b16 v[36:37], v8 offset:0
    ds_read_b64_tr_b16 v[38:39], v8 offset:512
    ds_read_b64_tr_b16 v[40:41], v7 offset:8192
    ds_read_b64_tr_b16 v[42:43], v7 offset:8704
    ds_read_b64_tr_b16 v[44:45], v8 offset:8192
    ds_read_b64_tr_b16 v[46:47], v8 offset:8704
    ds_read_b64_tr_b16 v[48:49], v9 offset:0
    ds_read_b64_tr_b16 v[50:51], v9 offset:512
    ds_read_b64_tr_b16 v[52:53], v10 offset:0
    ds_read_b64_tr_b16 v[54:55], v10 offset:512
    s_waitcnt lgkmcnt(13)
    v_mfma_f32_16x16x32_bf16 v[96:99], v[32:35], v[16:19], 0
    ds_read_b128 v[56:59], v6 offset:0
    s_waitcnt lgkmcnt(13)
    v_mfma_f32_16x16x32_bf16 v[104:107], v[32:35], v[20:23], 0
    ds_read_b64_tr_b16 v[72:73], v7 offset:4096
    s_waitcnt lgkmcnt(13)
    v_mfma_f32_16x16x32_bf16 v[112:115], v[32:35], v[24:27], 0
    ds_read_b64_tr_b16 v[74:75], v7 offset:4608
    s_waitcnt lgkmcnt(13)
    v_mfma_f32_16x16x32_bf16 v[120:123], v[32:35], v[28:31], 0
    ds_read_b128 v[60:63], v6 offset:1024
    s_waitcnt lgkmcnt(12)
    v_mfma_f32_16x16x32_bf16 v[100:103], v[36:39], v[16:19], 0
    ds_read_b128 v[64:67], v6 offset:4096
    v_mfma_f32_16x16x32_bf16 v[108:111], v[36:39], v[20:23], 0
    ds_read_b128 v[68:71], v6 offset:5120
    v_mfma_f32_16x16x32_bf16 v[116:119], v[36:39], v[24:27], 0
    ds_read_b64_tr_b16 v[76:77], v8 offset:4096
    v_mfma_f32_16x16x32_bf16 v[124:127], v[36:39], v[28:31], 0
    ds_read_b64_tr_b16 v[78:79], v8 offset:4608
    s_waitcnt lgkmcnt(14)
    v_mfma_f32_16x16x32_bf16 v[128:131], v[40:43], v[16:19], 0
    ds_read_b64_tr_b16 v[80:81], v7 offset:12288
    v_mfma_f32_16x16x32_bf16 v[136:139], v[40:43], v[20:23], 0
    ds_read_b64_tr_b16 v[82:83], v7 offset:12800
    v_mfma_f32_16x16x32_bf16 v[144:147], v[40:43], v[24:27], 0
    ds_read_b64_tr_b16 v[84:85], v8 offset:12288
    v_mfma_f32_16x16x32_bf16 v[152:155], v[40:43], v[28:31], 0
    ds_read_b64_tr_b16 v[86:87], v8 offset:12800
    s_waitcnt lgkmcnt(15)
    v_mfma_f32_16x16x32_bf16 v[132:135], v[44:47], v[16:19], 0
    ds_read_b64_tr_b16 v[88:89], v9 offset:4096
    v_mfma_f32_16x16x32_bf16 v[140:143], v[44:47], v[20:23], 0
    ds_read_b64_tr_b16 v[90:91], v9 offset:4608
    v_mfma_f32_16x16x32_bf16 v[148:151], v[44:47], v[24:27], 0
    ds_read_b64_tr_b16 v[92:93], v10 offset:4096
    v_mfma_f32_16x16x32_bf16 v[156:159], v[44:47], v[28:31], 0
    ds_read_b64_tr_b16 v[94:95], v10 offset:4608
    s_waitcnt lgkmcnt(15)
    v_mfma_f32_16x16x32_bf16 v[160:163], v[16:19], v[48:51], 0
    v_mfma_f32_16x16x32_bf16 v[164:167], v[20:23], v[48:51], 0
    v_mfma_f32_16x16x32_bf16 v[176:179], v[24:27], v[48:51], 0
    v_mfma_f32_16x16x32_bf16 v[180:183], v[28:31], v[48:51], 0
    v_mfma_f32_16x16x32_bf16 v[168:171], v[16:19], v[52:55], 0
    v_mfma_f32_16x16x32_bf16 v[172:175], v[20:23], v[52:55], 0
    v_mfma_f32_16x16x32_bf16 v[184:187], v[24:27], v[52:55], 0
    v_mfma_f32_16x16x32_bf16 v[188:191], v[28:31], v[52:55], 0
    s_waitcnt lgkmcnt(13)
    v_mfma_f32_16x16x32_bf16 v[96:99], v[72:75], v[56:59], v[96:99]
    s_waitcnt lgkmcnt(12)
    v_mfma_f32_16x16x32_bf16 v[104:107], v[72:75], v[60:63], v[104:107]
    s_waitcnt lgkmcnt(0)
    s_barrier
    s_and_b32 s52, s51, 7
    s_cbranch_scc1 TT_98
    buffer_load_dword v14, v255, s[24:27], 0 offen sc1
TT_98:
    buffer_load_dword v14, v12, s[32:35], s62 offen
    s_add_u32 s62, s62, s63
    ds_read_b128 v[16:19], v5 offset:16384
    v_mfma_f32_16x16x32_bf16 v[112:115], v[72:75], v[64:67], v[112:115]
    ds_read_b64_tr_b16 v[32:33], v7 offset:16384
    v_mfma_f32_16x16x32_bf16 v[120:123], v[72:75], v[68:71], v[120:123]
    ds_read_b64_tr_b16 v[34:35], v7 offset:16896
    v_mfma_f32_16x16x32_bf16 v[100:103], v[76:79], v[56:59], v[100:103]
    ds_read_b128 v[20:23], v5 offset:17408
    v_mfma_f32_16x16x32_bf16 v[108:111], v[76:79], v[60:63], v[108:111]
    ds_read_b128 v[24:27], v5 offset:20480
    v_mfma_f32_16x16x32_bf16 v[116:119], v[76:79], v[64:67], v[116:119]
    ds_read_b128 v[28:31], v5 offset:21504
    v_mfma_f32_16x16x32_bf16 v[124:127], v[76:79], v[68:71], v[124:127]
    ds_read_b64_tr_b16 v[36:37], v8 offset:16384
    v_mfma_f32_16x16x32_bf16 v[128:131], v[80:83], v[56:59], v[128:131]
    ds_read_b64_tr_b16 v[38:39], v8 offset:16896
    v_mfma_f32_16x16x32_bf16 v[136:139], v[80:83], v[60:63], v[136:139]
    ds_read_b64_tr_b16 v[40:41], v7 offset:24576
    v_mfma_f32_16x16x32_bf16 v[144:147], v[80:83], v[64:67], v[144:147]
    ds_read_b64_tr_b16 v[42:43], v7 offset:25088
    v_mfma_f32_16x16x32_bf16 v[152:155], v[80:83], v[68:71], v[152:155]
    ds_read_b64_tr_b16 v[44:45], v8 offset:24576
    v_mfma_f32_16x16x32_bf16 v[132:135], v[84:87], v[56:59], v[132:135]
    ds_read_b64_tr_b16 v[46:47], v8 offset:25088
    v_mfma_f32_16x16x32_bf16 v[140:143], v[84:87], v[60:63], v[140:143]
    ds_read_b64_tr_b16 v[48:49], v9 offset:8192
    v_mfma_f32_16x16x32_bf16 v[148:151], v[84:87], v[64:67], v[148:151]
    ds_read_b64_tr_b16 v[50:51], v9 offset:8704
    v_mfma_f32_16x16x32_bf16 v[156:159], v[84:87], v[68:71], v[156:159]
    ds_read_b64_tr_b16 v[52:53], v10 offset:8192
    v_mfma_f32_16x16x32_bf16 v[160:163], v[56:59], v[88:91], v[160:163]
    ds_read_b64_tr_b16 v[54:55], v10 offset:8704
    v_mfma_f32_16x16x32_bf16 v[164:167], v[60:63], v[88:91], v[164:167]
    v_mfma_f32_16x16x32_bf16 v[176:179], v[64:67], v[88:91], v[176:179]
    v_mfma_f32_16x16x32_bf16 v[180:183], v[68:71], v[88:91], v[180:183]
    v_mfma_f32_16x16x32_bf16 v[168:171], v[56:59], v[92:95], v[168:171]
    v_mfma_f32_16x16x32_bf16 v[172:175], v[60:63], v[92:95], v[172:175]
    v_mfma_f32_16x16x32_bf16 v[184:187], v[64:67], v[92:95], v[184:187]
    v_mfma_f32_16x16x32_bf16 v[188:191], v[68:71], v[92:95], v[188:191]
    s_waitcnt lgkmcnt(13)
    v_mfma_f32_16x16x32_bf16 v[96:99], v[32:35], v[16:19], v[96:99]
    ds_read_b128 v[56:59], v6 offset:16384
    s_waitcnt lgkmcnt(13)
    v_mfma_f32_16x16x32_bf16 v[104:107], v[32:35], v[20:23], v[104:107]
    ds_read_b64_tr_b16 v[72:73], v7 offset:20480
    s_waitcnt lgkmcnt(13)
    v_mfma_f32_16x16x32_bf16 v[112:115], v[32:35], v[24:27], v[112:115]
    ds_read_b64_tr_b16 v[74:75], v7 offset:20992
    s_waitcnt lgkmcnt(13)
    v_mfma_f32_16x16x32_bf16 v[120:123], v[32:35], v[28:31], v[120:123]
    ds_read_b128 v[60:63], v6 offset:17408
    s_waitcnt lgkmcnt(12)
    v_mfma_f32_16x16x32_bf16 v[100:103], v[36:39], v[16:19], v[100:103]
    ds_read_b128 v[64:67], v6 offset:20480
    v_mfma_f32_16x16x32_bf16 v[108:111], v[36:39], v[20:23], v[108:111]
    ds_read_b128 v[68:71], v6 offset:21504
    v_mfma_f32_16x16x32_bf16 v[116:119], v[36:39], v[24:27], v[116:119]
    ds_read_b64_tr_b16 v[76:77], v8 offset:20480
    v_mfma_f32_16x16x32_bf16 v[124:127], v[36:39], v[28:31], v[124:127]
    ds_read_b64_tr_b16 v[78:79], v8 offset:20992
    s_waitcnt lgkmcnt(14)
    v_mfma_f32_16x16x32_bf16 v[128:131], v[40:43], v[16:19], v[128:131]
    ds_read_b64_tr_b16 v[80:81], v7 offset:28672
    v_mfma_f32_16x16x32_bf16 v[136:139], v[40:43], v[20:23], v[136:139]
    ds_read_b64_tr_b16 v[82:83], v7 offset:29184
    v_mfma_f32_16x16x32_bf16 v[144:147], v[40:43], v[24:27], v[144:147]
    ds_read_b64_tr_b16 v[84:85], v8 offset:28672
    v_mfma_f32_16x16x32_bf16 v[152:155], v[40:43], v[28:31], v[152:155]
    ds_read_b64_tr_b16 v[86:87], v8 offset:29184
    s_waitcnt lgkmcnt(15)
    v_mfma_f32_16x16x32_bf16 v[132:135], v[44:47], v[16:19], v[132:135]
    ds_read_b64_tr_b16 v[88:89], v9 offset:12288
    v_mfma_f32_16x16x32_bf16 v[140:143], v[44:47], v[20:23], v[140:143]
    ds_read_b64_tr_b16 v[90:91], v9 offset:12800
    v_mfma_f32_16x16x32_bf16 v[148:151], v[44:47], v[24:27], v[148:151]
    ds_read_b64_tr_b16 v[92:93], v10 offset:12288
    v_mfma_f32_16x16x32_bf16 v[156:159], v[44:47], v[28:31], v[156:159]
    ds_read_b64_tr_b16 v[94:95], v10 offset:12800
    s_waitcnt lgkmcnt(15)
    v_mfma_f32_16x16x32_bf16 v[160:163], v[16:19], v[48:51], v[160:163]
    v_mfma_f32_16x16x32_bf16 v[164:167], v[20:23], v[48:51], v[164:167]
    v_mfma_f32_16x16x32_bf16 v[176:179], v[24:27], v[48:51], v[176:179]
    v_mfma_f32_16x16x32_bf16 v[180:183], v[28:31], v[48:51], v[180:183]
    v_mfma_f32_16x16x32_bf16 v[168:171], v[16:19], v[52:55], v[168:171]
    v_mfma_f32_16x16x32_bf16 v[172:175], v[20:23], v[52:55], v[172:175]
    v_mfma_f32_16x16x32_bf16 v[184:187], v[24:27], v[52:55], v[184:187]
    v_mfma_f32_16x16x32_bf16 v[188:191], v[28:31], v[52:55], v[188:191]
    s_waitcnt lgkmcnt(13)
    v_mfma_f32_16x16x32_bf16 v[96:99], v[72:75], v[56:59], v[96:99]
    s_waitcnt lgkmcnt(12)
    v_mfma_f32_16x16x32_bf16 v[104:107], v[72:75], v[60:63], v[104:107]
    s_waitcnt lgkmcnt(0)
    s_barrier
    v_and_b32 v15, 7, v1
    v_lshlrev_b32 v15, 7, v15
    buffer_load_dword v14, v15, s[40:43], s75 offen
    ds_read_b128 v[16:19], v5 offset:32768
    v_mfma_f32_16x16x32_bf16 v[112:115], v[72:75], v[64:67], v[112:115]
    ds_read_b64_tr_b16 v[32:33], v7 offset:32768
    v_mfma_f32_16x16x32_bf16 v[120:123], v[72:75], v[68:71], v[120:123]
    ds_read_b64_tr_b16 v[34:35], v7 offset:33280
    v_mfma_f32_16x16x32_bf16 v[100:103], v[76:79], v[56:59], v[100:103]
    ds_read_b128 v[20:23], v5 offset:33792
    v_mfma_f32_16x16x32_bf16 v[108:111], v[76:79], v[60:63], v[108:111]
    ds_read_b128 v[24:27], v5 offset:36864
    v_mfma_f32_16x16x32_bf16 v[116:119], v[76:79], v[64:67], v[116:119]
    ds_read_b128 v[28:31], v5 offset:37888
    v_mfma_f32_16x16x32_bf16 v[124:127], v[76:79], v[68:71], v[124:127]
    ds_read_b64_tr_b16 v[36:37], v8 offset:32768
    v_mfma_f32_16x16x32_bf16 v[128:131], v[80:83], v[56:59], v[128:131]
    ds_read_b64_tr_b16 v[38:39], v8 offset:33280
    v_mfma_f32_16x16x32_bf16 v[136:139], v[80:83], v[60:63], v[136:139]
    ds_read_b64_tr_b16 v[40:41], v7 offset:40960
    v_mfma_f32_16x16x32_bf16 v[144:147], v[80:83], v[64:67], v[144:147]
    ds_read_b64_tr_b16 v[42:43], v7 offset:41472
    v_mfma_f32_16x16x32_bf16 v[152:155], v[80:83], v[68:71], v[152:155]
    ds_read_b64_tr_b16 v[44:45], v8 offset:40960
    v_mfma_f32_16x16x32_bf16 v[132:135], v[84:87], v[56:59], v[132:135]
    ds_read_b64_tr_b16 v[46:47], v8 offset:41472
    v_mfma_f32_16x16x32_bf16 v[140:143], v[84:87], v[60:63], v[140:143]
    ds_read_b64_tr_b16 v[48:49], v9 offset:16384
    v_mfma_f32_16x16x32_bf16 v[148:151], v[84:87], v[64:67], v[148:151]
    ds_read_b64_tr_b16 v[50:51], v9 offset:16896
    v_mfma_f32_16x16x32_bf16 v[156:159], v[84:87], v[68:71], v[156:159]
    ds_read_b64_tr_b16 v[52:53], v10 offset:16384
    v_mfma_f32_16x16x32_bf16 v[160:163], v[56:59], v[88:91], v[160:163]
    ds_read_b64_tr_b16 v[54:55], v10 offset:16896
    v_mfma_f32_16x16x32_bf16 v[164:167], v[60:63], v[88:91], v[164:167]
    v_mfma_f32_16x16x32_bf16 v[176:179], v[64:67], v[88:91], v[176:179]
    v_mfma_f32_16x16x32_bf16 v[180:183], v[68:71], v[88:91], v[180:183]
    v_mfma_f32_16x16x32_bf16 v[168:171], v[56:59], v[92:95], v[168:171]
    v_mfma_f32_16x16x32_bf16 v[172:175], v[60:63], v[92:95], v[172:175]
    v_mfma_f32_16x16x32_bf16 v[184:187], v[64:67], v[92:95], v[184:187]
    v_mfma_f32_16x16x32_bf16 v[188:191], v[68:71], v[92:95], v[188:191]
    s_waitcnt lgkmcnt(13)
    v_mfma_f32_16x16x32_bf16 v[96:99], v[32:35], v[16:19], v[96:99]
    ds_read_b128 v[56:59], v6 offset:32768
    s_waitcnt lgkmcnt(13)
    v_mfma_f32_16x16x32_bf16 v[104:107], v[32:35], v[20:23], v[104:107]
    ds_read_b64_tr_b16 v[72:73], v7 offset:36864
    s_waitcnt lgkmcnt(13)
    v_mfma_f32_16x16x32_bf16 v[112:115], v[32:35], v[24:27], v[112:115]
    ds_read_b64_tr_b16 v[74:75], v7 offset:37376
    s_waitcnt lgkmcnt(13)
    v_mfma_f32_16x16x32_bf16 v[120:123], v[32:35], v[28:31], v[120:123]
    ds_read_b128 v[60:63], v6 offset:33792
    s_waitcnt lgkmcnt(12)
    v_mfma_f32_16x16x32_bf16 v[100:103], v[36:39], v[16:19], v[100:103]
    ds_read_b128 v[64:67], v6 offset:36864
    v_mfma_f32_16x16x32_bf16 v[108:111], v[36:39], v[20:23], v[108:111]
    ds_read_b128 v[68:71], v6 offset:37888
    v_mfma_f32_16x16x32_bf16 v[116:119], v[36:39], v[24:27], v[116:119]
    ds_read_b64_tr_b16 v[76:77], v8 offset:36864
    v_mfma_f32_16x16x32_bf16 v[124:127], v[36:39], v[28:31], v[124:127]
    ds_read_b64_tr_b16 v[78:79], v8 offset:37376
    s_waitcnt lgkmcnt(14)
    v_mfma_f32_16x16x32_bf16 v[128:131], v[40:43], v[16:19], v[128:131]
    ds_read_b64_tr_b16 v[80:81], v7 offset:45056
    v_mfma_f32_16x16x32_bf16 v[136:139], v[40:43], v[20:23], v[136:139]
    ds_read_b64_tr_b16 v[82:83], v7 offset:45568
    v_mfma_f32_16x16x32_bf16 v[144:147], v[40:43], v[24:27], v[144:147]
    ds_read_b64_tr_b16 v[84:85], v8 offset:45056
    v_mfma_f32_16x16x32_bf16 v[152:155], v[40:43], v[28:31], v[152:155]
    ds_read_b64_tr_b16 v[86:87], v8 offset:45568
    s_waitcnt lgkmcnt(15)
    v_mfma_f32_16x16x32_bf16 v[132:135], v[44:47], v[16:19], v[132:135]
    ds_read_b64_tr_b16 v[88:89], v9 offset:20480
    v_mfma_f32_16x16x32_bf16 v[140:143], v[44:47], v[20:23], v[140:143]
    ds_read_b64_tr_b16 v[90:91], v9 offset:20992
    v_mfma_f32_16x16x32_bf16 v[148:151], v[44:47], v[24:27], v[148:151]
    ds_read_b64_tr_b16 v[92:93], v10 offset:20480
    v_mfma_f32_16x16x32_bf16 v[156:159], v[44:47], v[28:31], v[156:159]
    ds_read_b64_tr_b16 v[94:95], v10 offset:20992
    s_waitcnt lgkmcnt(15)
    v_mfma_f32_16x16x32_bf16 v[160:163], v[16:19], v[48:51], v[160:163]
    v_mfma_f32_16x16x32_bf16 v[164:167], v[20:23], v[48:51], v[164:167]
    v_mfma_f32_16x16x32_bf16 v[176:179], v[24:27], v[48:51], v[176:179]
    v_mfma_f32_16x16x32_bf16 v[180:183], v[28:31], v[48:51], v[180:183]
    v_mfma_f32_16x16x32_bf16 v[168:171], v[16:19], v[52:55], v[168:171]
    v_mfma_f32_16x16x32_bf16 v[172:175], v[20:23], v[52:55], v[172:175]
    v_mfma_f32_16x16x32_bf16 v[184:187], v[24:27], v[52:55], v[184:187]
    v_mfma_f32_16x16x32_bf16 v[188:191], v[28:31], v[52:55], v[188:191]
    s_waitcnt lgkmcnt(13)
    v_mfma_f32_16x16x32_bf16 v[96:99], v[72:75], v[56:59], v[96:99]
    s_waitcnt lgkmcnt(12)
    v_mfma_f32_16x16x32_bf16 v[104:107], v[72:75], v[60:63], v[104:107]
    s_waitcnt lgkmcnt(0)
    s_barrier
    buffer_load_dword v14, v12, s[32:35], s62 offen
    s_add_u32 s62, s62, s63
    ds_read_b128 v[16:19], v5 offset:49152
    v_mfma_f32_16x16x32_bf16 v[112:115], v[72:75], v[64:67], v[112:115]
    ds_read_b64_tr_b16 v[32:33], v7 offset:49152
    v_mfma_f32_16x16x32_bf16 v[120:123], v[72:75], v[68:71], v[120:123]
    ds_read_b64_tr_b16 v[34:35], v7 offset:49664
    v_mfma_f32_16x16x32_bf16 v[100:103], v[76:79], v[56:59], v[100:103]
    ds_read_b128 v[20:23], v5 offset:50176
    v_mfma_f32_16x16x32_bf16 v[108:111], v[76:79], v[60:63], v[108:111]
    ds_read_b128 v[24:27], v5 offset:53248
    v_mfma_f32_16x16x32_bf16 v[116:119], v[76:79], v[64:67], v[116:119]
    ds_read_b128 v[28:31], v5 offset:54272
    v_mfma_f32_16x16x32_bf16 v[124:127], v[76:79], v[68:71], v[124:127]
    ds_read_b64_tr_b16 v[36:37], v8 offset:49152
    v_mfma_f32_16x16x32_bf16 v[128:131], v[80:83], v[56:59], v[128:131]
    ds_read_b64_tr_b16 v[38:39], v8 offset:49664
    v_mfma_f32_16x16x32_bf16 v[136:139], v[80:83], v[60:63], v[136:139]
    ds_read_b64_tr_b16 v[40:41], v7 offset:57344
    v_mfma_f32_16x16x32_bf16 v[144:147], v[80:83], v[64:67], v[144:147]
    ds_read_b64_tr_b16 v[42:43], v7 offset:57856
    v_mfma_f32_16x16x32_bf16 v[152:155], v[80:83], v[68:71], v[152:155]
    ds_read_b64_tr_b16 v[44:45], v8 offset:57344
    v_mfma_f32_16x16x32_bf16 v[132:135], v[84:87], v[56:59], v[132:135]
    ds_read_b64_tr_b16 v[46:47], v8 offset:57856
    v_mfma_f32_16x16x32_bf16 v[140:143], v[84:87], v[60:63], v[140:143]
    ds_read_b64_tr_b16 v[48:49], v9 offset:24576
    v_mfma_f32_16x16x32_bf16 v[148:151], v[84:87], v[64:67], v[148:151]
    ds_read_b64_tr_b16 v[50:51], v9 offset:25088
    v_mfma_f32_16x16x32_bf16 v[156:159], v[84:87], v[68:71], v[156:159]
    ds_read_b64_tr_b16 v[52:53], v10 offset:24576
    v_mfma_f32_16x16x32_bf16 v[160:163], v[56:59], v[88:91], v[160:163]
    ds_read_b64_tr_b16 v[54:55], v10 offset:25088
    v_mfma_f32_16x16x32_bf16 v[164:167], v[60:63], v[88:91], v[164:167]
    v_mfma_f32_16x16x32_bf16 v[176:179], v[64:67], v[88:91], v[176:179]
    v_mfma_f32_16x16x32_bf16 v[180:183], v[68:71], v[88:91], v[180:183]
    v_mfma_f32_16x16x32_bf16 v[168:171], v[56:59], v[92:95], v[168:171]
    v_mfma_f32_16x16x32_bf16 v[172:175], v[60:63], v[92:95], v[172:175]
    v_mfma_f32_16x16x32_bf16 v[184:187], v[64:67], v[92:95], v[184:187]
    v_mfma_f32_16x16x32_bf16 v[188:191], v[68:71], v[92:95], v[188:191]
    s_waitcnt lgkmcnt(13)
    v_mfma_f32_16x16x32_bf16 v[96:99], v[32:35], v[16:19], v[96:99]
    ds_read_b128 v[56:59], v6 offset:49152
    s_waitcnt lgkmcnt(13)
    v_mfma_f32_16x16x32_bf16 v[104:107], v[32:35], v[20:23], v[104:107]
    ds_read_b64_tr_b16 v[72:73], v7 offset:53248
    s_waitcnt lgkmcnt(13)
    v_mfma_f32_16x16x32_bf16 v[112:115], v[32:35], v[24:27], v[112:115]
    ds_read_b64_tr_b16 v[74:75], v7 offset:53760
    s_waitcnt lgkmcnt(13)
    v_mfma_f32_16x16x32_bf16 v[120:123], v[32:35], v[28:31], v[120:123]
    ds_read_b128 v[60:63], v6 offset:50176
    s_waitcnt lgkmcnt(12)
    v_mfma_f32_16x16x32_bf16 v[100:103], v[36:39], v[16:19], v[100:103]
    ds_read_b128 v[64:67], v6 offset:53248
    v_mfma_f32_16x16x32_bf16 v[108:111], v[36:39], v[20:23], v[108:111]
    ds_read_b128 v[68:71], v6 offset:54272
    v_mfma_f32_16x16x32_bf16 v[116:119], v[36:39], v[24:27], v[116:119]
    ds_read_b64_tr_b16 v[76:77], v8 offset:53248
    v_mfma_f32_16x16x32_bf16 v[124:127], v[36:39], v[28:31], v[124:127]
    ds_read_b64_tr_b16 v[78:79], v8 offset:53760
    s_waitcnt lgkmcnt(14)
    v_mfma_f32_16x16x32_bf16 v[128:131], v[40:43], v[16:19], v[128:131]
    ds_read_b64_tr_b16 v[80:81], v7 offset:61440
    v_mfma_f32_16x16x32_bf16 v[136:139], v[40:43], v[20:23], v[136:139]
    ds_read_b64_tr_b16 v[82:83], v7 offset:61952
    v_mfma_f32_16x16x32_bf16 v[144:147], v[40:43], v[24:27], v[144:147]
    ds_read_b64_tr_b16 v[84:85], v8 offset:61440
    v_mfma_f32_16x16x32_bf16 v[152:155], v[40:43], v[28:31], v[152:155]
    ds_read_b64_tr_b16 v[86:87], v8 offset:61952
    s_waitcnt lgkmcnt(15)
    v_mfma_f32_16x16x32_bf16 v[132:135], v[44:47], v[16:19], v[132:135]
    ds_read_b64_tr_b16 v[88:89], v9 offset:28672
    v_mfma_f32_16x16x32_bf16 v[140:143], v[44:47], v[20:23], v[140:143]
    ds_read_b64_tr_b16 v[90:91], v9 offset:29184
    v_mfma_f32_16x16x32_bf16 v[148:151], v[44:47], v[24:27], v[148:151]
    ds_read_b64_tr_b16 v[92:93], v10 offset:28672
    v_mfma_f32_16x16x32_bf16 v[156:159], v[44:47], v[28:31], v[156:159]
    ds_read_b64_tr_b16 v[94:95], v10 offset:29184
    s_waitcnt lgkmcnt(15)
    v_mfma_f32_16x16x32_bf16 v[160:163], v[16:19], v[48:51], v[160:163]
    v_mfma_f32_16x16x32_bf16 v[164:167], v[20:23], v[48:51], v[164:167]
    v_mfma_f32_16x16x32_bf16 v[176:179], v[24:27], v[48:51], v[176:179]
    v_mfma_f32_16x16x32_bf16 v[180:183], v[28:31], v[48:51], v[180:183]
    v_mfma_f32_16x16x32_bf16 v[168:171], v[16:19], v[52:55], v[168:171]
    v_mfma_f32_16x16x32_bf16 v[172:175], v[20:23], v[52:55], v[172:175]
    v_mfma_f32_16x16x32_bf16 v[184:187], v[24:27], v[52:55], v[184:187]
    v_mfma_f32_16x16x32_bf16 v[188:191], v[28:31], v[52:55], v[188:191]
    s_waitcnt lgkmcnt(13)
    v_mfma_f32_16x16x32_bf16 v[96:99], v[72:75], v[56:59], v[96:99]
    s_waitcnt lgkmcnt(12)
    v_mfma_f32_16x16x32_bf16 v[104:107], v[72:75], v[60:63], v[104:107]
    s_waitcnt lgkmcnt(0)
    s_barrier
    buffer_load_dword v14, v13, s[32:35], s64 offen
    ds_read_b128 v[16:19], v5 offset:0
    v_mfma_f32_16x16x32_bf16 v[112:115], v[72:75], v[64:67], v[112:115]
    ds_read_b64_tr_b16 v[32:33], v7 offset:0
    v_mfma_f32_16x16x32_bf16 v[120:123], v[72:75], v[68:71], v[120:123]
    ds_read_b64_tr_b16 v[34:35], v7 offset:512
    v_mfma_f32_16x16x32_bf16 v[100:103], v[76:79], v[56:59], v[100:103]
    ds_read_b128 v[20:23], v5 offset:1024
    v_mfma_f32_16x16x32_bf16 v[108:111], v[76:79], v[60:63], v[108:111]
    ds_read_b128 v[24:27], v5 offset:4096
    v_mfma_f32_16x16x32_bf16 v[116:119], v[76:79], v[64:67], v[116:119]
    ds_read_b128 v[28:31], v5 offset:5120
    v_mfma_f32_16x16x32_bf16 v[124:127], v[76:79], v[68:71], v[124:127]
    ds_read_b64_tr_b16 v[36:37], v8 offset:0
    v_mfma_f32_16x16x32_bf16 v[128:131], v[80:83], v[56:59], v[128:131]
    ds_read_b64_tr_b16 v[38:39], v8 offset:512
    v_mfma_f32_16x16x32_bf16 v[136:139], v[80:83], v[60:63], v[136:139]
    ds_read_b64_tr_b16 v[40:41], v7 offset:8192
    v_mfma_f32_16x16x32_bf16 v[144:147], v[80:83], v[64:67], v[144:147]
    ds_read_b64_tr_b16 v[42:43], v7 offset:8704
    v_mfma_f32_16x16x32_bf16 v[152:155], v[80:83], v[68:71], v[152:155]
    ds_read_b64_tr_b16 v[44:45], v8 offset:8192
    v_mfma_f32_16x16x32_bf16 v[132:135], v[84:87], v[56:59], v[132:135]
    ds_read_b64_tr_b16 v[46:47], v8 offset:8704
    v_mfma_f32_16x16x32_bf16 v[140:143], v[84:87], v[60:63], v[140:143]
    ds_read_b64_tr_b16 v[48:49], v9 offset:0
    v_mfma_f32_16x16x32_bf16 v[148:151], v[84:87], v[64:67], v[148:151]
    ds_read_b64_tr_b16 v[50:51], v9 offset:512
    v_mfma_f32_16x16x32_bf16 v[156:159], v[84:87], v[68:71], v[156:159]
    ds_read_b64_tr_b16 v[52:53], v10 offset:0
    v_mfma_f32_16x16x32_bf16 v[160:163], v[56:59], v[88:91], v[160:163]
    ds_read_b64_tr_b16 v[54:55], v10 offset:512
    v_mfma_f32_16x16x32_bf16 v[164:167], v[60:63], v[88:91], v[164:167]
    v_mfma_f32_16x16x32_bf16 v[176:179], v[64:67], v[88:91], v[176:179]
    v_mfma_f32_16x16x32_bf16 v[180:183], v[68:71], v[88:91], v[180:183]
    v_mfma_f32_16x16x32_bf16 v[168:171], v[56:59], v[92:95], v[168:171]
    v_mfma_f32_16x16x32_bf16 v[172:175], v[60:63], v[92:95], v[172:175]
    v_mfma_f32_16x16x32_bf16 v[184:187], v[64:67], v[92:95], v[184:187]
    v_mfma_f32_16x16x32_bf16 v[188:191], v[68:71], v[92:95], v[188:191]
    s_waitcnt lgkmcnt(13)
    v_mfma_f32_16x16x32_bf16 v[96:99], v[32:35], v[16:19], v[96:99]
    ds_read_b128 v[56:59], v6 offset:0
    s_waitcnt lgkmcnt(13)
    v_mfma_f32_16x16x32_bf16 v[104:107], v[32:35], v[20:23], v[104:107]
    ds_read_b64_tr_b16 v[72:73], v7 offset:4096
    s_waitcnt lgkmcnt(13)
    v_mfma_f32_16x16x32_bf16 v[112:115], v[32:35], v[24:27], v[112:115]
    ds_read_b64_tr_b16 v[74:75], v7 offset:4608
    s_waitcnt lgkmcnt(13)
    v_mfma_f32_16x16x32_bf16 v[120:123], v[32:35], v[28:31], v[120:123]
    ds_read_b128 v[60:63], v6 offset:1024
    s_waitcnt lgkmcnt(12)
    v_mfma_f32_16x16x32_bf16 v[100:103], v[36:39], v[16:19], v[100:103]
    ds_read_b128 v[64:67], v6 offset:4096
    v_mfma_f32_16x16x32_bf16 v[108:111], v[36:39], v[20:23], v[108:111]
    ds_read_b128 v[68:71], v6 offset:5120
    v_mfma_f32_16x16x32_bf16 v[116:119], v[36:39], v[24:27], v[116:119]
    ds_read_b64_tr_b16 v[76:77], v8 offset:4096
    v_mfma_f32_16x16x32_bf16 v[124:127], v[36:39], v[28:31], v[124:127]
    ds_read_b64_tr_b16 v[78:79], v8 offset:4608
    s_waitcnt lgkmcnt(14)
    v_mfma_f32_16x16x32_bf16 v[128:131], v[40:43], v[16:19], v[128:131]
    ds_read_b64_tr_b16 v[80:81], v7 offset:12288
    v_mfma_f32_16x16x32_bf16 v[136:139], v[40:43], v[20:23], v[136:139]
    ds_read_b64_tr_b16 v[82:83], v7 offset:12800
    v_mfma_f32_16x16x32_bf16 v[144:147], v[40:43], v[24:27], v[144:147]
    ds_read_b64_tr_b16 v[84:85], v8 offset:12288
    v_mfma_f32_16x16x32_bf16 v[152:155], v[40:43], v[28:31], v[152:155]
    ds_read_b64_tr_b16 v[86:87], v8 offset:12800
    s_waitcnt lgkmcnt(15)
    v_mfma_f32_16x16x32_bf16 v[132:135], v[44:47], v[16:19], v[132:135]
    ds_read_b64_tr_b16 v[88:89], v9 offset:4096
    v_mfma_f32_16x16x32_bf16 v[140:143], v[44:47], v[20:23], v[140:143]
    ds_read_b64_tr_b16 v[90:91], v9 offset:4608
    v_mfma_f32_16x16x32_bf16 v[148:151], v[44:47], v[24:27], v[148:151]
    ds_read_b64_tr_b16 v[92:93], v10 offset:4096
    v_mfma_f32_16x16x32_bf16 v[156:159], v[44:47], v[28:31], v[156:159]
    ds_read_b64_tr_b16 v[94:95], v10 offset:4608
    s_waitcnt lgkmcnt(15)
    v_mfma_f32_16x16x32_bf16 v[160:163], v[16:19], v[48:51], v[160:163]
    v_mfma_f32_16x16x32_bf16 v[164:167], v[20:23], v[48:51], v[164:167]
    v_mfma_f32_16x16x32_bf16 v[176:179], v[24:27], v[48:51], v[176:179]
    v_mfma_f32_16x16x32_bf16 v[180:183], v[28:31], v[48:51], v[180:183]
    v_mfma_f32_16x16x32_bf16 v[168:171], v[16:19], v[52:55], v[168:171]
    v_mfma_f32_16x16x32_bf16 v[172:175], v[20:23], v[52:55], v[172:175]
    v_mfma_f32_16x16x32_bf16 v[184:187], v[24:27], v[52:55], v[184:187]
    v_mfma_f32_16x16x32_bf16 v[188:191], v[28:31], v[52:55], v[188:191]
    s_waitcnt lgkmcnt(13)
    v_mfma_f32_16x16x32_bf16 v[96:99], v[72:75], v[56:59], v[96:99]
    s_waitcnt lgkmcnt(12)
    v_mfma_f32_16x16x32_bf16 v[104:107], v[72:75], v[60:63], v[104:107]
    s_waitcnt lgkmcnt(0)
    s_barrier
    buffer_load_dword v15, v0, s[36:39], 0 offen sc1
    ds_read_b128 v[16:19], v5 offset:16384
    v_mfma_f32_16x16x32_bf16 v[112:115], v[72:75], v[64:67], v[112:115]
    ds_read_b64_tr_b16 v[32:33], v7 offset:16384
    v_mfma_f32_16x16x32_bf16 v[120:123], v[72:75], v[68:71], v[120:123]
    ds_read_b64_tr_b16 v[34:35], v7 offset:16896
    v_mfma_f32_16x16x32_bf16 v[100:103], v[76:79], v[56:59], v[100:103]
    ds_read_b128 v[20:23], v5 offset:17408
    v_mfma_f32_16x16x32_bf16 v[108:111], v[76:79], v[60:63], v[108:111]
    ds_read_b128 v[24:27], v5 offset:20480
    v_mfma_f32_16x16x32_bf16 v[116:119], v[76:79], v[64:67], v[116:119]
    ds_read_b128 v[28:31], v5 offset:21504
    v_mfma_f32_16x16x32_bf16 v[124:127], v[76:79], v[68:71], v[124:127]
    ds_read_b64_tr_b16 v[36:37], v8 offset:16384
    v_mfma_f32_16x16x32_bf16 v[128:131], v[80:83], v[56:59], v[128:131]
    ds_read_b64_tr_b16 v[38:39], v8 offset:16896
    v_mfma_f32_16x16x32_bf16 v[136:139], v[80:83], v[60:63], v[136:139]
    ds_read_b64_tr_b16 v[40:41], v7 offset:24576
    v_mfma_f32_16x16x32_bf16 v[144:147], v[80:83], v[64:67], v[144:147]
    ds_read_b64_tr_b16 v[42:43], v7 offset:25088
    v_mfma_f32_16x16x32_bf16 v[152:155], v[80:83], v[68:71], v[152:155]
    ds_read_b64_tr_b16 v[44:45], v8 offset:24576
    v_mfma_f32_16x16x32_bf16 v[132:135], v[84:87], v[56:59], v[132:135]
    ds_read_b64_tr_b16 v[46:47], v8 offset:25088
    v_mfma_f32_16x16x32_bf16 v[140:143], v[84:87], v[60:63], v[140:143]
    ds_read_b64_tr_b16 v[48:49], v9 offset:8192
    v_mfma_f32_16x16x32_bf16 v[148:151], v[84:87], v[64:67], v[148:151]
    ds_read_b64_tr_b16 v[50:51], v9 offset:8704
    v_mfma_f32_16x16x32_bf16 v[156:159], v[84:87], v[68:71], v[156:159]
    ds_read_b64_tr_b16 v[52:53], v10 offset:8192
    v_mfma_f32_16x16x32_bf16 v[160:163], v[56:59], v[88:91], v[160:163]
    ds_read_b64_tr_b16 v[54:55], v10 offset:8704
    v_mfma_f32_16x16x32_bf16 v[164:167], v[60:63], v[88:91], v[164:167]
    v_mfma_f32_16x16x32_bf16 v[176:179], v[64:67], v[88:91], v[176:179]
    v_mfma_f32_16x16x32_bf16 v[180:183], v[68:71], v[88:91], v[180:183]
    v_mfma_f32_16x16x32_bf16 v[168:171], v[56:59], v[92:95], v[168:171]
    v_mfma_f32_16x16x32_bf16 v[172:175], v[60:63], v[92:95], v[172:175]
    v_mfma_f32_16x16x32_bf16 v[184:187], v[64:67], v[92:95], v[184:187]
    v_mfma_f32_16x16x32_bf16 v[188:191], v[68:71], v[92:95], v[188:191]
    s_waitcnt lgkmcnt(13)
    v_mfma_f32_16x16x32_bf16 v[96:99], v[32:35], v[16:19], v[96:99]
    ds_read_b128 v[56:59], v6 offset:16384
    s_waitcnt lgkmcnt(13)
    v_mfma_f32_16x16x32_bf16 v[104:107], v[32:35], v[20:23], v[104:107]
    ds_read_b64_tr_b16 v[72:73], v7 offset:20480
    s_waitcnt lgkmcnt(13)
    v_mfma_f32_16x16x32_bf16 v[112:115], v[32:35], v[24:27], v[112:115]
    ds_read_b64_tr_b16 v[74:75], v7 offset:20992
    s_waitcnt lgkmcnt(13)
    v_mfma_f32_16x16x32_bf16 v[120:123], v[32:35], v[28:31], v[120:123]
    ds_read_b128 v[60:63], v6 offset:17408
    s_waitcnt lgkmcnt(12)
    v_mfma_f32_16x16x32_bf16 v[100:103], v[36:39], v[16:19], v[100:103]
    ds_read_b128 v[64:67], v6 offset:20480
    v_mfma_f32_16x16x32_bf16 v[108:111], v[36:39], v[20:23], v[108:111]
    ds_read_b128 v[68:71], v6 offset:21504
    v_mfma_f32_16x16x32_bf16 v[116:119], v[36:39], v[24:27], v[116:119]
    ds_read_b64_tr_b16 v[76:77], v8 offset:20480
    v_mfma_f32_16x16x32_bf16 v[124:127], v[36:39], v[28:31], v[124:127]
    ds_read_b64_tr_b16 v[78:79], v8 offset:20992
    s_waitcnt lgkmcnt(14)
    v_mfma_f32_16x16x32_bf16 v[128:131], v[40:43], v[16:19], v[128:131]
    ds_read_b64_tr_b16 v[80:81], v7 offset:28672
    v_mfma_f32_16x16x32_bf16 v[136:139], v[40:43], v[20:23], v[136:139]
    ds_read_b64_tr_b16 v[82:83], v7 offset:29184
    v_mfma_f32_16x16x32_bf16 v[144:147], v[40:43], v[24:27], v[144:147]
    ds_read_b64_tr_b16 v[84:85], v8 offset:28672
    v_mfma_f32_16x16x32_bf16 v[152:155], v[40:43], v[28:31], v[152:155]
    ds_read_b64_tr_b16 v[86:87], v8 offset:29184
    s_waitcnt lgkmcnt(15)
    v_mfma_f32_16x16x32_bf16 v[132:135], v[44:47], v[16:19], v[132:135]
    ds_read_b64_tr_b16 v[88:89], v9 offset:12288
    v_mfma_f32_16x16x32_bf16 v[140:143], v[44:47], v[20:23], v[140:143]
    ds_read_b64_tr_b16 v[90:91], v9 offset:12800
    v_mfma_f32_16x16x32_bf16 v[148:151], v[44:47], v[24:27], v[148:151]
    ds_read_b64_tr_b16 v[92:93], v10 offset:12288
    v_mfma_f32_16x16x32_bf16 v[156:159], v[44:47], v[28:31], v[156:159]
    ds_read_b64_tr_b16 v[94:95], v10 offset:12800
    s_waitcnt lgkmcnt(15)
    v_mfma_f32_16x16x32_bf16 v[160:163], v[16:19], v[48:51], v[160:163]
    v_mfma_f32_16x16x32_bf16 v[164:167], v[20:23], v[48:51], v[164:167]
    v_mfma_f32_16x16x32_bf16 v[176:179], v[24:27], v[48:51], v[176:179]
    v_mfma_f32_16x16x32_bf16 v[180:183], v[28:31], v[48:51], v[180:183]
    v_mfma_f32_16x16x32_bf16 v[168:171], v[16:19], v[52:55], v[168:171]
    v_mfma_f32_16x16x32_bf16 v[172:175], v[20:23], v[52:55], v[172:175]
    v_mfma_f32_16x16x32_bf16 v[184:187], v[24:27], v[52:55], v[184:187]
    v_mfma_f32_16x16x32_bf16 v[188:191], v[28:31], v[52:55], v[188:191]
    s_waitcnt lgkmcnt(13)
    v_mfma_f32_16x16x32_bf16 v[96:99], v[72:75], v[56:59], v[96:99]
    s_waitcnt lgkmcnt(12)
    v_mfma_f32_16x16x32_bf16 v[104:107], v[72:75], v[60:63], v[104:107]
    s_waitcnt lgkmcnt(0)
    s_barrier
    ds_read_b128 v[16:19], v5 offset:32768
    v_mfma_f32_16x16x32_bf16 v[112:115], v[72:75], v[64:67], v[112:115]
    ds_read_b64_tr_b16 v[32:33], v7 offset:32768
    v_mfma_f32_16x16x32_bf16 v[120:123], v[72:75], v[68:71], v[120:123]
    ds_read_b64_tr_b16 v[34:35], v7 offset:33280
    v_mfma_f32_16x16x32_bf16 v[100:103], v[76:79], v[56:59], v[100:103]
    ds_read_b128 v[20:23], v5 offset:33792
    v_mfma_f32_16x16x32_bf16 v[108:111], v[76:79], v[60:63], v[108:111]
    ds_read_b128 v[24:27], v5 offset:36864
    v_mfma_f32_16x16x32_bf16 v[116:119], v[76:79], v[64:67], v[116:119]
    ds_read_b128 v[28:31], v5 offset:37888
    v_mfma_f32_16x16x32_bf16 v[124:127], v[76:79], v[68:71], v[124:127]
    ds_read_b64_tr_b16 v[36:37], v8 offset:32768
    v_mfma_f32_16x16x32_bf16 v[128:131], v[80:83], v[56:59], v[128:131]
    ds_read_b64_tr_b16 v[38:39], v8 offset:33280
    v_mfma_f32_16x16x32_bf16 v[136:139], v[80:83], v[60:63], v[136:139]
    ds_read_b64_tr_b16 v[40:41], v7 offset:40960
    v_mfma_f32_16x16x32_bf16 v[144:147], v[80:83], v[64:67], v[144:147]
    ds_read_b64_tr_b16 v[42:43], v7 offset:41472
    v_mfma_f32_16x16x32_bf16 v[152:155], v[80:83], v[68:71], v[152:155]
    ds_read_b64_tr_b16 v[44:45], v8 offset:40960
    v_mfma_f32_16x16x32_bf16 v[132:135], v[84:87], v[56:59], v[132:135]
    ds_read_b64_tr_b16 v[46:47], v8 offset:41472
    v_mfma_f32_16x16x32_bf16 v[140:143], v[84:87], v[60:63], v[140:143]
    ds_read_b64_tr_b16 v[48:49], v9 offset:16384
    v_mfma_f32_16x16x32_bf16 v[148:151], v[84:87], v[64:67], v[148:151]
    ds_read_b64_tr_b16 v[50:51], v9 offset:16896
    v_mfma_f32_16x16x32_bf16 v[156:159], v[84:87], v[68:71], v[156:159]
    ds_read_b64_tr_b16 v[52:53], v10 offset:16384
    v_mfma_f32_16x16x32_bf16 v[160:163], v[56:59], v[88:91], v[160:163]
    ds_read_b64_tr_b16 v[54:55], v10 offset:16896
    v_mfma_f32_16x16x32_bf16 v[164:167], v[60:63], v[88:91], v[164:167]
    v_mfma_f32_16x16x32_bf16 v[176:179], v[64:67], v[88:91], v[176:179]
    v_mfma_f32_16x16x32_bf16 v[180:183], v[68:71], v[88:91], v[180:183]
    v_mfma_f32_16x16x32_bf16 v[168:171], v[56:59], v[92:95], v[168:171]
    v_mfma_f32_16x16x32_bf16 v[172:175], v[60:63], v[92:95], v[172:175]
    v_mfma_f32_16x16x32_bf16 v[184:187], v[64:67], v[92:95], v[184:187]
    v_mfma_f32_16x16x32_bf16 v[188:191], v[68:71], v[92:95], v[188:191]
    s_waitcnt lgkmcnt(13)
    v_mfma_f32_16x16x32_bf16 v[96:99], v[32:35], v[16:19], v[96:99]
    ds_read_b128 v[56:59], v6 offset:32768
    s_waitcnt lgkmcnt(13)
    v_mfma_f32_16x16x32_bf16 v[104:107], v[32:35], v[20:23], v[104:107]
    ds_read_b64_tr_b16 v[72:73], v7 offset:36864
    s_waitcnt lgkmcnt(13)
    v_mfma_f32_16x16x32_bf16 v[112:115], v[32:35], v[24:27], v[112:115]
    ds_read_b64_tr_b16 v[74:75], v7 offset:37376
    s_waitcnt lgkmcnt(13)
    v_mfma_f32_16x16x32_bf16 v[120:123], v[32:35], v[28:31], v[120:123]
    ds_read_b128 v[60:63], v6 offset:33792
    s_waitcnt lgkmcnt(12)
    v_mfma_f32_16x16x32_bf16 v[100:103], v[36:39], v[16:19], v[100:103]
    ds_read_b128 v[64:67], v6 offset:36864
    v_mfma_f32_16x16x32_bf16 v[108:111], v[36:39], v[20:23], v[108:111]
    ds_read_b128 v[68:71], v6 offset:37888
    v_mfma_f32_16x16x32_bf16 v[116:119], v[36:39], v[24:27], v[116:119]
    ds_read_b64_tr_b16 v[76:77], v8 offset:36864
    v_mfma_f32_16x16x32_bf16 v[124:127], v[36:39], v[28:31], v[124:127]
    ds_read_b64_tr_b16 v[78:79], v8 offset:37376
    s_waitcnt lgkmcnt(14)
    v_mfma_f32_16x16x32_bf16 v[128:131], v[40:43], v[16:19], v[128:131]
    ds_read_b64_tr_b16 v[80:81], v7 offset:45056
    v_mfma_f32_16x16x32_bf16 v[136:139], v[40:43], v[20:23], v[136:139]
    ds_read_b64_tr_b16 v[82:83], v7 offset:45568
    v_mfma_f32_16x16x32_bf16 v[144:147], v[40:43], v[24:27], v[144:147]
    ds_read_b64_tr_b16 v[84:85], v8 offset:45056
    v_mfma_f32_16x16x32_bf16 v[152:155], v[40:43], v[28:31], v[152:155]
    ds_read_b64_tr_b16 v[86:87], v8 offset:45568
    s_waitcnt lgkmcnt(15)
    v_mfma_f32_16x16x32_bf16 v[132:135], v[44:47], v[16:19], v[132:135]
    ds_read_b64_tr_b16 v[88:89], v9 offset:20480
    v_mfma_f32_16x16x32_bf16 v[140:143], v[44:47], v[20:23], v[140:143]
    ds_read_b64_tr_b16 v[90:91], v9 offset:20992
    v_mfma_f32_16x16x32_bf16 v[148:151], v[44:47], v[24:27], v[148:151]
    ds_read_b64_tr_b16 v[92:93], v10 offset:20480
    v_mfma_f32_16x16x32_bf16 v[156:159], v[44:47], v[28:31], v[156:159]
    ds_read_b64_tr_b16 v[94:95], v10 offset:20992
    s_waitcnt lgkmcnt(15)
    v_mfma_f32_16x16x32_bf16 v[160:163], v[16:19], v[48:51], v[160:163]
    v_mfma_f32_16x16x32_bf16 v[164:167], v[20:23], v[48:51], v[164:167]
    v_mfma_f32_16x16x32_bf16 v[176:179], v[24:27], v[48:51], v[176:179]
    v_mfma_f32_16x16x32_bf16 v[180:183], v[28:31], v[48:51], v[180:183]
    v_mfma_f32_16x16x32_bf16 v[168:171], v[16:19], v[52:55], v[168:171]
    v_mfma_f32_16x16x32_bf16 v[172:175], v[20:23], v[52:55], v[172:175]
    v_mfma_f32_16x16x32_bf16 v[184:187], v[24:27], v[52:55], v[184:187]
    v_mfma_f32_16x16x32_bf16 v[188:191], v[28:31], v[52:55], v[188:191]
    s_waitcnt lgkmcnt(13)
    v_mfma_f32_16x16x32_bf16 v[96:99], v[72:75], v[56:59], v[96:99]
    s_waitcnt lgkmcnt(12)
    v_mfma_f32_16x16x32_bf16 v[104:107], v[72:75], v[60:63], v[104:107]
    s_waitcnt lgkmcnt(0)
    s_barrier
    ds_read_b128 v[16:19], v5 offset:49152
    v_mfma_f32_16x16x32_bf16 v[112:115], v[72:75], v[64:67], v[112:115]
    ds_read_b64_tr_b16 v[32:33], v7 offset:49152
    v_mfma_f32_16x16x32_bf16 v[120:123], v[72:75], v[68:71], v[120:123]
    ds_read_b64_tr_b16 v[34:35], v7 offset:49664
    v_mfma_f32_16x16x32_bf16 v[100:103], v[76:79], v[56:59], v[100:103]
    ds_read_b128 v[20:23], v5 offset:50176
    v_mfma_f32_16x16x32_bf16 v[108:111], v[76:79], v[60:63], v[108:111]
    ds_read_b128 v[24:27], v5 offset:53248
    v_mfma_f32_16x16x32_bf16 v[116:119], v[76:79], v[64:67], v[116:119]
    ds_read_b128 v[28:31], v5 offset:54272
    v_mfma_f32_16x16x32_bf16 v[124:127], v[76:79], v[68:71], v[124:127]
    ds_read_b64_tr_b16 v[36:37], v8 offset:49152
    v_mfma_f32_16x16x32_bf16 v[128:131], v[80:83], v[56:59], v[128:131]
    ds_read_b64_tr_b16 v[38:39], v8 offset:49664
    v_mfma_f32_16x16x32_bf16 v[136:139], v[80:83], v[60:63], v[136:139]
    ds_read_b64_tr_b16 v[40:41], v7 offset:57344
    v_mfma_f32_16x16x32_bf16 v[144:147], v[80:83], v[64:67], v[144:147]
    ds_read_b64_tr_b16 v[42:43], v7 offset:57856
    v_mfma_f32_16x16x32_bf16 v[152:155], v[80:83], v[68:71], v[152:155]
    ds_read_b64_tr_b16 v[44:45], v8 offset:57344
    v_mfma_f32_16x16x32_bf16 v[132:135], v[84:87], v[56:59], v[132:135]
    ds_read_b64_tr_b16 v[46:47], v8 offset:57856
    v_mfma_f32_16x16x32_bf16 v[140:143], v[84:87], v[60:63], v[140:143]
    ds_read_b64_tr_b16 v[48:49], v9 offset:24576
    v_mfma_f32_16x16x32_bf16 v[148:151], v[84:87], v[64:67], v[148:151]
    ds_read_b64_tr_b16 v[50:51], v9 offset:25088
    v_mfma_f32_16x16x32_bf16 v[156:159], v[84:87], v[68:71], v[156:159]
    ds_read_b64_tr_b16 v[52:53], v10 offset:24576
    v_mfma_f32_16x16x32_bf16 v[160:163], v[56:59], v[88:91], v[160:163]
    ds_read_b64_tr_b16 v[54:55], v10 offset:25088
    v_mfma_f32_16x16x32_bf16 v[164:167], v[60:63], v[88:91], v[164:167]
    v_mfma_f32_16x16x32_bf16 v[176:179], v[64:67], v[88:91], v[176:179]
    v_mfma_f32_16x16x32_bf16 v[180:183], v[68:71], v[88:91], v[180:183]
    v_mfma_f32_16x16x32_bf16 v[168:171], v[56:59], v[92:95], v[168:171]
    v_mfma_f32_16x16x32_bf16 v[172:175], v[60:63], v[92:95], v[172:175]
    v_mfma_f32_16x16x32_bf16 v[184:187], v[64:67], v[92:95], v[184:187]
    v_mfma_f32_16x16x32_bf16 v[188:191], v[68:71], v[92:95], v[188:191]
    s_waitcnt lgkmcnt(13)
    v_mfma_f32_16x16x32_bf16 v[96:99], v[32:35], v[16:19], v[96:99]
    ds_read_b128 v[56:59], v6 offset:49152
    s_waitcnt lgkmcnt(13)
    v_mfma_f32_16x16x32_bf16 v[104:107], v[32:35], v[20:23], v[104:107]
    ds_read_b64_tr_b16 v[72:73], v7 offset:53248
    s_waitcnt lgkmcnt(13)
    v_mfma_f32_16x16x32_bf16 v[112:115], v[32:35], v[24:27], v[112:115]
    ds_read_b64_tr_b16 v[74:75], v7 offset:53760
    s_waitcnt lgkmcnt(13)
    v_mfma_f32_16x16x32_bf16 v[120:123], v[32:35], v[28:31], v[120:123]
    ds_read_b128 v[60:63], v6 offset:50176
    s_waitcnt lgkmcnt(12)
    v_mfma_f32_16x16x32_bf16 v[100:103], v[36:39], v[16:19], v[100:103]
    ds_read_b128 v[64:67], v6 offset:53248
    v_mfma_f32_16x16x32_bf16 v[108:111], v[36:39], v[20:23], v[108:111]
    ds_read_b128 v[68:71], v6 offset:54272
    v_mfma_f32_16x16x32_bf16 v[116:119], v[36:39], v[24:27], v[116:119]
    ds_read_b64_tr_b16 v[76:77], v8 offset:53248
    v_mfma_f32_16x16x32_bf16 v[124:127], v[36:39], v[28:31], v[124:127]
    ds_read_b64_tr_b16 v[78:79], v8 offset:53760
    s_waitcnt lgkmcnt(14)
    v_mfma_f32_16x16x32_bf16 v[128:131], v[40:43], v[16:19], v[128:131]
    ds_read_b64_tr_b16 v[80:81], v7 offset:61440
    v_mfma_f32_16x16x32_bf16 v[136:139], v[40:43], v[20:23], v[136:139]
    ds_read_b64_tr_b16 v[82:83], v7 offset:61952
    v_mfma_f32_16x16x32_bf16 v[144:147], v[40:43], v[24:27], v[144:147]
    ds_read_b64_tr_b16 v[84:85], v8 offset:61440
    v_mfma_f32_16x16x32_bf16 v[152:155], v[40:43], v[28:31], v[152:155]
    ds_read_b64_tr_b16 v[86:87], v8 offset:61952
    s_waitcnt lgkmcnt(15)
    v_mfma_f32_16x16x32_bf16 v[132:135], v[44:47], v[16:19], v[132:135]
    ds_read_b64_tr_b16 v[88:89], v9 offset:28672
    v_mfma_f32_16x16x32_bf16 v[140:143], v[44:47], v[20:23], v[140:143]
    ds_read_b64_tr_b16 v[90:91], v9 offset:29184
    v_mfma_f32_16x16x32_bf16 v[148:151], v[44:47], v[24:27], v[148:151]
    ds_read_b64_tr_b16 v[92:93], v10 offset:28672
    v_mfma_f32_16x16x32_bf16 v[156:159], v[44:47], v[28:31], v[156:159]
    ds_read_b64_tr_b16 v[94:95], v10 offset:29184
    s_waitcnt lgkmcnt(15)
    v_mfma_f32_16x16x32_bf16 v[160:163], v[16:19], v[48:51], v[160:163]
    v_mfma_f32_16x16x32_bf16 v[164:167], v[20:23], v[48:51], v[164:167]
    v_mfma_f32_16x16x32_bf16 v[176:179], v[24:27], v[48:51], v[176:179]
    v_mfma_f32_16x16x32_bf16 v[180:183], v[28:31], v[48:51], v[180:183]
    v_mfma_f32_16x16x32_bf16 v[168:171], v[16:19], v[52:55], v[168:171]
    v_mfma_f32_16x16x32_bf16 v[172:175], v[20:23], v[52:55], v[172:175]
    v_mfma_f32_16x16x32_bf16 v[184:187], v[24:27], v[52:55], v[184:187]
    v_mfma_f32_16x16x32_bf16 v[188:191], v[28:31], v[52:55], v[188:191]
    s_waitcnt lgkmcnt(13)
    v_mfma_f32_16x16x32_bf16 v[96:99], v[72:75], v[56:59], v[96:99]
    s_waitcnt lgkmcnt(12)
    v_mfma_f32_16x16x32_bf16 v[104:107], v[72:75], v[60:63], v[104:107]
    s_waitcnt lgkmcnt(0)
    s_barrier
    ds_read_b128 v[16:19], v5 offset:49152
    v_mfma_f32_16x16x32_bf16 v[112:115], v[72:75], v[64:67], v[112:115]
    ds_read_b64_tr_b16 v[32:33], v7 offset:0
    v_mfma_f32_16x16x32_bf16 v[120:123], v[72:75], v[68:71], v[120:123]
    ds_read_b64_tr_b16 v[34:35], v7 offset:512
    v_mfma_f32_16x16x32_bf16 v[100:103], v[76:79], v[56:59], v[100:103]
    ds_read_b128 v[20:23], v5 offset:50176
    v_mfma_f32_16x16x32_bf16 v[108:111], v[76:79], v[60:63], v[108:111]
    ds_read_b128 v[24:27], v5 offset:53248
    v_mfma_f32_16x16x32_bf16 v[116:119], v[76:79], v[64:67], v[116:119]
    ds_read_b128 v[28:31], v5 offset:54272
    v_mfma_f32_16x16x32_bf16 v[124:127], v[76:79], v[68:71], v[124:127]
    ds_read_b64_tr_b16 v[36:37], v8 offset:0
    v_mfma_f32_16x16x32_bf16 v[128:131], v[80:83], v[56:59], v[128:131]
    ds_read_b64_tr_b16 v[38:39], v8 offset:512
    v_mfma_f32_16x16x32_bf16 v[136:139], v[80:83], v[60:63], v[136:139]
    ds_read_b64_tr_b16 v[40:41], v7 offset:8192
    v_mfma_f32_16x16x32_bf16 v[144:147], v[80:83], v[64:67], v[144:147]
    ds_read_b64_tr_b16 v[42:43], v7 offset:8704
    v_mfma_f32_16x16x32_bf16 v[152:155], v[80:83], v[68:71], v[152:155]
    ds_read_b64_tr_b16 v[44:45], v8 offset:8192
    v_mfma_f32_16x16x32_bf16 v[132:135], v[84:87], v[56:59], v[132:135]
    ds_read_b64_tr_b16 v[46:47], v8 offset:8704
    v_mfma_f32_16x16x32_bf16 v[140:143], v[84:87], v[60:63], v[140:143]
    v_mfma_f32_16x16x32_bf16 v[148:151], v[84:87], v[64:67], v[148:151]
    v_mfma_f32_16x16x32_bf16 v[156:159], v[84:87], v[68:71], v[156:159]
    v_mfma_f32_16x16x32_bf16 v[160:163], v[56:59], v[88:91], v[160:163]
    v_mfma_f32_16x16x32_bf16 v[164:167], v[60:63], v[88:91], v[164:167]
    v_mfma_f32_16x16x32_bf16 v[176:179], v[64:67], v[88:91], v[176:179]
    v_mfma_f32_16x16x32_bf16 v[180:183], v[68:71], v[88:91], v[180:183]
    v_mfma_f32_16x16x32_bf16 v[168:171], v[56:59], v[92:95], v[168:171]
    v_mfma_f32_16x16x32_bf16 v[172:175], v[60:63], v[92:95], v[172:175]
    v_mfma_f32_16x16x32_bf16 v[184:187], v[64:67], v[92:95], v[184:187]
    v_mfma_f32_16x16x32_bf16 v[188:191], v[68:71], v[92:95], v[188:191]
    s_waitcnt vmcnt(0)
NL_99:
    v_readfirstlane_b32 s94, v15
    s_cmp_lg_u32 s94, 0
    s_cbranch_scc1 ND_100
    s_sub_u32 s3, s3, 32
    s_cmp_lt_i32 s3, 0
    s_cbranch_scc1 ND_100
    s_sleep 4
    buffer_load_dword v15, v0, s[36:39], 0 offen sc1
    s_waitcnt vmcnt(0)
    s_branch NL_99
ND_100:
    s_mov_b32 s74, 0
    s_waitcnt lgkmcnt(9)
    v_mfma_f32_16x16x32_bf16 v[192:195], v[32:35], v[16:19], 0
    ds_read_b128 v[56:59], v6 offset:49152
    s_waitcnt lgkmcnt(9)
    v_mfma_f32_16x16x32_bf16 v[200:203], v[32:35], v[20:23], 0
    ds_read_b64_tr_b16 v[72:73], v7 offset:4096
    s_waitcnt lgkmcnt(9)
    v_mfma_f32_16x16x32_bf16 v[208:211], v[32:35], v[24:27], 0
    ds_read_b64_tr_b16 v[74:75], v7 offset:4608
    v_add_u32 v9, 0x10000, v7
    v_add_u32 v10, 0x10000, v8
    v_cvt_pk_bf16_f32 v160, v160, v161
    v_cvt_pk_bf16_f32 v161, v162, v163
    v_cvt_pk_bf16_f32 v162, v164, v165
    s_waitcnt lgkmcnt(9)
    v_mfma_f32_16x16x32_bf16 v[216:219], v[32:35], v[28:31], 0
    ds_read_b128 v[60:63], v6 offset:50176
    v_cvt_pk_bf16_f32 v163, v166, v167
    buffer_store_dwordx4 v[160:163], v4, s[28:31], s68 offen offset:0 sc1
    v_cvt_pk_bf16_f32 v168, v168, v169
    v_cvt_pk_bf16_f32 v169, v170, v171
    v_cvt_pk_bf16_f32 v170, v172, v173
    s_waitcnt lgkmcnt(8)
    v_mfma_f32_16x16x32_bf16 v[196:199], v[36:39], v[16:19], 0
    ds_read_b128 v[64:67], v6 offset:53248
    v_cvt_pk_bf16_f32 v171, v174, v175
    buffer_store_dwordx4 v[168:171], v4, s[28:31], s69 offen offset:0 sc1
    v_cvt_pk_bf16_f32 v176, v176, v177
    v_cvt_pk_bf16_f32 v177, v178, v179
    v_cvt_pk_bf16_f32 v178, v180, v181
    v_mfma_f32_16x16x32_bf16 v[204:207], v[36:39], v[20:23], 0
    ds_read_b128 v[68:71], v6 offset:54272
    v_cvt_pk_bf16_f32 v179, v182, v183
    buffer_store_dwordx4 v[176:179], v4, s[28:31], s68 offen offset:1024 sc1
    v_cvt_pk_bf16_f32 v184, v184, v185
    v_cvt_pk_bf16_f32 v185, v186, v187
    v_cvt_pk_bf16_f32 v186, v188, v189
    v_mfma_f32_16x16x32_bf16 v[212:215], v[36:39], v[24:27], 0
    ds_read_b64_tr_b16 v[76:77], v8 offset:4096
    v_cvt_pk_bf16_f32 v187, v190, v191
    buffer_store_dwordx4 v[184:187], v4, s[28:31], s69 offen offset:1024 sc1
    v_mul_f32 v96, v96, v128
    v_mul_f32 v97, v97, v129
    v_mul_f32 v98, v98, v130
    v_mfma_f32_16x16x32_bf16 v[220:223], v[36:39], v[28:31], 0
    ds_read_b64_tr_b16 v[78:79], v8 offset:4608
    v_mul_f32 v99, v99, v131
    s_waitcnt lgkmcnt(10)
    v_mfma_f32_16x16x32_bf16 v[224:227], v[40:43], v[16:19], 0
    ds_read_b64_tr_b16 v[80:81], v7 offset:12288
    v_mul_f32 v100, v100, v132
    v_mfma_f32_16x16x32_bf16 v[232:235], v[40:43], v[20:23], 0
    ds_read_b64_tr_b16 v[82:83], v7 offset:12800
    v_mul_f32 v101, v101, v133
    v_mfma_f32_16x16x32_bf16 v[240:243], v[40:43], v[24:27], 0
    ds_read_b64_tr_b16 v[84:85], v8 offset:12288
    v_mul_f32 v102, v102, v134
    v_mfma_f32_16x16x32_bf16 v[248:251], v[40:43], v[28:31], 0
    ds_read_b64_tr_b16 v[86:87], v8 offset:12800
    v_mul_f32 v103, v103, v135
    s_getreg_b32 s52, hwreg(HW_REG_IB_STS, 0, 4)
    s_add_u32 s52, s52, s74
    s_cmp_le_u32 s52, 0
    s_cbranch_scc0 FK_101_r
    s_waitcnt vmcnt(0)
    s_mov_b64 exec, 1
    buffer_store_dword v15, v11, s[28:31], s70 offen sc1
    s_mov_b64 exec, -1
    s_mov_b32 s74, 64
FK_101_r:
    s_waitcnt lgkmcnt(12)
    v_mfma_f32_16x16x32_bf16 v[228:231], v[44:47], v[16:19], 0
    v_mfma_f32_16x16x32_bf16 v[236:239], v[44:47], v[20:23], 0
    v_mfma_f32_16x16x32_bf16 v[244:247], v[44:47], v[24:27], 0
    v_mfma_f32_16x16x32_bf16 v[252:255], v[44:47], v[28:31], 0
    s_waitcnt lgkmcnt(9)
    v_mfma_f32_16x16x32_bf16 v[192:195], v[72:75], v[56:59], v[192:195]
    s_waitcnt lgkmcnt(8)
    v_mfma_f32_16x16x32_bf16 v[200:203], v[72:75], v[60:63], v[200:203]
    s_waitcnt lgkmcnt(0)
    s_barrier
    ds_read_b128 v[16:19], v5 offset:32768
    v_mfma_f32_16x16x32_bf16 v[208:211], v[72:75], v[64:67], v[208:211]
    ds_read_b64_tr_b16 v[32:33], v7 offset:16384
    v_cvt_pk_bf16_f32 v96, v96, v97
    v_mfma_f32_16x16x32_bf16 v[216:219], v[72:75], v[68:71], v[216:219]
    ds_read_b64_tr_b16 v[34:35], v7 offset:16896
    v_cvt_pk_bf16_f32 v97, v98, v99
    s_getreg_b32 s52, hwreg(HW_REG_IB_STS, 0, 4)
    s_add_u32 s52, s52, s74
    s_cmp_le_u32 s52, 0
    s_cbranch_scc0 FK_102_r
    s_waitcnt vmcnt(0)
    s_mov_b64 exec, 1
    buffer_store_dword v15, v11, s[28:31], s70 offen sc1
    s_mov_b64 exec, -1
    s_mov_b32 s74, 64
FK_102_r:
    v_mfma_f32_16x16x32_bf16 v[196:199], v[76:79], v[56:59], v[196:199]
    ds_read_b128 v[20:23], v5 offset:33792
    v_cvt_pk_bf16_f32 v98, v100, v101
    v_mfma_f32_16x16x32_bf16 v[204:207], v[76:79], v[60:63], v[204:207]
    ds_read_b128 v[24:27], v5 offset:36864
    v_cvt_pk_bf16_f32 v99, v102, v103
    v_mfma_f32_16x16x32_bf16 v[212:215], v[76:79], v[64:67], v[212:215]
    ds_read_b128 v[28:31], v5 offset:37888
    v_mul_f32 v104, v104, v136
    v_mfma_f32_16x16x32_bf16 v[220:223], v[76:79], v[68:71], v[220:223]
    ds_read_b64_tr_b16 v[36:37], v8 offset:16384
    v_mul_f32 v105, v105, v137
    v_mfma_f32_16x16x32_bf16 v[224:227], v[80:83], v[56:59], v[224:227]
    ds_read_b64_tr_b16 v[38:39], v8 offset:16896
    v_mul_f32 v106, v106, v138
    v_mfma_f32_16x16x32_bf16 v[232:235], v[80:83], v[60:63], v[232:235]
    ds_read_b64_tr_b16 v[40:41], v7 offset:24576
    v_mul_f32 v107, v107, v139
    v_mfma_f32_16x16x32_bf16 v[240:243], v[80:83], v[64:67], v[240:243]
    ds_read_b64_tr_b16 v[42:43], v7 offset:25088
    v_mul_f32 v108, v108, v140
    v_mfma_f32_16x16x32_bf16 v[248:251], v[80:83], v[68:71], v[248:251]
    ds_read_b64_tr_b16 v[44:45], v8 offset:24576
    v_mul_f32 v109, v109, v141
    s_getreg_b32 s52, hwreg(HW_REG_IB_STS, 0, 4)
    s_add_u32 s52, s52, s74
    s_cmp_le_u32 s52, 0
    s_cbranch_scc0 FK_103_r
    s_waitcnt vmcnt(0)
    s_mov_b64 exec, 1
    buffer_store_dword v15, v11, s[28:31], s70 offen sc1
    s_mov_b64 exec, -1
    s_mov_b32 s74, 64
FK_103_r:
    v_mfma_f32_16x16x32_bf16 v[228:231], v[84:87], v[56:59], v[228:231]
    ds_read_b64_tr_b16 v[46:47], v8 offset:25088
    v_mul_f32 v110, v110, v142
    v_mfma_f32_16x16x32_bf16 v[236:239], v[84:87], v[60:63], v[236:239]
    v_mul_f32 v111, v111, v143
    v_cvt_pk_bf16_f32 v104, v104, v105
    v_mfma_f32_16x16x32_bf16 v[244:247], v[84:87], v[64:67], v[244:247]
    v_cvt_pk_bf16_f32 v105, v106, v107
    v_cvt_pk_bf16_f32 v106, v108, v109
    v_mfma_f32_16x16x32_bf16 v[252:255], v[84:87], v[68:71], v[252:255]
    v_cvt_pk_bf16_f32 v107, v110, v111
    v_permlane32_swap_b32 v96, v104
    s_waitcnt lgkmcnt(9)
    v_mfma_f32_16x16x32_bf16 v[192:195], v[32:35], v[16:19], v[192:195]
    ds_read_b128 v[56:59], v6 offset:32768
    s_waitcnt lgkmcnt(9)
    v_mfma_f32_16x16x32_bf16 v[200:203], v[32:35], v[20:23], v[200:203]
    ds_read_b64_tr_b16 v[72:73], v7 offset:20480
    s_waitcnt lgkmcnt(9)
    v_mfma_f32_16x16x32_bf16 v[208:211], v[32:35], v[24:27], v[208:211]
    ds_read_b64_tr_b16 v[74:75], v7 offset:20992
    v_permlane32_swap_b32 v97, v105
    s_waitcnt lgkmcnt(9)
    v_mfma_f32_16x16x32_bf16 v[216:219], v[32:35], v[28:31], v[216:219]
    ds_read_b128 v[60:63], v6 offset:33792
    v_permlane32_swap_b32 v98, v106
    s_getreg_b32 s52, hwreg(HW_REG_IB_STS, 0, 4)
    s_add_u32 s52, s52, s74
    s_cmp_le_u32 s52, 0
    s_cbranch_scc0 FK_104_r
    s_waitcnt vmcnt(0)
    s_mov_b64 exec, 1
    buffer_store_dword v15, v11, s[28:31], s70 offen sc1
    s_mov_b64 exec, -1
    s_mov_b32 s74, 64
FK_104_r:
    s_waitcnt lgkmcnt(8)
    v_mfma_f32_16x16x32_bf16 v[196:199], v[36:39], v[16:19], v[196:199]
    ds_read_b128 v[64:67], v6 offset:36864
    v_permlane32_swap_b32 v99, v107
    v_mfma_f32_16x16x32_bf16 v[204:207], v[36:39], v[20:23], v[204:207]
    ds_read_b128 v[68:71], v6 offset:37888
    v_mfma_f32_16x16x32_bf16 v[212:215], v[36:39], v[24:27], v[212:215]
    ds_read_b64_tr_b16 v[76:77], v8 offset:20480
    v_mfma_f32_16x16x32_bf16 v[220:223], v[36:39], v[28:31], v[220:223]
    ds_read_b64_tr_b16 v[78:79], v8 offset:20992
    s_waitcnt lgkmcnt(10)
    v_mfma_f32_16x16x32_bf16 v[224:227], v[40:43], v[16:19], v[224:227]
    ds_read_b64_tr_b16 v[80:81], v7 offset:28672
    v_mfma_f32_16x16x32_bf16 v[232:235], v[40:43], v[20:23], v[232:235]
    ds_read_b64_tr_b16 v[82:83], v7 offset:29184
    v_mfma_f32_16x16x32_bf16 v[240:243], v[40:43], v[24:27], v[240:243]
    ds_read_b64_tr_b16 v[84:85], v8 offset:28672
    v_mfma_f32_16x16x32_bf16 v[248:251], v[40:43], v[28:31], v[248:251]
    ds_read_b64_tr_b16 v[86:87], v8 offset:29184
    s_getreg_b32 s52, hwreg(HW_REG_IB_STS, 0, 4)
    s_add_u32 s52, s52, s74
    s_cmp_le_u32 s52, 0
    s_cbranch_scc0 FK_105_r
    s_waitcnt vmcnt(0)
    s_mov_b64 exec, 1
    buffer_store_dword v15, v11, s[28:31], s70 offen sc1
    s_mov_b64 exec, -1
    s_mov_b32 s74, 64
FK_105_r:
    s_waitcnt lgkmcnt(12)
    v_mfma_f32_16x16x32_bf16 v[228:231], v[44:47], v[16:19], v[228:231]
    v_mfma_f32_16x16x32_bf16 v[236:239], v[44:47], v[20:23], v[236:239]
    v_mfma_f32_16x16x32_bf16 v[244:247], v[44:47], v[24:27], v[244:247]
    v_mfma_f32_16x16x32_bf16 v[252:255], v[44:47], v[28:31], v[252:255]
    s_waitcnt lgkmcnt(9)
    v_mfma_f32_16x16x32_bf16 v[192:195], v[72:75], v[56:59], v[192:195]
    s_waitcnt lgkmcnt(8)
    v_mfma_f32_16x16x32_bf16 v[200:203], v[72:75], v[60:63], v[200:203]
    s_waitcnt lgkmcnt(0)
    s_barrier
    ds_read_b128 v[16:19], v5 offset:16384
    v_mfma_f32_16x16x32_bf16 v[208:211], v[72:75], v[64:67], v[208:211]
    ds_read_b64_tr_b16 v[32:33], v7 offset:32768
    v_mfma_f32_16x16x32_bf16 v[216:219], v[72:75], v[68:71], v[216:219]
    ds_read_b64_tr_b16 v[34:35], v7 offset:33280
    s_getreg_b32 s52, hwreg(HW_REG_IB_STS, 0, 4)
    s_add_u32 s52, s52, s74
    s_cmp_le_u32 s52, 0
    s_cbranch_scc0 FK_106_r
    s_waitcnt vmcnt(0)
    s_mov_b64 exec, 1
    buffer_store_dword v15, v11, s[28:31], s70 offen sc1
    s_mov_b64 exec, -1
    s_mov_b32 s74, 64
FK_106_r:
    v_mfma_f32_16x16x32_bf16 v[196:199], v[76:79], v[56:59], v[196:199]
    ds_read_b128 v[20:23], v5 offset:17408
    v_mfma_f32_16x16x32_bf16 v[204:207], v[76:79], v[60:63], v[204:207]
    ds_read_b128 v[24:27], v5 offset:20480
    v_mfma_f32_16x16x32_bf16 v[212:215], v[76:79], v[64:67], v[212:215]
    ds_read_b128 v[28:31], v5 offset:21504
    v_mfma_f32_16x16x32_bf16 v[220:223], v[76:79], v[68:71], v[220:223]
    ds_read_b64_tr_b16 v[36:37], v8 offset:32768
    v_mfma_f32_16x16x32_bf16 v[224:227], v[80:83], v[56:59], v[224:227]
    ds_read_b64_tr_b16 v[38:39], v8 offset:33280
    v_mfma_f32_16x16x32_bf16 v[232:235], v[80:83], v[60:63], v[232:235]
    ds_read_b64_tr_b16 v[40:41], v7 offset:40960
    v_mfma_f32_16x16x32_bf16 v[240:243], v[80:83], v[64:67], v[240:243]
    ds_read_b64_tr_b16 v[42:43], v7 offset:41472
    v_mfma_f32_16x16x32_bf16 v[248:251], v[80:83], v[68:71], v[248:251]
    ds_read_b64_tr_b16 v[44:45], v8 offset:40960
    s_getreg_b32 s52, hwreg(HW_REG_IB_STS, 0, 4)
    s_add_u32 s52, s52, s74
    s_cmp_le_u32 s52, 0
    s_cbranch_scc0 FK_107_r
    s_waitcnt vmcnt(0)
    s_mov_b64 exec, 1
    buffer_store_dword v15, v11, s[28:31], s70 offen sc1
    s_mov_b64 exec, -1
    s_mov_b32 s74, 64
FK_107_r:
    v_mfma_f32_16x16x32_bf16 v[228:231], v[84:87], v[56:59], v[228:231]
    ds_read_b64_tr_b16 v[46:47], v8 offset:41472
    v_mfma_f32_16x16x32_bf16 v[236:239], v[84:87], v[60:63], v[236:239]
    v_mfma_f32_16x16x32_bf16 v[244:247], v[84:87], v[64:67], v[244:247]
    v_mfma_f32_16x16x32_bf16 v[252:255], v[84:87], v[68:71], v[252:255]
    s_waitcnt lgkmcnt(9)
    v_mfma_f32_16x16x32_bf16 v[192:195], v[32:35], v[16:19], v[192:195]
    ds_read_b128 v[56:59], v6 offset:16384
    s_waitcnt lgkmcnt(9)
    v_mfma_f32_16x16x32_bf16 v[200:203], v[32:35], v[20:23], v[200:203]
    ds_read_b64_tr_b16 v[72:73], v7 offset:36864
    s_waitcnt lgkmcnt(9)
    v_mfma_f32_16x16x32_bf16 v[208:211], v[32:35], v[24:27], v[208:211]
    ds_read_b64_tr_b16 v[74:75], v7 offset:37376
    s_waitcnt lgkmcnt(9)
    v_mfma_f32_16x16x32_bf16 v[216:219], v[32:35], v[28:31], v[216:219]
    ds_read_b128 v[60:63], v6 offset:17408
    s_getreg_b32 s52, hwreg(HW_REG_IB_STS, 0, 4)
    s_add_u32 s52, s52, s74
    s_cmp_le_u32 s52, 0
    s_cbranch_scc0 FK_108_r
    s_waitcnt vmcnt(0)
    s_mov_b64 exec, 1
    buffer_store_dword v15, v11, s[28:31], s70 offen sc1
    s_mov_b64 exec, -1
    s_mov_b32 s74, 64
FK_108_r:
    s_waitcnt lgkmcnt(8)
    v_mfma_f32_16x16x32_bf16 v[196:199], v[36:39], v[16:19], v[196:199]
    ds_read_b128 v[64:67], v6 offset:20480
    v_mfma_f32_16x16x32_bf16 v[204:207], v[36:39], v[20:23], v[204:207]
    ds_read_b128 v[68:71], v6 offset:21504
    v_mfma_f32_16x16x32_bf16 v[212:215], v[36:39], v[24:27], v[212:215]
    ds_read_b64_tr_b16 v[76:77], v8 offset:36864
    v_mfma_f32_16x16x32_bf16 v[220:223], v[36:39], v[28:31], v[220:223]
    ds_read_b64_tr_b16 v[78:79], v8 offset:37376
    s_waitcnt lgkmcnt(10)
    v_mfma_f32_16x16x32_bf16 v[224:227], v[40:43], v[16:19], v[224:227]
    ds_read_b64_tr_b16 v[80:81], v7 offset:45056
    v_mfma_f32_16x16x32_bf16 v[232:235], v[40:43], v[20:23], v[232:235]
    ds_read_b64_tr_b16 v[82:83], v7 offset:45568
    v_mfma_f32_16x16x32_bf16 v[240:243], v[40:43], v[24:27], v[240:243]
    ds_read_b64_tr_b16 v[84:85], v8 offset:45056
    v_mfma_f32_16x16x32_bf16 v[248:251], v[40:43], v[28:31], v[248:251]
    ds_read_b64_tr_b16 v[86:87], v8 offset:45568
    s_getreg_b32 s52, hwreg(HW_REG_IB_STS, 0, 4)
    s_add_u32 s52, s52, s74
    s_cmp_le_u32 s52, 0
    s_cbranch_scc0 FK_109_r
    s_waitcnt vmcnt(0)
    s_mov_b64 exec, 1
    buffer_store_dword v15, v11, s[28:31], s70 offen sc1
    s_mov_b64 exec, -1
    s_mov_b32 s74, 64
FK_109_r:
    s_waitcnt lgkmcnt(12)
    v_mfma_f32_16x16x32_bf16 v[228:231], v[44:47], v[16:19], v[228:231]
    v_mfma_f32_16x16x32_bf16 v[236:239], v[44:47], v[20:23], v[236:239]
    v_mfma_f32_16x16x32_bf16 v[244:247], v[44:47], v[24:27], v[244:247]
    v_mfma_f32_16x16x32_bf16 v[252:255], v[44:47], v[28:31], v[252:255]
    s_waitcnt lgkmcnt(9)
    v_mfma_f32_16x16x32_bf16 v[192:195], v[72:75], v[56:59], v[192:195]
    s_waitcnt lgkmcnt(8)
    v_mfma_f32_16x16x32_bf16 v[200:203], v[72:75], v[60:63], v[200:203]
    s_waitcnt lgkmcnt(0)
    s_barrier
    ds_read_b128 v[16:19], v5 offset:0
    v_mfma_f32_16x16x32_bf16 v[208:211], v[72:75], v[64:67], v[208:211]
    ds_read_b64_tr_b16 v[32:33], v7 offset:49152
    v_mfma_f32_16x16x32_bf16 v[216:219], v[72:75], v[68:71], v[216:219]
    ds_read_b64_tr_b16 v[34:35], v7 offset:49664
    s_getreg_b32 s52, hwreg(HW_REG_IB_STS, 0, 4)
    s_add_u32 s52, s52, s74
    s_cmp_le_u32 s52, 0
    s_cbranch_scc0 FK_110_r
    s_waitcnt vmcnt(0)
    s_mov_b64 exec, 1
    buffer_store_dword v15, v11, s[28:31], s70 offen sc1
    s_mov_b64 exec, -1
    s_mov_b32 s74, 64
FK_110_r:
    v_mfma_f32_16x16x32_bf16 v[196:199], v[76:79], v[56:59], v[196:199]
    ds_read_b128 v[20:23], v5 offset:1024
    v_mfma_f32_16x16x32_bf16 v[204:207], v[76:79], v[60:63], v[204:207]
    ds_read_b128 v[24:27], v5 offset:4096
    v_mfma_f32_16x16x32_bf16 v[212:215], v[76:79], v[64:67], v[212:215]
    ds_read_b128 v[28:31], v5 offset:5120
    v_mfma_f32_16x16x32_bf16 v[220:223], v[76:79], v[68:71], v[220:223]
    ds_read_b64_tr_b16 v[36:37], v8 offset:49152
    v_mfma_f32_16x16x32_bf16 v[224:227], v[80:83], v[56:59], v[224:227]
    ds_read_b64_tr_b16 v[38:39], v8 offset:49664
    v_mfma_f32_16x16x32_bf16 v[232:235], v[80:83], v[60:63], v[232:235]
    ds_read_b64_tr_b16 v[40:41], v7 offset:57344
    v_mfma_f32_16x16x32_bf16 v[240:243], v[80:83], v[64:67], v[240:243]
    ds_read_b64_tr_b16 v[42:43], v7 offset:57856
    v_mfma_f32_16x16x32_bf16 v[248:251], v[80:83], v[68:71], v[248:251]
    ds_read_b64_tr_b16 v[44:45], v8 offset:57344
    s_getreg_b32 s52, hwreg(HW_REG_IB_STS, 0, 4)
    s_add_u32 s52, s52, s74
    s_cmp_le_u32 s52, 0
    s_cbranch_scc0 FK_111_r
    s_waitcnt vmcnt(0)
    s_mov_b64 exec, 1
    buffer_store_dword v15, v11, s[28:31], s70 offen sc1
    s_mov_b64 exec, -1
    s_mov_b32 s74, 64
FK_111_r:
    v_mfma_f32_16x16x32_bf16 v[228:231], v[84:87], v[56:59], v[228:231]
    ds_read_b64_tr_b16 v[46:47], v8 offset:57856
    v_mfma_f32_16x16x32_bf16 v[236:239], v[84:87], v[60:63], v[236:239]
    v_mfma_f32_16x16x32_bf16 v[244:247], v[84:87], v[64:67], v[244:247]
    v_mfma_f32_16x16x32_bf16 v[252:255], v[84:87], v[68:71], v[252:255]
    s_waitcnt lgkmcnt(9)
    v_mfma_f32_16x16x32_bf16 v[192:195], v[32:35], v[16:19], v[192:195]
    ds_read_b128 v[56:59], v6 offset:0
    s_waitcnt lgkmcnt(9)
    v_mfma_f32_16x16x32_bf16 v[200:203], v[32:35], v[20:23], v[200:203]
    ds_read_b64_tr_b16 v[72:73], v7 offset:53248
    s_waitcnt lgkmcnt(9)
    v_mfma_f32_16x16x32_bf16 v[208:211], v[32:35], v[24:27], v[208:211]
    ds_read_b64_tr_b16 v[74:75], v7 offset:53760
    buffer_store_dwordx4 v[96:99], v3, s[28:31], s58 offen sc1
    s_waitcnt lgkmcnt(9)
    v_mfma_f32_16x16x32_bf16 v[216:219], v[32:35], v[28:31], v[216:219]
    ds_read_b128 v[60:63], v6 offset:1024
    buffer_store_dwordx4 v[104:107], v3, s[28:31], s58 offen offset:1024 sc1
    s_getreg_b32 s52, hwreg(HW_REG_IB_STS, 0, 4)
    s_add_u32 s52, s52, s74
    s_cmp_le_u32 s52, 2
    s_cbranch_scc0 FK_112_r
    s_waitcnt vmcnt(2)
    s_mov_b64 exec, 1
    buffer_store_dword v15, v11, s[28:31], s70 offen sc1
    s_mov_b64 exec, -1
    s_mov_b32 s74, 64
FK_112_r:
    s_waitcnt lgkmcnt(8)
    v_mfma_f32_16x16x32_bf16 v[196:199], v[36:39], v[16:19], v[196:199]
    ds_read_b128 v[64:67], v6 offset:4096
    v_mul_f32 v112, v112, v144
    v_mfma_f32_16x16x32_bf16 v[204:207], v[36:39], v[20:23], v[204:207]
    ds_read_b128 v[68:71], v6 offset:5120
    v_mul_f32 v113, v113, v145
    v_mfma_f32_16x16x32_bf16 v[212:215], v[36:39], v[24:27], v[212:215]
    ds_read_b64_tr_b16 v[76:77], v8 offset:53248
    v_mul_f32 v114, v114, v146
    v_mfma_f32_16x16x32_bf16 v[220:223], v[36:39], v[28:31], v[220:223]
    ds_read_b64_tr_b16 v[78:79], v8 offset:53760
    v_mul_f32 v115, v115, v147
    s_waitcnt lgkmcnt(10)
    v_mfma_f32_16x16x32_bf16 v[224:227], v[40:43], v[16:19], v[224:227]
    ds_read_b64_tr_b16 v[80:81], v7 offset:61440
    v_mul_f32 v116, v116, v148
    v_mfma_f32_16x16x32_bf16 v[232:235], v[40:43], v[20:23], v[232:235]
    ds_read_b64_tr_b16 v[82:83], v7 offset:61952
    v_mul_f32 v117, v117, v149
    v_mfma_f32_16x16x32_bf16 v[240:243], v[40:43], v[24:27], v[240:243]
    ds_read_b64_tr_b16 v[84:85], v8 offset:61440
    v_mul_f32 v118, v118, v150
    v_mfma_f32_16x16x32_bf16 v[248:251], v[40:43], v[28:31], v[248:251]
    ds_read_b64_tr_b16 v[86:87], v8 offset:61952
    v_mul_f32 v119, v119, v151
    s_getreg_b32 s52, hwreg(HW_REG_IB_STS, 0, 4)
    s_add_u32 s52, s52, s74
    s_cmp_le_u32 s52, 2
    s_cbranch_scc0 FK_113_r
    s_waitcnt vmcnt(2)
    s_mov_b64 exec, 1
    buffer_store_dword v15, v11, s[28:31], s70 offen sc1
    s_mov_b64 exec, -1
    s_mov_b32 s74, 64
FK_113_r:
    s_waitcnt lgkmcnt(12)
    v_mfma_f32_16x16x32_bf16 v[228:231], v[44:47], v[16:19], v[228:231]
    v_cvt_pk_bf16_f32 v112, v112, v113
    v_cvt_pk_bf16_f32 v113, v114, v115
    v_mfma_f32_16x16x32_bf16 v[236:239], v[44:47], v[20:23], v[236:239]
    v_cvt_pk_bf16_f32 v114, v116, v117
    v_cvt_pk_bf16_f32 v115, v118, v119
    v_mfma_f32_16x16x32_bf16 v[244:247], v[44:47], v[24:27], v[244:247]
    v_mul_f32 v120, v120, v152
    v_mul_f32 v121, v121, v153
    v_mfma_f32_16x16x32_bf16 v[252:255], v[44:47], v[28:31], v[252:255]
    v_mul_f32 v122, v122, v154
    v_mul_f32 v123, v123, v155
    v_subrev_u32 v5, 0x10000, v5
    s_waitcnt lgkmcnt(9)
    v_mfma_f32_16x16x32_bf16 v[192:195], v[72:75], v[56:59], v[192:195]
    s_waitcnt lgkmcnt(8)
    v_mfma_f32_16x16x32_bf16 v[200:203], v[72:75], v[60:63], v[200:203]
    s_waitcnt lgkmcnt(0)
    s_barrier
    ds_read_b128 v[16:19], v5 offset:49152
    v_mfma_f32_16x16x32_bf16 v[208:211], v[72:75], v[64:67], v[208:211]
    ds_read_b64_tr_b16 v[32:33], v9 offset:0
    v_mul_f32 v124, v124, v156
    v_mfma_f32_16x16x32_bf16 v[216:219], v[72:75], v[68:71], v[216:219]
    ds_read_b64_tr_b16 v[34:35], v9 offset:512
    v_mul_f32 v125, v125, v157
    s_getreg_b32 s52, hwreg(HW_REG_IB_STS, 0, 4)
    s_add_u32 s52, s52, s74
    s_cmp_le_u32 s52, 2
    s_cbranch_scc0 FK_114_r
    s_waitcnt vmcnt(2)
    s_mov_b64 exec, 1
    buffer_store_dword v15, v11, s[28:31], s70 offen sc1
    s_mov_b64 exec, -1
    s_mov_b32 s74, 64
FK_114_r:
    v_mfma_f32_16x16x32_bf16 v[196:199], v[76:79], v[56:59], v[196:199]
    ds_read_b128 v[20:23], v5 offset:50176
    v_mul_f32 v126, v126, v158
    v_mfma_f32_16x16x32_bf16 v[204:207], v[76:79], v[60:63], v[204:207]
    ds_read_b128 v[24:27], v5 offset:53248
    v_mul_f32 v127, v127, v159
    v_mfma_f32_16x16x32_bf16 v[212:215], v[76:79], v[64:67], v[212:215]
    ds_read_b128 v[28:31], v5 offset:54272
    v_cvt_pk_bf16_f32 v120, v120, v121
    v_mfma_f32_16x16x32_bf16 v[220:223], v[76:79], v[68:71], v[220:223]
    ds_read_b64_tr_b16 v[36:37], v10 offset:0
    v_cvt_pk_bf16_f32 v121, v122, v123
    v_mfma_f32_16x16x32_bf16 v[224:227], v[80:83], v[56:59], v[224:227]
    ds_read_b64_tr_b16 v[38:39], v10 offset:512
    v_cvt_pk_bf16_f32 v122, v124, v125
    v_mfma_f32_16x16x32_bf16 v[232:235], v[80:83], v[60:63], v[232:235]
    ds_read_b64_tr_b16 v[40:41], v9 offset:8192
    v_cvt_pk_bf16_f32 v123, v126, v127
    v_mfma_f32_16x16x32_bf16 v[240:243], v[80:83], v[64:67], v[240:243]
    ds_read_b64_tr_b16 v[42:43], v9 offset:8704
    v_permlane32_swap_b32 v112, v120
    v_mfma_f32_16x16x32_bf16 v[248:251], v[80:83], v[68:71], v[248:251]
    ds_read_b64_tr_b16 v[44:45], v10 offset:8192
    v_permlane32_swap_b32 v113, v121
    s_getreg_b32 s52, hwreg(HW_REG_IB_STS, 0, 4)
    s_add_u32 s52, s52, s74
    s_cmp_le_u32 s52, 2
    s_cbranch_scc0 FK_115_r
    s_waitcnt vmcnt(2)
    s_mov_b64 exec, 1
    buffer_store_dword v15, v11, s[28:31], s70 offen sc1
    s_mov_b64 exec, -1
    s_mov_b32 s74, 64
FK_115_r:
    v_mfma_f32_16x16x32_bf16 v[228:231], v[84:87], v[56:59], v[228:231]
    ds_read_b64_tr_b16 v[46:47], v10 offset:8704
    v_permlane32_swap_b32 v114, v122
    v_mfma_f32_16x16x32_bf16 v[236:239], v[84:87], v[60:63], v[236:239]
    v_permlane32_swap_b32 v115, v123
    buffer_store_dwordx4 v[112:115], v3, s[28:31], s59 offen sc1
    v_mfma_f32_16x16x32_bf16 v[244:247], v[84:87], v[64:67], v[244:247]
    buffer_store_dwordx4 v[120:123], v3, s[28:31], s59 offen offset:1024 sc1
    v_mfma_f32_16x16x32_bf16 v[252:255], v[84:87], v[68:71], v[252:255]
    v_subrev_u32 v6, 0x10000, v6
    s_waitcnt lgkmcnt(9)
    v_mfma_f32_16x16x32_bf16 v[192:195], v[32:35], v[16:19], v[192:195]
    ds_read_b128 v[56:59], v6 offset:49152
    s_waitcnt lgkmcnt(9)
    v_mfma_f32_16x16x32_bf16 v[200:203], v[32:35], v[20:23], v[200:203]
    ds_read_b64_tr_b16 v[72:73], v9 offset:4096
    s_waitcnt lgkmcnt(9)
    v_mfma_f32_16x16x32_bf16 v[208:211], v[32:35], v[24:27], v[208:211]
    ds_read_b64_tr_b16 v[74:75], v9 offset:4608
    s_waitcnt lgkmcnt(9)
    v_mfma_f32_16x16x32_bf16 v[216:219], v[32:35], v[28:31], v[216:219]
    ds_read_b128 v[60:63], v6 offset:50176
    s_getreg_b32 s52, hwreg(HW_REG_IB_STS, 0, 4)
    s_add_u32 s52, s52, s74
    s_cmp_le_u32 s52, 4
    s_cbranch_scc0 FK_116_r
    s_waitcnt vmcnt(4)
    s_mov_b64 exec, 1
    buffer_store_dword v15, v11, s[28:31], s70 offen sc1
    s_mov_b64 exec, -1
    s_mov_b32 s74, 64
FK_116_r:
    s_waitcnt lgkmcnt(8)
    v_mfma_f32_16x16x32_bf16 v[196:199], v[36:39], v[16:19], v[196:199]
    ds_read_b128 v[64:67], v6 offset:53248
    v_mfma_f32_16x16x32_bf16 v[204:207], v[36:39], v[20:23], v[204:207]
    ds_read_b128 v[68:71], v6 offset:54272
    v_mfma_f32_16x16x32_bf16 v[212:215], v[36:39], v[24:27], v[212:215]
    ds_read_b64_tr_b16 v[76:77], v10 offset:4096
    v_mfma_f32_16x16x32_bf16 v[220:223], v[36:39], v[28:31], v[220:223]
    ds_read_b64_tr_b16 v[78:79], v10 offset:4608
    s_waitcnt lgkmcnt(10)
    v_mfma_f32_16x16x32_bf16 v[224:227], v[40:43], v[16:19], v[224:227]
    ds_read_b64_tr_b16 v[80:81], v9 offset:12288
    v_mfma_f32_16x16x32_bf16 v[232:235], v[40:43], v[20:23], v[232:235]
    ds_read_b64_tr_b16 v[82:83], v9 offset:12800
    v_mfma_f32_16x16x32_bf16 v[240:243], v[40:43], v[24:27], v[240:243]
    ds_read_b64_tr_b16 v[84:85], v10 offset:12288
    v_mfma_f32_16x16x32_bf16 v[248:251], v[40:43], v[28:31], v[248:251]
    ds_read_b64_tr_b16 v[86:87], v10 offset:12800
    s_getreg_b32 s52, hwreg(HW_REG_IB_STS, 0, 4)
    s_add_u32 s52, s52, s74
    s_cmp_le_u32 s52, 4
    s_cbranch_scc0 FK_117_r
    s_waitcnt vmcnt(4)
    s_mov_b64 exec, 1
    buffer_store_dword v15, v11, s[28:31], s70 offen sc1
    s_mov_b64 exec, -1
    s_mov_b32 s74, 64
FK_117_r:
    s_waitcnt lgkmcnt(12)
    v_mfma_f32_16x16x32_bf16 v[228:231], v[44:47], v[16:19], v[228:231]
    v_mfma_f32_16x16x32_bf16 v[236:239], v[44:47], v[20:23], v[236:239]
    v_mfma_f32_16x16x32_bf16 v[244:247], v[44:47], v[24:27], v[244:247]
    v_mfma_f32_16x16x32_bf16 v[252:255], v[44:47], v[28:31], v[252:255]
    v_add_u32 v5, 0x10000, v5
    s_waitcnt lgkmcnt(9)
    v_mfma_f32_16x16x32_bf16 v[192:195], v[72:75], v[56:59], v[192:195]
    s_waitcnt lgkmcnt(8)
    v_mfma_f32_16x16x32_bf16 v[200:203], v[72:75], v[60:63], v[200:203]
    s_waitcnt lgkmcnt(0)
    s_barrier
    ds_read_b128 v[16:19], v5 offset:49152
    v_mfma_f32_16x16x32_bf16 v[208:211], v[72:75], v[64:67], v[208:211]
    ds_read_b64_tr_b16 v[32:33], v7 offset:0
    v_mfma_f32_16x16x32_bf16 v[216:219], v[72:75], v[68:71], v[216:219]
    ds_read_b64_tr_b16 v[34:35], v7 offset:512
    s_getreg_b32 s52, hwreg(HW_REG_IB_STS, 0, 4)
    s_add_u32 s52, s52, s74
    s_cmp_le_u32 s52, 4
    s_cbranch_scc0 FK_118_r
    s_waitcnt vmcnt(4)
    s_mov_b64 exec, 1
    buffer_store_dword v15, v11, s[28:31], s70 offen sc1
    s_mov_b64 exec, -1
    s_mov_b32 s74, 64
FK_118_r:
    v_mfma_f32_16x16x32_bf16 v[196:199], v[76:79], v[56:59], v[196:199]
    ds_read_b128 v[20:23], v5 offset:50176
    v_mfma_f32_16x16x32_bf16 v[204:207], v[76:79], v[60:63], v[204:207]
    ds_read_b128 v[24:27], v5 offset:53248
    v_mfma_f32_16x16x32_bf16 v[212:215], v[76:79], v[64:67], v[212:215]
    ds_read_b128 v[28:31], v5 offset:54272
    v_mfma_f32_16x16x32_bf16 v[220:223], v[76:79], v[68:71], v[220:223]
    ds_read_b64_tr_b16 v[36:37], v8 offset:0
    v_mfma_f32_16x16x32_bf16 v[224:227], v[80:83], v[56:59], v[224:227]
    ds_read_b64_tr_b16 v[38:39], v8 offset:512
    v_mfma_f32_16x16x32_bf16 v[232:235], v[80:83], v[60:63], v[232:235]
    ds_read_b64_tr_b16 v[40:41], v7 offset:8192
    v_mfma_f32_16x16x32_bf16 v[240:243], v[80:83], v[64:67], v[240:243]
    ds_read_b64_tr_b16 v[42:43], v7 offset:8704
    v_mfma_f32_16x16x32_bf16 v[248:251], v[80:83], v[68:71], v[248:251]
    ds_read_b64_tr_b16 v[44:45], v8 offset:8192
    s_getreg_b32 s52, hwreg(HW_REG_IB_STS, 0, 4)
    s_add_u32 s52, s52, s74
    s_cmp_le_u32 s52, 4
    s_cbranch_scc0 FK_119_r
    s_waitcnt vmcnt(4)
    s_mov_b64 exec, 1
    buffer_store_dword v15, v11, s[28:31], s70 offen sc1
    s_mov_b64 exec, -1
    s_mov_b32 s74, 64
FK_119_r:
    v_mfma_f32_16x16x32_bf16 v[228:231], v[84:87], v[56:59], v[228:231]
    ds_read_b64_tr_b16 v[46:47], v8 offset:8704
    v_mfma_f32_16x16x32_bf16 v[236:239], v[84:87], v[60:63], v[236:239]
    v_mfma_f32_16x16x32_bf16 v[244:247], v[84:87], v[64:67], v[244:247]
    v_mfma_f32_16x16x32_bf16 v[252:255], v[84:87], v[68:71], v[252:255]
    v_add_u32 v6, 0x10000, v6
    s_waitcnt lgkmcnt(9)
    v_mfma_f32_16x16x32_bf16 v[192:195], v[32:35], v[16:19], v[192:195]
    ds_read_b128 v[56:59], v6 offset:49152
    s_waitcnt lgkmcnt(9)
    v_mfma_f32_16x16x32_bf16 v[200:203], v[32:35], v[20:23], v[200:203]
    ds_read_b64_tr_b16 v[72:73], v7 offset:4096
    s_waitcnt lgkmcnt(9)
    v_mfma_f32_16x16x32_bf16 v[208:211], v[32:35], v[24:27], v[208:211]
    ds_read_b64_tr_b16 v[74:75], v7 offset:4608
    s_waitcnt lgkmcnt(9)
    v_mfma_f32_16x16x32_bf16 v[216:219], v[32:35], v[28:31], v[216:219]
    ds_read_b128 v[60:63], v6 offset:50176
    s_getreg_b32 s52, hwreg(HW_REG_IB_STS, 0, 4)
    s_add_u32 s52, s52, s74
    s_cmp_le_u32 s52, 4
    s_cbranch_scc0 FK_120_r
    s_waitcnt vmcnt(4)
    s_mov_b64 exec, 1
    buffer_store_dword v15, v11, s[28:31], s70 offen sc1
    s_mov_b64 exec, -1
    s_mov_b32 s74, 64
FK_120_r:
    s_waitcnt lgkmcnt(8)
    v_mfma_f32_16x16x32_bf16 v[196:199], v[36:39], v[16:19], v[196:199]
    ds_read_b128 v[64:67], v6 offset:53248
    v_mfma_f32_16x16x32_bf16 v[204:207], v[36:39], v[20:23], v[204:207]
    ds_read_b128 v[68:71], v6 offset:54272
    v_mfma_f32_16x16x32_bf16 v[212:215], v[36:39], v[24:27], v[212:215]
    ds_read_b64_tr_b16 v[76:77], v8 offset:4096
    v_mfma_f32_16x16x32_bf16 v[220:223], v[36:39], v[28:31], v[220:223]
    ds_read_b64_tr_b16 v[78:79], v8 offset:4608
    s_waitcnt lgkmcnt(10)
    v_mfma_f32_16x16x32_bf16 v[224:227], v[40:43], v[16:19], v[224:227]
    ds_read_b64_tr_b16 v[80:81], v7 offset:12288
    v_mfma_f32_16x16x32_bf16 v[232:235], v[40:43], v[20:23], v[232:235]
    ds_read_b64_tr_b16 v[82:83], v7 offset:12800
    v_mfma_f32_16x16x32_bf16 v[240:243], v[40:43], v[24:27], v[240:243]
    ds_read_b64_tr_b16 v[84:85], v8 offset:12288
    v_mfma_f32_16x16x32_bf16 v[248:251], v[40:43], v[28:31], v[248:251]
    ds_read_b64_tr_b16 v[86:87], v8 offset:12800
    s_getreg_b32 s52, hwreg(HW_REG_IB_STS, 0, 4)
    s_add_u32 s52, s52, s74
    s_cmp_le_u32 s52, 4
    s_cbranch_scc0 FK_121_r
    s_waitcnt vmcnt(4)
    s_mov_b64 exec, 1
    buffer_store_dword v15, v11, s[28:31], s70 offen sc1
    s_mov_b64 exec, -1
    s_mov_b32 s74, 64
FK_121_r:
    s_waitcnt lgkmcnt(12)
    v_mfma_f32_16x16x32_bf16 v[228:231], v[44:47], v[16:19], v[228:231]
    ds_read_b32 v13, v0 offset:65336
    v_mfma_f32_16x16x32_bf16 v[236:239], v[44:47], v[20:23], v[236:239]
    v_mfma_f32_16x16x32_bf16 v[244:247], v[44:47], v[24:27], v[244:247]
    v_mfma_f32_16x16x32_bf16 v[252:255], v[44:47], v[28:31], v[252:255]
    s_waitcnt lgkmcnt(0)
    v_readfirstlane_b32 s52, v13
    s_cmp_ge_u32 s52, 4
    s_cbranch_scc1 CF_122
LW_123:
    ds_read_b32 v13, v0 offset:65336
    s_waitcnt lgkmcnt(0)
    v_readfirstlane_b32 s52, v13
    s_cmp_ge_u32 s52, 4
    s_cbranch_scc1 LD_124
    s_sub_u32 s3, s3, 1
    s_cmp_lt_i32 s3, 0
    s_cbranch_scc1 LD_124
    s_branch LW_123
LD_124:
CF_122:
    v_mfma_f32_16x16x32_bf16 v[192:195], v[72:75], v[56:59], v[192:195]
    ds_read_b128 v[16:19], v5 offset:32768
    v_mfma_f32_16x16x32_bf16 v[200:203], v[72:75], v[60:63], v[200:203]
    ds_read_b64_tr_b16 v[32:33], v7 offset:16384
    v_mfma_f32_16x16x32_bf16 v[208:211], v[72:75], v[64:67], v[208:211]
    ds_read_b64_tr_b16 v[34:35], v7 offset:16896
    v_mfma_f32_16x16x32_bf16 v[216:219], v[72:75], v[68:71], v[216:219]
    ds_read_b128 v[20:23], v5 offset:33792
    s_getreg_b32 s52, hwreg(HW_REG_IB_STS, 0, 4)
    s_add_u32 s52, s52, s74
    s_cmp_le_u32 s52, 4
    s_cbranch_scc0 FK_125_r
    s_waitcnt vmcnt(4)
    s_mov_b64 exec, 1
    buffer_store_dword v15, v11, s[28:31], s70 offen sc1
    s_mov_b64 exec, -1
    s_mov_b32 s74, 64
FK_125_r:
    v_mfma_f32_16x16x32_bf16 v[196:199], v[76:79], v[56:59], v[196:199]
    ds_read_b128 v[24:27], v5 offset:36864
    v_mfma_f32_16x16x32_bf16 v[204:207], v[76:79], v[60:63], v[204:207]
    ds_read_b128 v[28:31], v5 offset:37888
    v_mfma_f32_16x16x32_bf16 v[212:215], v[76:79], v[64:67], v[212:215]
    ds_read_b64_tr_b16 v[36:37], v8 offset:16384
    v_mfma_f32_16x16x32_bf16 v[220:223], v[76:79], v[68:71], v[220:223]
    ds_read_b64_tr_b16 v[38:39], v8 offset:16896
    v_mfma_f32_16x16x32_bf16 v[224:227], v[80:83], v[56:59], v[224:227]
    ds_read_b64_tr_b16 v[40:41], v7 offset:24576
    v_mfma_f32_16x16x32_bf16 v[232:235], v[80:83], v[60:63], v[232:235]
    ds_read_b64_tr_b16 v[42:43], v7 offset:25088
    v_mfma_f32_16x16x32_bf16 v[240:243], v[80:83], v[64:67], v[240:243]
    ds_read_b64_tr_b16 v[44:45], v8 offset:24576
    v_mfma_f32_16x16x32_bf16 v[248:251], v[80:83], v[68:71], v[248:251]
    ds_read_b64_tr_b16 v[46:47], v8 offset:25088
    s_getreg_b32 s52, hwreg(HW_REG_IB_STS, 0, 4)
    s_add_u32 s52, s52, s74
    s_cmp_le_u32 s52, 4
    s_cbranch_scc0 FK_126_r
    s_waitcnt vmcnt(4)
    s_mov_b64 exec, 1
    buffer_store_dword v15, v11, s[28:31], s70 offen sc1
    s_mov_b64 exec, -1
    s_mov_b32 s74, 64
FK_126_r:
    v_mfma_f32_16x16x32_bf16 v[228:231], v[84:87], v[56:59], v[228:231]
    v_mfma_f32_16x16x32_bf16 v[236:239], v[84:87], v[60:63], v[236:239]
    v_mfma_f32_16x16x32_bf16 v[244:247], v[84:87], v[64:67], v[244:247]
    v_mfma_f32_16x16x32_bf16 v[252:255], v[84:87], v[68:71], v[252:255]
    s_waitcnt lgkmcnt(9)
    v_mfma_f32_16x16x32_bf16 v[192:195], v[32:35], v[16:19], v[192:195]
    ds_read_b128 v[56:59], v6 offset:32768
    s_waitcnt lgkmcnt(9)
    v_mfma_f32_16x16x32_bf16 v[200:203], v[32:35], v[20:23], v[200:203]
    ds_read_b64_tr_b16 v[72:73], v7 offset:20480
    s_waitcnt lgkmcnt(9)
    v_mfma_f32_16x16x32_bf16 v[208:211], v[32:35], v[24:27], v[208:211]
    ds_read_b64_tr_b16 v[74:75], v7 offset:20992
    s_waitcnt lgkmcnt(9)
    v_mfma_f32_16x16x32_bf16 v[216:219], v[32:35], v[28:31], v[216:219]
    ds_read_b128 v[60:63], v6 offset:33792
    s_getreg_b32 s52, hwreg(HW_REG_IB_STS, 0, 4)
    s_add_u32 s52, s52, s74
    s_cmp_le_u32 s52, 4
    s_cbranch_scc0 FK_127_r
    s_waitcnt vmcnt(4)
    s_mov_b64 exec, 1
    buffer_store_dword v15, v11, s[28:31], s70 offen sc1
    s_mov_b64 exec, -1
    s_mov_b32 s74, 64
FK_127_r:
    s_waitcnt lgkmcnt(8)
    v_mfma_f32_16x16x32_bf16 v[196:199], v[36:39], v[16:19], v[196:199]
    ds_read_b128 v[64:67], v6 offset:36864
    v_mfma_f32_16x16x32_bf16 v[204:207], v[36:39], v[20:23], v[204:207]
    ds_read_b128 v[68:71], v6 offset:37888
    v_mfma_f32_16x16x32_bf16 v[212:215], v[36:39], v[24:27], v[212:215]
    ds_read_b64_tr_b16 v[76:77], v8 offset:20480
    v_mfma_f32_16x16x32_bf16 v[220:223], v[36:39], v[28:31], v[220:223]
    ds_read_b64_tr_b16 v[78:79], v8 offset:20992
    s_waitcnt lgkmcnt(10)
    v_mfma_f32_16x16x32_bf16 v[224:227], v[40:43], v[16:19], v[224:227]
    ds_read_b64_tr_b16 v[80:81], v7 offset:28672
    v_mfma_f32_16x16x32_bf16 v[232:235], v[40:43], v[20:23], v[232:235]
    ds_read_b64_tr_b16 v[82:83], v7 offset:29184
    v_mfma_f32_16x16x32_bf16 v[240:243], v[40:43], v[24:27], v[240:243]
    ds_read_b64_tr_b16 v[84:85], v8 offset:28672
    v_mfma_f32_16x16x32_bf16 v[248:251], v[40:43], v[28:31], v[248:251]
    ds_read_b64_tr_b16 v[86:87], v8 offset:29184
    s_getreg_b32 s52, hwreg(HW_REG_IB_STS, 0, 4)
    s_add_u32 s52, s52, s74
    s_cmp_le_u32 s52, 4
    s_cbranch_scc0 FK_128_r
    s_waitcnt vmcnt(4)
    s_mov_b64 exec, 1
    buffer_store_dword v15, v11, s[28:31], s70 offen sc1
    s_mov_b64 exec, -1
    s_mov_b32 s74, 64
FK_128_r:
    s_waitcnt lgkmcnt(12)
    v_mfma_f32_16x16x32_bf16 v[228:231], v[44:47], v[16:19], v[228:231]
    v_mfma_f32_16x16x32_bf16 v[236:239], v[44:47], v[20:23], v[236:239]
    v_mfma_f32_16x16x32_bf16 v[244:247], v[44:47], v[24:27], v[244:247]
    v_mfma_f32_16x16x32_bf16 v[252:255], v[44:47], v[28:31], v[252:255]
    s_waitcnt lgkmcnt(9)
    v_mfma_f32_16x16x32_bf16 v[192:195], v[72:75], v[56:59], v[192:195]
    ds_read_b128 v[16:19], v5 offset:16384
    s_waitcnt lgkmcnt(9)
    v_mfma_f32_16x16x32_bf16 v[200:203], v[72:75], v[60:63], v[200:203]
    ds_read_b64_tr_b16 v[32:33], v7 offset:32768
    s_waitcnt lgkmcnt(9)
    v_mfma_f32_16x16x32_bf16 v[208:211], v[72:75], v[64:67], v[208:211]
    ds_read_b64_tr_b16 v[34:35], v7 offset:33280
    s_waitcnt lgkmcnt(9)
    v_mfma_f32_16x16x32_bf16 v[216:219], v[72:75], v[68:71], v[216:219]
    ds_read_b128 v[20:23], v5 offset:17408
    s_getreg_b32 s52, hwreg(HW_REG_IB_STS, 0, 4)
    s_add_u32 s52, s52, s74
    s_cmp_le_u32 s52, 4
    s_cbranch_scc0 FK_129_r
    s_waitcnt vmcnt(4)
    s_mov_b64 exec, 1
    buffer_store_dword v15, v11, s[28:31], s70 offen sc1
    s_mov_b64 exec, -1
    s_mov_b32 s74, 64
FK_129_r:
    s_waitcnt lgkmcnt(8)
    v_mfma_f32_16x16x32_bf16 v[196:199], v[76:79], v[56:59], v[196:199]
    ds_read_b128 v[24:27], v5 offset:20480
    v_mfma_f32_16x16x32_bf16 v[204:207], v[76:79], v[60:63], v[204:207]
    ds_read_b128 v[28:31], v5 offset:21504
    v_mfma_f32_16x16x32_bf16 v[212:215], v[76:79], v[64:67], v[212:215]
    ds_read_b64_tr_b16 v[36:37], v8 offset:32768
    v_mfma_f32_16x16x32_bf16 v[220:223], v[76:79], v[68:71], v[220:223]
    ds_read_b64_tr_b16 v[38:39], v8 offset:33280
    s_waitcnt lgkmcnt(10)
    v_mfma_f32_16x16x32_bf16 v[224:227], v[80:83], v[56:59], v[224:227]
    ds_read_b64_tr_b16 v[40:41], v7 offset:40960
    v_mfma_f32_16x16x32_bf16 v[232:235], v[80:83], v[60:63], v[232:235]
    ds_read_b64_tr_b16 v[42:43], v7 offset:41472
    v_mfma_f32_16x16x32_bf16 v[240:243], v[80:83], v[64:67], v[240:243]
    ds_read_b64_tr_b16 v[44:45], v8 offset:40960
    v_mfma_f32_16x16x32_bf16 v[248:251], v[80:83], v[68:71], v[248:251]
    ds_read_b64_tr_b16 v[46:47], v8 offset:41472
    s_getreg_b32 s52, hwreg(HW_REG_IB_STS, 0, 4)
    s_add_u32 s52, s52, s74
    s_cmp_le_u32 s52, 4
    s_cbranch_scc0 FK_130_r
    s_waitcnt vmcnt(4)
    s_mov_b64 exec, 1
    buffer_store_dword v15, v11, s[28:31], s70 offen sc1
    s_mov_b64 exec, -1
    s_mov_b32 s74, 64
FK_130_r:
    s_waitcnt lgkmcnt(12)
    v_mfma_f32_16x16x32_bf16 v[228:231], v[84:87], v[56:59], v[228:231]
    v_mfma_f32_16x16x32_bf16 v[236:239], v[84:87], v[60:63], v[236:239]
    v_mfma_f32_16x16x32_bf16 v[244:247], v[84:87], v[64:67], v[244:247]
    v_mfma_f32_16x16x32_bf16 v[252:255], v[84:87], v[68:71], v[252:255]
    s_waitcnt lgkmcnt(9)
    v_mfma_f32_16x16x32_bf16 v[192:195], v[32:35], v[16:19], v[192:195]
    ds_read_b128 v[56:59], v6 offset:16384
    s_waitcnt lgkmcnt(9)
    v_mfma_f32_16x16x32_bf16 v[200:203], v[32:35], v[20:23], v[200:203]
    ds_read_b64_tr_b16 v[72:73], v7 offset:36864
    s_waitcnt lgkmcnt(9)
    v_mfma_f32_16x16x32_bf16 v[208:211], v[32:35], v[24:27], v[208:211]
    ds_read_b64_tr_b16 v[74:75], v7 offset:37376
    s_waitcnt lgkmcnt(9)
    v_mfma_f32_16x16x32_bf16 v[216:219], v[32:35], v[28:31], v[216:219]
    ds_read_b128 v[60:63], v6 offset:17408
    s_getreg_b32 s52, hwreg(HW_REG_IB_STS, 0, 4)
    s_add_u32 s52, s52, s74
    s_cmp_le_u32 s52, 4
    s_cbranch_scc0 FK_131_r
    s_waitcnt vmcnt(4)
    s_mov_b64 exec, 1
    buffer_store_dword v15, v11, s[28:31], s70 offen sc1
    s_mov_b64 exec, -1
    s_mov_b32 s74, 64
FK_131_r:
    s_waitcnt lgkmcnt(8)
    v_mfma_f32_16x16x32_bf16 v[196:199], v[36:39], v[16:19], v[196:199]
    ds_read_b128 v[64:67], v6 offset:20480
    v_mfma_f32_16x16x32_bf16 v[204:207], v[36:39], v[20:23], v[204:207]
    ds_read_b128 v[68:71], v6 offset:21504
    v_mfma_f32_16x16x32_bf16 v[212:215], v[36:39], v[24:27], v[212:215]
    ds_read_b64_tr_b16 v[76:77], v8 offset:36864
    v_mfma_f32_16x16x32_bf16 v[220:223], v[36:39], v[28:31], v[220:223]
    ds_read_b64_tr_b16 v[78:79], v8 offset:37376
    s_waitcnt lgkmcnt(10)
    v_mfma_f32_16x16x32_bf16 v[224:227], v[40:43], v[16:19], v[224:227]
    ds_read_b64_tr_b16 v[80:81], v7 offset:45056
    v_mfma_f32_16x16x32_bf16 v[232:235], v[40:43], v[20:23], v[232:235]
    ds_read_b64_tr_b16 v[82:83], v7 offset:45568
    v_mfma_f32_16x16x32_bf16 v[240:243], v[40:43], v[24:27], v[240:243]
    ds_read_b64_tr_b16 v[84:85], v8 offset:45056
    v_mfma_f32_16x16x32_bf16 v[248:251], v[40:43], v[28:31], v[248:251]
    ds_read_b64_tr_b16 v[86:87], v8 offset:45568
    s_getreg_b32 s52, hwreg(HW_REG_IB_STS, 0, 4)
    s_add_u32 s52, s52, s74
    s_cmp_le_u32 s52, 4
    s_cbranch_scc0 FK_132_r
    s_waitcnt vmcnt(4)
    s_mov_b64 exec, 1
    buffer_store_dword v15, v11, s[28:31], s70 offen sc1
    s_mov_b64 exec, -1
    s_mov_b32 s74, 64
FK_132_r:
    s_waitcnt lgkmcnt(12)
    v_mfma_f32_16x16x32_bf16 v[228:231], v[44:47], v[16:19], v[228:231]
    v_mfma_f32_16x16x32_bf16 v[236:239], v[44:47], v[20:23], v[236:239]
    v_mfma_f32_16x16x32_bf16 v[244:247], v[44:47], v[24:27], v[244:247]
    v_mfma_f32_16x16x32_bf16 v[252:255], v[44:47], v[28:31], v[252:255]
    s_cmp_eq_u32 s74, 0
    s_cbranch_scc0 FK_133_r
    s_waitcnt vmcnt(4)
    s_mov_b64 exec, 1
    buffer_store_dword v15, v11, s[28:31], s70 offen sc1
    s_mov_b64 exec, -1
    s_mov_b32 s74, 64
FK_133_r:
    s_waitcnt lgkmcnt(9)
    v_mfma_f32_16x16x32_bf16 v[192:195], v[72:75], v[56:59], v[192:195]
    s_waitcnt lgkmcnt(2)
    v_mfma_f32_16x16x32_bf16 v[224:227], v[80:83], v[56:59], v[224:227]
    v_mfma_f32_16x16x32_bf16 v[196:199], v[76:79], v[56:59], v[196:199]
    s_waitcnt lgkmcnt(0)
    v_mfma_f32_16x16x32_bf16 v[228:231], v[84:87], v[56:59], v[228:231]
    v_mfma_f32_16x16x32_bf16 v[200:203], v[72:75], v[60:63], v[200:203]
    v_mfma_f32_16x16x32_bf16 v[232:235], v[80:83], v[60:63], v[232:235]
    s_nop 2
    v_mul_f32 v192, v192, v224
    v_mul_f32 v193, v193, v225
    v_mul_f32 v194, v194, v226
    v_mfma_f32_16x16x32_bf16 v[204:207], v[76:79], v[60:63], v[204:207]
    v_mul_f32 v195, v195, v227
    v_mul_f32 v196, v196, v228
    v_mul_f32 v197, v197, v229
    v_mfma_f32_16x16x32_bf16 v[236:239], v[84:87], v[60:63], v[236:239]
    v_mul_f32 v198, v198, v230
    v_mul_f32 v199, v199, v231
    v_cvt_pk_bf16_f32 v192, v192, v193
    v_mfma_f32_16x16x32_bf16 v[208:211], v[72:75], v[64:67], v[208:211]
    v_cvt_pk_bf16_f32 v193, v194, v195
    v_cvt_pk_bf16_f32 v194, v196, v197
    v_cvt_pk_bf16_f32 v195, v198, v199
    v_mfma_f32_16x16x32_bf16 v[240:243], v[80:83], v[64:67], v[240:243]
    v_mul_f32 v200, v200, v232
    v_mul_f32 v201, v201, v233
    v_mul_f32 v202, v202, v234
    v_mfma_f32_16x16x32_bf16 v[212:215], v[76:79], v[64:67], v[212:215]
    v_mul_f32 v203, v203, v235
    v_mul_f32 v204, v204, v236
    v_mul_f32 v205, v205, v237
    v_mfma_f32_16x16x32_bf16 v[244:247], v[84:87], v[64:67], v[244:247]
    v_mul_f32 v206, v206, v238
    v_mul_f32 v207, v207, v239
    v_cvt_pk_bf16_f32 v200, v200, v201
    v_mfma_f32_16x16x32_bf16 v[216:219], v[72:75], v[68:71], v[216:219]
    v_cvt_pk_bf16_f32 v201, v202, v203
    v_cvt_pk_bf16_f32 v202, v204, v205
    v_cvt_pk_bf16_f32 v203, v206, v207
    v_mfma_f32_16x16x32_bf16 v[248:251], v[80:83], v[68:71], v[248:251]
    v_permlane32_swap_b32 v192, v200
    v_permlane32_swap_b32 v193, v201
    v_permlane32_swap_b32 v194, v202
    v_mfma_f32_16x16x32_bf16 v[220:223], v[76:79], v[68:71], v[220:223]
    v_permlane32_swap_b32 v195, v203
    buffer_store_dwordx4 v[192:195], v3, s[28:31], s60 offen sc1
    buffer_store_dwordx4 v[200:203], v3, s[28:31], s60 offen offset:1024 sc1
    v_mfma_f32_16x16x32_bf16 v[252:255], v[84:87], v[68:71], v[252:255]
    v_mul_f32 v208, v208, v240
    v_mul_f32 v209, v209, v241
    v_mul_f32 v210, v210, v242
    v_mul_f32 v211, v211, v243
    v_mul_f32 v212, v212, v244
    v_mul_f32 v213, v213, v245
    v_mul_f32 v214, v214, v246
    v_mul_f32 v215, v215, v247
    v_cvt_pk_bf16_f32 v208, v208, v209
    v_cvt_pk_bf16_f32 v209, v210, v211
    v_cvt_pk_bf16_f32 v210, v212, v213
    v_cvt_pk_bf16_f32 v211, v214, v215
    v_mul_f32 v216, v216, v248
    v_mul_f32 v217, v217, v249
    v_mul_f32 v218, v218, v250
    v_mul_f32 v219, v219, v251
    v_mul_f32 v220, v220, v252
    v_mul_f32 v221, v221, v253
    v_mul_f32 v222, v222, v254
    v_mul_f32 v223, v223, v255
    v_cvt_pk_bf16_f32 v216, v216, v217
    v_cvt_pk_bf16_f32 v217, v218, v219
    v_cvt_pk_bf16_f32 v218, v220, v221
    v_cvt_pk_bf16_f32 v219, v222, v223
    v_permlane32_swap_b32 v208, v216
    v_permlane32_swap_b32 v209, v217
    v_permlane32_swap_b32 v210, v218
    v_permlane32_swap_b32 v211, v219
    buffer_store_dwordx4 v[208:211], v3, s[28:31], s61 offen sc1
    buffer_store_dwordx4 v[216:219], v3, s[28:31], s61 offen offset:1024 sc1
C_ATT:
    s_mov_b32 s74, 0
    v_mov_b32 v3, 65280
    v_mov_b32 v4, 1
    s_mov_b64 exec, 1
    ds_add_u32 v3, v4 offset:4
    s_mov_b64 exec, -1
    s_lshl_b32 s45, s50, 2
    s_and_b32 s52, s51, 3
    s_add_u32 s45, s45, s52
    s_lshr_b32 s46, s51, 2
    s_and_b32 s47, s44, 3
    s_lshl_b32 s56, s47, 10
    s_lshl_b32 s52, s45, 16
    s_add_u32 s57, s52, 0x208000
    s_add_u32 s55, s52, s56
    s_add_u32 s55, s55, 0x200000
    v_lshlrev_b32 v2, 4, v1
    s_lshl_b32 s53, s46, 3
    s_lshl_b32 s54, s47, 1
    s_add_u32 s53, s53, s54
    v_add_u32 v6, s56, v2
    v_add_u32 v7, s56, v6
    v_add_u32 v6, 65536, v6
    s_lshl_b32 s58, s53, 15
    s_lshl_b32 s54, s45, 10
    s_add_u32 s58, s58, s54
    s_add_u32 s58, s58, 0x608000
    v_lshrrev_b32 v5, 5, v1
    v_and_b32 v22, 27, v1
    v_mov_b32 v23, 0x3f803f80
    v_cmp_eq_u32 vcc, 16, v22
    s_nop 1
    v_cndmask_b32 v23, 0, v23, vcc
    v_mov_b32 v128, v23
    v_mov_b32 v129, v23
    v_mov_b32 v130, v23
    v_mov_b32 v131, v23
    v_mov_b32 v132, v23
    v_mov_b32 v133, v23
    v_mov_b32 v134, v23
    v_mov_b32 v135, v23
    v_mov_b32 v136, v23
    v_mov_b32 v137, v23
    v_mov_b32 v138, v23
    v_mov_b32 v139, v23
    v_mov_b32 v140, v23
    v_mov_b32 v141, v23
    v_mov_b32 v142, v23
    v_mov_b32 v143, v23
    v_add_u32 v16, 0x10000, v2
    v_add_u32 v17, 0x20000, v2
    v_and_b32 v22, 15, v1
    v_lshlrev_b32 v22, 4, v22
    v_lshl_add_u32 v21, v5, 8, v22
    v_add_u32 v19, 0x10000, v21
    v_add_u32 v20, 0x20000, v21
LW_134:
    ds_read_b32 v22, v3 offset:0
    s_waitcnt lgkmcnt(0)
    v_readfirstlane_b32 s70, v22
    s_cmp_ge_u32 s70, 4
    s_cbranch_scc1 LD_135
    s_sub_u32 s3, s3, 1
    s_cmp_lt_i32 s3, 0
    s_cbranch_scc1 LD_135
    s_branch LW_134
LD_135:
    ds_read_b128 v[8:11], v7 offset:50176
    ds_read_b128 v[12:15], v7 offset:49152
    ds_read_b128 v[72:75], v6 offset:8192
    s_mov_b32 s96, 0x0000ffff
    s_mov_b32 s97, 0x0000ffff
    s_mov_b32 s70, 0x3eb8aa3b
    ds_read_b128 v[120:123], v16 offset:8192
    s_mov_b64 exec, s[96:97]
    ds_read_b128 v[128:131], v19 offset:12288
    ds_read_b128 v[132:135], v19 offset:12800
    s_mov_b64 exec, -1
    s_waitcnt lgkmcnt(5)
    v_lshlrev_b32 v24, 16, v8
    v_and_b32 v25, 0xffff0000, v8
    v_mul_f32 v24, s70, v24
    v_mul_f32 v25, s70, v25
    v_cvt_pk_bf16_f32 v8, v24, v25
    v_lshlrev_b32 v26, 16, v9
    v_and_b32 v27, 0xffff0000, v9
    v_mul_f32 v26, s70, v26
    v_mul_f32 v27, s70, v27
    v_cvt_pk_bf16_f32 v9, v26, v27
    v_lshlrev_b32 v28, 16, v10
    v_and_b32 v29, 0xffff0000, v10
    v_mul_f32 v28, s70, v28
    v_mul_f32 v29, s70, v29
    v_cvt_pk_bf16_f32 v10, v28, v29
    v_lshlrev_b32 v30, 16, v11
    v_and_b32 v31, 0xffff0000, v11
    v_mul_f32 v30, s70, v30
    v_mul_f32 v31, s70, v31
    v_cvt_pk_bf16_f32 v11, v30, v31
    s_waitcnt lgkmcnt(4)
    v_lshlrev_b32 v32, 16, v12
    v_and_b32 v33, 0xffff0000, v12
    v_mul_f32 v32, s70, v32
    v_mul_f32 v33, s70, v33
    v_cvt_pk_bf16_f32 v12, v32, v33
    v_lshlrev_b32 v34, 16, v13
    v_and_b32 v35, 0xffff0000, v13
    v_mul_f32 v34, s70, v34
    v_mul_f32 v35, s70, v35
    v_cvt_pk_bf16_f32 v13, v34, v35
    v_lshlrev_b32 v36, 16, v14
    v_and_b32 v37, 0xffff0000, v14
    v_mul_f32 v36, s70, v36
    v_mul_f32 v37, s70, v37
    v_cvt_pk_bf16_f32 v14, v36, v37
    v_lshlrev_b32 v38, 16, v15
    v_and_b32 v39, 0xffff0000, v15
    v_mul_f32 v38, s70, v38
    v_mul_f32 v39, s70, v39
    v_cvt_pk_bf16_f32 v15, v38, v39
    s_waitcnt lgkmcnt(3)
    v_mfma_f32_32x32x16_bf16 v[24:39], v[72:75], v[8:11], 0
    v_mfma_f32_32x32x16_bf16 v[40:55], v[72:75], v[12:15], 0
    s_mov_b32 s48, 1
    s_mul_i32 s59, s45, 229376
    s_mul_i32 s52, s47, 28672
    s_add_u32 s59, s59, s52
    s_add_u32 s59, s59, 0xa03800
    s_add_u32 s60, s59, 114688
    s_mul_i32 s61, s46, 229376
    s_lshl_b32 s52, s52, 1
    s_add_u32 s61, s61, s52
    s_add_u32 s61, s61, 0x807000
    s_nop 0
    v_max3_f32 v22, v24, v25, v26
    v_max3_f32 v22, v22, v27, v28
    v_max3_f32 v22, v22, v29, v30
    v_max3_f32 v22, v22, v31, v32
    v_max3_f32 v22, v22, v33, v34
    v_max3_f32 v22, v22, v35, v36
    v_max3_f32 v22, v22, v37, v38
    v_max_f32 v22, v22, v39
    v_mov_b32 v6, v22
    s_nop 1
    v_permlane32_swap_b32 v22, v6
    v_max_f32 v22, v22, v6
    v_mul_f32 v24, -1.0, v22
    v_mul_f32 v25, -1.0, v22
    v_mul_f32 v26, -1.0, v22
    v_mul_f32 v27, -1.0, v22
    v_mul_f32 v28, -1.0, v22
    v_mul_f32 v29, -1.0, v22
    v_mul_f32 v30, -1.0, v22
    v_mul_f32 v31, -1.0, v22
    v_mul_f32 v32, -1.0, v22
    v_mul_f32 v33, -1.0, v22
    v_mul_f32 v34, -1.0, v22
    v_mul_f32 v35, -1.0, v22
    v_mul_f32 v36, -1.0, v22
    v_mul_f32 v37, -1.0, v22
    v_mul_f32 v38, -1.0, v22
    v_mul_f32 v39, -1.0, v22
    v_max3_f32 v23, v40, v41, v42
    v_max3_f32 v23, v23, v43, v44
    v_max3_f32 v23, v23, v45, v46
    v_max3_f32 v23, v23, v47, v48
    v_max3_f32 v23, v23, v49, v50
    v_max3_f32 v23, v23, v51, v52
    v_max3_f32 v23, v23, v53, v54
    v_max_f32 v23, v23, v55
    v_mov_b32 v6, v23
    s_nop 1
    v_permlane32_swap_b32 v23, v6
    v_max_f32 v23, v23, v6
    v_mul_f32 v40, -1.0, v23
    v_mul_f32 v41, -1.0, v23
    v_mul_f32 v42, -1.0, v23
    v_mul_f32 v43, -1.0, v23
    v_mul_f32 v44, -1.0, v23
    v_mul_f32 v45, -1.0, v23
    v_mul_f32 v46, -1.0, v23
    v_mul_f32 v47, -1.0, v23
    v_mul_f32 v48, -1.0, v23
    v_mul_f32 v49, -1.0, v23
    v_mul_f32 v50, -1.0, v23
    v_mul_f32 v51, -1.0, v23
    v_mul_f32 v52, -1.0, v23
    v_mul_f32 v53, -1.0, v23
    v_mul_f32 v54, -1.0, v23
    v_mul_f32 v55, -1.0, v23
    s_setprio 1
    s_waitcnt lgkmcnt(2)
    v_mfma_f32_32x32x16_bf16 v[56:71], v[120:123], v[8:11], v[24:39]
    s_nop 7
    s_nop 3
    v_exp_f32 v56, v56
    v_exp_f32 v57, v57
    v_exp_f32 v58, v58
    v_exp_f32 v59, v59
    v_exp_f32 v60, v60
    v_mfma_f32_32x32x16_bf16 v[72:87], v[120:123], v[12:15], v[40:55]
    ds_read_b128 v[124:127], v16 offset:9216
    s_mov_b64 exec, s[96:97]
    ds_read_b128 v[136:139], v19 offset:13312
    ds_read_b128 v[140:143], v19 offset:13824
    s_mov_b64 exec, -1
    s_lshl_b32 s62, s46, 16
    s_lshl_b32 s52, s47, 14
    s_add_u32 s62, s62, s52
    s_add_u32 s62, s62, 0x1180000
    s_lshl_b32 s65, s45, 16
    s_lshl_b32 s52, s47, 13
    s_add_u32 s63, s65, s52
    s_add_u32 s63, s63, 0x608000
    s_lshl_b32 s64, s45, 9
    s_add_u32 s64, s64, 0x1100100
    s_lshl_b32 s52, s46, 7
    s_add_u32 s65, s65, s52
    s_lshl_b32 s52, s47, 5
    s_add_u32 s65, s65, s52
    s_add_u32 s65, s65, 32768
    s_lshl_b32 s52, s45, 7
    s_add_u32 s52, s52, 0x1114000
    s_lshl_b32 s53, s46, 9
    s_lshl_b32 s54, s47, 7
    s_add_u32 s53, s53, s54
    s_add_u32 s53, s53, 0x1117f80
    s_sub_u32 s53, s53, s52
    v_mul_lo_u32 v18, v5, s53
    v_lshl_add_u32 v18, v1, 2, v18
    v_add_u32 v18, s52, v18
    s_lshl_b32 s52, s47, 3
    s_lshr_b32 s75, 0xf0e010b, s52
    s_and_b32 s75, s75, 0xff
    s_lshl_b32 s75, s75, 13
    s_and_b32 s52, s47, 1
    s_lshl_b32 s52, s52, 12
    s_mov_b32 s72, 73728
    s_mov_b32 s73, 98304
    s_cmp_ge_u32 s47, 2
    s_cselect_b32 s72, 81920, s72
    s_cselect_b32 s73, 106496, s73
    s_add_u32 s72, s72, s52
    s_add_u32 s73, s73, s52
    v_exp_f32 v61, v61
    v_exp_f32 v62, v62
    v_exp_f32 v63, v63
    v_exp_f32 v64, v64
    v_cvt_pk_bf16_f32 v144, v56, v57
    v_cvt_pk_bf16_f32 v145, v58, v59
    v_cvt_pk_bf16_f32 v146, v60, v61
    v_cvt_pk_bf16_f32 v147, v62, v63
    v_exp_f32 v65, v65
    v_exp_f32 v66, v66
    v_exp_f32 v67, v67
    s_waitcnt lgkmcnt(3)
    v_mfma_f32_32x32x16_bf16 v[88:103], v[128:131], v[144:147], 0
    v_exp_f32 v68, v68
    v_exp_f32 v69, v69
    v_exp_f32 v70, v70
    v_exp_f32 v71, v71
    v_cvt_pk_bf16_f32 v148, v64, v65
    v_cvt_pk_bf16_f32 v149, v66, v67
    v_cvt_pk_bf16_f32 v150, v68, v69
    v_cvt_pk_bf16_f32 v151, v70, v71
    v_exp_f32 v72, v72
    v_exp_f32 v73, v73
    v_mfma_f32_32x32x16_bf16 v[88:103], v[132:135], v[148:151], v[88:103]
    v_exp_f32 v74, v74
    v_exp_f32 v75, v75
    v_exp_f32 v76, v76
    s_waitcnt lgkmcnt(0)
    v_mfma_f32_32x32x16_bf16 v[56:71], v[124:127], v[8:11], v[24:39]
    s_getreg_b32 s52, hwreg(HW_REG_IB_STS, 0, 4)
    s_add_u32 s52, s52, s74
    s_cmp_le_u32 s52, 0
    s_cbranch_scc0 HK_136_r
    s_waitcnt vmcnt(0)
    v_mov_b32 v6, s94
    s_mov_b64 exec, 1
    buffer_store_dword v6, off, s[28:31], s95 sc1
    s_mov_b64 exec, -1
    s_mov_b32 s74, 64
    s_nop 3
HK_136_r:
    v_exp_f32 v77, v77
    v_exp_f32 v78, v78
    v_exp_f32 v79, v79
    v_exp_f32 v80, v80
    v_cvt_pk_bf16_f32 v152, v72, v73
    v_cvt_pk_bf16_f32 v153, v74, v75
    v_cvt_pk_bf16_f32 v154, v76, v77
    v_cvt_pk_bf16_f32 v155, v78, v79
    v_exp_f32 v81, v81
    v_exp_f32 v82, v82
    v_exp_f32 v83, v83
    v_mfma_f32_32x32x16_bf16 v[104:119], v[128:131], v[152:155], 0
    v_exp_f32 v84, v84
    v_exp_f32 v85, v85
    v_exp_f32 v86, v86
    v_exp_f32 v87, v87
    s_getreg_b32 s52, hwreg(HW_REG_IB_STS, 0, 4)
    s_add_u32 s52, s52, s74
    s_cmp_le_u32 s52, 0
    s_cbranch_scc0 HK_137_r
    s_waitcnt vmcnt(0)
    v_mov_b32 v6, s94
    s_mov_b64 exec, 1
    buffer_store_dword v6, off, s[28:31], s95 sc1
    s_mov_b64 exec, -1
    s_mov_b32 s74, 64
    s_nop 3
HK_137_r:
    v_cvt_pk_bf16_f32 v156, v80, v81
    v_cvt_pk_bf16_f32 v157, v82, v83
    v_cvt_pk_bf16_f32 v158, v84, v85
    v_cvt_pk_bf16_f32 v159, v86, v87
    v_exp_f32 v56, v56
    v_exp_f32 v57, v57
    v_mfma_f32_32x32x16_bf16 v[104:119], v[132:135], v[156:159], v[104:119]
    v_exp_f32 v58, v58
    v_exp_f32 v59, v59
    v_exp_f32 v60, v60
    v_mfma_f32_32x32x16_bf16 v[72:87], v[124:127], v[12:15], v[40:55]
    ds_read_b128 v[120:123], v16 offset:10240
    s_mov_b64 exec, s[96:97]
    ds_read_b128 v[128:131], v19 offset:14336
    ds_read_b128 v[132:135], v19 offset:14848
    s_mov_b64 exec, -1
    s_getreg_b32 s52, hwreg(HW_REG_IB_STS, 0, 4)
    s_add_u32 s52, s52, s74
    s_cmp_le_u32 s52, 0
    s_cbranch_scc0 HK_138_r
    s_waitcnt vmcnt(0)
    v_mov_b32 v6, s94
    s_mov_b64 exec, 1
    buffer_store_dword v6, off, s[28:31], s95 sc1
    s_mov_b64 exec, -1
    s_mov_b32 s74, 64
    s_nop 3
HK_138_r:
    ds_read_b32 v22, v3 offset:4
    v_exp_f32 v61, v61
    v_exp_f32 v62, v62
    v_exp_f32 v63, v63
    v_exp_f32 v64, v64
    v_cvt_pk_bf16_f32 v144, v56, v57
    v_cvt_pk_bf16_f32 v145, v58, v59
    v_cvt_pk_bf16_f32 v146, v60, v61
    v_cvt_pk_bf16_f32 v147, v62, v63
    v_exp_f32 v65, v65
    v_exp_f32 v66, v66
    v_exp_f32 v67, v67
    v_mfma_f32_32x32x16_bf16 v[88:103], v[136:139], v[144:147], v[88:103]
    v_exp_f32 v68, v68
    v_exp_f32 v69, v69
    v_exp_f32 v70, v70
    v_exp_f32 v71, v71
    s_getreg_b32 s52, hwreg(HW_REG_IB_STS, 0, 4)
    s_add_u32 s52, s52, s74
    s_cmp_le_u32 s52, 0
    s_cbranch_scc0 HK_139_r
    s_waitcnt vmcnt(0)
    v_mov_b32 v6, s94
    s_mov_b64 exec, 1
    buffer_store_dword v6, off, s[28:31], s95 sc1
    s_mov_b64 exec, -1
    s_mov_b32 s74, 64
    s_nop 3
HK_139_r:
    v_cvt_pk_bf16_f32 v148, v64, v65
    v_cvt_pk_bf16_f32 v149, v66, v67
    v_cvt_pk_bf16_f32 v150, v68, v69
    v_cvt_pk_bf16_f32 v151, v70, v71
    v_exp_f32 v72, v72
    v_exp_f32 v73, v73
    v_mfma_f32_32x32x16_bf16 v[88:103], v[140:143], v[148:151], v[88:103]
    v_exp_f32 v74, v74
    v_exp_f32 v75, v75
    v_exp_f32 v76, v76
    s_waitcnt lgkmcnt(0)
    v_mfma_f32_32x32x16_bf16 v[56:71], v[120:123], v[8:11], v[24:39]
    s_getreg_b32 s52, hwreg(HW_REG_IB_STS, 0, 4)
    s_add_u32 s52, s52, s74
    s_cmp_le_u32 s52, 0
    s_cbranch_scc0 HK_140_r
    s_waitcnt vmcnt(0)
    v_mov_b32 v6, s94
    s_mov_b64 exec, 1
    buffer_store_dword v6, off, s[28:31], s95 sc1
    s_mov_b64 exec, -1
    s_mov_b32 s74, 64
    s_nop 3
HK_140_r:
    v_readfirstlane_b32 s70, v22
    s_cmp_ge_u32 s70, 4
    s_cbranch_scc1 C_CD_K
LW_141:
    ds_read_b32 v22, v3 offset:4
    s_waitcnt lgkmcnt(0)
    v_readfirstlane_b32 s70, v22
    s_cmp_ge_u32 s70, 4
    s_cbranch_scc1 LD_142
    s_sub_u32 s3, s3, 1
    s_cmp_lt_i32 s3, 0
    s_cbranch_scc1 LD_142
    s_sleep 1
    s_branch LW_141
LD_142:
C_CD_K:
    s_add_u32 m0, s56, 8192
    s_add_u32 s52, s55, 0xb000
    buffer_load_dwordx4 v2, s[28:31], s52 offen sc1 lds
    s_add_u32 m0, s56, 12288
    s_add_u32 s52, s55, 0x20b000
    buffer_load_dwordx4 v2, s[28:31], s52 offen sc1 lds
    v_exp_f32 v77, v77
    v_exp_f32 v78, v78
    v_exp_f32 v79, v79
    v_exp_f32 v80, v80
    v_cvt_pk_bf16_f32 v152, v72, v73
    v_cvt_pk_bf16_f32 v153, v74, v75
    v_cvt_pk_bf16_f32 v154, v76, v77
    v_cvt_pk_bf16_f32 v155, v78, v79
    v_exp_f32 v81, v81
    v_exp_f32 v82, v82
    v_exp_f32 v83, v83
    v_mfma_f32_32x32x16_bf16 v[104:119], v[136:139], v[152:155], v[104:119]
    v_exp_f32 v84, v84
    v_exp_f32 v85, v85
    v_exp_f32 v86, v86
    v_exp_f32 v87, v87
    s_getreg_b32 s52, hwreg(HW_REG_IB_STS, 0, 4)
    s_add_u32 s52, s52, s74
    s_cmp_le_u32 s52, 2
    s_cbranch_scc0 HK_143_r
    s_waitcnt vmcnt(2)
    v_mov_b32 v6, s94
    s_mov_b64 exec, 1
    buffer_store_dword v6, off, s[28:31], s95 sc1
    s_mov_b64 exec, -1
    s_mov_b32 s74, 64
    s_nop 3
HK_143_r:
    v_cvt_pk_bf16_f32 v156, v80, v81
    v_cvt_pk_bf16_f32 v157, v82, v83
    v_cvt_pk_bf16_f32 v158, v84, v85
    v_cvt_pk_bf16_f32 v159, v86, v87
    v_exp_f32 v56, v56
    v_exp_f32 v57, v57
    v_mfma_f32_32x32x16_bf16 v[104:119], v[140:143], v[156:159], v[104:119]
    v_exp_f32 v58, v58
    v_exp_f32 v59, v59
    v_exp_f32 v60, v60
    v_mfma_f32_32x32x16_bf16 v[72:87], v[120:123], v[12:15], v[40:55]
    ds_read_b128 v[124:127], v16 offset:11264
    s_mov_b64 exec, s[96:97]
    ds_read_b128 v[136:139], v19 offset:15360
    ds_read_b128 v[140:143], v19 offset:15872
    s_mov_b64 exec, -1
    s_getreg_b32 s52, hwreg(HW_REG_IB_STS, 0, 4)
    s_add_u32 s52, s52, s74
    s_cmp_le_u32 s52, 2
    s_cbranch_scc0 HK_144_r
    s_waitcnt vmcnt(2)
    v_mov_b32 v6, s94
    s_mov_b64 exec, 1
    buffer_store_dword v6, off, s[28:31], s95 sc1
    s_mov_b64 exec, -1
    s_mov_b32 s74, 64
    s_nop 3
HK_144_r:
    ds_read_b32 v22, v3 offset:0
    s_add_u32 m0, s56, 114688
    s_add_u32 s52, s55, 0xc000
    buffer_load_dwordx4 v2, s[28:31], s52 offen sc1 lds
    s_add_u32 m0, s56, 118784
    s_add_u32 s52, s55, 0x20c000
    buffer_load_dwordx4 v2, s[28:31], s52 offen sc1 lds
    v_exp_f32 v61, v61
    v_exp_f32 v62, v62
    v_exp_f32 v63, v63
    v_exp_f32 v64, v64
    v_cvt_pk_bf16_f32 v144, v56, v57
    v_cvt_pk_bf16_f32 v145, v58, v59
    v_cvt_pk_bf16_f32 v146, v60, v61
    v_cvt_pk_bf16_f32 v147, v62, v63
    v_exp_f32 v65, v65
    v_exp_f32 v66, v66
    v_exp_f32 v67, v67
    v_mfma_f32_32x32x16_bf16 v[88:103], v[128:131], v[144:147], v[88:103]
    v_exp_f32 v68, v68
    v_exp_f32 v69, v69
    v_exp_f32 v70, v70
    v_exp_f32 v71, v71
    s_getreg_b32 s52, hwreg(HW_REG_IB_STS, 0, 4)
    s_add_u32 s52, s52, s74
    s_cmp_le_u32 s52, 4
    s_cbranch_scc0 HK_145_r
    s_waitcnt vmcnt(4)
    v_mov_b32 v6, s94
    s_mov_b64 exec, 1
    buffer_store_dword v6, off, s[28:31], s95 sc1
    s_mov_b64 exec, -1
    s_mov_b32 s74, 64
    s_nop 3
HK_145_r:
    v_cvt_pk_bf16_f32 v148, v64, v65
    v_cvt_pk_bf16_f32 v149, v66, v67
    v_cvt_pk_bf16_f32 v150, v68, v69
    v_cvt_pk_bf16_f32 v151, v70, v71
    v_exp_f32 v72, v72
    v_exp_f32 v73, v73
    v_mfma_f32_32x32x16_bf16 v[88:103], v[132:135], v[148:151], v[88:103]
    v_exp_f32 v74, v74
    v_exp_f32 v75, v75
    v_exp_f32 v76, v76
    s_waitcnt lgkmcnt(0)
    v_mfma_f32_32x32x16_bf16 v[56:71], v[124:127], v[8:11], v[24:39]
    s_getreg_b32 s52, hwreg(HW_REG_IB_STS, 0, 4)
    s_add_u32 s52, s52, s74
    s_cmp_le_u32 s52, 4
    s_cbranch_scc0 HK_146_r
    s_waitcnt vmcnt(4)
    v_mov_b32 v6, s94
    s_mov_b64 exec, 1
    buffer_store_dword v6, off, s[28:31], s95 sc1
    s_mov_b64 exec, -1
    s_mov_b32 s74, 64
    s_nop 3
HK_146_r:
    v_readfirstlane_b32 s70, v22
    s_cmp_ge_u32 s70, 8
    s_cbranch_scc1 C_A8_K
LW_147:
    ds_read_b32 v22, v3 offset:0
    s_waitcnt lgkmcnt(0)
    v_readfirstlane_b32 s70, v22
    s_cmp_ge_u32 s70, 8
    s_cbranch_scc1 LD_148
    s_sub_u32 s3, s3, 1
    s_cmp_lt_i32 s3, 0
    s_cbranch_scc1 LD_148
    s_sleep 1
    s_branch LW_147
LD_148:
C_A8_K:
    s_add_u32 m0, s56, 122880
    s_add_u32 s52, s55, 0xd000
    buffer_load_dwordx4 v2, s[28:31], s52 offen sc1 lds
    s_add_u32 m0, s56, 126976
    s_add_u32 s52, s55, 0x20d000
    buffer_load_dwordx4 v2, s[28:31], s52 offen sc1 lds
    v_exp_f32 v77, v77
    v_exp_f32 v78, v78
    v_exp_f32 v79, v79
    v_exp_f32 v80, v80
    v_cvt_pk_bf16_f32 v152, v72, v73
    v_cvt_pk_bf16_f32 v153, v74, v75
    v_cvt_pk_bf16_f32 v154, v76, v77
    v_cvt_pk_bf16_f32 v155, v78, v79
    v_exp_f32 v81, v81
    v_exp_f32 v82, v82
    v_exp_f32 v83, v83
    v_mfma_f32_32x32x16_bf16 v[104:119], v[128:131], v[152:155], v[104:119]
    v_exp_f32 v84, v84
    v_exp_f32 v85, v85
    v_exp_f32 v86, v86
    v_exp_f32 v87, v87
    s_getreg_b32 s52, hwreg(HW_REG_IB_STS, 0, 4)
    s_add_u32 s52, s52, s74
    s_cmp_le_u32 s52, 6
    s_cbranch_scc0 HK_149_r
    s_waitcnt vmcnt(6)
    v_mov_b32 v6, s94
    s_mov_b64 exec, 1
    buffer_store_dword v6, off, s[28:31], s95 sc1
    s_mov_b64 exec, -1
    s_mov_b32 s74, 64
    s_nop 3
HK_149_r:
    v_cvt_pk_bf16_f32 v156, v80, v81
    v_cvt_pk_bf16_f32 v157, v82, v83
    v_cvt_pk_bf16_f32 v158, v84, v85
    v_cvt_pk_bf16_f32 v159, v86, v87
    v_exp_f32 v56, v56
    v_exp_f32 v57, v57
    v_mfma_f32_32x32x16_bf16 v[104:119], v[132:135], v[156:159], v[104:119]
    v_exp_f32 v58, v58
    v_exp_f32 v59, v59
    v_exp_f32 v60, v60
    v_mfma_f32_32x32x16_bf16 v[72:87], v[124:127], v[12:15], v[40:55]
    ds_read_b128 v[120:123], v16 offset:16384
    s_mov_b64 exec, s[96:97]
    ds_read_b128 v[128:131], v19 offset:20480
    ds_read_b128 v[132:135], v19 offset:20992
    s_mov_b64 exec, -1
    s_getreg_b32 s52, hwreg(HW_REG_IB_STS, 0, 4)
    s_add_u32 s52, s52, s74
    s_cmp_le_u32 s52, 6
    s_cbranch_scc0 HK_150_r
    s_waitcnt vmcnt(6)
    v_mov_b32 v6, s94
    s_mov_b64 exec, 1
    buffer_store_dword v6, off, s[28:31], s95 sc1
    s_mov_b64 exec, -1
    s_mov_b32 s74, 64
    s_nop 3
HK_150_r:
    s_add_u32 m0, s56, 16384
    s_add_u32 s52, s55, 0xe000
    buffer_load_dwordx4 v2, s[28:31], s52 offen sc1 lds
    s_add_u32 m0, s56, 20480
    s_add_u32 s52, s55, 0x20e000
    buffer_load_dwordx4 v2, s[28:31], s52 offen sc1 lds
    v_exp_f32 v61, v61
    v_exp_f32 v62, v62
    v_exp_f32 v63, v63
    v_exp_f32 v64, v64
    v_cvt_pk_bf16_f32 v144, v56, v57
    v_cvt_pk_bf16_f32 v145, v58, v59
    v_cvt_pk_bf16_f32 v146, v60, v61
    v_cvt_pk_bf16_f32 v147, v62, v63
    v_exp_f32 v65, v65
    v_exp_f32 v66, v66
    v_exp_f32 v67, v67
    v_mfma_f32_32x32x16_bf16 v[88:103], v[136:139], v[144:147], v[88:103]
    v_exp_f32 v68, v68
    v_exp_f32 v69, v69
    v_exp_f32 v70, v70
    v_exp_f32 v71, v71
    s_getreg_b32 s52, hwreg(HW_REG_IB_STS, 0, 4)
    s_add_u32 s52, s52, s74
    s_cmp_le_u32 s52, 8
    s_cbranch_scc0 HK_151_r
    s_waitcnt vmcnt(8)
    v_mov_b32 v6, s94
    s_mov_b64 exec, 1
    buffer_store_dword v6, off, s[28:31], s95 sc1
    s_mov_b64 exec, -1
    s_mov_b32 s74, 64
    s_nop 3
HK_151_r:
    v_cvt_pk_bf16_f32 v148, v64, v65
    v_cvt_pk_bf16_f32 v149, v66, v67
    v_cvt_pk_bf16_f32 v150, v68, v69
    v_cvt_pk_bf16_f32 v151, v70, v71
    v_exp_f32 v72, v72
    v_exp_f32 v73, v73
    v_mfma_f32_32x32x16_bf16 v[88:103], v[140:143], v[148:151], v[88:103]
    v_exp_f32 v74, v74
    v_exp_f32 v75, v75
    v_exp_f32 v76, v76
    s_waitcnt lgkmcnt(0)
    v_mfma_f32_32x32x16_bf16 v[56:71], v[120:123], v[8:11], v[24:39]
    s_getreg_b32 s52, hwreg(HW_REG_IB_STS, 0, 4)
    s_add_u32 s52, s52, s74
    s_cmp_le_u32 s52, 8
    s_cbranch_scc0 HK_152_r
    s_waitcnt vmcnt(8)
    v_mov_b32 v6, s94
    s_mov_b64 exec, 1
    buffer_store_dword v6, off, s[28:31], s95 sc1
    s_mov_b64 exec, -1
    s_mov_b32 s74, 64
    s_nop 3
HK_152_r:
    s_add_u32 m0, s56, 24576
    s_add_u32 s52, s55, 0xf000
    buffer_load_dwordx4 v2, s[28:31], s52 offen sc1 lds
    s_add_u32 m0, s56, 28672
    s_add_u32 s52, s55, 0x20f000
    buffer_load_dwordx4 v2, s[28:31], s52 offen sc1 lds
    v_exp_f32 v77, v77
    v_exp_f32 v78, v78
    v_exp_f32 v79, v79
    v_exp_f32 v80, v80
    v_cvt_pk_bf16_f32 v152, v72, v73
    v_cvt_pk_bf16_f32 v153, v74, v75
    v_cvt_pk_bf16_f32 v154, v76, v77
    v_cvt_pk_bf16_f32 v155, v78, v79
    v_exp_f32 v81, v81
    v_exp_f32 v82, v82
    v_exp_f32 v83, v83
    v_mfma_f32_32x32x16_bf16 v[104:119], v[136:139], v[152:155], v[104:119]
    v_exp_f32 v84, v84
    v_exp_f32 v85, v85
    v_exp_f32 v86, v86
    v_exp_f32 v87, v87
    s_getreg_b32 s52, hwreg(HW_REG_IB_STS, 0, 4)
    s_add_u32 s52, s52, s74
    s_cmp_le_u32 s52, 10
    s_cbranch_scc0 HK_153_r
    s_waitcnt vmcnt(10)
    v_mov_b32 v6, s94
    s_mov_b64 exec, 1
    buffer_store_dword v6, off, s[28:31], s95 sc1
    s_mov_b64 exec, -1
    s_mov_b32 s74, 64
    s_nop 3
HK_153_r:
    v_cvt_pk_bf16_f32 v156, v80, v81
    v_cvt_pk_bf16_f32 v157, v82, v83
    v_cvt_pk_bf16_f32 v158, v84, v85
    v_cvt_pk_bf16_f32 v159, v86, v87
    v_exp_f32 v56, v56
    v_exp_f32 v57, v57
    v_mfma_f32_32x32x16_bf16 v[104:119], v[140:143], v[156:159], v[104:119]
    v_exp_f32 v58, v58
    v_exp_f32 v59, v59
    v_exp_f32 v60, v60
    v_mfma_f32_32x32x16_bf16 v[72:87], v[120:123], v[12:15], v[40:55]
    ds_read_b128 v[124:127], v16 offset:17408
    s_mov_b64 exec, s[96:97]
    ds_read_b128 v[136:139], v19 offset:21504
    ds_read_b128 v[140:143], v19 offset:22016
    s_mov_b64 exec, -1
    s_cmp_eq_u32 s74, 0
    s_cbranch_scc0 HK_154_r
    s_waitcnt vmcnt(10)
    v_mov_b32 v6, s94
    s_mov_b64 exec, 1
    buffer_store_dword v6, off, s[28:31], s95 sc1
    s_mov_b64 exec, -1
    s_mov_b32 s74, 64
    s_nop 3
HK_154_r:
    v_exp_f32 v61, v61
    v_exp_f32 v62, v62
    v_exp_f32 v63, v63
    v_exp_f32 v64, v64
    v_cvt_pk_bf16_f32 v144, v56, v57
    v_cvt_pk_bf16_f32 v145, v58, v59
    v_cvt_pk_bf16_f32 v146, v60, v61
    v_cvt_pk_bf16_f32 v147, v62, v63
    v_exp_f32 v65, v65
    v_exp_f32 v66, v66
    v_exp_f32 v67, v67
    v_mfma_f32_32x32x16_bf16 v[88:103], v[128:131], v[144:147], v[88:103]
    v_exp_f32 v68, v68
    v_exp_f32 v69, v69
    v_exp_f32 v70, v70
    v_exp_f32 v71, v71
    v_cvt_pk_bf16_f32 v148, v64, v65
    v_cvt_pk_bf16_f32 v149, v66, v67
    v_cvt_pk_bf16_f32 v150, v68, v69
    v_cvt_pk_bf16_f32 v151, v70, v71
    v_exp_f32 v72, v72
    v_exp_f32 v73, v73
    v_mfma_f32_32x32x16_bf16 v[88:103], v[132:135], v[148:151], v[88:103]
    v_exp_f32 v74, v74
    v_exp_f32 v75, v75
    v_exp_f32 v76, v76
    s_waitcnt lgkmcnt(0)
    v_mfma_f32_32x32x16_bf16 v[56:71], v[124:127], v[8:11], v[24:39]
    v_exp_f32 v77, v77
    v_exp_f32 v78, v78
    v_exp_f32 v79, v79
    v_exp_f32 v80, v80
    v_cvt_pk_bf16_f32 v152, v72, v73
    v_cvt_pk_bf16_f32 v153, v74, v75
    v_cvt_pk_bf16_f32 v154, v76, v77
    v_cvt_pk_bf16_f32 v155, v78, v79
    v_exp_f32 v81, v81
    v_exp_f32 v82, v82
    v_exp_f32 v83, v83
    v_mfma_f32_32x32x16_bf16 v[104:119], v[128:131], v[152:155], v[104:119]
    v_exp_f32 v84, v84
    v_exp_f32 v85, v85
    v_exp_f32 v86, v86
    v_exp_f32 v87, v87
    v_cvt_pk_bf16_f32 v156, v80, v81
    v_cvt_pk_bf16_f32 v157, v82, v83
    v_cvt_pk_bf16_f32 v158, v84, v85
    v_cvt_pk_bf16_f32 v159, v86, v87
    v_exp_f32 v56, v56
    v_exp_f32 v57, v57
    v_mfma_f32_32x32x16_bf16 v[104:119], v[132:135], v[156:159], v[104:119]
    v_exp_f32 v58, v58
    v_exp_f32 v59, v59
    v_exp_f32 v60, v60
    v_mfma_f32_32x32x16_bf16 v[72:87], v[124:127], v[12:15], v[40:55]
    ds_read_b128 v[120:123], v16 offset:18432
    s_mov_b64 exec, s[96:97]
    ds_read_b128 v[128:131], v19 offset:22528
    ds_read_b128 v[132:135], v19 offset:23040
    s_mov_b64 exec, -1
    buffer_load_dword v0, v18, s[28:31], 0 offen sc1
    v_exp_f32 v61, v61
    v_exp_f32 v62, v62
    v_exp_f32 v63, v63
    v_exp_f32 v64, v64
    v_cvt_pk_bf16_f32 v144, v56, v57
    v_cvt_pk_bf16_f32 v145, v58, v59
    v_cvt_pk_bf16_f32 v146, v60, v61
    v_cvt_pk_bf16_f32 v147, v62, v63
    v_exp_f32 v65, v65
    v_exp_f32 v66, v66
    v_exp_f32 v67, v67
    v_mfma_f32_32x32x16_bf16 v[88:103], v[136:139], v[144:147], v[88:103]
    v_exp_f32 v68, v68
    v_exp_f32 v69, v69
    v_exp_f32 v70, v70
    v_exp_f32 v71, v71
    v_cvt_pk_bf16_f32 v148, v64, v65
    v_cvt_pk_bf16_f32 v149, v66, v67
    v_cvt_pk_bf16_f32 v150, v68, v69
    v_cvt_pk_bf16_f32 v151, v70, v71
    v_exp_f32 v72, v72
    v_exp_f32 v73, v73
    v_mfma_f32_32x32x16_bf16 v[88:103], v[140:143], v[148:151], v[88:103]
    v_exp_f32 v74, v74
    v_exp_f32 v75, v75
    v_exp_f32 v76, v76
    s_waitcnt lgkmcnt(0)
    v_mfma_f32_32x32x16_bf16 v[56:71], v[120:123], v[8:11], v[24:39]
    v_exp_f32 v77, v77
    v_exp_f32 v78, v78
    v_exp_f32 v79, v79
    v_exp_f32 v80, v80
    v_cvt_pk_bf16_f32 v152, v72, v73
    v_cvt_pk_bf16_f32 v153, v74, v75
    v_cvt_pk_bf16_f32 v154, v76, v77
    v_cvt_pk_bf16_f32 v155, v78, v79
    v_exp_f32 v81, v81
    v_exp_f32 v82, v82
    v_exp_f32 v83, v83
    v_mfma_f32_32x32x16_bf16 v[104:119], v[136:139], v[152:155], v[104:119]
    v_exp_f32 v84, v84
    v_exp_f32 v85, v85
    v_exp_f32 v86, v86
    v_exp_f32 v87, v87
    v_cvt_pk_bf16_f32 v156, v80, v81
    v_cvt_pk_bf16_f32 v157, v82, v83
    v_cvt_pk_bf16_f32 v158, v84, v85
    v_cvt_pk_bf16_f32 v159, v86, v87
    v_exp_f32 v56, v56
    v_exp_f32 v57, v57
    v_mfma_f32_32x32x16_bf16 v[104:119], v[140:143], v[156:159], v[104:119]
    v_exp_f32 v58, v58
    v_exp_f32 v59, v59
    v_exp_f32 v60, v60
    v_mfma_f32_32x32x16_bf16 v[72:87], v[120:123], v[12:15], v[40:55]
    ds_read_b128 v[124:127], v16 offset:19456
    s_mov_b64 exec, s[96:97]
    ds_read_b128 v[136:139], v19 offset:23552
    ds_read_b128 v[140:143], v19 offset:24064
    s_mov_b64 exec, -1
    v_exp_f32 v61, v61
    v_exp_f32 v62, v62
    v_exp_f32 v63, v63
    v_exp_f32 v64, v64
    v_cvt_pk_bf16_f32 v144, v56, v57
    v_cvt_pk_bf16_f32 v145, v58, v59
    v_cvt_pk_bf16_f32 v146, v60, v61
    v_cvt_pk_bf16_f32 v147, v62, v63
    v_exp_f32 v65, v65
    v_exp_f32 v66, v66
    v_exp_f32 v67, v67
    v_mfma_f32_32x32x16_bf16 v[88:103], v[128:131], v[144:147], v[88:103]
    v_exp_f32 v68, v68
    v_exp_f32 v69, v69
    v_exp_f32 v70, v70
    v_exp_f32 v71, v71
    v_cvt_pk_bf16_f32 v148, v64, v65
    v_cvt_pk_bf16_f32 v149, v66, v67
    v_cvt_pk_bf16_f32 v150, v68, v69
    v_cvt_pk_bf16_f32 v151, v70, v71
    v_exp_f32 v72, v72
    v_exp_f32 v73, v73
    v_mfma_f32_32x32x16_bf16 v[88:103], v[132:135], v[148:151], v[88:103]
    v_exp_f32 v74, v74
    v_exp_f32 v75, v75
    v_exp_f32 v76, v76
    s_waitcnt lgkmcnt(0)
    v_mfma_f32_32x32x16_bf16 v[56:71], v[124:127], v[8:11], v[24:39]
    s_waitcnt vmcnt(0)
C_DW:
    v_cmp_eq_u32 vcc, s94, v0
    s_cmp_eq_u64 vcc, -1
    s_cbranch_scc1 C_DK
    s_sub_u32 s3, s3, 32
    s_cmp_lt_i32 s3, 0
    s_cbranch_scc1 C_DK
    s_sleep 10
    buffer_load_dword v0, v18, s[28:31], 0 offen sc1
    s_waitcnt vmcnt(0)
    s_branch C_DW
C_DK:
    v_add_u32 v18, s75, v2
    buffer_load_dwordx4 v[224:227], v2, s[28:31], s61 offen offset:0 sc1
    buffer_load_dwordx4 v[232:235], v2, s[28:31], s59 offen offset:0 sc1
    buffer_load_dwordx4 v[228:231], v2, s[28:31], s61 offen offset:1024 sc1
    buffer_load_dwordx4 v[236:239], v2, s[28:31], s60 offen offset:0 sc1
    v_exp_f32 v77, v77
    v_exp_f32 v78, v78
    v_exp_f32 v79, v79
    v_exp_f32 v80, v80
    v_cvt_pk_bf16_f32 v152, v72, v73
    v_cvt_pk_bf16_f32 v153, v74, v75
    v_cvt_pk_bf16_f32 v154, v76, v77
    v_cvt_pk_bf16_f32 v155, v78, v79
    v_exp_f32 v81, v81
    v_exp_f32 v82, v82
    v_exp_f32 v83, v83
    v_mfma_f32_32x32x16_bf16 v[104:119], v[128:131], v[152:155], v[104:119]
    v_exp_f32 v84, v84
    v_exp_f32 v85, v85
    v_exp_f32 v86, v86
    v_exp_f32 v87, v87
    v_cvt_pk_bf16_f32 v156, v80, v81
    v_cvt_pk_bf16_f32 v157, v82, v83
    v_cvt_pk_bf16_f32 v158, v84, v85
    v_cvt_pk_bf16_f32 v159, v86, v87
    v_exp_f32 v56, v56
    v_exp_f32 v57, v57
    v_mfma_f32_32x32x16_bf16 v[104:119], v[132:135], v[156:159], v[104:119]
    v_exp_f32 v58, v58
    v_exp_f32 v59, v59
    v_exp_f32 v60, v60
    v_mfma_f32_32x32x16_bf16 v[72:87], v[124:127], v[12:15], v[40:55]
    ds_read_b128 v[120:123], v16 offset:24576
    s_mov_b64 exec, s[96:97]
    ds_read_b128 v[128:131], v19 offset:28672
    ds_read_b128 v[132:135], v19 offset:29184
    s_mov_b64 exec, -1
    buffer_load_dwordx4 v[240:243], v2, s[28:31], s61 offen offset:2048 sc1
    buffer_load_dwordx4 v[248:251], v2, s[28:31], s59 offen offset:1024 sc1
    buffer_load_dwordx4 v[244:247], v2, s[28:31], s61 offen offset:3072 sc1
    buffer_load_dwordx4 v[252:255], v2, s[28:31], s60 offen offset:1024 sc1
    s_add_u32 s61, s61, 4096
    v_exp_f32 v61, v61
    v_exp_f32 v62, v62
    v_exp_f32 v63, v63
    v_exp_f32 v64, v64
    v_cvt_pk_bf16_f32 v144, v56, v57
    v_cvt_pk_bf16_f32 v145, v58, v59
    v_cvt_pk_bf16_f32 v146, v60, v61
    v_cvt_pk_bf16_f32 v147, v62, v63
    v_exp_f32 v65, v65
    v_exp_f32 v66, v66
    v_exp_f32 v67, v67
    v_mfma_f32_32x32x16_bf16 v[88:103], v[136:139], v[144:147], v[88:103]
    v_exp_f32 v68, v68
    v_exp_f32 v69, v69
    v_exp_f32 v70, v70
    v_exp_f32 v71, v71
    v_cvt_pk_bf16_f32 v148, v64, v65
    v_cvt_pk_bf16_f32 v149, v66, v67
    v_cvt_pk_bf16_f32 v150, v68, v69
    v_cvt_pk_bf16_f32 v151, v70, v71
    v_exp_f32 v72, v72
    v_exp_f32 v73, v73
    v_mfma_f32_32x32x16_bf16 v[88:103], v[140:143], v[148:151], v[88:103]
    v_exp_f32 v74, v74
    v_exp_f32 v75, v75
    v_exp_f32 v76, v76
    s_waitcnt lgkmcnt(0)
    v_mfma_f32_32x32x16_bf16 v[56:71], v[120:123], v[8:11], v[24:39]
    v_exp_f32 v77, v77
    v_exp_f32 v78, v78
    v_exp_f32 v79, v79
    v_exp_f32 v80, v80
    v_cvt_pk_bf16_f32 v152, v72, v73
    v_cvt_pk_bf16_f32 v153, v74, v75
    v_cvt_pk_bf16_f32 v154, v76, v77
    v_cvt_pk_bf16_f32 v155, v78, v79
    v_exp_f32 v81, v81
    v_exp_f32 v82, v82
    v_exp_f32 v83, v83
    v_mfma_f32_32x32x16_bf16 v[104:119], v[136:139], v[152:155], v[104:119]
    v_exp_f32 v84, v84
    v_exp_f32 v85, v85
    v_exp_f32 v86, v86
    v_exp_f32 v87, v87
    v_cvt_pk_bf16_f32 v156, v80, v81
    v_cvt_pk_bf16_f32 v157, v82, v83
    v_cvt_pk_bf16_f32 v158, v84, v85
    v_cvt_pk_bf16_f32 v159, v86, v87
    v_exp_f32 v56, v56
    v_exp_f32 v57, v57
    v_mfma_f32_32x32x16_bf16 v[104:119], v[140:143], v[156:159], v[104:119]
    v_exp_f32 v58, v58
    v_exp_f32 v59, v59
    v_exp_f32 v60, v60
    v_mfma_f32_32x32x16_bf16 v[72:87], v[120:123], v[12:15], v[40:55]
    ds_read_b128 v[124:127], v16 offset:25600
    s_mov_b64 exec, s[96:97]
    ds_read_b128 v[136:139], v19 offset:29696
    ds_read_b128 v[140:143], v19 offset:30208
    s_mov_b64 exec, -1
    v_exp_f32 v61, v61
    v_exp_f32 v62, v62
    v_exp_f32 v63, v63
    v_exp_f32 v64, v64
    s_waitcnt vmcnt(5)
    v_mfma_f32_32x32x16_bf16 v[160:175], v[224:227], v[232:235], 0
    v_cvt_pk_bf16_f32 v144, v56, v57
    v_cvt_pk_bf16_f32 v145, v58, v59
    v_cvt_pk_bf16_f32 v146, v60, v61
    v_cvt_pk_bf16_f32 v147, v62, v63
    v_exp_f32 v65, v65
    v_exp_f32 v66, v66
    v_exp_f32 v67, v67
    v_mfma_f32_32x32x16_bf16 v[88:103], v[128:131], v[144:147], v[88:103]
    v_exp_f32 v68, v68
    v_exp_f32 v69, v69
    v_exp_f32 v70, v70
    v_exp_f32 v71, v71
    v_mfma_f32_32x32x16_bf16 v[176:191], v[228:231], v[232:235], 0
    v_cvt_pk_bf16_f32 v148, v64, v65
    v_cvt_pk_bf16_f32 v149, v66, v67
    v_cvt_pk_bf16_f32 v150, v68, v69
    v_cvt_pk_bf16_f32 v151, v70, v71
    v_exp_f32 v72, v72
    v_exp_f32 v73, v73
    v_mfma_f32_32x32x16_bf16 v[88:103], v[132:135], v[148:151], v[88:103]
    v_exp_f32 v74, v74
    v_exp_f32 v75, v75
    v_exp_f32 v76, v76
    s_waitcnt lgkmcnt(0)
    v_mfma_f32_32x32x16_bf16 v[56:71], v[124:127], v[8:11], v[24:39]
    v_exp_f32 v77, v77
    v_exp_f32 v78, v78
    v_exp_f32 v79, v79
    v_exp_f32 v80, v80
    s_waitcnt vmcnt(4)
    v_mfma_f32_32x32x16_bf16 v[192:207], v[224:227], v[236:239], 0
    v_cvt_pk_bf16_f32 v152, v72, v73
    v_cvt_pk_bf16_f32 v153, v74, v75
    v_cvt_pk_bf16_f32 v154, v76, v77
    v_cvt_pk_bf16_f32 v155, v78, v79
    v_exp_f32 v81, v81
    v_exp_f32 v82, v82
    v_exp_f32 v83, v83
    v_mfma_f32_32x32x16_bf16 v[104:119], v[128:131], v[152:155], v[104:119]
    v_exp_f32 v84, v84
    v_exp_f32 v85, v85
    v_exp_f32 v86, v86
    v_exp_f32 v87, v87
    v_mfma_f32_32x32x16_bf16 v[208:223], v[228:231], v[236:239], 0
    v_cvt_pk_bf16_f32 v156, v80, v81
    v_cvt_pk_bf16_f32 v157, v82, v83
    v_cvt_pk_bf16_f32 v158, v84, v85
    v_cvt_pk_bf16_f32 v159, v86, v87
    v_exp_f32 v56, v56
    v_exp_f32 v57, v57
    v_mfma_f32_32x32x16_bf16 v[104:119], v[132:135], v[156:159], v[104:119]
    v_exp_f32 v58, v58
    v_exp_f32 v59, v59
    v_exp_f32 v60, v60
    v_mfma_f32_32x32x16_bf16 v[72:87], v[124:127], v[12:15], v[40:55]
    ds_read_b128 v[120:123], v16 offset:26624
    s_mov_b64 exec, s[96:97]
    ds_read_b128 v[128:131], v19 offset:30720
    ds_read_b128 v[132:135], v19 offset:31232
    s_mov_b64 exec, -1
    s_mov_b64 exec, 1
    ds_add_u32 v3, v4 offset:12
    s_mov_b64 exec, -1
    buffer_load_dwordx4 v[224:227], v2, s[28:31], s61 offen offset:0 sc1
    buffer_load_dwordx4 v[232:235], v2, s[28:31], s59 offen offset:2048 sc1
    buffer_load_dwordx4 v[228:231], v2, s[28:31], s61 offen offset:1024 sc1
    buffer_load_dwordx4 v[236:239], v2, s[28:31], s60 offen offset:2048 sc1
    v_exp_f32 v61, v61
    v_exp_f32 v62, v62
    v_exp_f32 v63, v63
    v_exp_f32 v64, v64
    s_waitcnt vmcnt(5)
    v_mfma_f32_32x32x16_bf16 v[160:175], v[240:243], v[248:251], v[160:175]
    v_cvt_pk_bf16_f32 v144, v56, v57
    v_cvt_pk_bf16_f32 v145, v58, v59
    v_cvt_pk_bf16_f32 v146, v60, v61
    v_cvt_pk_bf16_f32 v147, v62, v63
    v_exp_f32 v65, v65
    v_exp_f32 v66, v66
    v_exp_f32 v67, v67
    v_mfma_f32_32x32x16_bf16 v[88:103], v[136:139], v[144:147], v[88:103]
    v_exp_f32 v68, v68
    v_exp_f32 v69, v69
    v_exp_f32 v70, v70
    v_exp_f32 v71, v71
    v_mfma_f32_32x32x16_bf16 v[176:191], v[244:247], v[248:251], v[176:191]
    v_cvt_pk_bf16_f32 v148, v64, v65
    v_cvt_pk_bf16_f32 v149, v66, v67
    v_cvt_pk_bf16_f32 v150, v68, v69
    v_cvt_pk_bf16_f32 v151, v70, v71
    v_exp_f32 v72, v72
    v_exp_f32 v73, v73
    v_mfma_f32_32x32x16_bf16 v[88:103], v[140:143], v[148:151], v[88:103]
    v_exp_f32 v74, v74
    v_exp_f32 v75, v75
    v_exp_f32 v76, v76
    s_waitcnt lgkmcnt(0)
    v_mfma_f32_32x32x16_bf16 v[56:71], v[120:123], v[8:11], v[24:39]
    v_exp_f32 v77, v77
    v_exp_f32 v78, v78
    v_exp_f32 v79, v79
    v_exp_f32 v80, v80
    s_waitcnt vmcnt(4)
    v_mfma_f32_32x32x16_bf16 v[192:207], v[240:243], v[252:255], v[192:207]
    v_cvt_pk_bf16_f32 v152, v72, v73
    v_cvt_pk_bf16_f32 v153, v74, v75
    v_cvt_pk_bf16_f32 v154, v76, v77
    v_cvt_pk_bf16_f32 v155, v78, v79
    v_exp_f32 v81, v81
    v_exp_f32 v82, v82
    v_exp_f32 v83, v83
    v_mfma_f32_32x32x16_bf16 v[104:119], v[136:139], v[152:155], v[104:119]
    v_exp_f32 v84, v84
    v_exp_f32 v85, v85
    v_exp_f32 v86, v86
    v_exp_f32 v87, v87
    v_mfma_f32_32x32x16_bf16 v[208:223], v[244:247], v[252:255], v[208:223]
    v_cvt_pk_bf16_f32 v156, v80, v81
    v_cvt_pk_bf16_f32 v157, v82, v83
    v_cvt_pk_bf16_f32 v158, v84, v85
    v_cvt_pk_bf16_f32 v159, v86, v87
    v_exp_f32 v56, v56
    v_exp_f32 v57, v57
    v_mfma_f32_32x32x16_bf16 v[104:119], v[140:143], v[156:159], v[104:119]
    v_exp_f32 v58, v58
    v_exp_f32 v59, v59
    v_exp_f32 v60, v60
    v_mfma_f32_32x32x16_bf16 v[72:87], v[120:123], v[12:15], v[40:55]
    ds_read_b128 v[124:127], v16 offset:27648
    s_mov_b64 exec, s[96:97]
    ds_read_b128 v[136:139], v19 offset:31744
    ds_read_b128 v[140:143], v19 offset:32256
    s_mov_b64 exec, -1
    ds_read_b32 v22, v3 offset:12
    buffer_load_dwordx4 v[240:243], v2, s[28:31], s61 offen offset:2048 sc1
    buffer_load_dwordx4 v[248:251], v2, s[28:31], s59 offen offset:3072 sc1
    buffer_load_dwordx4 v[244:247], v2, s[28:31], s61 offen offset:3072 sc1
    buffer_load_dwordx4 v[252:255], v2, s[28:31], s60 offen offset:3072 sc1
    s_add_u32 s61, s61, 4096
    s_add_u32 s59, s59, 4096
    s_add_u32 s60, s60, 4096
    v_exp_f32 v61, v61
    v_exp_f32 v62, v62
    v_exp_f32 v63, v63
    v_exp_f32 v64, v64
    s_waitcnt vmcnt(5)
    v_mfma_f32_32x32x16_bf16 v[160:175], v[224:227], v[232:235], v[160:175]
    v_cvt_pk_bf16_f32 v144, v56, v57
    v_cvt_pk_bf16_f32 v145, v58, v59
    v_cvt_pk_bf16_f32 v146, v60, v61
    v_cvt_pk_bf16_f32 v147, v62, v63
    v_exp_f32 v65, v65
    v_exp_f32 v66, v66
    v_exp_f32 v67, v67
    v_mfma_f32_32x32x16_bf16 v[88:103], v[128:131], v[144:147], v[88:103]
    v_exp_f32 v68, v68
    v_exp_f32 v69, v69
    v_exp_f32 v70, v70
    v_exp_f32 v71, v71
    v_mfma_f32_32x32x16_bf16 v[176:191], v[228:231], v[232:235], v[176:191]
    v_cvt_pk_bf16_f32 v148, v64, v65
    v_cvt_pk_bf16_f32 v149, v66, v67
    v_cvt_pk_bf16_f32 v150, v68, v69
    v_cvt_pk_bf16_f32 v151, v70, v71
    v_exp_f32 v72, v72
    v_exp_f32 v73, v73
    v_mfma_f32_32x32x16_bf16 v[88:103], v[132:135], v[148:151], v[88:103]
    v_exp_f32 v74, v74
    v_exp_f32 v75, v75
    v_exp_f32 v76, v76
    s_waitcnt lgkmcnt(0)
    v_mfma_f32_32x32x16_bf16 v[56:71], v[124:127], v[8:11], v[24:39]
    v_readfirstlane_b32 s70, v22
    s_cmp_ge_u32 s70, 4
    s_cbranch_scc1 C_AH_K
LW_155:
    ds_read_b32 v22, v3 offset:12
    s_waitcnt lgkmcnt(0)
    v_readfirstlane_b32 s70, v22
    s_cmp_ge_u32 s70, 4
    s_cbranch_scc1 LD_156
    s_sub_u32 s3, s3, 1
    s_cmp_lt_i32 s3, 0
    s_cbranch_scc1 LD_156
    s_sleep 1
    s_branch LW_155
LD_156:
C_AH_K:
    v_exp_f32 v77, v77
    v_exp_f32 v78, v78
    v_exp_f32 v79, v79
    v_exp_f32 v80, v80
    s_waitcnt vmcnt(4)
    v_mfma_f32_32x32x16_bf16 v[192:207], v[224:227], v[236:239], v[192:207]
    v_cvt_pk_bf16_f32 v152, v72, v73
    v_cvt_pk_bf16_f32 v153, v74, v75
    v_cvt_pk_bf16_f32 v154, v76, v77
    v_cvt_pk_bf16_f32 v155, v78, v79
    v_exp_f32 v81, v81
    v_exp_f32 v82, v82
    v_exp_f32 v83, v83
    v_mfma_f32_32x32x16_bf16 v[104:119], v[128:131], v[152:155], v[104:119]
    v_exp_f32 v84, v84
    v_exp_f32 v85, v85
    v_exp_f32 v86, v86
    v_exp_f32 v87, v87
    v_mfma_f32_32x32x16_bf16 v[208:223], v[228:231], v[236:239], v[208:223]
    v_cvt_pk_bf16_f32 v156, v80, v81
    v_cvt_pk_bf16_f32 v157, v82, v83
    v_cvt_pk_bf16_f32 v158, v84, v85
    v_cvt_pk_bf16_f32 v159, v86, v87
    v_exp_f32 v56, v56
    v_exp_f32 v57, v57
    v_mfma_f32_32x32x16_bf16 v[104:119], v[132:135], v[156:159], v[104:119]
    v_exp_f32 v58, v58
    v_exp_f32 v59, v59
    v_exp_f32 v60, v60
    v_mfma_f32_32x32x16_bf16 v[72:87], v[124:127], v[12:15], v[40:55]
    ds_read_b128 v[120:123], v2 offset:8192
    s_mov_b64 exec, s[96:97]
    ds_read_b128 v[128:131], v21 offset:12288
    ds_read_b128 v[132:135], v21 offset:12800
    s_mov_b64 exec, -1
    buffer_load_dwordx4 v[224:227], v2, s[28:31], s61 offen offset:0 sc1
    buffer_load_dwordx4 v[232:235], v2, s[28:31], s59 offen offset:0 sc1
    buffer_load_dwordx4 v[228:231], v2, s[28:31], s61 offen offset:1024 sc1
    buffer_load_dwordx4 v[236:239], v2, s[28:31], s60 offen offset:0 sc1
    v_exp_f32 v61, v61
    v_exp_f32 v62, v62
    v_exp_f32 v63, v63
    v_exp_f32 v64, v64
    s_waitcnt vmcnt(5)
    v_mfma_f32_32x32x16_bf16 v[160:175], v[240:243], v[248:251], v[160:175]
    v_cvt_pk_bf16_f32 v144, v56, v57
    v_cvt_pk_bf16_f32 v145, v58, v59
    v_cvt_pk_bf16_f32 v146, v60, v61
    v_cvt_pk_bf16_f32 v147, v62, v63
    v_exp_f32 v65, v65
    v_exp_f32 v66, v66
    v_exp_f32 v67, v67
    v_mfma_f32_32x32x16_bf16 v[88:103], v[136:139], v[144:147], v[88:103]
    v_exp_f32 v68, v68
    v_exp_f32 v69, v69
    v_exp_f32 v70, v70
    v_exp_f32 v71, v71
    v_mfma_f32_32x32x16_bf16 v[176:191], v[244:247], v[248:251], v[176:191]
    v_cvt_pk_bf16_f32 v148, v64, v65
    v_cvt_pk_bf16_f32 v149, v66, v67
    v_cvt_pk_bf16_f32 v150, v68, v69
    v_cvt_pk_bf16_f32 v151, v70, v71
    v_exp_f32 v72, v72
    v_exp_f32 v73, v73
    v_mfma_f32_32x32x16_bf16 v[88:103], v[140:143], v[148:151], v[88:103]
    v_exp_f32 v74, v74
    v_exp_f32 v75, v75
    v_exp_f32 v76, v76
    s_waitcnt lgkmcnt(0)
    v_mfma_f32_32x32x16_bf16 v[56:71], v[120:123], v[8:11], v[24:39]
    v_exp_f32 v77, v77
    v_exp_f32 v78, v78
    v_exp_f32 v79, v79
    v_exp_f32 v80, v80
    s_waitcnt vmcnt(4)
    v_mfma_f32_32x32x16_bf16 v[192:207], v[240:243], v[252:255], v[192:207]
    v_cvt_pk_bf16_f32 v152, v72, v73
    v_cvt_pk_bf16_f32 v153, v74, v75
    v_cvt_pk_bf16_f32 v154, v76, v77
    v_cvt_pk_bf16_f32 v155, v78, v79
    v_exp_f32 v81, v81
    v_exp_f32 v82, v82
    v_exp_f32 v83, v83
    v_mfma_f32_32x32x16_bf16 v[104:119], v[136:139], v[152:155], v[104:119]
    v_exp_f32 v84, v84
    v_exp_f32 v85, v85
    v_exp_f32 v86, v86
    v_exp_f32 v87, v87
    v_mfma_f32_32x32x16_bf16 v[208:223], v[244:247], v[252:255], v[208:223]
    v_cvt_pk_bf16_f32 v156, v80, v81
    v_cvt_pk_bf16_f32 v157, v82, v83
    v_cvt_pk_bf16_f32 v158, v84, v85
    v_cvt_pk_bf16_f32 v159, v86, v87
    v_exp_f32 v56, v56
    v_exp_f32 v57, v57
    v_mfma_f32_32x32x16_bf16 v[104:119], v[140:143], v[156:159], v[104:119]
    v_exp_f32 v58, v58
    v_exp_f32 v59, v59
    v_exp_f32 v60, v60
    v_mfma_f32_32x32x16_bf16 v[72:87], v[120:123], v[12:15], v[40:55]
    ds_read_b128 v[124:127], v2 offset:9216
    s_mov_b64 exec, s[96:97]
    ds_read_b128 v[136:139], v21 offset:13312
    ds_read_b128 v[140:143], v21 offset:13824
    s_mov_b64 exec, -1
    buffer_load_dwordx4 v[240:243], v2, s[28:31], s61 offen offset:2048 sc1
    buffer_load_dwordx4 v[248:251], v2, s[28:31], s59 offen offset:1024 sc1
    buffer_load_dwordx4 v[244:247], v2, s[28:31], s61 offen offset:3072 sc1
    buffer_load_dwordx4 v[252:255], v2, s[28:31], s60 offen offset:1024 sc1
    s_add_u32 s61, s61, 4096
    v_exp_f32 v61, v61
    v_exp_f32 v62, v62
    v_exp_f32 v63, v63
    v_exp_f32 v64, v64
    s_waitcnt vmcnt(5)
    v_mfma_f32_32x32x16_bf16 v[160:175], v[224:227], v[232:235], v[160:175]
    v_cvt_pk_bf16_f32 v144, v56, v57
    v_cvt_pk_bf16_f32 v145, v58, v59
    v_cvt_pk_bf16_f32 v146, v60, v61
    v_cvt_pk_bf16_f32 v147, v62, v63
    v_exp_f32 v65, v65
    v_exp_f32 v66, v66
    v_exp_f32 v67, v67
    v_mfma_f32_32x32x16_bf16 v[88:103], v[128:131], v[144:147], v[88:103]
    v_exp_f32 v68, v68
    v_exp_f32 v69, v69
    v_exp_f32 v70, v70
    v_exp_f32 v71, v71
    v_mfma_f32_32x32x16_bf16 v[176:191], v[228:231], v[232:235], v[176:191]
    v_cvt_pk_bf16_f32 v148, v64, v65
    v_cvt_pk_bf16_f32 v149, v66, v67
    v_cvt_pk_bf16_f32 v150, v68, v69
    v_cvt_pk_bf16_f32 v151, v70, v71
    v_exp_f32 v72, v72
    v_exp_f32 v73, v73
    v_mfma_f32_32x32x16_bf16 v[88:103], v[132:135], v[148:151], v[88:103]
    v_exp_f32 v74, v74
    v_exp_f32 v75, v75
    v_exp_f32 v76, v76
    s_waitcnt lgkmcnt(0)
    v_mfma_f32_32x32x16_bf16 v[56:71], v[124:127], v[8:11], v[24:39]
    v_exp_f32 v77, v77
    v_exp_f32 v78, v78
    v_exp_f32 v79, v79
    v_exp_f32 v80, v80
    s_waitcnt vmcnt(4)
    v_mfma_f32_32x32x16_bf16 v[192:207], v[224:227], v[236:239], v[192:207]
    v_cvt_pk_bf16_f32 v152, v72, v73
    v_cvt_pk_bf16_f32 v153, v74, v75
    v_cvt_pk_bf16_f32 v154, v76, v77
    v_cvt_pk_bf16_f32 v155, v78, v79
    v_exp_f32 v81, v81
    v_exp_f32 v82, v82
    v_exp_f32 v83, v83
    v_mfma_f32_32x32x16_bf16 v[104:119], v[128:131], v[152:155], v[104:119]
    v_exp_f32 v84, v84
    v_exp_f32 v85, v85
    v_exp_f32 v86, v86
    v_exp_f32 v87, v87
    v_mfma_f32_32x32x16_bf16 v[208:223], v[228:231], v[236:239], v[208:223]
    v_cvt_pk_bf16_f32 v156, v80, v81
    v_cvt_pk_bf16_f32 v157, v82, v83
    v_cvt_pk_bf16_f32 v158, v84, v85
    v_cvt_pk_bf16_f32 v159, v86, v87
    v_exp_f32 v56, v56
    v_exp_f32 v57, v57
    v_mfma_f32_32x32x16_bf16 v[104:119], v[132:135], v[156:159], v[104:119]
    v_exp_f32 v58, v58
    v_exp_f32 v59, v59
    v_exp_f32 v60, v60
    v_mfma_f32_32x32x16_bf16 v[72:87], v[124:127], v[12:15], v[40:55]
    ds_read_b128 v[120:123], v2 offset:10240
    s_mov_b64 exec, s[96:97]
    ds_read_b128 v[128:131], v21 offset:14336
    ds_read_b128 v[132:135], v21 offset:14848
    s_mov_b64 exec, -1
    buffer_load_dwordx4 v[224:227], v2, s[28:31], s61 offen offset:0 sc1
    buffer_load_dwordx4 v[232:235], v2, s[28:31], s59 offen offset:2048 sc1
    buffer_load_dwordx4 v[228:231], v2, s[28:31], s61 offen offset:1024 sc1
    buffer_load_dwordx4 v[236:239], v2, s[28:31], s60 offen offset:2048 sc1
    v_exp_f32 v61, v61
    v_exp_f32 v62, v62
    v_exp_f32 v63, v63
    v_exp_f32 v64, v64
    s_waitcnt vmcnt(5)
    v_mfma_f32_32x32x16_bf16 v[160:175], v[240:243], v[248:251], v[160:175]
    v_cvt_pk_bf16_f32 v144, v56, v57
    v_cvt_pk_bf16_f32 v145, v58, v59
    v_cvt_pk_bf16_f32 v146, v60, v61
    v_cvt_pk_bf16_f32 v147, v62, v63
    v_exp_f32 v65, v65
    v_exp_f32 v66, v66
    v_exp_f32 v67, v67
    v_mfma_f32_32x32x16_bf16 v[88:103], v[136:139], v[144:147], v[88:103]
    v_exp_f32 v68, v68
    v_exp_f32 v69, v69
    v_exp_f32 v70, v70
    v_exp_f32 v71, v71
    v_mfma_f32_32x32x16_bf16 v[176:191], v[244:247], v[248:251], v[176:191]
    v_cvt_pk_bf16_f32 v148, v64, v65
    v_cvt_pk_bf16_f32 v149, v66, v67
    v_cvt_pk_bf16_f32 v150, v68, v69
    v_cvt_pk_bf16_f32 v151, v70, v71
    v_exp_f32 v72, v72
    v_exp_f32 v73, v73
    v_mfma_f32_32x32x16_bf16 v[88:103], v[140:143], v[148:151], v[88:103]
    v_exp_f32 v74, v74
    v_exp_f32 v75, v75
    v_exp_f32 v76, v76
    s_waitcnt lgkmcnt(0)
    v_mfma_f32_32x32x16_bf16 v[56:71], v[120:123], v[8:11], v[24:39]
    v_exp_f32 v77, v77
    v_exp_f32 v78, v78
    v_exp_f32 v79, v79
    v_exp_f32 v80, v80
    s_waitcnt vmcnt(4)
    v_mfma_f32_32x32x16_bf16 v[192:207], v[240:243], v[252:255], v[192:207]
    v_cvt_pk_bf16_f32 v152, v72, v73
    v_cvt_pk_bf16_f32 v153, v74, v75
    v_cvt_pk_bf16_f32 v154, v76, v77
    v_cvt_pk_bf16_f32 v155, v78, v79
    v_exp_f32 v81, v81
    v_exp_f32 v82, v82
    v_exp_f32 v83, v83
    v_mfma_f32_32x32x16_bf16 v[104:119], v[136:139], v[152:155], v[104:119]
    v_exp_f32 v84, v84
    v_exp_f32 v85, v85
    v_exp_f32 v86, v86
    v_exp_f32 v87, v87
    v_mfma_f32_32x32x16_bf16 v[208:223], v[244:247], v[252:255], v[208:223]
    v_cvt_pk_bf16_f32 v156, v80, v81
    v_cvt_pk_bf16_f32 v157, v82, v83
    v_cvt_pk_bf16_f32 v158, v84, v85
    v_cvt_pk_bf16_f32 v159, v86, v87
    v_exp_f32 v56, v56
    v_exp_f32 v57, v57
    v_mfma_f32_32x32x16_bf16 v[104:119], v[140:143], v[156:159], v[104:119]
    v_exp_f32 v58, v58
    v_exp_f32 v59, v59
    v_exp_f32 v60, v60
    v_mfma_f32_32x32x16_bf16 v[72:87], v[120:123], v[12:15], v[40:55]
    ds_read_b128 v[124:127], v2 offset:11264
    s_mov_b64 exec, s[96:97]
    ds_read_b128 v[136:139], v21 offset:15360
    ds_read_b128 v[140:143], v21 offset:15872
    s_mov_b64 exec, -1
    buffer_load_dwordx4 v[240:243], v2, s[28:31], s61 offen offset:2048 sc1
    buffer_load_dwordx4 v[248:251], v2, s[28:31], s59 offen offset:3072 sc1
    buffer_load_dwordx4 v[244:247], v2, s[28:31], s61 offen offset:3072 sc1
    buffer_load_dwordx4 v[252:255], v2, s[28:31], s60 offen offset:3072 sc1
    s_add_u32 s61, s61, 4096
    s_add_u32 s59, s59, 4096
    s_add_u32 s60, s60, 4096
    v_exp_f32 v61, v61
    v_exp_f32 v62, v62
    v_exp_f32 v63, v63
    v_exp_f32 v64, v64
    s_waitcnt vmcnt(5)
    v_mfma_f32_32x32x16_bf16 v[160:175], v[224:227], v[232:235], v[160:175]
    v_cvt_pk_bf16_f32 v144, v56, v57
    v_cvt_pk_bf16_f32 v145, v58, v59
    v_cvt_pk_bf16_f32 v146, v60, v61
    v_cvt_pk_bf16_f32 v147, v62, v63
    v_exp_f32 v65, v65
    v_exp_f32 v66, v66
    v_exp_f32 v67, v67
    v_mfma_f32_32x32x16_bf16 v[88:103], v[128:131], v[144:147], v[88:103]
    v_exp_f32 v68, v68
    v_exp_f32 v69, v69
    v_exp_f32 v70, v70
    v_exp_f32 v71, v71
    v_mfma_f32_32x32x16_bf16 v[176:191], v[228:231], v[232:235], v[176:191]
    v_cvt_pk_bf16_f32 v148, v64, v65
    v_cvt_pk_bf16_f32 v149, v66, v67
    v_cvt_pk_bf16_f32 v150, v68, v69
    v_cvt_pk_bf16_f32 v151, v70, v71
    v_exp_f32 v72, v72
    v_exp_f32 v73, v73
    v_mfma_f32_32x32x16_bf16 v[88:103], v[132:135], v[148:151], v[88:103]
    v_exp_f32 v74, v74
    v_exp_f32 v75, v75
    v_exp_f32 v76, v76
    s_waitcnt lgkmcnt(0)
    v_mfma_f32_32x32x16_bf16 v[56:71], v[124:127], v[8:11], v[24:39]
    v_exp_f32 v77, v77
    v_exp_f32 v78, v78
    v_exp_f32 v79, v79
    v_exp_f32 v80, v80
    s_waitcnt vmcnt(4)
    v_mfma_f32_32x32x16_bf16 v[192:207], v[224:227], v[236:239], v[192:207]
    v_cvt_pk_bf16_f32 v152, v72, v73
    v_cvt_pk_bf16_f32 v153, v74, v75
    v_cvt_pk_bf16_f32 v154, v76, v77
    v_cvt_pk_bf16_f32 v155, v78, v79
    v_exp_f32 v81, v81
    v_exp_f32 v82, v82
    v_exp_f32 v83, v83
    v_mfma_f32_32x32x16_bf16 v[104:119], v[128:131], v[152:155], v[104:119]
    v_exp_f32 v84, v84
    v_exp_f32 v85, v85
    v_exp_f32 v86, v86
    v_exp_f32 v87, v87
    v_mfma_f32_32x32x16_bf16 v[208:223], v[228:231], v[236:239], v[208:223]
    v_cvt_pk_bf16_f32 v156, v80, v81
    v_cvt_pk_bf16_f32 v157, v82, v83
    v_cvt_pk_bf16_f32 v158, v84, v85
    v_cvt_pk_bf16_f32 v159, v86, v87
    v_exp_f32 v56, v56
    v_exp_f32 v57, v57
    v_mfma_f32_32x32x16_bf16 v[104:119], v[132:135], v[156:159], v[104:119]
    v_exp_f32 v58, v58
    v_exp_f32 v59, v59
    v_exp_f32 v60, v60
    v_mfma_f32_32x32x16_bf16 v[72:87], v[124:127], v[12:15], v[40:55]
    ds_read_b128 v[120:123], v16 offset:49152
    s_mov_b64 exec, s[96:97]
    ds_read_b128 v[128:131], v19 offset:53248
    ds_read_b128 v[132:135], v19 offset:53760
    s_mov_b64 exec, -1
    buffer_load_dwordx4 v[224:227], v2, s[28:31], s61 offen offset:0 sc1
    buffer_load_dwordx4 v[232:235], v2, s[28:31], s59 offen offset:0 sc1
    buffer_load_dwordx4 v[228:231], v2, s[28:31], s61 offen offset:1024 sc1
    buffer_load_dwordx4 v[236:239], v2, s[28:31], s60 offen offset:0 sc1
    v_exp_f32 v61, v61
    v_exp_f32 v62, v62
    v_exp_f32 v63, v63
    v_exp_f32 v64, v64
    s_waitcnt vmcnt(5)
    v_mfma_f32_32x32x16_bf16 v[160:175], v[240:243], v[248:251], v[160:175]
    v_cvt_pk_bf16_f32 v144, v56, v57
    v_cvt_pk_bf16_f32 v145, v58, v59
    v_cvt_pk_bf16_f32 v146, v60, v61
    v_cvt_pk_bf16_f32 v147, v62, v63
    v_exp_f32 v65, v65
    v_exp_f32 v66, v66
    v_exp_f32 v67, v67
    v_mfma_f32_32x32x16_bf16 v[88:103], v[136:139], v[144:147], v[88:103]
    v_exp_f32 v68, v68
    v_exp_f32 v69, v69
    v_exp_f32 v70, v70
    v_exp_f32 v71, v71
    v_mfma_f32_32x32x16_bf16 v[176:191], v[244:247], v[248:251], v[176:191]
    v_cvt_pk_bf16_f32 v148, v64, v65
    v_cvt_pk_bf16_f32 v149, v66, v67
    v_cvt_pk_bf16_f32 v150, v68, v69
    v_cvt_pk_bf16_f32 v151, v70, v71
    v_exp_f32 v72, v72
    v_exp_f32 v73, v73
    v_mfma_f32_32x32x16_bf16 v[88:103], v[140:143], v[148:151], v[88:103]
    v_exp_f32 v74, v74
    v_exp_f32 v75, v75
    v_exp_f32 v76, v76
    s_waitcnt lgkmcnt(0)
    v_mfma_f32_32x32x16_bf16 v[56:71], v[120:123], v[8:11], v[24:39]
    v_exp_f32 v77, v77
    v_exp_f32 v78, v78
    v_exp_f32 v79, v79
    v_exp_f32 v80, v80
    s_waitcnt vmcnt(4)
    v_mfma_f32_32x32x16_bf16 v[192:207], v[240:243], v[252:255], v[192:207]
    v_cvt_pk_bf16_f32 v152, v72, v73
    v_cvt_pk_bf16_f32 v153, v74, v75
    v_cvt_pk_bf16_f32 v154, v76, v77
    v_cvt_pk_bf16_f32 v155, v78, v79
    v_exp_f32 v81, v81
    v_exp_f32 v82, v82
    v_exp_f32 v83, v83
    v_mfma_f32_32x32x16_bf16 v[104:119], v[136:139], v[152:155], v[104:119]
    v_exp_f32 v84, v84
    v_exp_f32 v85, v85
    v_exp_f32 v86, v86
    v_exp_f32 v87, v87
    v_mfma_f32_32x32x16_bf16 v[208:223], v[244:247], v[252:255], v[208:223]
    v_cvt_pk_bf16_f32 v156, v80, v81
    v_cvt_pk_bf16_f32 v157, v82, v83
    v_cvt_pk_bf16_f32 v158, v84, v85
    v_cvt_pk_bf16_f32 v159, v86, v87
    v_exp_f32 v56, v56
    v_exp_f32 v57, v57
    v_mfma_f32_32x32x16_bf16 v[104:119], v[140:143], v[156:159], v[104:119]
    v_exp_f32 v58, v58
    v_exp_f32 v59, v59
    v_exp_f32 v60, v60
    v_mfma_f32_32x32x16_bf16 v[72:87], v[120:123], v[12:15], v[40:55]
    ds_read_b128 v[124:127], v16 offset:50176
    s_mov_b64 exec, s[96:97]
    ds_read_b128 v[136:139], v19 offset:54272
    ds_read_b128 v[140:143], v19 offset:54784
    s_mov_b64 exec, -1
    buffer_load_dwordx4 v[240:243], v2, s[28:31], s61 offen offset:2048 sc1
    buffer_load_dwordx4 v[248:251], v2, s[28:31], s59 offen offset:1024 sc1
    buffer_load_dwordx4 v[244:247], v2, s[28:31], s61 offen offset:3072 sc1
    buffer_load_dwordx4 v[252:255], v2, s[28:31], s60 offen offset:1024 sc1
    s_add_u32 s61, s61, 4096
    v_exp_f32 v61, v61
    v_exp_f32 v62, v62
    v_exp_f32 v63, v63
    v_exp_f32 v64, v64
    s_waitcnt vmcnt(5)
    v_mfma_f32_32x32x16_bf16 v[160:175], v[224:227], v[232:235], v[160:175]
    v_cvt_pk_bf16_f32 v144, v56, v57
    v_cvt_pk_bf16_f32 v145, v58, v59
    v_cvt_pk_bf16_f32 v146, v60, v61
    v_cvt_pk_bf16_f32 v147, v62, v63
    v_exp_f32 v65, v65
    v_exp_f32 v66, v66
    v_exp_f32 v67, v67
    v_mfma_f32_32x32x16_bf16 v[88:103], v[128:131], v[144:147], v[88:103]
    v_exp_f32 v68, v68
    v_exp_f32 v69, v69
    v_exp_f32 v70, v70
    v_exp_f32 v71, v71
    v_mfma_f32_32x32x16_bf16 v[176:191], v[228:231], v[232:235], v[176:191]
    v_cvt_pk_bf16_f32 v148, v64, v65
    v_cvt_pk_bf16_f32 v149, v66, v67
    v_cvt_pk_bf16_f32 v150, v68, v69
    v_cvt_pk_bf16_f32 v151, v70, v71
    v_exp_f32 v72, v72
    v_exp_f32 v73, v73
    v_mfma_f32_32x32x16_bf16 v[88:103], v[132:135], v[148:151], v[88:103]
    v_exp_f32 v74, v74
    v_exp_f32 v75, v75
    v_exp_f32 v76, v76
    s_waitcnt lgkmcnt(0)
    v_mfma_f32_32x32x16_bf16 v[56:71], v[124:127], v[8:11], v[24:39]
    v_exp_f32 v77, v77
    v_exp_f32 v78, v78
    v_exp_f32 v79, v79
    v_exp_f32 v80, v80
    s_waitcnt vmcnt(4)
    v_mfma_f32_32x32x16_bf16 v[192:207], v[224:227], v[236:239], v[192:207]
    v_cvt_pk_bf16_f32 v152, v72, v73
    v_cvt_pk_bf16_f32 v153, v74, v75
    v_cvt_pk_bf16_f32 v154, v76, v77
    v_cvt_pk_bf16_f32 v155, v78, v79
    v_exp_f32 v81, v81
    v_exp_f32 v82, v82
    v_exp_f32 v83, v83
    v_mfma_f32_32x32x16_bf16 v[104:119], v[128:131], v[152:155], v[104:119]
    v_exp_f32 v84, v84
    v_exp_f32 v85, v85
    v_exp_f32 v86, v86
    v_exp_f32 v87, v87
    v_mfma_f32_32x32x16_bf16 v[208:223], v[228:231], v[236:239], v[208:223]
    v_cvt_pk_bf16_f32 v156, v80, v81
    v_cvt_pk_bf16_f32 v157, v82, v83
    v_cvt_pk_bf16_f32 v158, v84, v85
    v_cvt_pk_bf16_f32 v159, v86, v87
    v_exp_f32 v56, v56
    v_exp_f32 v57, v57
    v_mfma_f32_32x32x16_bf16 v[104:119], v[132:135], v[156:159], v[104:119]
    v_exp_f32 v58, v58
    v_exp_f32 v59, v59
    v_exp_f32 v60, v60
    v_mfma_f32_32x32x16_bf16 v[72:87], v[124:127], v[12:15], v[40:55]
    ds_read_b128 v[120:123], v16 offset:51200
    s_mov_b64 exec, s[96:97]
    ds_read_b128 v[128:131], v19 offset:55296
    ds_read_b128 v[132:135], v19 offset:55808
    s_mov_b64 exec, -1
    buffer_load_dwordx4 v[224:227], v2, s[28:31], s61 offen offset:0 sc1
    buffer_load_dwordx4 v[232:235], v2, s[28:31], s59 offen offset:2048 sc1
    buffer_load_dwordx4 v[228:231], v2, s[28:31], s61 offen offset:1024 sc1
    buffer_load_dwordx4 v[236:239], v2, s[28:31], s60 offen offset:2048 sc1
    v_exp_f32 v61, v61
    v_exp_f32 v62, v62
    v_exp_f32 v63, v63
    v_exp_f32 v64, v64
    s_waitcnt vmcnt(5)
    v_mfma_f32_32x32x16_bf16 v[160:175], v[240:243], v[248:251], v[160:175]
    v_cvt_pk_bf16_f32 v144, v56, v57
    v_cvt_pk_bf16_f32 v145, v58, v59
    v_cvt_pk_bf16_f32 v146, v60, v61
    v_cvt_pk_bf16_f32 v147, v62, v63
    v_exp_f32 v65, v65
    v_exp_f32 v66, v66
    v_exp_f32 v67, v67
    v_mfma_f32_32x32x16_bf16 v[88:103], v[136:139], v[144:147], v[88:103]
    v_exp_f32 v68, v68
    v_exp_f32 v69, v69
    v_exp_f32 v70, v70
    v_exp_f32 v71, v71
    v_mfma_f32_32x32x16_bf16 v[176:191], v[244:247], v[248:251], v[176:191]
    v_cvt_pk_bf16_f32 v148, v64, v65
    v_cvt_pk_bf16_f32 v149, v66, v67
    v_cvt_pk_bf16_f32 v150, v68, v69
    v_cvt_pk_bf16_f32 v151, v70, v71
    v_exp_f32 v72, v72
    v_exp_f32 v73, v73
    v_mfma_f32_32x32x16_bf16 v[88:103], v[140:143], v[148:151], v[88:103]
    v_exp_f32 v74, v74
    v_exp_f32 v75, v75
    v_exp_f32 v76, v76
    s_waitcnt lgkmcnt(0)
    v_mfma_f32_32x32x16_bf16 v[56:71], v[120:123], v[8:11], v[24:39]
    v_exp_f32 v77, v77
    v_exp_f32 v78, v78
    v_exp_f32 v79, v79
    v_exp_f32 v80, v80
    s_waitcnt vmcnt(4)
    v_mfma_f32_32x32x16_bf16 v[192:207], v[240:243], v[252:255], v[192:207]
    v_cvt_pk_bf16_f32 v152, v72, v73
    v_cvt_pk_bf16_f32 v153, v74, v75
    v_cvt_pk_bf16_f32 v154, v76, v77
    v_cvt_pk_bf16_f32 v155, v78, v79
    v_exp_f32 v81, v81
    v_exp_f32 v82, v82
    v_exp_f32 v83, v83
    v_mfma_f32_32x32x16_bf16 v[104:119], v[136:139], v[152:155], v[104:119]
    v_exp_f32 v84, v84
    v_exp_f32 v85, v85
    v_exp_f32 v86, v86
    v_exp_f32 v87, v87
    v_mfma_f32_32x32x16_bf16 v[208:223], v[244:247], v[252:255], v[208:223]
    v_cvt_pk_bf16_f32 v156, v80, v81
    v_cvt_pk_bf16_f32 v157, v82, v83
    v_cvt_pk_bf16_f32 v158, v84, v85
    v_cvt_pk_bf16_f32 v159, v86, v87
    v_exp_f32 v56, v56
    v_exp_f32 v57, v57
    v_mfma_f32_32x32x16_bf16 v[104:119], v[140:143], v[156:159], v[104:119]
    v_exp_f32 v58, v58
    v_exp_f32 v59, v59
    v_exp_f32 v60, v60
    v_mfma_f32_32x32x16_bf16 v[72:87], v[120:123], v[12:15], v[40:55]
    ds_read_b128 v[124:127], v16 offset:52224
    s_mov_b64 exec, s[96:97]
    ds_read_b128 v[136:139], v19 offset:56320
    ds_read_b128 v[140:143], v19 offset:56832
    s_mov_b64 exec, -1
    buffer_load_dwordx4 v[240:243], v2, s[28:31], s61 offen offset:2048 sc1
    buffer_load_dwordx4 v[248:251], v2, s[28:31], s59 offen offset:3072 sc1
    buffer_load_dwordx4 v[244:247], v2, s[28:31], s61 offen offset:3072 sc1
    buffer_load_dwordx4 v[252:255], v2, s[28:31], s60 offen offset:3072 sc1
    s_add_u32 s61, s61, 4096
    s_add_u32 s59, s59, 4096
    s_add_u32 s60, s60, 4096
    v_exp_f32 v61, v61
    v_exp_f32 v62, v62
    v_exp_f32 v63, v63
    v_exp_f32 v64, v64
    s_waitcnt vmcnt(5)
    v_mfma_f32_32x32x16_bf16 v[160:175], v[224:227], v[232:235], v[160:175]
    v_cvt_pk_bf16_f32 v144, v56, v57
    v_cvt_pk_bf16_f32 v145, v58, v59
    v_cvt_pk_bf16_f32 v146, v60, v61
    v_cvt_pk_bf16_f32 v147, v62, v63
    v_exp_f32 v65, v65
    v_exp_f32 v66, v66
    v_exp_f32 v67, v67
    v_mfma_f32_32x32x16_bf16 v[88:103], v[128:131], v[144:147], v[88:103]
    v_exp_f32 v68, v68
    v_exp_f32 v69, v69
    v_exp_f32 v70, v70
    v_exp_f32 v71, v71
    v_mfma_f32_32x32x16_bf16 v[176:191], v[228:231], v[232:235], v[176:191]
    v_cvt_pk_bf16_f32 v148, v64, v65
    v_cvt_pk_bf16_f32 v149, v66, v67
    v_cvt_pk_bf16_f32 v150, v68, v69
    v_cvt_pk_bf16_f32 v151, v70, v71
    v_exp_f32 v72, v72
    v_exp_f32 v73, v73
    v_mfma_f32_32x32x16_bf16 v[88:103], v[132:135], v[148:151], v[88:103]
    v_exp_f32 v74, v74
    v_exp_f32 v75, v75
    v_exp_f32 v76, v76
    s_waitcnt lgkmcnt(0)
    v_mfma_f32_32x32x16_bf16 v[56:71], v[124:127], v[8:11], v[24:39]
    v_exp_f32 v77, v77
    v_exp_f32 v78, v78
    v_exp_f32 v79, v79
    v_exp_f32 v80, v80
    s_waitcnt vmcnt(4)
    v_mfma_f32_32x32x16_bf16 v[192:207], v[224:227], v[236:239], v[192:207]
    v_cvt_pk_bf16_f32 v152, v72, v73
    v_cvt_pk_bf16_f32 v153, v74, v75
    v_cvt_pk_bf16_f32 v154, v76, v77
    v_cvt_pk_bf16_f32 v155, v78, v79
    v_exp_f32 v81, v81
    v_exp_f32 v82, v82
    v_exp_f32 v83, v83
    v_mfma_f32_32x32x16_bf16 v[104:119], v[128:131], v[152:155], v[104:119]
    v_exp_f32 v84, v84
    v_exp_f32 v85, v85
    v_exp_f32 v86, v86
    v_exp_f32 v87, v87
    v_mfma_f32_32x32x16_bf16 v[208:223], v[228:231], v[236:239], v[208:223]
    v_cvt_pk_bf16_f32 v156, v80, v81
    v_cvt_pk_bf16_f32 v157, v82, v83
    v_cvt_pk_bf16_f32 v158, v84, v85
    v_cvt_pk_bf16_f32 v159, v86, v87
    v_exp_f32 v56, v56
    v_exp_f32 v57, v57
    v_mfma_f32_32x32x16_bf16 v[104:119], v[132:135], v[156:159], v[104:119]
    v_exp_f32 v58, v58
    v_exp_f32 v59, v59
    v_exp_f32 v60, v60
    v_mfma_f32_32x32x16_bf16 v[72:87], v[124:127], v[12:15], v[40:55]
    ds_read_b128 v[120:123], v16 offset:57344
    s_mov_b64 exec, s[96:97]
    ds_read_b128 v[128:131], v19 offset:61440
    ds_read_b128 v[132:135], v19 offset:61952
    s_mov_b64 exec, -1
    buffer_load_dwordx4 v[224:227], v2, s[28:31], s61 offen offset:0 sc1
    buffer_load_dwordx4 v[232:235], v2, s[28:31], s59 offen offset:0 sc1
    buffer_load_dwordx4 v[228:231], v2, s[28:31], s61 offen offset:1024 sc1
    buffer_load_dwordx4 v[236:239], v2, s[28:31], s60 offen offset:0 sc1
    v_exp_f32 v61, v61
    v_exp_f32 v62, v62
    v_exp_f32 v63, v63
    v_exp_f32 v64, v64
    s_waitcnt vmcnt(5)
    v_mfma_f32_32x32x16_bf16 v[160:175], v[240:243], v[248:251], v[160:175]
    v_cvt_pk_bf16_f32 v144, v56, v57
    v_cvt_pk_bf16_f32 v145, v58, v59
    v_cvt_pk_bf16_f32 v146, v60, v61
    v_cvt_pk_bf16_f32 v147, v62, v63
    v_exp_f32 v65, v65
    v_exp_f32 v66, v66
    v_exp_f32 v67, v67
    v_mfma_f32_32x32x16_bf16 v[88:103], v[136:139], v[144:147], v[88:103]
    v_exp_f32 v68, v68
    v_exp_f32 v69, v69
    v_exp_f32 v70, v70
    v_exp_f32 v71, v71
    v_mfma_f32_32x32x16_bf16 v[176:191], v[244:247], v[248:251], v[176:191]
    v_cvt_pk_bf16_f32 v148, v64, v65
    v_cvt_pk_bf16_f32 v149, v66, v67
    v_cvt_pk_bf16_f32 v150, v68, v69
    v_cvt_pk_bf16_f32 v151, v70, v71
    v_exp_f32 v72, v72
    v_exp_f32 v73, v73
    v_mfma_f32_32x32x16_bf16 v[88:103], v[140:143], v[148:151], v[88:103]
    v_exp_f32 v74, v74
    v_exp_f32 v75, v75
    v_exp_f32 v76, v76
    s_waitcnt lgkmcnt(0)
    v_mfma_f32_32x32x16_bf16 v[56:71], v[120:123], v[8:11], v[24:39]
    v_exp_f32 v77, v77
    v_exp_f32 v78, v78
    v_exp_f32 v79, v79
    v_exp_f32 v80, v80
    s_waitcnt vmcnt(4)
    v_mfma_f32_32x32x16_bf16 v[192:207], v[240:243], v[252:255], v[192:207]
    v_cvt_pk_bf16_f32 v152, v72, v73
    v_cvt_pk_bf16_f32 v153, v74, v75
    v_cvt_pk_bf16_f32 v154, v76, v77
    v_cvt_pk_bf16_f32 v155, v78, v79
    v_exp_f32 v81, v81
    v_exp_f32 v82, v82
    v_exp_f32 v83, v83
    v_mfma_f32_32x32x16_bf16 v[104:119], v[136:139], v[152:155], v[104:119]
    v_exp_f32 v84, v84
    v_exp_f32 v85, v85
    v_exp_f32 v86, v86
    v_exp_f32 v87, v87
    v_mfma_f32_32x32x16_bf16 v[208:223], v[244:247], v[252:255], v[208:223]
    v_cvt_pk_bf16_f32 v156, v80, v81
    v_cvt_pk_bf16_f32 v157, v82, v83
    v_cvt_pk_bf16_f32 v158, v84, v85
    v_cvt_pk_bf16_f32 v159, v86, v87
    v_exp_f32 v56, v56
    v_exp_f32 v57, v57
    v_mfma_f32_32x32x16_bf16 v[104:119], v[140:143], v[156:159], v[104:119]
    v_exp_f32 v58, v58
    v_exp_f32 v59, v59
    v_exp_f32 v60, v60
    v_mfma_f32_32x32x16_bf16 v[72:87], v[120:123], v[12:15], v[40:55]
    ds_read_b128 v[124:127], v16 offset:58368
    s_mov_b64 exec, s[96:97]
    ds_read_b128 v[136:139], v19 offset:62464
    ds_read_b128 v[140:143], v19 offset:62976
    s_mov_b64 exec, -1
    buffer_load_dwordx4 v[240:243], v2, s[28:31], s61 offen offset:2048 sc1
    buffer_load_dwordx4 v[248:251], v2, s[28:31], s59 offen offset:1024 sc1
    buffer_load_dwordx4 v[244:247], v2, s[28:31], s61 offen offset:3072 sc1
    buffer_load_dwordx4 v[252:255], v2, s[28:31], s60 offen offset:1024 sc1
    s_add_u32 s61, s61, 4096
    v_exp_f32 v61, v61
    v_exp_f32 v62, v62
    v_exp_f32 v63, v63
    v_exp_f32 v64, v64
    s_waitcnt vmcnt(5)
    v_mfma_f32_32x32x16_bf16 v[160:175], v[224:227], v[232:235], v[160:175]
    v_cvt_pk_bf16_f32 v144, v56, v57
    v_cvt_pk_bf16_f32 v145, v58, v59
    v_cvt_pk_bf16_f32 v146, v60, v61
    v_cvt_pk_bf16_f32 v147, v62, v63
    v_exp_f32 v65, v65
    v_exp_f32 v66, v66
    v_exp_f32 v67, v67
    v_mfma_f32_32x32x16_bf16 v[88:103], v[128:131], v[144:147], v[88:103]
    v_exp_f32 v68, v68
    v_exp_f32 v69, v69
    v_exp_f32 v70, v70
    v_exp_f32 v71, v71
    v_mfma_f32_32x32x16_bf16 v[176:191], v[228:231], v[232:235], v[176:191]
    v_cvt_pk_bf16_f32 v148, v64, v65
    v_cvt_pk_bf16_f32 v149, v66, v67
    v_cvt_pk_bf16_f32 v150, v68, v69
    v_cvt_pk_bf16_f32 v151, v70, v71
    v_exp_f32 v72, v72
    v_exp_f32 v73, v73
    v_mfma_f32_32x32x16_bf16 v[88:103], v[132:135], v[148:151], v[88:103]
    v_exp_f32 v74, v74
    v_exp_f32 v75, v75
    v_exp_f32 v76, v76
    s_waitcnt lgkmcnt(0)
    v_mfma_f32_32x32x16_bf16 v[56:71], v[124:127], v[8:11], v[24:39]
    v_exp_f32 v77, v77
    v_exp_f32 v78, v78
    v_exp_f32 v79, v79
    v_exp_f32 v80, v80
    s_waitcnt vmcnt(4)
    v_mfma_f32_32x32x16_bf16 v[192:207], v[224:227], v[236:239], v[192:207]
    v_cvt_pk_bf16_f32 v152, v72, v73
    v_cvt_pk_bf16_f32 v153, v74, v75
    v_cvt_pk_bf16_f32 v154, v76, v77
    v_cvt_pk_bf16_f32 v155, v78, v79
    v_exp_f32 v81, v81
    v_exp_f32 v82, v82
    v_exp_f32 v83, v83
    v_mfma_f32_32x32x16_bf16 v[104:119], v[128:131], v[152:155], v[104:119]
    v_exp_f32 v84, v84
    v_exp_f32 v85, v85
    v_exp_f32 v86, v86
    v_exp_f32 v87, v87
    v_mfma_f32_32x32x16_bf16 v[208:223], v[228:231], v[236:239], v[208:223]
    v_cvt_pk_bf16_f32 v156, v80, v81
    v_cvt_pk_bf16_f32 v157, v82, v83
    v_cvt_pk_bf16_f32 v158, v84, v85
    v_cvt_pk_bf16_f32 v159, v86, v87
    v_exp_f32 v56, v56
    v_exp_f32 v57, v57
    v_mfma_f32_32x32x16_bf16 v[104:119], v[132:135], v[156:159], v[104:119]
    v_exp_f32 v58, v58
    v_exp_f32 v59, v59
    v_exp_f32 v60, v60
    v_mfma_f32_32x32x16_bf16 v[72:87], v[124:127], v[12:15], v[40:55]
    ds_read_b128 v[120:123], v16 offset:59392
    s_mov_b64 exec, s[96:97]
    ds_read_b128 v[128:131], v19 offset:63488
    ds_read_b128 v[132:135], v19 offset:64000
    s_mov_b64 exec, -1
    v_exp_f32 v61, v61
    v_exp_f32 v62, v62
    v_exp_f32 v63, v63
    v_exp_f32 v64, v64
    s_waitcnt vmcnt(1)
    v_mfma_f32_32x32x16_bf16 v[160:175], v[240:243], v[248:251], v[160:175]
    v_cvt_pk_bf16_f32 v144, v56, v57
    v_cvt_pk_bf16_f32 v145, v58, v59
    v_cvt_pk_bf16_f32 v146, v60, v61
    v_cvt_pk_bf16_f32 v147, v62, v63
    v_exp_f32 v65, v65
    v_exp_f32 v66, v66
    v_exp_f32 v67, v67
    v_mfma_f32_32x32x16_bf16 v[88:103], v[136:139], v[144:147], v[88:103]
    v_exp_f32 v68, v68
    v_exp_f32 v69, v69
    v_exp_f32 v70, v70
    v_exp_f32 v71, v71
    v_mfma_f32_32x32x16_bf16 v[176:191], v[244:247], v[248:251], v[176:191]
    v_cvt_pk_bf16_f32 v148, v64, v65
    v_cvt_pk_bf16_f32 v149, v66, v67
    v_cvt_pk_bf16_f32 v150, v68, v69
    v_cvt_pk_bf16_f32 v151, v70, v71
    v_exp_f32 v72, v72
    v_exp_f32 v73, v73
    v_mfma_f32_32x32x16_bf16 v[88:103], v[140:143], v[148:151], v[88:103]
    v_exp_f32 v74, v74
    v_exp_f32 v75, v75
    v_exp_f32 v76, v76
    s_waitcnt lgkmcnt(0)
    v_mfma_f32_32x32x16_bf16 v[56:71], v[120:123], v[8:11], v[24:39]
    v_exp_f32 v77, v77
    v_exp_f32 v78, v78
    v_exp_f32 v79, v79
    v_exp_f32 v80, v80
    s_waitcnt vmcnt(0)
    v_mfma_f32_32x32x16_bf16 v[192:207], v[240:243], v[252:255], v[192:207]
    v_cvt_pk_bf16_f32 v152, v72, v73
    v_cvt_pk_bf16_f32 v153, v74, v75
    v_cvt_pk_bf16_f32 v154, v76, v77
    v_cvt_pk_bf16_f32 v155, v78, v79
    v_exp_f32 v81, v81
    v_exp_f32 v82, v82
    v_exp_f32 v83, v83
    v_mfma_f32_32x32x16_bf16 v[104:119], v[136:139], v[152:155], v[104:119]
    v_exp_f32 v84, v84
    v_exp_f32 v85, v85
    v_exp_f32 v86, v86
    v_exp_f32 v87, v87
    v_mfma_f32_32x32x16_bf16 v[208:223], v[244:247], v[252:255], v[208:223]
    v_cvt_pk_bf16_f32 v156, v80, v81
    v_cvt_pk_bf16_f32 v157, v82, v83
    v_cvt_pk_bf16_f32 v158, v84, v85
    v_cvt_pk_bf16_f32 v159, v86, v87
    v_exp_f32 v56, v56
    v_exp_f32 v57, v57
    v_mfma_f32_32x32x16_bf16 v[104:119], v[140:143], v[156:159], v[104:119]
    v_exp_f32 v58, v58
    v_exp_f32 v59, v59
    v_exp_f32 v60, v60
    v_mfma_f32_32x32x16_bf16 v[72:87], v[120:123], v[12:15], v[40:55]
    ds_read_b128 v[124:127], v16 offset:60416
    s_mov_b64 exec, s[96:97]
    ds_read_b128 v[136:139], v19 offset:64512
    ds_read_b128 v[140:143], v19 offset:65024
    s_mov_b64 exec, -1
    v_exp_f32 v61, v61
    v_exp_f32 v62, v62
    v_exp_f32 v63, v63
    v_exp_f32 v64, v64
    v_cvt_pk_bf16_f32 v144, v56, v57
    v_cvt_pk_bf16_f32 v145, v58, v59
    v_cvt_pk_bf16_f32 v146, v60, v61
    v_cvt_pk_bf16_f32 v147, v62, v63
    v_exp_f32 v65, v65
    v_exp_f32 v66, v66
    v_exp_f32 v67, v67
    v_mfma_f32_32x32x16_bf16 v[88:103], v[128:131], v[144:147], v[88:103]
    v_exp_f32 v68, v68
    v_exp_f32 v69, v69
    v_exp_f32 v70, v70
    v_exp_f32 v71, v71
    v_cvt_pk_bf16_f32 v148, v64, v65
    v_cvt_pk_bf16_f32 v149, v66, v67
    v_cvt_pk_bf16_f32 v150, v68, v69
    v_cvt_pk_bf16_f32 v151, v70, v71
    v_exp_f32 v72, v72
    v_exp_f32 v73, v73
    v_mfma_f32_32x32x16_bf16 v[88:103], v[132:135], v[148:151], v[88:103]
    v_exp_f32 v74, v74
    v_exp_f32 v75, v75
    v_exp_f32 v76, v76
    s_waitcnt lgkmcnt(0)
    v_mfma_f32_32x32x16_bf16 v[56:71], v[124:127], v[8:11], v[24:39]
    v_exp_f32 v77, v77
    v_exp_f32 v78, v78
    v_exp_f32 v79, v79
    v_exp_f32 v80, v80
    v_cvt_pk_bf16_f32 v152, v72, v73
    v_cvt_pk_bf16_f32 v153, v74, v75
    v_cvt_pk_bf16_f32 v154, v76, v77
    v_cvt_pk_bf16_f32 v155, v78, v79
    v_exp_f32 v81, v81
    v_exp_f32 v82, v82
    v_exp_f32 v83, v83
    v_mfma_f32_32x32x16_bf16 v[104:119], v[128:131], v[152:155], v[104:119]
    v_exp_f32 v84, v84
    v_exp_f32 v85, v85
    v_exp_f32 v86, v86
    v_exp_f32 v87, v87
    v_cvt_pk_bf16_f32 v156, v80, v81
    v_cvt_pk_bf16_f32 v157, v82, v83
    v_cvt_pk_bf16_f32 v158, v84, v85
    v_cvt_pk_bf16_f32 v159, v86, v87
    v_exp_f32 v56, v56
    v_exp_f32 v57, v57
    v_mfma_f32_32x32x16_bf16 v[104:119], v[132:135], v[156:159], v[104:119]
    v_exp_f32 v58, v58
    v_exp_f32 v59, v59
    v_exp_f32 v60, v60
    v_mfma_f32_32x32x16_bf16 v[72:87], v[124:127], v[12:15], v[40:55]
    ds_read_b128 v[120:123], v2 offset:16384
    s_mov_b64 exec, s[96:97]
    ds_read_b128 v[128:131], v21 offset:20480
    ds_read_b128 v[132:135], v21 offset:20992
    s_mov_b64 exec, -1
    v_exp_f32 v61, v61
    v_exp_f32 v62, v62
    v_exp_f32 v63, v63
    v_exp_f32 v64, v64
    v_cvt_pk_bf16_f32 v144, v56, v57
    v_cvt_pk_bf16_f32 v145, v58, v59
    v_cvt_pk_bf16_f32 v146, v60, v61
    v_cvt_pk_bf16_f32 v147, v62, v63
    v_exp_f32 v65, v65
    v_exp_f32 v66, v66
    v_exp_f32 v67, v67
    v_mfma_f32_32x32x16_bf16 v[88:103], v[136:139], v[144:147], v[88:103]
    v_exp_f32 v68, v68
    v_exp_f32 v69, v69
    v_exp_f32 v70, v70
    v_exp_f32 v71, v71
    v_cvt_pk_bf16_f32 v148, v64, v65
    v_cvt_pk_bf16_f32 v149, v66, v67
    v_cvt_pk_bf16_f32 v150, v68, v69
    v_cvt_pk_bf16_f32 v151, v70, v71
    v_exp_f32 v72, v72
    v_exp_f32 v73, v73
    v_mfma_f32_32x32x16_bf16 v[88:103], v[140:143], v[148:151], v[88:103]
    v_exp_f32 v74, v74
    v_exp_f32 v75, v75
    v_exp_f32 v76, v76
    s_waitcnt lgkmcnt(0)
    v_mfma_f32_32x32x16_bf16 v[56:71], v[120:123], v[8:11], v[24:39]
    s_mov_b64 exec, 1
    ds_add_u32 v3, v4 offset:12
    s_mov_b64 exec, -1
    v_exp_f32 v77, v77
    v_exp_f32 v78, v78
    v_exp_f32 v79, v79
    v_exp_f32 v80, v80
    v_cvt_pk_bf16_f32 v152, v72, v73
    v_cvt_pk_bf16_f32 v153, v74, v75
    v_cvt_pk_bf16_f32 v154, v76, v77
    v_cvt_pk_bf16_f32 v155, v78, v79
    v_exp_f32 v81, v81
    v_exp_f32 v82, v82
    v_exp_f32 v83, v83
    v_mfma_f32_32x32x16_bf16 v[104:119], v[136:139], v[152:155], v[104:119]
    v_exp_f32 v84, v84
    v_exp_f32 v85, v85
    v_exp_f32 v86, v86
    v_exp_f32 v87, v87
    v_cvt_pk_bf16_f32 v156, v80, v81
    v_cvt_pk_bf16_f32 v157, v82, v83
    v_cvt_pk_bf16_f32 v158, v84, v85
    v_cvt_pk_bf16_f32 v159, v86, v87
    v_exp_f32 v56, v56
    v_exp_f32 v57, v57
    v_mfma_f32_32x32x16_bf16 v[104:119], v[140:143], v[156:159], v[104:119]
    v_exp_f32 v58, v58
    v_exp_f32 v59, v59
    v_exp_f32 v60, v60
    v_mfma_f32_32x32x16_bf16 v[72:87], v[120:123], v[12:15], v[40:55]
    ds_read_b128 v[124:127], v2 offset:17408
    s_mov_b64 exec, s[96:97]
    ds_read_b128 v[136:139], v21 offset:21504
    ds_read_b128 v[140:143], v21 offset:22016
    s_mov_b64 exec, -1
    ds_read_b32 v22, v3 offset:12
    v_exp_f32 v61, v61
    v_exp_f32 v62, v62
    v_exp_f32 v63, v63
    v_exp_f32 v64, v64
    v_cvt_pk_bf16_f32 v144, v56, v57
    v_cvt_pk_bf16_f32 v145, v58, v59
    v_cvt_pk_bf16_f32 v146, v60, v61
    v_cvt_pk_bf16_f32 v147, v62, v63
    v_exp_f32 v65, v65
    v_exp_f32 v66, v66
    v_exp_f32 v67, v67
    v_mfma_f32_32x32x16_bf16 v[88:103], v[128:131], v[144:147], v[88:103]
    v_exp_f32 v68, v68
    v_exp_f32 v69, v69
    v_exp_f32 v70, v70
    v_exp_f32 v71, v71
    v_cvt_pk_bf16_f32 v148, v64, v65
    v_cvt_pk_bf16_f32 v149, v66, v67
    v_cvt_pk_bf16_f32 v150, v68, v69
    v_cvt_pk_bf16_f32 v151, v70, v71
    v_exp_f32 v72, v72
    v_exp_f32 v73, v73
    v_mfma_f32_32x32x16_bf16 v[88:103], v[132:135], v[148:151], v[88:103]
    v_exp_f32 v74, v74
    v_exp_f32 v75, v75
    v_exp_f32 v76, v76
    s_waitcnt lgkmcnt(0)
    v_mfma_f32_32x32x16_bf16 v[56:71], v[124:127], v[8:11], v[24:39]
    v_readfirstlane_b32 s70, v22
    s_cmp_ge_u32 s70, 8
    s_cbranch_scc1 C_A2_K
LW_157:
    ds_read_b32 v22, v3 offset:12
    s_waitcnt lgkmcnt(0)
    v_readfirstlane_b32 s70, v22
    s_cmp_ge_u32 s70, 8
    s_cbranch_scc1 LD_158
    s_sub_u32 s3, s3, 1
    s_cmp_lt_i32 s3, 0
    s_cbranch_scc1 LD_158
    s_sleep 1
    s_branch LW_157
LD_158:
C_A2_K:
    v_exp_f32 v77, v77
    v_exp_f32 v78, v78
    v_exp_f32 v79, v79
    v_exp_f32 v80, v80
    v_cvt_pk_bf16_f32 v152, v72, v73
    v_cvt_pk_bf16_f32 v153, v74, v75
    v_cvt_pk_bf16_f32 v154, v76, v77
    v_cvt_pk_bf16_f32 v155, v78, v79
    v_exp_f32 v81, v81
    v_exp_f32 v82, v82
    v_exp_f32 v83, v83
    v_mfma_f32_32x32x16_bf16 v[104:119], v[128:131], v[152:155], v[104:119]
    v_exp_f32 v84, v84
    v_exp_f32 v85, v85
    v_exp_f32 v86, v86
    v_exp_f32 v87, v87
    v_cvt_pk_bf16_f32 v156, v80, v81
    v_cvt_pk_bf16_f32 v157, v82, v83
    v_cvt_pk_bf16_f32 v158, v84, v85
    v_cvt_pk_bf16_f32 v159, v86, v87
    v_exp_f32 v56, v56
    v_exp_f32 v57, v57
    v_mfma_f32_32x32x16_bf16 v[104:119], v[132:135], v[156:159], v[104:119]
    v_exp_f32 v58, v58
    v_exp_f32 v59, v59
    v_exp_f32 v60, v60
    v_mfma_f32_32x32x16_bf16 v[72:87], v[124:127], v[12:15], v[40:55]
    ds_read_b128 v[120:123], v2 offset:18432
    s_mov_b64 exec, s[96:97]
    ds_read_b128 v[128:131], v21 offset:22528
    ds_read_b128 v[132:135], v21 offset:23040
    s_mov_b64 exec, -1
    v_exp_f32 v61, v61
    v_cvt_pk_bf16_f32 v224, v160, v176
    v_exp_f32 v62, v62
    v_cvt_pk_bf16_f32 v225, v161, v177
    v_exp_f32 v63, v63
    v_cvt_pk_bf16_f32 v226, v162, v178
    v_exp_f32 v64, v64
    v_cvt_pk_bf16_f32 v227, v163, v179
    v_cvt_pk_bf16_f32 v144, v56, v57
    v_cvt_pk_bf16_f32 v145, v58, v59
    v_cvt_pk_bf16_f32 v146, v60, v61
    v_cvt_pk_bf16_f32 v147, v62, v63
    v_exp_f32 v65, v65
    ds_write_b128 v18, v[224:227] offset:0
    v_exp_f32 v66, v66
    v_cvt_pk_bf16_f32 v228, v164, v180
    v_exp_f32 v67, v67
    v_mfma_f32_32x32x16_bf16 v[88:103], v[136:139], v[144:147], v[88:103]
    v_exp_f32 v68, v68
    v_cvt_pk_bf16_f32 v229, v165, v181
    v_exp_f32 v69, v69
    v_cvt_pk_bf16_f32 v230, v166, v182
    v_exp_f32 v70, v70
    v_cvt_pk_bf16_f32 v231, v167, v183
    v_exp_f32 v71, v71
    ds_write_b128 v18, v[228:231] offset:1024
    v_cvt_pk_bf16_f32 v148, v64, v65
    v_cvt_pk_bf16_f32 v224, v168, v184
    v_cvt_pk_bf16_f32 v149, v66, v67
    v_cvt_pk_bf16_f32 v225, v169, v185
    v_cvt_pk_bf16_f32 v150, v68, v69
    v_cvt_pk_bf16_f32 v226, v170, v186
    v_cvt_pk_bf16_f32 v151, v70, v71
    v_cvt_pk_bf16_f32 v227, v171, v187
    v_exp_f32 v72, v72
    v_exp_f32 v73, v73
    v_mfma_f32_32x32x16_bf16 v[88:103], v[140:143], v[148:151], v[88:103]
    v_exp_f32 v74, v74
    v_exp_f32 v75, v75
    v_exp_f32 v76, v76
    s_waitcnt lgkmcnt(0)
    v_mfma_f32_32x32x16_bf16 v[56:71], v[120:123], v[8:11], v[24:39]
    v_exp_f32 v77, v77
    ds_write_b128 v18, v[224:227] offset:2048
    v_exp_f32 v78, v78
    v_cvt_pk_bf16_f32 v228, v172, v188
    v_exp_f32 v79, v79
    v_cvt_pk_bf16_f32 v229, v173, v189
    v_exp_f32 v80, v80
    v_cvt_pk_bf16_f32 v230, v174, v190
    v_cvt_pk_bf16_f32 v152, v72, v73
    v_cvt_pk_bf16_f32 v153, v74, v75
    v_cvt_pk_bf16_f32 v154, v76, v77
    v_cvt_pk_bf16_f32 v155, v78, v79
    v_exp_f32 v81, v81
    v_cvt_pk_bf16_f32 v231, v175, v191
    v_exp_f32 v82, v82
    ds_write_b128 v18, v[228:231] offset:3072
    v_exp_f32 v83, v83
    v_mfma_f32_32x32x16_bf16 v[104:119], v[136:139], v[152:155], v[104:119]
    v_exp_f32 v84, v84
    v_cvt_pk_bf16_f32 v224, v192, v208
    v_exp_f32 v85, v85
    v_cvt_pk_bf16_f32 v225, v193, v209
    v_exp_f32 v86, v86
    v_cvt_pk_bf16_f32 v226, v194, v210
    v_exp_f32 v87, v87
    v_cvt_pk_bf16_f32 v227, v195, v211
    v_cvt_pk_bf16_f32 v156, v80, v81
    ds_write_b128 v18, v[224:227] offset:4096
    v_cvt_pk_bf16_f32 v157, v82, v83
    v_cvt_pk_bf16_f32 v228, v196, v212
    v_cvt_pk_bf16_f32 v158, v84, v85
    v_cvt_pk_bf16_f32 v229, v197, v213
    v_cvt_pk_bf16_f32 v159, v86, v87
    v_cvt_pk_bf16_f32 v230, v198, v214
    v_exp_f32 v56, v56
    v_exp_f32 v57, v57
    v_mfma_f32_32x32x16_bf16 v[104:119], v[140:143], v[156:159], v[104:119]
    v_exp_f32 v58, v58
    v_exp_f32 v59, v59
    v_exp_f32 v60, v60
    v_mfma_f32_32x32x16_bf16 v[72:87], v[120:123], v[12:15], v[40:55]
    ds_read_b128 v[124:127], v2 offset:19456
    s_mov_b64 exec, s[96:97]
    ds_read_b128 v[136:139], v21 offset:23552
    ds_read_b128 v[140:143], v21 offset:24064
    s_mov_b64 exec, -1
    buffer_load_dwordx4 v[160:163], v2, s[28:31], s62 offen offset:0 sc1
    buffer_load_dwordx4 v[164:167], v2, s[28:31], s62 offen offset:1024 sc1
    s_setprio 0
    v_exp_f32 v61, v61
    v_cvt_pk_bf16_f32 v231, v199, v215
    v_exp_f32 v62, v62
    ds_write_b128 v18, v[228:231] offset:5120
    v_exp_f32 v63, v63
    v_cvt_pk_bf16_f32 v224, v200, v216
    v_exp_f32 v64, v64
    v_cvt_pk_bf16_f32 v225, v201, v217
    v_cvt_pk_bf16_f32 v144, v56, v57
    v_cvt_pk_bf16_f32 v145, v58, v59
    v_cvt_pk_bf16_f32 v146, v60, v61
    v_cvt_pk_bf16_f32 v147, v62, v63
    v_exp_f32 v65, v65
    v_cvt_pk_bf16_f32 v226, v202, v218
    v_exp_f32 v66, v66
    v_cvt_pk_bf16_f32 v227, v203, v219
    v_exp_f32 v67, v67
    v_mfma_f32_32x32x16_bf16 v[88:103], v[128:131], v[144:147], v[88:103]
    v_exp_f32 v68, v68
    ds_write_b128 v18, v[224:227] offset:6144
    v_exp_f32 v69, v69
    v_cvt_pk_bf16_f32 v228, v204, v220
    v_exp_f32 v70, v70
    v_cvt_pk_bf16_f32 v229, v205, v221
    v_exp_f32 v71, v71
    v_cvt_pk_bf16_f32 v230, v206, v222
    v_cvt_pk_bf16_f32 v148, v64, v65
    v_cvt_pk_bf16_f32 v231, v207, v223
    v_cvt_pk_bf16_f32 v149, v66, v67
    ds_write_b128 v18, v[228:231] offset:7168
    v_cvt_pk_bf16_f32 v150, v68, v69
    v_cvt_pk_bf16_f32 v151, v70, v71
    v_exp_f32 v72, v72
    v_exp_f32 v73, v73
    v_mfma_f32_32x32x16_bf16 v[88:103], v[132:135], v[148:151], v[88:103]
    v_exp_f32 v74, v74
    v_exp_f32 v75, v75
    v_exp_f32 v76, v76
    s_waitcnt lgkmcnt(0)
    v_mfma_f32_32x32x16_bf16 v[56:71], v[124:127], v[8:11], v[24:39]
    buffer_load_dwordx4 v[168:171], v2, s[28:31], s62 offen offset:2048 sc1
    buffer_load_dwordx4 v[172:175], v2, s[28:31], s62 offen offset:3072 sc1
    v_exp_f32 v77, v77
    v_exp_f32 v78, v78
    v_exp_f32 v79, v79
    v_exp_f32 v80, v80
    v_cvt_pk_bf16_f32 v152, v72, v73
    v_cvt_pk_bf16_f32 v153, v74, v75
    v_cvt_pk_bf16_f32 v154, v76, v77
    v_cvt_pk_bf16_f32 v155, v78, v79
    v_exp_f32 v81, v81
    v_exp_f32 v82, v82
    v_exp_f32 v83, v83
    v_mfma_f32_32x32x16_bf16 v[104:119], v[128:131], v[152:155], v[104:119]
    v_exp_f32 v84, v84
    v_exp_f32 v85, v85
    v_exp_f32 v86, v86
    v_exp_f32 v87, v87
    v_cvt_pk_bf16_f32 v156, v80, v81
    v_cvt_pk_bf16_f32 v157, v82, v83
    v_cvt_pk_bf16_f32 v158, v84, v85
    v_cvt_pk_bf16_f32 v159, v86, v87
    v_exp_f32 v56, v56
    v_exp_f32 v57, v57
    v_mfma_f32_32x32x16_bf16 v[104:119], v[132:135], v[156:159], v[104:119]
    v_exp_f32 v58, v58
    v_exp_f32 v59, v59
    v_exp_f32 v60, v60
    v_mfma_f32_32x32x16_bf16 v[72:87], v[124:127], v[12:15], v[40:55]
    ds_read_b128 v[120:123], v2 offset:24576
    s_mov_b64 exec, s[96:97]
    ds_read_b128 v[128:131], v21 offset:28672
    ds_read_b128 v[132:135], v21 offset:29184
    s_mov_b64 exec, -1
    s_add_u32 s62, s62, 4096
    buffer_load_dwordx4 v[176:179], v2, s[28:31], s62 offen offset:0 sc1
    buffer_load_dwordx4 v[180:183], v2, s[28:31], s62 offen offset:1024 sc1
    v_exp_f32 v61, v61
    v_exp_f32 v62, v62
    v_exp_f32 v63, v63
    v_exp_f32 v64, v64
    v_cvt_pk_bf16_f32 v144, v56, v57
    v_cvt_pk_bf16_f32 v145, v58, v59
    v_cvt_pk_bf16_f32 v146, v60, v61
    v_cvt_pk_bf16_f32 v147, v62, v63
    v_exp_f32 v65, v65
    v_exp_f32 v66, v66
    v_exp_f32 v67, v67
    v_mfma_f32_32x32x16_bf16 v[88:103], v[136:139], v[144:147], v[88:103]
    v_exp_f32 v68, v68
    v_exp_f32 v69, v69
    v_exp_f32 v70, v70
    v_exp_f32 v71, v71
    v_cvt_pk_bf16_f32 v148, v64, v65
    v_cvt_pk_bf16_f32 v149, v66, v67
    v_cvt_pk_bf16_f32 v150, v68, v69
    v_cvt_pk_bf16_f32 v151, v70, v71
    v_exp_f32 v72, v72
    v_exp_f32 v73, v73
    v_mfma_f32_32x32x16_bf16 v[88:103], v[140:143], v[148:151], v[88:103]
    v_exp_f32 v74, v74
    v_exp_f32 v75, v75
    v_exp_f32 v76, v76
    s_waitcnt lgkmcnt(0)
    v_mfma_f32_32x32x16_bf16 v[56:71], v[120:123], v[8:11], v[24:39]
    buffer_load_dwordx4 v[184:187], v2, s[28:31], s62 offen offset:2048 sc1
    buffer_load_dwordx4 v[188:191], v2, s[28:31], s62 offen offset:3072 sc1
    v_exp_f32 v77, v77
    v_exp_f32 v78, v78
    v_exp_f32 v79, v79
    v_exp_f32 v80, v80
    v_cvt_pk_bf16_f32 v152, v72, v73
    v_cvt_pk_bf16_f32 v153, v74, v75
    v_cvt_pk_bf16_f32 v154, v76, v77
    v_cvt_pk_bf16_f32 v155, v78, v79
    v_exp_f32 v81, v81
    v_exp_f32 v82, v82
    v_exp_f32 v83, v83
    v_mfma_f32_32x32x16_bf16 v[104:119], v[136:139], v[152:155], v[104:119]
    v_exp_f32 v84, v84
    v_exp_f32 v85, v85
    v_exp_f32 v86, v86
    v_exp_f32 v87, v87
    v_cvt_pk_bf16_f32 v156, v80, v81
    v_cvt_pk_bf16_f32 v157, v82, v83
    v_cvt_pk_bf16_f32 v158, v84, v85
    v_cvt_pk_bf16_f32 v159, v86, v87
    v_exp_f32 v56, v56
    v_exp_f32 v57, v57
    v_mfma_f32_32x32x16_bf16 v[104:119], v[140:143], v[156:159], v[104:119]
    v_exp_f32 v58, v58
    v_exp_f32 v59, v59
    v_exp_f32 v60, v60
    v_mfma_f32_32x32x16_bf16 v[72:87], v[120:123], v[12:15], v[40:55]
    ds_read_b128 v[124:127], v2 offset:25600
    s_mov_b64 exec, s[96:97]
    ds_read_b128 v[136:139], v21 offset:29696
    ds_read_b128 v[140:143], v21 offset:30208
    s_mov_b64 exec, -1
    s_add_u32 s62, s62, 4096
    buffer_load_dwordx4 v[192:195], v2, s[28:31], s62 offen offset:0 sc1
    buffer_load_dwordx4 v[196:199], v2, s[28:31], s62 offen offset:1024 sc1
    v_exp_f32 v61, v61
    v_exp_f32 v62, v62
    v_exp_f32 v63, v63
    v_exp_f32 v64, v64
    v_cvt_pk_bf16_f32 v144, v56, v57
    v_cvt_pk_bf16_f32 v145, v58, v59
    v_cvt_pk_bf16_f32 v146, v60, v61
    v_cvt_pk_bf16_f32 v147, v62, v63
    v_exp_f32 v65, v65
    v_exp_f32 v66, v66
    v_exp_f32 v67, v67
    v_mfma_f32_32x32x16_bf16 v[88:103], v[128:131], v[144:147], v[88:103]
    v_exp_f32 v68, v68
    v_exp_f32 v69, v69
    v_exp_f32 v70, v70
    v_exp_f32 v71, v71
    v_cvt_pk_bf16_f32 v148, v64, v65
    v_cvt_pk_bf16_f32 v149, v66, v67
    v_cvt_pk_bf16_f32 v150, v68, v69
    v_cvt_pk_bf16_f32 v151, v70, v71
    v_exp_f32 v72, v72
    v_exp_f32 v73, v73
    v_mfma_f32_32x32x16_bf16 v[88:103], v[132:135], v[148:151], v[88:103]
    v_exp_f32 v74, v74
    v_exp_f32 v75, v75
    v_exp_f32 v76, v76
    s_waitcnt lgkmcnt(0)
    v_mfma_f32_32x32x16_bf16 v[56:71], v[124:127], v[8:11], v[24:39]
    buffer_load_dwordx4 v[200:203], v2, s[28:31], s62 offen offset:2048 sc1
    buffer_load_dwordx4 v[204:207], v2, s[28:31], s62 offen offset:3072 sc1
    v_exp_f32 v77, v77
    v_exp_f32 v78, v78
    v_exp_f32 v79, v79
    v_exp_f32 v80, v80
    v_cvt_pk_bf16_f32 v152, v72, v73
    v_cvt_pk_bf16_f32 v153, v74, v75
    v_cvt_pk_bf16_f32 v154, v76, v77
    v_cvt_pk_bf16_f32 v155, v78, v79
    v_exp_f32 v81, v81
    v_exp_f32 v82, v82
    v_exp_f32 v83, v83
    v_mfma_f32_32x32x16_bf16 v[104:119], v[128:131], v[152:155], v[104:119]
    v_exp_f32 v84, v84
    v_exp_f32 v85, v85
    v_exp_f32 v86, v86
    v_exp_f32 v87, v87
    v_cvt_pk_bf16_f32 v156, v80, v81
    v_cvt_pk_bf16_f32 v157, v82, v83
    v_cvt_pk_bf16_f32 v158, v84, v85
    v_cvt_pk_bf16_f32 v159, v86, v87
    v_exp_f32 v56, v56
    v_exp_f32 v57, v57
    v_mfma_f32_32x32x16_bf16 v[104:119], v[132:135], v[156:159], v[104:119]
    v_exp_f32 v58, v58
    v_exp_f32 v59, v59
    v_exp_f32 v60, v60
    v_mfma_f32_32x32x16_bf16 v[72:87], v[124:127], v[12:15], v[40:55]
    ds_read_b128 v[120:123], v2 offset:26624
    s_mov_b64 exec, s[96:97]
    ds_read_b128 v[128:131], v21 offset:30720
    ds_read_b128 v[132:135], v21 offset:31232
    s_mov_b64 exec, -1
    s_add_u32 s62, s62, 4096
    buffer_load_dwordx4 v[208:211], v2, s[28:31], s62 offen offset:0 sc1
    buffer_load_dwordx4 v[212:215], v2, s[28:31], s62 offen offset:1024 sc1
    v_exp_f32 v61, v61
    v_exp_f32 v62, v62
    v_exp_f32 v63, v63
    v_exp_f32 v64, v64
    v_cvt_pk_bf16_f32 v144, v56, v57
    v_cvt_pk_bf16_f32 v145, v58, v59
    v_cvt_pk_bf16_f32 v146, v60, v61
    v_cvt_pk_bf16_f32 v147, v62, v63
    v_exp_f32 v65, v65
    v_exp_f32 v66, v66
    v_exp_f32 v67, v67
    v_mfma_f32_32x32x16_bf16 v[88:103], v[136:139], v[144:147], v[88:103]
    v_exp_f32 v68, v68
    v_exp_f32 v69, v69
    v_exp_f32 v70, v70
    v_exp_f32 v71, v71
    v_cvt_pk_bf16_f32 v148, v64, v65
    v_cvt_pk_bf16_f32 v149, v66, v67
    v_cvt_pk_bf16_f32 v150, v68, v69
    v_cvt_pk_bf16_f32 v151, v70, v71
    v_exp_f32 v72, v72
    v_exp_f32 v73, v73
    v_mfma_f32_32x32x16_bf16 v[88:103], v[140:143], v[148:151], v[88:103]
    v_exp_f32 v74, v74
    v_exp_f32 v75, v75
    v_exp_f32 v76, v76
    s_waitcnt lgkmcnt(0)
    v_mfma_f32_32x32x16_bf16 v[56:71], v[120:123], v[8:11], v[24:39]
    buffer_load_dwordx4 v[216:219], v2, s[28:31], s62 offen offset:2048 sc1
    buffer_load_dwordx4 v[220:223], v2, s[28:31], s62 offen offset:3072 sc1
    s_mov_b64 exec, 1
    ds_add_u32 v3, v4 offset:48
    s_mov_b64 exec, -1
    v_and_b32 v6, 31, v1
    v_lshlrev_b32 v6, 3, v6
    buffer_load_dwordx2 v[22:23], v6, s[28:31], s64 offen sc1
    v_exp_f32 v77, v77
    v_exp_f32 v78, v78
    v_exp_f32 v79, v79
    v_exp_f32 v80, v80
    v_cvt_pk_bf16_f32 v152, v72, v73
    v_cvt_pk_bf16_f32 v153, v74, v75
    v_cvt_pk_bf16_f32 v154, v76, v77
    v_cvt_pk_bf16_f32 v155, v78, v79
    v_exp_f32 v81, v81
    v_exp_f32 v82, v82
    v_exp_f32 v83, v83
    v_mfma_f32_32x32x16_bf16 v[104:119], v[136:139], v[152:155], v[104:119]
    v_exp_f32 v84, v84
    v_exp_f32 v85, v85
    v_exp_f32 v86, v86
    v_exp_f32 v87, v87
    v_cvt_pk_bf16_f32 v156, v80, v81
    v_cvt_pk_bf16_f32 v157, v82, v83
    v_cvt_pk_bf16_f32 v158, v84, v85
    v_cvt_pk_bf16_f32 v159, v86, v87
    v_exp_f32 v56, v56
    v_exp_f32 v57, v57
    v_mfma_f32_32x32x16_bf16 v[104:119], v[140:143], v[156:159], v[104:119]
    v_exp_f32 v58, v58
    v_exp_f32 v59, v59
    v_exp_f32 v60, v60
    v_mfma_f32_32x32x16_bf16 v[72:87], v[120:123], v[12:15], v[40:55]
    ds_read_b128 v[124:127], v2 offset:27648
    s_mov_b64 exec, s[96:97]
    ds_read_b128 v[136:139], v21 offset:31744
    ds_read_b128 v[140:143], v21 offset:32256
    s_mov_b64 exec, -1
    s_add_u32 s74, s63, 4096
    buffer_load_dwordx4 v[224:227], v2, s[28:31], s63 offen offset:0 sc1
    buffer_load_dwordx4 v[228:231], v2, s[28:31], s63 offen offset:1024 sc1
    v_exp_f32 v61, v61
    v_exp_f32 v62, v62
    v_exp_f32 v63, v63
    v_exp_f32 v64, v64
    v_cvt_pk_bf16_f32 v144, v56, v57
    v_cvt_pk_bf16_f32 v145, v58, v59
    v_cvt_pk_bf16_f32 v146, v60, v61
    v_cvt_pk_bf16_f32 v147, v62, v63
    v_exp_f32 v65, v65
    v_exp_f32 v66, v66
    v_exp_f32 v67, v67
    v_mfma_f32_32x32x16_bf16 v[88:103], v[128:131], v[144:147], v[88:103]
    v_exp_f32 v68, v68
    v_exp_f32 v69, v69
    v_exp_f32 v70, v70
    v_exp_f32 v71, v71
    v_cvt_pk_bf16_f32 v148, v64, v65
    v_cvt_pk_bf16_f32 v149, v66, v67
    v_cvt_pk_bf16_f32 v150, v68, v69
    v_cvt_pk_bf16_f32 v151, v70, v71
    v_exp_f32 v72, v72
    v_exp_f32 v73, v73
    v_mfma_f32_32x32x16_bf16 v[88:103], v[132:135], v[148:151], v[88:103]
    v_exp_f32 v74, v74
    v_exp_f32 v75, v75
    v_exp_f32 v76, v76
    s_waitcnt lgkmcnt(0)
    v_mfma_f32_32x32x16_bf16 v[56:71], v[124:127], v[8:11], v[24:39]
    buffer_load_dwordx4 v[232:235], v2, s[28:31], s63 offen offset:2048 sc1
    buffer_load_dwordx4 v[236:239], v2, s[28:31], s63 offen offset:3072 sc1
    v_exp_f32 v77, v77
    v_exp_f32 v78, v78
    v_exp_f32 v79, v79
    v_exp_f32 v80, v80
    v_cvt_pk_bf16_f32 v152, v72, v73
    v_cvt_pk_bf16_f32 v153, v74, v75
    v_cvt_pk_bf16_f32 v154, v76, v77
    v_cvt_pk_bf16_f32 v155, v78, v79
    v_exp_f32 v81, v81
    v_exp_f32 v82, v82
    v_exp_f32 v83, v83
    v_mfma_f32_32x32x16_bf16 v[104:119], v[128:131], v[152:155], v[104:119]
    v_exp_f32 v84, v84
    v_exp_f32 v85, v85
    v_exp_f32 v86, v86
    v_exp_f32 v87, v87
    v_cvt_pk_bf16_f32 v156, v80, v81
    v_cvt_pk_bf16_f32 v157, v82, v83
    v_cvt_pk_bf16_f32 v158, v84, v85
    v_cvt_pk_bf16_f32 v159, v86, v87
    v_exp_f32 v56, v56
    v_exp_f32 v57, v57
    v_mfma_f32_32x32x16_bf16 v[104:119], v[132:135], v[156:159], v[104:119]
    v_exp_f32 v58, v58
    v_exp_f32 v59, v59
    v_exp_f32 v60, v60
    v_mfma_f32_32x32x16_bf16 v[72:87], v[124:127], v[12:15], v[40:55]
    buffer_load_dwordx4 v[240:243], v2, s[28:31], s74 offen offset:0 sc1
    buffer_load_dwordx4 v[244:247], v2, s[28:31], s74 offen offset:1024 sc1
    v_exp_f32 v61, v61
    v_exp_f32 v62, v62
    v_exp_f32 v63, v63
    v_exp_f32 v64, v64
    v_cvt_pk_bf16_f32 v144, v56, v57
    v_cvt_pk_bf16_f32 v145, v58, v59
    v_cvt_pk_bf16_f32 v146, v60, v61
    v_cvt_pk_bf16_f32 v147, v62, v63
    v_exp_f32 v65, v65
    v_exp_f32 v66, v66
    v_exp_f32 v67, v67
    v_mfma_f32_32x32x16_bf16 v[88:103], v[136:139], v[144:147], v[88:103]
    v_exp_f32 v68, v68
    v_exp_f32 v69, v69
    v_exp_f32 v70, v70
    v_exp_f32 v71, v71
    v_cvt_pk_bf16_f32 v148, v64, v65
    v_cvt_pk_bf16_f32 v149, v66, v67
    v_cvt_pk_bf16_f32 v150, v68, v69
    v_cvt_pk_bf16_f32 v151, v70, v71
    v_exp_f32 v72, v72
    v_exp_f32 v73, v73
    v_mfma_f32_32x32x16_bf16 v[88:103], v[140:143], v[148:151], v[88:103]
    v_exp_f32 v74, v74
    v_exp_f32 v75, v75
    v_exp_f32 v76, v76
    s_waitcnt lgkmcnt(0)
    buffer_load_dwordx4 v[248:251], v2, s[28:31], s74 offen offset:2048 sc1
    buffer_load_dwordx4 v[252:255], v2, s[28:31], s74 offen offset:3072 sc1
    v_exp_f32 v77, v77
    v_exp_f32 v78, v78
    v_exp_f32 v79, v79
    v_exp_f32 v80, v80
    v_cvt_pk_bf16_f32 v152, v72, v73
    v_cvt_pk_bf16_f32 v153, v74, v75
    v_cvt_pk_bf16_f32 v154, v76, v77
    v_cvt_pk_bf16_f32 v155, v78, v79
    v_exp_f32 v81, v81
    v_exp_f32 v82, v82
    v_exp_f32 v83, v83
    v_mfma_f32_32x32x16_bf16 v[104:119], v[136:139], v[152:155], v[104:119]
    v_exp_f32 v84, v84
    v_exp_f32 v85, v85
    v_exp_f32 v86, v86
    v_exp_f32 v87, v87
    v_cvt_pk_bf16_f32 v156, v80, v81
    v_cvt_pk_bf16_f32 v157, v82, v83
    v_cvt_pk_bf16_f32 v158, v84, v85
    v_cvt_pk_bf16_f32 v159, v86, v87
    s_nop 1
    v_mfma_f32_32x32x16_bf16 v[104:119], v[140:143], v[156:159], v[104:119]
TAIL:
    s_setprio 1
    v_add_u32 v16, s72, v2
    v_add_u32 v17, s73, v2
    s_lshl_b32 s52, s44, 2
    v_add_u32 v19, s52, v3
    s_mov_b32 s70, 0x4f800000
    s_add_u32 s74, s63, 4096
    s_mov_b32 s24, s20
    s_mov_b32 s25, s21
    s_mov_b32 s26, 0x200000
    s_mov_b32 s27, 0x00020000
    v_cmp_gt_f32 vcc, s70, v96
    v_cmp_gt_f32 s[98:99], s70, v112
    s_and_b64 vcc, vcc, s[98:99]
    s_cmp_eq_u64 vcc, -1
    s_cbranch_scc0 A_FALL
A_FIN:
    v_mov_b32 v113, v40
    ds_write_b128 v16, v[104:107]
    ds_write_b128 v16, v[108:111] offset:1024
    ds_write_b64 v16, v[112:113] offset:2048
    s_mov_b64 exec, 1
    ds_write_b32 v19, v4 offset:16
    s_mov_b64 exec, -1
    v_xor_b32 v19, 16, v19
LW_159:
    ds_read_b32 v6, v19 offset:16
    s_waitcnt lgkmcnt(0)
    v_readfirstlane_b32 s70, v6
    s_cmp_ge_u32 s70, 1
    s_cbranch_scc1 LD_160
    s_sub_u32 s3, s3, 1
    s_cmp_lt_i32 s3, 0
    s_cbranch_scc1 LD_160
    s_branch LW_159
LD_160:
    ds_read_b64 v[64:65], v17 offset:2048
    ds_read_b128 v[56:59], v17
    ds_read_b128 v[60:63], v17 offset:1024
    s_waitcnt lgkmcnt(2)
    v_min_f32 v72, v24, v65
    v_sub_f32 v73, v72, v65
    v_sub_f32 v72, v72, v24
    v_exp_f32 v72, v72
    v_exp_f32 v73, v73
    v_mul_f32 v6, v72, v96
    v_fma_f32 v6, v73, v64, v6
    v_rcp_f32 v6, v6
    s_nop 0
    v_mul_f32 v72, v72, v6
    v_mul_f32 v73, v73, v6
    v_mul_f32 v88, v72, v88
    v_mul_f32 v89, v72, v89
    v_mul_f32 v90, v72, v90
    v_mul_f32 v91, v72, v91
    v_mul_f32 v92, v72, v92
    v_mul_f32 v93, v72, v93
    v_mul_f32 v94, v72, v94
    v_mul_f32 v95, v72, v95
    s_waitcnt lgkmcnt(0)
    v_fma_f32 v88, v73, v56, v88
    v_fma_f32 v89, v73, v57, v89
    v_fma_f32 v90, v73, v58, v90
    v_fma_f32 v91, v73, v59, v91
    v_fma_f32 v92, v73, v60, v92
    v_fma_f32 v93, v73, v61, v93
    v_fma_f32 v94, v73, v62, v94
    v_fma_f32 v95, v73, v63, v95
    v_cvt_pk_bf16_f32 v144, v88, v89
    v_cvt_pk_bf16_f32 v145, v90, v91
    v_cvt_pk_bf16_f32 v146, v92, v93
    v_cvt_pk_bf16_f32 v147, v94, v95
    buffer_store_dwordx4 v[144:147], v2, s[28:31], s58 offen sc1
    s_setprio 0
    s_movk_i32 s66, 0xff
    v_mov_b32 v24, 0
    v_mov_b32 v25, 0
    v_mov_b32 v26, 0
    v_mov_b32 v27, 0
    v_mov_b32 v28, 0
    v_mov_b32 v29, 0
    v_mov_b32 v30, 0
    v_mov_b32 v31, 0
    v_mov_b32 v32, 0
    v_mov_b32 v33, 0
    v_mov_b32 v34, 0
    v_mov_b32 v35, 0
    v_mov_b32 v36, 0
    v_mov_b32 v37, 0
    v_mov_b32 v38, 0
    v_mov_b32 v39, 0
    v_mov_b32 v40, 0
    v_mov_b32 v41, 0
    v_mov_b32 v42, 0
    v_mov_b32 v43, 0
    v_mov_b32 v44, 0
    v_mov_b32 v45, 0
    v_mov_b32 v46, 0
    v_mov_b32 v47, 0
    v_mov_b32 v48, 0
    v_mov_b32 v49, 0
    v_mov_b32 v50, 0
    v_mov_b32 v51, 0
    v_mov_b32 v52, 0
    v_mov_b32 v53, 0
    v_mov_b32 v54, 0
    v_mov_b32 v55, 0
    s_waitcnt vmcnt(1)
    v_cmp_ne_u32 vcc, -1, v224
    s_cmp_eq_u64 vcc, -1
    s_cbranch_scc0 T_K00
    v_mfma_f32_32x32x16_bf16 v[24:39], v[160:163], v[224:227], v[24:39]
    v_mfma_f32_32x32x16_bf16 v[40:55], v[164:167], v[224:227], v[40:55]
    s_bitset0_b32 s66, 0
T_K00:
    v_cmp_ne_u32 vcc, -1, v228
    s_cmp_eq_u64 vcc, -1
    s_cbranch_scc0 T_K01
    v_mfma_f32_32x32x16_bf16 v[24:39], v[168:171], v[228:231], v[24:39]
    v_mfma_f32_32x32x16_bf16 v[40:55], v[172:175], v[228:231], v[40:55]
    s_bitset0_b32 s66, 1
T_K01:
    v_cmp_ne_u32 vcc, -1, v232
    s_cmp_eq_u64 vcc, -1
    s_cbranch_scc0 T_K02
    v_mfma_f32_32x32x16_bf16 v[24:39], v[176:179], v[232:235], v[24:39]
    v_mfma_f32_32x32x16_bf16 v[40:55], v[180:183], v[232:235], v[40:55]
    s_bitset0_b32 s66, 2
T_K02:
    v_cmp_ne_u32 vcc, -1, v236
    s_cmp_eq_u64 vcc, -1
    s_cbranch_scc0 T_K03
    v_mfma_f32_32x32x16_bf16 v[24:39], v[184:187], v[236:239], v[24:39]
    v_mfma_f32_32x32x16_bf16 v[40:55], v[188:191], v[236:239], v[40:55]
    s_bitset0_b32 s66, 3
T_K03:
    v_cmp_ne_u32 vcc, -1, v240
    s_cmp_eq_u64 vcc, -1
    s_cbranch_scc0 T_K04
    v_mfma_f32_32x32x16_bf16 v[24:39], v[192:195], v[240:243], v[24:39]
    v_mfma_f32_32x32x16_bf16 v[40:55], v[196:199], v[240:243], v[40:55]
    s_bitset0_b32 s66, 4
T_K04:
    v_cmp_ne_u32 vcc, -1, v244
    s_cmp_eq_u64 vcc, -1
    s_cbranch_scc0 T_K05
    v_mfma_f32_32x32x16_bf16 v[24:39], v[200:203], v[244:247], v[24:39]
    v_mfma_f32_32x32x16_bf16 v[40:55], v[204:207], v[244:247], v[40:55]
    s_bitset0_b32 s66, 5
T_K05:
    v_cmp_ne_u32 vcc, -1, v248
    s_cmp_eq_u64 vcc, -1
    s_cbranch_scc0 T_K06
    v_mfma_f32_32x32x16_bf16 v[24:39], v[208:211], v[248:251], v[24:39]
    v_mfma_f32_32x32x16_bf16 v[40:55], v[212:215], v[248:251], v[40:55]
    s_bitset0_b32 s66, 6
T_K06:
    v_cmp_ne_u32 vcc, -1, v252
    s_cmp_eq_u64 vcc, -1
    s_cbranch_scc0 T_K07
    v_mfma_f32_32x32x16_bf16 v[24:39], v[216:219], v[252:255], v[24:39]
    v_mfma_f32_32x32x16_bf16 v[40:55], v[220:223], v[252:255], v[40:55]
    s_bitset0_b32 s66, 7
T_K07:
    s_bitcmp1_b32 s66, 0
    s_cbranch_scc0 T_Q0
    buffer_load_dwordx4 v[224:227], v2, s[28:31], s63 offen offset:0 sc1
T_Q0:
    s_bitcmp1_b32 s66, 1
    s_cbranch_scc0 T_Q1
    buffer_load_dwordx4 v[228:231], v2, s[28:31], s63 offen offset:1024 sc1
T_Q1:
    s_bitcmp1_b32 s66, 2
    s_cbranch_scc0 T_Q2
    buffer_load_dwordx4 v[232:235], v2, s[28:31], s63 offen offset:2048 sc1
T_Q2:
    s_bitcmp1_b32 s66, 3
    s_cbranch_scc0 T_Q3
    buffer_load_dwordx4 v[236:239], v2, s[28:31], s63 offen offset:3072 sc1
T_Q3:
    s_bitcmp1_b32 s66, 4
    s_cbranch_scc0 T_Q4
    buffer_load_dwordx4 v[240:243], v2, s[28:31], s74 offen offset:0 sc1
T_Q4:
    s_bitcmp1_b32 s66, 5
    s_cbranch_scc0 T_Q5
    buffer_load_dwordx4 v[244:247], v2, s[28:31], s74 offen offset:1024 sc1
T_Q5:
    s_bitcmp1_b32 s66, 6
    s_cbranch_scc0 T_Q6
    buffer_load_dwordx4 v[248:251], v2, s[28:31], s74 offen offset:2048 sc1
T_Q6:
    s_bitcmp1_b32 s66, 7
    s_cbranch_scc0 T_Q7
    buffer_load_dwordx4 v[252:255], v2, s[28:31], s74 offen offset:3072 sc1
T_Q7:
LW_161:
    ds_read_b32 v6, v3 offset:48
    s_waitcnt lgkmcnt(0)
    v_readfirstlane_b32 s70, v6
    s_cmp_ge_u32 s70, 8
    s_cbranch_scc1 LD_162
    s_sub_u32 s3, s3, 1
    s_cmp_lt_i32 s3, 0
    s_cbranch_scc1 LD_162
    s_sleep 1
    s_branch LW_161
LD_162:
    s_lshl_b32 s52, s44, 10
    v_add_u32 v10, s52, v2
    v_add_u32 v11, 0x10000, v10
    v_add_u32 v12, 0x10000, v11
    ds_read_b128 v[56:59], v11 offset:0
    ds_read_b128 v[60:63], v12 offset:16384
    ds_read_b128 v[64:67], v12 offset:24576
    ds_read_b128 v[68:71], v10 offset:49152
    ds_read_b128 v[72:75], v11 offset:24576
    ds_read_b128 v[76:79], v10 offset:8192
    ds_read_b128 v[80:83], v11 offset:49152
    ds_read_b128 v[84:87], v11 offset:57344
T_GW:
    v_cmp_eq_u32 vcc, s94, v23
    s_cmp_eq_u64 vcc, -1
    s_cbranch_scc0 T_GS
T_GK:
    v_lshrrev_b32 v9, 16, v22
    v_sub_f32 v6, 1.0, v22
    v_cvt_pk_bf16_f32 v6, v6, v6
    v_lshrrev_b32 v7, 16, v6
    v_and_b32 v6, 0xffff0000, v6
    v_and_b32 v20, 31, v1
    v_lshlrev_b32 v20, 10, v20
    v_lshl_add_u32 v20, v5, 4, v20
    s_mul_i32 s52, s48, 98304
    s_add_u32 s52, s52, 32768
    s_add_u32 s53, s52, s56
    v_add_u32 v16, s53, v2
    s_lshl_b32 s53, s56, 2
    s_add_u32 s53, s53, s52
    v_add_u32 v17, s53, v2
    s_waitcnt lgkmcnt(7)
    v_dot2_f32_bf16 v120, v56, v7, 0
    v_dot2_f32_bf16 v124, v56, v6, 0
    v_dot2_f32_bf16 v121, v57, v7, 0
    v_dot2_f32_bf16 v125, v57, v6, 0
    v_dot2_f32_bf16 v122, v58, v7, 0
    v_dot2_f32_bf16 v126, v58, v6, 0
    v_dot2_f32_bf16 v123, v59, v7, 0
    v_dot2_f32_bf16 v127, v59, v6, 0
    s_waitcnt lgkmcnt(6)
    v_dot2_f32_bf16 v120, v60, v7, v120
    v_dot2_f32_bf16 v124, v60, v6, v124
    v_dot2_f32_bf16 v121, v61, v7, v121
    v_dot2_f32_bf16 v125, v61, v6, v125
    v_dot2_f32_bf16 v122, v62, v7, v122
    v_dot2_f32_bf16 v126, v62, v6, v126
    v_dot2_f32_bf16 v123, v63, v7, v123
    v_dot2_f32_bf16 v127, v63, v6, v127
    s_waitcnt lgkmcnt(5)
    v_dot2_f32_bf16 v120, v64, v7, v120
    v_dot2_f32_bf16 v124, v64, v6, v124
    v_dot2_f32_bf16 v121, v65, v7, v121
    v_dot2_f32_bf16 v125, v65, v6, v125
    v_dot2_f32_bf16 v122, v66, v7, v122
    v_dot2_f32_bf16 v126, v66, v6, v126
    v_dot2_f32_bf16 v123, v67, v7, v123
    v_dot2_f32_bf16 v127, v67, v6, v127
    s_waitcnt lgkmcnt(4)
    v_dot2_f32_bf16 v120, v68, v7, v120
    v_dot2_f32_bf16 v124, v68, v6, v124
    v_dot2_f32_bf16 v121, v69, v7, v121
    v_dot2_f32_bf16 v125, v69, v6, v125
    v_dot2_f32_bf16 v122, v70, v7, v122
    v_dot2_f32_bf16 v126, v70, v6, v126
    v_dot2_f32_bf16 v123, v71, v7, v123
    v_dot2_f32_bf16 v127, v71, v6, v127
    s_waitcnt lgkmcnt(3)
    v_dot2_f32_bf16 v120, v72, v7, v120
    v_dot2_f32_bf16 v124, v72, v6, v124
    v_dot2_f32_bf16 v121, v73, v7, v121
    v_dot2_f32_bf16 v125, v73, v6, v125
    v_dot2_f32_bf16 v122, v74, v7, v122
    v_dot2_f32_bf16 v126, v74, v6, v126
    v_dot2_f32_bf16 v123, v75, v7, v123
    v_dot2_f32_bf16 v127, v75, v6, v127
    s_waitcnt lgkmcnt(2)
    v_dot2_f32_bf16 v120, v76, v7, v120
    v_dot2_f32_bf16 v124, v76, v6, v124
    v_dot2_f32_bf16 v121, v77, v7, v121
    v_dot2_f32_bf16 v125, v77, v6, v125
    v_dot2_f32_bf16 v122, v78, v7, v122
    v_dot2_f32_bf16 v126, v78, v6, v126
    v_dot2_f32_bf16 v123, v79, v7, v123
    v_dot2_f32_bf16 v127, v79, v6, v127
    s_waitcnt lgkmcnt(1)
    v_dot2_f32_bf16 v120, v80, v7, v120
    v_dot2_f32_bf16 v124, v80, v6, v124
    v_dot2_f32_bf16 v121, v81, v7, v121
    v_dot2_f32_bf16 v125, v81, v6, v125
    v_dot2_f32_bf16 v122, v82, v7, v122
    v_dot2_f32_bf16 v126, v82, v6, v126
    v_dot2_f32_bf16 v123, v83, v7, v123
    v_dot2_f32_bf16 v127, v83, v6, v127
    s_waitcnt lgkmcnt(0)
    v_dot2_f32_bf16 v120, v84, v7, v120
    v_dot2_f32_bf16 v124, v84, v6, v124
    v_dot2_f32_bf16 v121, v85, v7, v121
    v_dot2_f32_bf16 v125, v85, v6, v125
    v_dot2_f32_bf16 v122, v86, v7, v122
    v_dot2_f32_bf16 v126, v86, v6, v126
    v_dot2_f32_bf16 v123, v87, v7, v123
    v_dot2_f32_bf16 v127, v87, v6, v127
    s_cmp_eq_u32 s66, 0
    s_cbranch_scc1 T_D
    s_branch T_W
T_L:
    s_cmp_eq_u32 s66, 0
    s_cbranch_scc1 T_D
    s_sub_u32 s3, s3, 32
    s_cmp_lt_i32 s3, 0
    s_cbranch_scc1 T_D
    s_andn2_b32 s52, s66, 3
    s_cbranch_scc0 PP0
    s_andn2_b32 s52, s66, 12
    s_cbranch_scc0 PP1
    s_andn2_b32 s52, s66, 48
    s_cbranch_scc0 PP2
    s_andn2_b32 s52, s66, 192
    s_cbranch_scc0 PP3
    s_sleep 6
    s_bitcmp1_b32 s66, 0
    s_cbranch_scc0 T_R0
    buffer_load_dwordx4 v[224:227], v2, s[28:31], s63 offen offset:0 sc1
T_R0:
    s_bitcmp1_b32 s66, 1
    s_cbranch_scc0 T_R1
    buffer_load_dwordx4 v[228:231], v2, s[28:31], s63 offen offset:1024 sc1
T_R1:
    s_bitcmp1_b32 s66, 2
    s_cbranch_scc0 T_R2
    buffer_load_dwordx4 v[232:235], v2, s[28:31], s63 offen offset:2048 sc1
T_R2:
    s_bitcmp1_b32 s66, 3
    s_cbranch_scc0 T_R3
    buffer_load_dwordx4 v[236:239], v2, s[28:31], s63 offen offset:3072 sc1
T_R3:
    s_bitcmp1_b32 s66, 4
    s_cbranch_scc0 T_R4
    buffer_load_dwordx4 v[240:243], v2, s[28:31], s74 offen offset:0 sc1
T_R4:
    s_bitcmp1_b32 s66, 5
    s_cbranch_scc0 T_R5
    buffer_load_dwordx4 v[244:247], v2, s[28:31], s74 offen offset:1024 sc1
T_R5:
    s_bitcmp1_b32 s66, 6
    s_cbranch_scc0 T_R6
    buffer_load_dwordx4 v[248:251], v2, s[28:31], s74 offen offset:2048 sc1
T_R6:
    s_bitcmp1_b32 s66, 7
    s_cbranch_scc0 T_R7
    buffer_load_dwordx4 v[252:255], v2, s[28:31], s74 offen offset:3072 sc1
T_R7:
T_W:
    s_waitcnt vmcnt(0)
    s_bitcmp1_b32 s66, 0
    s_cbranch_scc0 T_K10
    v_cmp_ne_u32 vcc, -1, v224
    s_cmp_eq_u64 vcc, -1
    s_cbranch_scc0 T_K10
    v_mfma_f32_32x32x16_bf16 v[24:39], v[160:163], v[224:227], v[24:39]
    v_mfma_f32_32x32x16_bf16 v[40:55], v[164:167], v[224:227], v[40:55]
    s_bitset0_b32 s66, 0
T_K10:
    s_bitcmp1_b32 s66, 1
    s_cbranch_scc0 T_K11
    v_cmp_ne_u32 vcc, -1, v228
    s_cmp_eq_u64 vcc, -1
    s_cbranch_scc0 T_K11
    v_mfma_f32_32x32x16_bf16 v[24:39], v[168:171], v[228:231], v[24:39]
    v_mfma_f32_32x32x16_bf16 v[40:55], v[172:175], v[228:231], v[40:55]
    s_bitset0_b32 s66, 1
T_K11:
    s_bitcmp1_b32 s66, 2
    s_cbranch_scc0 T_K12
    v_cmp_ne_u32 vcc, -1, v232
    s_cmp_eq_u64 vcc, -1
    s_cbranch_scc0 T_K12
    v_mfma_f32_32x32x16_bf16 v[24:39], v[176:179], v[232:235], v[24:39]
    v_mfma_f32_32x32x16_bf16 v[40:55], v[180:183], v[232:235], v[40:55]
    s_bitset0_b32 s66, 2
T_K12:
    s_bitcmp1_b32 s66, 3
    s_cbranch_scc0 T_K13
    v_cmp_ne_u32 vcc, -1, v236
    s_cmp_eq_u64 vcc, -1
    s_cbranch_scc0 T_K13
    v_mfma_f32_32x32x16_bf16 v[24:39], v[184:187], v[236:239], v[24:39]
    v_mfma_f32_32x32x16_bf16 v[40:55], v[188:191], v[236:239], v[40:55]
    s_bitset0_b32 s66, 3
T_K13:
    s_bitcmp1_b32 s66, 4
    s_cbranch_scc0 T_K14
    v_cmp_ne_u32 vcc, -1, v240
    s_cmp_eq_u64 vcc, -1
    s_cbranch_scc0 T_K14
    v_mfma_f32_32x32x16_bf16 v[24:39], v[192:195], v[240:243], v[24:39]
    v_mfma_f32_32x32x16_bf16 v[40:55], v[196:199], v[240:243], v[40:55]
    s_bitset0_b32 s66, 4
T_K14:
    s_bitcmp1_b32 s66, 5
    s_cbranch_scc0 T_K15
    v_cmp_ne_u32 vcc, -1, v244
    s_cmp_eq_u64 vcc, -1
    s_cbranch_scc0 T_K15
    v_mfma_f32_32x32x16_bf16 v[24:39], v[200:203], v[244:247], v[24:39]
    v_mfma_f32_32x32x16_bf16 v[40:55], v[204:207], v[244:247], v[40:55]
    s_bitset0_b32 s66, 5
T_K15:
    s_bitcmp1_b32 s66, 6
    s_cbranch_scc0 T_K16
    v_cmp_ne_u32 vcc, -1, v248
    s_cmp_eq_u64 vcc, -1
    s_cbranch_scc0 T_K16
    v_mfma_f32_32x32x16_bf16 v[24:39], v[208:211], v[248:251], v[24:39]
    v_mfma_f32_32x32x16_bf16 v[40:55], v[212:215], v[248:251], v[40:55]
    s_bitset0_b32 s66, 6
T_K16:
    s_bitcmp1_b32 s66, 7
    s_cbranch_scc0 T_K17
    v_cmp_ne_u32 vcc, -1, v252
    s_cmp_eq_u64 vcc, -1
    s_cbranch_scc0 T_K17
    v_mfma_f32_32x32x16_bf16 v[24:39], v[216:219], v[252:255], v[24:39]
    v_mfma_f32_32x32x16_bf16 v[40:55], v[220:223], v[252:255], v[40:55]
    s_bitset0_b32 s66, 7
T_K17:
    s_branch T_L
T_D:
    s_nop 7
    s_nop 7
    v_cvt_pk_bf16_f32 v144, v24, v40
    v_cvt_pk_bf16_f32 v145, v25, v41
    v_cvt_pk_bf16_f32 v146, v26, v42
    v_cvt_pk_bf16_f32 v147, v27, v43
    ds_write_b128 v16, v[144:147] offset:0
    v_cvt_pk_bf16_f32 v148, v28, v44
    v_cvt_pk_bf16_f32 v149, v29, v45
    v_cvt_pk_bf16_f32 v150, v30, v46
    v_cvt_pk_bf16_f32 v151, v31, v47
    ds_write_b128 v16, v[148:151] offset:4096
    v_cvt_pk_bf16_f32 v152, v32, v48
    v_cvt_pk_bf16_f32 v153, v33, v49
    v_cvt_pk_bf16_f32 v154, v34, v50
    v_cvt_pk_bf16_f32 v155, v35, v51
    ds_write_b128 v16, v[152:155] offset:8192
    v_cvt_pk_bf16_f32 v156, v36, v52
    v_cvt_pk_bf16_f32 v157, v37, v53
    v_cvt_pk_bf16_f32 v158, v38, v54
    v_cvt_pk_bf16_f32 v159, v39, v55
    ds_write_b128 v16, v[156:159] offset:12288
    s_waitcnt lgkmcnt(0)
    s_barrier
    ds_read_b128 v[56:59], v17 offset:0
    ds_read_b128 v[60:63], v17 offset:1024
    ds_read_b128 v[64:67], v17 offset:2048
    ds_read_b128 v[68:71], v17 offset:3072
    s_waitcnt lgkmcnt(3)
    v_dot2_f32_bf16 v120, v56, v9, v120
    v_dot2_f32_bf16 v124, v56, v22, v124
    v_dot2_f32_bf16 v121, v57, v9, v121
    v_dot2_f32_bf16 v125, v57, v22, v125
    v_dot2_f32_bf16 v122, v58, v9, v122
    v_dot2_f32_bf16 v126, v58, v22, v126
    v_dot2_f32_bf16 v123, v59, v9, v123
    v_dot2_f32_bf16 v127, v59, v22, v127
    s_waitcnt lgkmcnt(2)
    v_dot2_f32_bf16 v120, v60, v9, v120
    v_dot2_f32_bf16 v124, v60, v22, v124
    v_dot2_f32_bf16 v121, v61, v9, v121
    v_dot2_f32_bf16 v125, v61, v22, v125
    v_dot2_f32_bf16 v122, v62, v9, v122
    v_dot2_f32_bf16 v126, v62, v22, v126
    v_dot2_f32_bf16 v123, v63, v9, v123
    v_dot2_f32_bf16 v127, v63, v22, v127
    s_waitcnt lgkmcnt(1)
    v_dot2_f32_bf16 v120, v64, v9, v120
    v_dot2_f32_bf16 v124, v64, v22, v124
    v_dot2_f32_bf16 v121, v65, v9, v121
    v_dot2_f32_bf16 v125, v65, v22, v125
    v_dot2_f32_bf16 v122, v66, v9, v122
    v_dot2_f32_bf16 v126, v66, v22, v126
    v_dot2_f32_bf16 v123, v67, v9, v123
    v_dot2_f32_bf16 v127, v67, v22, v127
    s_waitcnt lgkmcnt(0)
    v_dot2_f32_bf16 v120, v68, v9, v120
    v_dot2_f32_bf16 v124, v68, v22, v124
    v_dot2_f32_bf16 v121, v69, v9, v121
    v_dot2_f32_bf16 v125, v69, v22, v125
    v_dot2_f32_bf16 v122, v70, v9, v122
    v_dot2_f32_bf16 v126, v70, v22, v126
    v_dot2_f32_bf16 v123, v71, v9, v123
    v_dot2_f32_bf16 v127, v71, v22, v127
    v_cvt_pk_bf16_f32 v144, v120, v124
    v_cvt_pk_bf16_f32 v145, v121, v125
    v_cvt_pk_bf16_f32 v146, v122, v126
    v_cvt_pk_bf16_f32 v147, v123, v127
    buffer_store_dwordx4 v[144:147], v20, s[24:27], s65 offen
    s_waitcnt vmcnt(0)
    s_endpgm
T_GS:
    s_sub_u32 s3, s3, 32
    s_cmp_lt_i32 s3, 0
    s_cbranch_scc1 T_GK
    v_and_b32 v6, 31, v1
    v_lshlrev_b32 v6, 3, v6
    buffer_load_dwordx2 v[22:23], v6, s[28:31], s64 offen sc1
    s_waitcnt vmcnt(0)
    s_branch T_GW
PP0:
    buffer_load_dwordx4 v[224:227], v2, s[28:31], s63 offen offset:0 sc1
    buffer_load_dwordx4 v[228:231], v2, s[28:31], s63 offen offset:1024 sc1
    s_sleep 3
    buffer_load_dwordx4 v[88:91], v2, s[28:31], s63 offen offset:0 sc1
    buffer_load_dwordx4 v[92:95], v2, s[28:31], s63 offen offset:1024 sc1
    s_sleep 3
PL0:
    buffer_load_dwordx4 v[96:99], v2, s[28:31], s63 offen offset:0 sc1
    buffer_load_dwordx4 v[100:103], v2, s[28:31], s63 offen offset:1024 sc1
    s_waitcnt vmcnt(4)
    v_cmp_ne_u32 vcc, -1, v224
    s_bitcmp1_b32 s66, 0
    s_cbranch_scc0 PK000
    s_cmp_eq_u64 vcc, -1
    s_cbranch_scc0 PK000
    v_mfma_f32_32x32x16_bf16 v[24:39], v[160:163], v[224:227], v[24:39]
    v_mfma_f32_32x32x16_bf16 v[40:55], v[164:167], v[224:227], v[40:55]
    s_bitset0_b32 s66, 0
PK000:
    v_cmp_ne_u32 vcc, -1, v228
    s_bitcmp1_b32 s66, 1
    s_cbranch_scc0 PK001
    s_cmp_eq_u64 vcc, -1
    s_cbranch_scc0 PK001
    v_mfma_f32_32x32x16_bf16 v[24:39], v[168:171], v[228:231], v[24:39]
    v_mfma_f32_32x32x16_bf16 v[40:55], v[172:175], v[228:231], v[40:55]
    s_bitset0_b32 s66, 1
PK001:
    s_cmp_eq_u32 s66, 0
    s_cbranch_scc1 T_D
    s_sub_u32 s3, s3, 16
    s_cmp_lt_i32 s3, 0
    s_cbranch_scc1 T_D
    s_sleep 3
    buffer_load_dwordx4 v[224:227], v2, s[28:31], s63 offen offset:0 sc1
    buffer_load_dwordx4 v[228:231], v2, s[28:31], s63 offen offset:1024 sc1
    s_waitcnt vmcnt(4)
    v_cmp_ne_u32 vcc, -1, v88
    s_bitcmp1_b32 s66, 0
    s_cbranch_scc0 PK010
    s_cmp_eq_u64 vcc, -1
    s_cbranch_scc0 PK010
    v_mfma_f32_32x32x16_bf16 v[24:39], v[160:163], v[88:91], v[24:39]
    v_mfma_f32_32x32x16_bf16 v[40:55], v[164:167], v[88:91], v[40:55]
    s_bitset0_b32 s66, 0
PK010:
    v_cmp_ne_u32 vcc, -1, v92
    s_bitcmp1_b32 s66, 1
    s_cbranch_scc0 PK011
    s_cmp_eq_u64 vcc, -1
    s_cbranch_scc0 PK011
    v_mfma_f32_32x32x16_bf16 v[24:39], v[168:171], v[92:95], v[24:39]
    v_mfma_f32_32x32x16_bf16 v[40:55], v[172:175], v[92:95], v[40:55]
    s_bitset0_b32 s66, 1
PK011:
    s_cmp_eq_u32 s66, 0
    s_cbranch_scc1 T_D
    s_sub_u32 s3, s3, 16
    s_cmp_lt_i32 s3, 0
    s_cbranch_scc1 T_D
    s_sleep 3
    buffer_load_dwordx4 v[88:91], v2, s[28:31], s63 offen offset:0 sc1
    buffer_load_dwordx4 v[92:95], v2, s[28:31], s63 offen offset:1024 sc1
    s_waitcnt vmcnt(4)
    v_cmp_ne_u32 vcc, -1, v96
    s_bitcmp1_b32 s66, 0
    s_cbranch_scc0 PK020
    s_cmp_eq_u64 vcc, -1
    s_cbranch_scc0 PK020
    v_mfma_f32_32x32x16_bf16 v[24:39], v[160:163], v[96:99], v[24:39]
    v_mfma_f32_32x32x16_bf16 v[40:55], v[164:167], v[96:99], v[40:55]
    s_bitset0_b32 s66, 0
PK020:
    v_cmp_ne_u32 vcc, -1, v100
    s_bitcmp1_b32 s66, 1
    s_cbranch_scc0 PK021
    s_cmp_eq_u64 vcc, -1
    s_cbranch_scc0 PK021
    v_mfma_f32_32x32x16_bf16 v[24:39], v[168:171], v[100:103], v[24:39]
    v_mfma_f32_32x32x16_bf16 v[40:55], v[172:175], v[100:103], v[40:55]
    s_bitset0_b32 s66, 1
PK021:
    s_cmp_eq_u32 s66, 0
    s_cbranch_scc1 T_D
    s_sub_u32 s3, s3, 16
    s_cmp_lt_i32 s3, 0
    s_cbranch_scc1 T_D
    s_sleep 3
    s_branch PL0
PP1:
    buffer_load_dwordx4 v[232:235], v2, s[28:31], s63 offen offset:2048 sc1
    buffer_load_dwordx4 v[236:239], v2, s[28:31], s63 offen offset:3072 sc1
    s_sleep 3
    buffer_load_dwordx4 v[88:91], v2, s[28:31], s63 offen offset:2048 sc1
    buffer_load_dwordx4 v[92:95], v2, s[28:31], s63 offen offset:3072 sc1
    s_sleep 3
PL1:
    buffer_load_dwordx4 v[96:99], v2, s[28:31], s63 offen offset:2048 sc1
    buffer_load_dwordx4 v[100:103], v2, s[28:31], s63 offen offset:3072 sc1
    s_waitcnt vmcnt(4)
    v_cmp_ne_u32 vcc, -1, v232
    s_bitcmp1_b32 s66, 2
    s_cbranch_scc0 PK100
    s_cmp_eq_u64 vcc, -1
    s_cbranch_scc0 PK100
    v_mfma_f32_32x32x16_bf16 v[24:39], v[176:179], v[232:235], v[24:39]
    v_mfma_f32_32x32x16_bf16 v[40:55], v[180:183], v[232:235], v[40:55]
    s_bitset0_b32 s66, 2
PK100:
    v_cmp_ne_u32 vcc, -1, v236
    s_bitcmp1_b32 s66, 3
    s_cbranch_scc0 PK101
    s_cmp_eq_u64 vcc, -1
    s_cbranch_scc0 PK101
    v_mfma_f32_32x32x16_bf16 v[24:39], v[184:187], v[236:239], v[24:39]
    v_mfma_f32_32x32x16_bf16 v[40:55], v[188:191], v[236:239], v[40:55]
    s_bitset0_b32 s66, 3
PK101:
    s_cmp_eq_u32 s66, 0
    s_cbranch_scc1 T_D
    s_sub_u32 s3, s3, 16
    s_cmp_lt_i32 s3, 0
    s_cbranch_scc1 T_D
    s_sleep 3
    buffer_load_dwordx4 v[232:235], v2, s[28:31], s63 offen offset:2048 sc1
    buffer_load_dwordx4 v[236:239], v2, s[28:31], s63 offen offset:3072 sc1
    s_waitcnt vmcnt(4)
    v_cmp_ne_u32 vcc, -1, v88
    s_bitcmp1_b32 s66, 2
    s_cbranch_scc0 PK110
    s_cmp_eq_u64 vcc, -1
    s_cbranch_scc0 PK110
    v_mfma_f32_32x32x16_bf16 v[24:39], v[176:179], v[88:91], v[24:39]
    v_mfma_f32_32x32x16_bf16 v[40:55], v[180:183], v[88:91], v[40:55]
    s_bitset0_b32 s66, 2
PK110:
    v_cmp_ne_u32 vcc, -1, v92
    s_bitcmp1_b32 s66, 3
    s_cbranch_scc0 PK111
    s_cmp_eq_u64 vcc, -1
    s_cbranch_scc0 PK111
    v_mfma_f32_32x32x16_bf16 v[24:39], v[184:187], v[92:95], v[24:39]
    v_mfma_f32_32x32x16_bf16 v[40:55], v[188:191], v[92:95], v[40:55]
    s_bitset0_b32 s66, 3
PK111:
    s_cmp_eq_u32 s66, 0
    s_cbranch_scc1 T_D
    s_sub_u32 s3, s3, 16
    s_cmp_lt_i32 s3, 0
    s_cbranch_scc1 T_D
    s_sleep 3
    buffer_load_dwordx4 v[88:91], v2, s[28:31], s63 offen offset:2048 sc1
    buffer_load_dwordx4 v[92:95], v2, s[28:31], s63 offen offset:3072 sc1
    s_waitcnt vmcnt(4)
    v_cmp_ne_u32 vcc, -1, v96
    s_bitcmp1_b32 s66, 2
    s_cbranch_scc0 PK120
    s_cmp_eq_u64 vcc, -1
    s_cbranch_scc0 PK120
    v_mfma_f32_32x32x16_bf16 v[24:39], v[176:179], v[96:99], v[24:39]
    v_mfma_f32_32x32x16_bf16 v[40:55], v[180:183], v[96:99], v[40:55]
    s_bitset0_b32 s66, 2
PK120:
    v_cmp_ne_u32 vcc, -1, v100
    s_bitcmp1_b32 s66, 3
    s_cbranch_scc0 PK121
    s_cmp_eq_u64 vcc, -1
    s_cbranch_scc0 PK121
    v_mfma_f32_32x32x16_bf16 v[24:39], v[184:187], v[100:103], v[24:39]
    v_mfma_f32_32x32x16_bf16 v[40:55], v[188:191], v[100:103], v[40:55]
    s_bitset0_b32 s66, 3
PK121:
    s_cmp_eq_u32 s66, 0
    s_cbranch_scc1 T_D
    s_sub_u32 s3, s3, 16
    s_cmp_lt_i32 s3, 0
    s_cbranch_scc1 T_D
    s_sleep 3
    s_branch PL1
PP2:
    buffer_load_dwordx4 v[240:243], v2, s[28:31], s74 offen offset:0 sc1
    buffer_load_dwordx4 v[244:247], v2, s[28:31], s74 offen offset:1024 sc1
    s_sleep 3
    buffer_load_dwordx4 v[88:91], v2, s[28:31], s74 offen offset:0 sc1
    buffer_load_dwordx4 v[92:95], v2, s[28:31], s74 offen offset:1024 sc1
    s_sleep 3
PL2:
    buffer_load_dwordx4 v[96:99], v2, s[28:31], s74 offen offset:0 sc1
    buffer_load_dwordx4 v[100:103], v2, s[28:31], s74 offen offset:1024 sc1
    s_waitcnt vmcnt(4)
    v_cmp_ne_u32 vcc, -1, v240
    s_bitcmp1_b32 s66, 4
    s_cbranch_scc0 PK200
    s_cmp_eq_u64 vcc, -1
    s_cbranch_scc0 PK200
    v_mfma_f32_32x32x16_bf16 v[24:39], v[192:195], v[240:243], v[24:39]
    v_mfma_f32_32x32x16_bf16 v[40:55], v[196:199], v[240:243], v[40:55]
    s_bitset0_b32 s66, 4
PK200:
    v_cmp_ne_u32 vcc, -1, v244
    s_bitcmp1_b32 s66, 5
    s_cbranch_scc0 PK201
    s_cmp_eq_u64 vcc, -1
    s_cbranch_scc0 PK201
    v_mfma_f32_32x32x16_bf16 v[24:39], v[200:203], v[244:247], v[24:39]
    v_mfma_f32_32x32x16_bf16 v[40:55], v[204:207], v[244:247], v[40:55]
    s_bitset0_b32 s66, 5
PK201:
    s_cmp_eq_u32 s66, 0
    s_cbranch_scc1 T_D
    s_sub_u32 s3, s3, 16
    s_cmp_lt_i32 s3, 0
    s_cbranch_scc1 T_D
    s_sleep 3
    buffer_load_dwordx4 v[240:243], v2, s[28:31], s74 offen offset:0 sc1
    buffer_load_dwordx4 v[244:247], v2, s[28:31], s74 offen offset:1024 sc1
    s_waitcnt vmcnt(4)
    v_cmp_ne_u32 vcc, -1, v88
    s_bitcmp1_b32 s66, 4
    s_cbranch_scc0 PK210
    s_cmp_eq_u64 vcc, -1
    s_cbranch_scc0 PK210
    v_mfma_f32_32x32x16_bf16 v[24:39], v[192:195], v[88:91], v[24:39]
    v_mfma_f32_32x32x16_bf16 v[40:55], v[196:199], v[88:91], v[40:55]
    s_bitset0_b32 s66, 4
PK210:
    v_cmp_ne_u32 vcc, -1, v92
    s_bitcmp1_b32 s66, 5
    s_cbranch_scc0 PK211
    s_cmp_eq_u64 vcc, -1
    s_cbranch_scc0 PK211
    v_mfma_f32_32x32x16_bf16 v[24:39], v[200:203], v[92:95], v[24:39]
    v_mfma_f32_32x32x16_bf16 v[40:55], v[204:207], v[92:95], v[40:55]
    s_bitset0_b32 s66, 5
PK211:
    s_cmp_eq_u32 s66, 0
    s_cbranch_scc1 T_D
    s_sub_u32 s3, s3, 16
    s_cmp_lt_i32 s3, 0
    s_cbranch_scc1 T_D
    s_sleep 3
    buffer_load_dwordx4 v[88:91], v2, s[28:31], s74 offen offset:0 sc1
    buffer_load_dwordx4 v[92:95], v2, s[28:31], s74 offen offset:1024 sc1
    s_waitcnt vmcnt(4)
    v_cmp_ne_u32 vcc, -1, v96
    s_bitcmp1_b32 s66, 4
    s_cbranch_scc0 PK220
    s_cmp_eq_u64 vcc, -1
    s_cbranch_scc0 PK220
    v_mfma_f32_32x32x16_bf16 v[24:39], v[192:195], v[96:99], v[24:39]
    v_mfma_f32_32x32x16_bf16 v[40:55], v[196:199], v[96:99], v[40:55]
    s_bitset0_b32 s66, 4
PK220:
    v_cmp_ne_u32 vcc, -1, v100
    s_bitcmp1_b32 s66, 5
    s_cbranch_scc0 PK221
    s_cmp_eq_u64 vcc, -1
    s_cbranch_scc0 PK221
    v_mfma_f32_32x32x16_bf16 v[24:39], v[200:203], v[100:103], v[24:39]
    v_mfma_f32_32x32x16_bf16 v[40:55], v[204:207], v[100:103], v[40:55]
    s_bitset0_b32 s66, 5
PK221:
    s_cmp_eq_u32 s66, 0
    s_cbranch_scc1 T_D
    s_sub_u32 s3, s3, 16
    s_cmp_lt_i32 s3, 0
    s_cbranch_scc1 T_D
    s_sleep 3
    s_branch PL2
PP3:
    buffer_load_dwordx4 v[248:251], v2, s[28:31], s74 offen offset:2048 sc1
    buffer_load_dwordx4 v[252:255], v2, s[28:31], s74 offen offset:3072 sc1
    s_sleep 3
    buffer_load_dwordx4 v[88:91], v2, s[28:31], s74 offen offset:2048 sc1
    buffer_load_dwordx4 v[92:95], v2, s[28:31], s74 offen offset:3072 sc1
    s_sleep 3
PL3:
    buffer_load_dwordx4 v[96:99], v2, s[28:31], s74 offen offset:2048 sc1
    buffer_load_dwordx4 v[100:103], v2, s[28:31], s74 offen offset:3072 sc1
    s_waitcnt vmcnt(4)
    v_cmp_ne_u32 vcc, -1, v248
    s_bitcmp1_b32 s66, 6
    s_cbranch_scc0 PK300
    s_cmp_eq_u64 vcc, -1
    s_cbranch_scc0 PK300
    v_mfma_f32_32x32x16_bf16 v[24:39], v[208:211], v[248:251], v[24:39]
    v_mfma_f32_32x32x16_bf16 v[40:55], v[212:215], v[248:251], v[40:55]
    s_bitset0_b32 s66, 6
PK300:
    v_cmp_ne_u32 vcc, -1, v252
    s_bitcmp1_b32 s66, 7
    s_cbranch_scc0 PK301
    s_cmp_eq_u64 vcc, -1
    s_cbranch_scc0 PK301
    v_mfma_f32_32x32x16_bf16 v[24:39], v[216:219], v[252:255], v[24:39]
    v_mfma_f32_32x32x16_bf16 v[40:55], v[220:223], v[252:255], v[40:55]
    s_bitset0_b32 s66, 7
PK301:
    s_cmp_eq_u32 s66, 0
    s_cbranch_scc1 T_D
    s_sub_u32 s3, s3, 16
    s_cmp_lt_i32 s3, 0
    s_cbranch_scc1 T_D
    s_sleep 3
    buffer_load_dwordx4 v[248:251], v2, s[28:31], s74 offen offset:2048 sc1
    buffer_load_dwordx4 v[252:255], v2, s[28:31], s74 offen offset:3072 sc1
    s_waitcnt vmcnt(4)
    v_cmp_ne_u32 vcc, -1, v88
    s_bitcmp1_b32 s66, 6
    s_cbranch_scc0 PK310
    s_cmp_eq_u64 vcc, -1
    s_cbranch_scc0 PK310
    v_mfma_f32_32x32x16_bf16 v[24:39], v[208:211], v[88:91], v[24:39]
    v_mfma_f32_32x32x16_bf16 v[40:55], v[212:215], v[88:91], v[40:55]
    s_bitset0_b32 s66, 6
PK310:
    v_cmp_ne_u32 vcc, -1, v92
    s_bitcmp1_b32 s66, 7
    s_cbranch_scc0 PK311
    s_cmp_eq_u64 vcc, -1
    s_cbranch_scc0 PK311
    v_mfma_f32_32x32x16_bf16 v[24:39], v[216:219], v[92:95], v[24:39]
    v_mfma_f32_32x32x16_bf16 v[40:55], v[220:223], v[92:95], v[40:55]
    s_bitset0_b32 s66, 7
PK311:
    s_cmp_eq_u32 s66, 0
    s_cbranch_scc1 T_D
    s_sub_u32 s3, s3, 16
    s_cmp_lt_i32 s3, 0
    s_cbranch_scc1 T_D
    s_sleep 3
    buffer_load_dwordx4 v[88:91], v2, s[28:31], s74 offen offset:2048 sc1
    buffer_load_dwordx4 v[92:95], v2, s[28:31], s74 offen offset:3072 sc1
    s_waitcnt vmcnt(4)
    v_cmp_ne_u32 vcc, -1, v96
    s_bitcmp1_b32 s66, 6
    s_cbranch_scc0 PK320
    s_cmp_eq_u64 vcc, -1
    s_cbranch_scc0 PK320
    v_mfma_f32_32x32x16_bf16 v[24:39], v[208:211], v[96:99], v[24:39]
    v_mfma_f32_32x32x16_bf16 v[40:55], v[212:215], v[96:99], v[40:55]
    s_bitset0_b32 s66, 6
PK320:
    v_cmp_ne_u32 vcc, -1, v100
    s_bitcmp1_b32 s66, 7
    s_cbranch_scc0 PK321
    s_cmp_eq_u64 vcc, -1
    s_cbranch_scc0 PK321
    v_mfma_f32_32x32x16_bf16 v[24:39], v[216:219], v[100:103], v[24:39]
    v_mfma_f32_32x32x16_bf16 v[40:55], v[220:223], v[100:103], v[40:55]
    s_bitset0_b32 s66, 7
PK321:
    s_cmp_eq_u32 s66, 0
    s_cbranch_scc1 T_D
    s_sub_u32 s3, s3, 16
    s_cmp_lt_i32 s3, 0
    s_cbranch_scc1 T_D
    s_sleep 3
    s_branch PL3
A_FALL:
    s_mov_b32 s52, s57
    s_mov_b32 s54, 0
    v_mov_b32 v16, 0xff800000
    v_mov_b32 v17, 0xff800000
A_MAXL:
    buffer_load_dwordx4 v[120:123], v2, s[28:31], s52 offen sc1
    s_waitcnt vmcnt(0)
    v_mfma_f32_32x32x16_bf16 v[56:71], v[120:123], v[8:11], 0
    v_mfma_f32_32x32x16_bf16 v[72:87], v[120:123], v[12:15], 0
    s_add_u32 s52, s52, 1024
    s_nop 7
    s_nop 1
    v_max3_f32 v16, v56, v57, v16
    v_max3_f32 v16, v58, v59, v16
    v_max3_f32 v16, v60, v61, v16
    v_max3_f32 v16, v62, v63, v16
    v_max3_f32 v16, v64, v65, v16
    v_max3_f32 v16, v66, v67, v16
    v_max3_f32 v16, v68, v69, v16
    v_max3_f32 v16, v70, v71, v16
    v_max3_f32 v17, v72, v73, v17
    v_max3_f32 v17, v74, v75, v17
    v_max3_f32 v17, v76, v77, v17
    v_max3_f32 v17, v78, v79, v17
    v_max3_f32 v17, v80, v81, v17
    v_max3_f32 v17, v82, v83, v17
    v_max3_f32 v17, v84, v85, v17
    v_max3_f32 v17, v86, v87, v17
    s_add_u32 s54, s54, 1
    s_cmp_lt_u32 s54, 32
    s_cbranch_scc1 A_MAXL
    v_mov_b32 v6, v16
    s_nop 1
    v_permlane32_swap_b32 v16, v6
    v_max_f32 v16, v16, v6
    v_mul_f32 v24, -1.0, v16
    v_mul_f32 v25, -1.0, v16
    v_mul_f32 v26, -1.0, v16
    v_mul_f32 v27, -1.0, v16
    v_mul_f32 v28, -1.0, v16
    v_mul_f32 v29, -1.0, v16
    v_mul_f32 v30, -1.0, v16
    v_mul_f32 v31, -1.0, v16
    v_mul_f32 v32, -1.0, v16
    v_mul_f32 v33, -1.0, v16
    v_mul_f32 v34, -1.0, v16
    v_mul_f32 v35, -1.0, v16
    v_mul_f32 v36, -1.0, v16
    v_mul_f32 v37, -1.0, v16
    v_mul_f32 v38, -1.0, v16
    v_mul_f32 v39, -1.0, v16
    v_mov_b32 v6, v17
    s_nop 1
    v_permlane32_swap_b32 v17, v6
    v_max_f32 v17, v17, v6
    v_mul_f32 v40, -1.0, v17
    v_mul_f32 v41, -1.0, v17
    v_mul_f32 v42, -1.0, v17
    v_mul_f32 v43, -1.0, v17
    v_mul_f32 v44, -1.0, v17
    v_mul_f32 v45, -1.0, v17
    v_mul_f32 v46, -1.0, v17
    v_mul_f32 v47, -1.0, v17
    v_mul_f32 v48, -1.0, v17
    v_mul_f32 v49, -1.0, v17
    v_mul_f32 v50, -1.0, v17
    v_mul_f32 v51, -1.0, v17
    v_mul_f32 v52, -1.0, v17
    v_mul_f32 v53, -1.0, v17
    v_mul_f32 v54, -1.0, v17
    v_mul_f32 v55, -1.0, v17
    v_mov_b32 v88, 0
    v_mov_b32 v89, 0
    v_mov_b32 v90, 0
    v_mov_b32 v91, 0
    v_mov_b32 v92, 0
    v_mov_b32 v93, 0
    v_mov_b32 v94, 0
    v_mov_b32 v95, 0
    v_mov_b32 v96, 0
    v_mov_b32 v97, 0
    v_mov_b32 v98, 0
    v_mov_b32 v99, 0
    v_mov_b32 v100, 0
    v_mov_b32 v101, 0
    v_mov_b32 v102, 0
    v_mov_b32 v103, 0
    v_mov_b32 v104, 0
    v_mov_b32 v105, 0
    v_mov_b32 v106, 0
    v_mov_b32 v107, 0
    v_mov_b32 v108, 0
    v_mov_b32 v109, 0
    v_mov_b32 v110, 0
    v_mov_b32 v111, 0
    v_mov_b32 v112, 0
    v_mov_b32 v113, 0
    v_mov_b32 v114, 0
    v_mov_b32 v115, 0
    v_mov_b32 v116, 0
    v_mov_b32 v117, 0
    v_mov_b32 v118, 0
    v_mov_b32 v119, 0
    s_mov_b32 s52, s57
    s_add_u32 s53, s57, 0x200000
    s_mov_b32 s54, 0
A_FBL:
    buffer_load_dwordx4 v[120:123], v2, s[28:31], s52 offen sc1
    s_mov_b64 exec, s[96:97]
    buffer_load_dwordx4 v[128:131], v21, s[28:31], s53 offen sc1
    buffer_load_dwordx4 v[132:135], v21, s[28:31], s53 offen offset:512 sc1
    s_mov_b64 exec, -1
    s_waitcnt vmcnt(0)
    v_mfma_f32_32x32x16_bf16 v[56:71], v[120:123], v[8:11], v[24:39]
    v_mfma_f32_32x32x16_bf16 v[72:87], v[120:123], v[12:15], v[40:55]
    s_add_u32 s52, s52, 1024
    s_add_u32 s53, s53, 1024
    s_nop 7
    s_nop 0
    v_exp_f32 v56, v56
    v_exp_f32 v57, v57
    v_exp_f32 v58, v58
    v_exp_f32 v59, v59
    v_exp_f32 v60, v60
    v_exp_f32 v61, v61
    v_exp_f32 v62, v62
    v_exp_f32 v63, v63
    v_exp_f32 v64, v64
    v_exp_f32 v65, v65
    v_exp_f32 v66, v66
    v_exp_f32 v67, v67
    v_exp_f32 v68, v68
    v_exp_f32 v69, v69
    v_exp_f32 v70, v70
    v_exp_f32 v71, v71
    v_cvt_pk_bf16_f32 v144, v56, v57
    v_cvt_pk_bf16_f32 v145, v58, v59
    v_cvt_pk_bf16_f32 v146, v60, v61
    v_cvt_pk_bf16_f32 v147, v62, v63
    v_cvt_pk_bf16_f32 v148, v64, v65
    v_cvt_pk_bf16_f32 v149, v66, v67
    v_cvt_pk_bf16_f32 v150, v68, v69
    v_cvt_pk_bf16_f32 v151, v70, v71
    v_mfma_f32_32x32x16_bf16 v[88:103], v[128:131], v[144:147], v[88:103]
    s_nop 0
    v_mfma_f32_32x32x16_bf16 v[88:103], v[132:135], v[148:151], v[88:103]
    v_exp_f32 v72, v72
    v_exp_f32 v73, v73
    v_exp_f32 v74, v74
    v_exp_f32 v75, v75
    v_exp_f32 v76, v76
    v_exp_f32 v77, v77
    v_exp_f32 v78, v78
    v_exp_f32 v79, v79
    v_exp_f32 v80, v80
    v_exp_f32 v81, v81
    v_exp_f32 v82, v82
    v_exp_f32 v83, v83
    v_exp_f32 v84, v84
    v_exp_f32 v85, v85
    v_exp_f32 v86, v86
    v_exp_f32 v87, v87
    v_cvt_pk_bf16_f32 v152, v72, v73
    v_cvt_pk_bf16_f32 v153, v74, v75
    v_cvt_pk_bf16_f32 v154, v76, v77
    v_cvt_pk_bf16_f32 v155, v78, v79
    v_cvt_pk_bf16_f32 v156, v80, v81
    v_cvt_pk_bf16_f32 v157, v82, v83
    v_cvt_pk_bf16_f32 v158, v84, v85
    v_cvt_pk_bf16_f32 v159, v86, v87
    v_mfma_f32_32x32x16_bf16 v[104:119], v[128:131], v[152:155], v[104:119]
    s_nop 0
    v_mfma_f32_32x32x16_bf16 v[104:119], v[132:135], v[156:159], v[104:119]
    s_nop 7
    s_nop 7
    s_add_u32 s54, s54, 1
    s_cmp_lt_u32 s54, 32
    s_cbranch_scc1 A_FBL
    v_add_u32 v16, s72, v2
    v_add_u32 v17, s73, v2
    s_branch A_FIN
K_END:
    s_endpgm

.section .rodata,"a"
.p2align 6
.amdhsa_kernel mono_kernel
  .amdhsa_next_free_vgpr 256
  .amdhsa_next_free_sgpr 102
  .amdhsa_accum_offset 256
  .amdhsa_group_segment_fixed_size 0
  .amdhsa_kernarg_size 88
  .amdhsa_user_sgpr_count 2
  .amdhsa_user_sgpr_kernarg_segment_ptr 1
  .amdhsa_system_sgpr_workgroup_id_x 1
.end_amdhsa_kernel
```
